```python
import torch

def _softmax(x, axis=-1):
    return torch.softmax(x, dim=axis)

def _gelu(x):
    return torch.nn.functional.gelu(x, approximate='tanh')

def _silu(x):
    return torch.nn.functional.silu(x)

def _sigmoid(x):
    return torch.sigmoid(x)

def _layernorm(x, axis=-1, eps=1e-05):
    m = x.mean(dim=axis, keepdim=True)
    v = x.var(dim=axis, keepdim=True, unbiased=False)
    return (x - m) / torch.sqrt(v + eps)

def _scatter_add(tgt, idx, src, axis=0):
    return tgt.clone().index_add_(axis, idx, src)

def _segment_sum(src, seg, n):
    out = torch.zeros((n,) + src.shape[1:], dtype=src.dtype)
    return out.index_add_(0, seg, src)

def _pad(x, pw):
    flat = tuple((v for pair in reversed(pw) for v in pair))
    return torch.nn.functional.pad(x, flat)
kernel_name = 'adaLN_cond__compressed_kv_cla__mixer_channel_mlp__prompt'

def setup_inputs():

    _w = lambda a: (lambda t: t.to(torch.bfloat16) if t.is_floating_point() else t)(torch.as_tensor(a))

    def _A_setup():
        B, H, Sq, Sk, D, M = (1, 32, 2048, 2048, 128, 512)
        Dc = 4 * D
        return {'x': _w((lambda *s: torch.randn(*s, dtype=torch.bfloat16) * 0.05)(B, Sq, M)), 'c_kv': _w((lambda *s: torch.randn(*s, dtype=torch.bfloat16) * 0.4)(B, Sk, Dc)), 'w_q': _w((lambda *s: torch.randn(*s, dtype=torch.bfloat16) * 3.2)(M, H, D) * M ** (-0.5)), 'w_uk': _w((lambda *s: torch.randn(*s, dtype=torch.bfloat16) * 3.2)(Dc, H, D) * Dc ** (-0.5)), 'w_uv': _w((lambda *s: torch.randn(*s, dtype=torch.bfloat16) * 0.4)(Dc, H, D) * Dc ** (-0.5)), 'w_o': _w((lambda *s: torch.randn(*s, dtype=torch.bfloat16) * 0.4)(H, D, M) * (H * D) ** (-0.5))}
    _A_in = _A_setup()

    def _B_setup():
        B, S, D, F = (1, 2048, 512, 1376)
        return {'x': _w((lambda *s: torch.randn(*s, dtype=torch.bfloat16) * 0.05)(B, S, D)), 'w1': _w((lambda *s: torch.randn(*s, dtype=torch.bfloat16) * 3.2)(D, F) * D ** (-0.5)), 'b1': _w((lambda *s: torch.randn(*s, dtype=torch.bfloat16) * 0.8)(F)), 'w2': _w((lambda *s: torch.randn(*s, dtype=torch.bfloat16) * 0.05)(F, D) * F ** (-0.5)), 'b2': _w((lambda *s: torch.randn(*s, dtype=torch.bfloat16) * 0.1)(D))}
    _B_in = _B_setup()
    return {'A_x': _A_in['x'], 'A_c_kv': _A_in['c_kv'], 'A_w_q': _A_in['w_q'], 'A_w_uk': _A_in['w_uk'], 'A_w_uv': _A_in['w_uv'], 'A_w_o': _A_in['w_o'], 'B_x': _B_in['x'], 'B_w1': _B_in['w1'], 'B_b1': _B_in['b1'], 'B_w2': _B_in['w2'], 'B_b2': _B_in['b2'], 'c': _w((lambda *s: torch.randn(*s, dtype=torch.bfloat16) * 0.1)(1, 512) * 8.0), 'w_mod': _w((lambda *s: torch.randn(*s, dtype=torch.bfloat16) * 0.1)(512, 6 * 512) * 512 ** (-0.5) * 8.0)}

def reference(A_x, A_c_kv, A_w_q, A_w_uk, A_w_uv, A_w_o, B_x, B_w1, B_b1, B_w2, B_b2, c, w_mod):

    def _A_ref(x, c_kv, w_q, w_uk, w_uv, w_o):
        B, Sq, M = (x.shape[0], x.shape[1], x.shape[2])
        Sk = c_kv.shape[1]
        H, D = (w_q.shape[1], w_q.shape[2])
        q = torch.einsum('bqm,mhd->bhqd', x, w_q)
        k = torch.einsum('bkc,chd->bhkd', c_kv, w_uk)
        v = torch.einsum('bkc,chd->bhkd', c_kv, w_uv)
        scores = torch.einsum('bhqd,bhkd->bhqk', q, k) * D ** (-0.5)
        off = Sk - Sq
        qi = torch.arange(Sq)[:, None]
        kj = torch.arange(Sk)[None, :]
        cmask = kj <= qi + off
        scores = torch.where(cmask[None, None], scores, -1000000000.0)
        p = _softmax(scores, axis=-1)
        ctx = torch.einsum('bhqk,bhkd->bhqd', p, v)
        return torch.einsum('bhqd,hdm->bqm', ctx, w_o)

    def _B_ref(x, w1, b1, w2, b2):
        y = _layernorm(x, axis=-1)
        h = _gelu(torch.einsum('bsd,df->bsf', y, w1) + b1)
        return torch.einsum('bsf,fd->bsd', h, w2) + b2
    x = A_x
    mod = (_silu(c) @ w_mod).reshape(c.shape[0], 6, 1, -1)
    sa, ca, ga, sb, cb, gb = (mod[:, 0].clone(), mod[:, 1].clone(), mod[:, 2].clone(), mod[:, 3].clone(), mod[:, 4].clone(), mod[:, 5].clone())
    h = _layernorm(x, axis=-1) * (1 + ca) + sa
    x = x + ga * _A_ref(h, A_c_kv, A_w_q, A_w_uk, A_w_uv, A_w_o)
    h = _layernorm(x, axis=-1) * (1 + cb) + sb
    x = x + gb * _B_ref(h, B_w1, B_b1, B_w2, B_b2)
    return x
```

```asm
; @launch grid=(256,1,1) block=(256,1,1) lds=163840
.amdgcn_target "amdgcn-amd-amdhsa--gfx950"
.text
.p2align 8
.globl adaLN_cond__compressed_kv_cla__mixer_channel_mlp__prompt_kernel
.type adaLN_cond__compressed_kv_cla__mixer_channel_mlp__prompt_kernel,@function
adaLN_cond__compressed_kv_cla__mixer_channel_mlp__prompt_kernel:
    s_cmp_ge_u32 s2, 256
    s_cbranch_scc1 main_done1
    v_lshrrev_b32 v18, 6, v0
    v_and_b32 v1, 63, v0
    v_readfirstlane_b32 s3, v18
    s_load_dwordx4 s[4:7], s[0:1], 0
    s_load_dwordx4 s[8:11], s[0:1], 16
    s_load_dwordx2 s[26:27], s[0:1], 32
    s_load_dwordx4 s[20:23], s[0:1], 88
    s_load_dwordx4 s[96:99], s[0:1], 112
    s_and_b32 s14, s2, 7
    s_lshr_b32 s15, s2, 3
    s_lshr_b32 s16, s15, 3
    s_lshl_b32 s14, s14, 2
    s_add_u32 s14, s14, s16
    s_and_b32 s15, s15, 7
    s_add_u32 s34, s15, s16
    s_and_b32 s34, s34, 1
    s_mul_i32 s34, s34, 4
    s_lshl_b32 s52, s3, 17
    s_lshl_b32 s53, s14, 8
    s_add_u32 s52, s52, s53
    v_lshrrev_b32 v19, 4, v1
    v_and_b32 v18, 15, v1
    v_lshlrev_b32 v4, 1, v19
    v_xor_b32 v18, v18, v4
    v_mul_u32_u24 v4, 8192, v19
    v_add_u32 v4, s52, v4
    v_xor_b32 v19, 8, v18
    v_lshl_add_u32 v6, v19, 4, v4
    v_lshl_add_u32 v4, v18, 4, v4
    v_add_u32 v5, 31744, v4
    v_add_u32 v7, 95232, v6
    v_add_u32 v6, 63488, v6
    v_and_b32 v18, 7, v1
    v_bfe_u32 v19, v1, 4, 1
    v_xor_b32 v18, v18, v19
    v_lshrrev_b32 v20, 3, v1
    v_lshlrev_b32 v20, 10, v20
    v_lshl_add_u32 v20, v18, 4, v20
    v_xor_b32 v21, 32, v20
    v_add_u32 v21, 7168, v21
    v_xor_b32 v22, 64, v20
    v_add_u32 v22, 14336, v22
    v_xor_b32 v23, 96, v20
    v_add_u32 v23, 21504, v23
    s_lshl_b32 s55, s3, 12
    s_lshl_b32 s53, s15, 18
    s_lshl_b32 s52, s34, 7
    s_add_u32 s53, s53, s52
    s_lshl_b32 s54, s3, 15
    s_add_u32 s54, s54, s53
    s_and_b32 s52, s3, 1
    s_lshl_b32 s52, s52, 15
    s_add_u32 s53, s53, s52
    s_lshr_b32 s52, s3, 1
    s_lshl_b32 s52, s52, 7
    s_xor_b32 s53, s53, s52
    s_lshl_b32 s52, s34, 19
    s_lshr_b32 s59, s2, 3
    s_lshl_b32 s59, s59, 2
    s_add_u32 s59, s59, s3
    s_lshl_b32 s59, s59, 15
    s_and_b32 s60, s14, -4
    s_lshl_b32 s60, s60, 8
    s_add_u32 s59, s59, s60
    v_lshrrev_b32 v18, 4, v1
    v_lshlrev_b32 v24, 13, v18
    v_and_b32 v18, 15, v1
    v_lshl_add_u32 v24, v18, 4, v24
    v_add_u32 v24, s59, v24
    v_lshrrev_b32 v29, 1, v0
    v_and_b32 v30, 1, v0
    v_mul_u32_u24 v28, 6144, v29
    v_lshl_add_u32 v28, v30, 4, v28
    v_lshlrev_b32 v29, 1, v29
    s_and_b32 s35, s2, 7
    s_lshl_b32 s35, s35, 3
    s_add_u32 s35, s35, s15
    s_mul_i32 s61, s16, 786432
    s_lshl_b32 s62, s35, 5
    s_add_u32 s61, s61, s62
    s_lshl_b32 s62, s16, 8
    s_waitcnt lgkmcnt(0)
    s_mov_b64 s[12:13], s[98:99]
    s_mov_b32 s76, s20
    s_mov_b32 s77, s21
    s_mov_b32 s78, 0x400
    s_mov_b32 s79, 0x20000
    s_mov_b32 s80, s22
    s_mov_b32 s81, s23
    s_mov_b32 s82, 0x300000
    s_mov_b32 s83, 0x20000
    buffer_load_dwordx4 v[72:75], v28, s[80:83], s61 offen
    buffer_load_ushort v64, v29, s[76:79], s62 offen
    s_mov_b32 s21, s35
    s_mov_b32 s88, s96
    s_mov_b32 s89, s97
    s_mov_b32 s90, 0x100
    s_mov_b32 s91, 0x20000
    s_mov_b32 s64, s6
    s_mov_b32 s65, s7
    s_mov_b32 s66, 0x200000
    s_mov_b32 s67, 0x20000
    s_mov_b32 s68, s10
    s_mov_b32 s69, s11
    s_mov_b32 s70, 0x400000
    s_mov_b32 s71, 0x20000
    s_mov_b32 s72, s26
    s_mov_b32 s73, s27
    s_mov_b32 s74, 0x400000
    s_mov_b32 s75, 0x20000
    s_add_u32 m0, s55, 49152
    s_xor_b32 s60, s52, 0
    buffer_load_dwordx4 v4, s[68:71], s60 offen offset:0  lds
    buffer_load_dwordx4 v5, s[68:71], s60 offen offset:1024  lds
    buffer_load_dwordx4 v6, s[68:71], s60 offen offset:2048  lds
    buffer_load_dwordx4 v7, s[68:71], s60 offen offset:3072  lds
    s_add_u32 m0, s55, 65536
    s_xor_b32 s60, s54, 0
    buffer_load_dwordx4 v20, s[64:67], s60 offen offset:0 lds
    buffer_load_dwordx4 v21, s[64:67], s60 offen offset:1024 lds
    buffer_load_dwordx4 v22, s[64:67], s60 offen offset:2048 lds
    buffer_load_dwordx4 v23, s[64:67], s60 offen offset:3072 lds
    s_add_u32 m0, s55, 98304
    s_xor_b32 s60, s52, 0
    buffer_load_dwordx4 v4, s[72:75], s60 offen offset:0  lds
    buffer_load_dwordx4 v5, s[72:75], s60 offen offset:1024  lds
    buffer_load_dwordx4 v6, s[72:75], s60 offen offset:2048  lds
    buffer_load_dwordx4 v7, s[72:75], s60 offen offset:3072  lds
    s_add_u32 s26, s15, s16
    s_and_b32 s26, s26, 3
    s_mul_i32 s26, s26, 2
    s_lshl_b32 s27, s26, 19
    s_mov_b32 s84, s12
    s_mov_b32 s85, s13
    s_mov_b32 s86, 0x20000
    s_mov_b32 s87, 0x20000
    s_add_u32 s44, s12, 0x1000000
    s_addc_u32 s45, s13, 0
    s_mov_b32 s46, 0x1000000
    s_mov_b32 s47, 0x20000
    s_add_u32 s48, s12, 0x2000000
    s_addc_u32 s49, s13, 0
    s_mov_b32 s50, 0x1000000
    s_mov_b32 s51, 0x20000
    s_add_u32 s40, s12, 0x100000
    s_addc_u32 s41, s13, 0
    s_mov_b32 s42, 0x200000
    s_mov_b32 s43, 0x20000
    s_mov_b32 s28, s8
    s_mov_b32 s29, s9
    s_mov_b32 s30, 0x400000
    s_mov_b32 s31, 0x20000
    s_mov_b32 s92, s4
    s_mov_b32 s93, s5
    s_mov_b32 s94, 0x200000
    s_mov_b32 s95, 0x20000
    v_lshlrev_b32 v2, 4, v1
    s_lshl_b32 s62, s2, 7
    s_add_u32 s62, s62, 65536
    s_cmp_eq_u32 s3, 0
    s_cselect_b32 s62, s62, 0x40000000
    v_mov_b32 v18, 0
    buffer_store_dword v18, off, s[84:87], s62 sc1
    s_and_b32 s20, s2, 3
    s_lshl_b32 s20, s20, 6
    v_and_b32 v26, 3, v1
    v_lshlrev_b32 v26, 6, v26
    v_bfe_u32 v18, v1, 2, 2
    v_and_b32 v19, 3, v1
    v_lshl_add_u32 v16, v18, 3, v19
    v_lshlrev_b32 v16, 7, v16
    v_bfe_u32 v19, v1, 1, 1
    v_lshl_add_u32 v18, v18, 1, v19
    v_lshrrev_b32 v19, 4, v1
    v_xor_b32 v18, v18, v19
    v_lshl_add_u32 v16, v18, 4, v16
    v_xor_b32 v17, 64, v16
    v_bfe_u32 v18, v1, 2, 2
    v_lshrrev_b32 v19, 4, v1
    v_lshl_add_u32 v12, v19, 3, v18
    v_lshlrev_b32 v12, 8, v12
    v_and_b32 v19, 1, v19
    v_lshl_add_u32 v18, v19, 2, v18
    v_lshl_add_u32 v12, v18, 5, v12
    v_and_b32 v18, 3, v1
    v_lshl_add_u32 v12, v18, 3, v12
    s_lshl_b32 s59, s3, 6
    v_xor_b32 v8, s59, v12
    v_xor_b32 v9, 32, v8
    v_mov_b32 v10, v8
    v_mov_b32 v11, v9
    s_lshl_b32 s56, s14, 19
    s_lshl_b32 s57, s15, 16
    s_add_u32 s56, s56, s57
    s_lshl_b32 s57, s3, 11
    s_add_u32 s57, s57, s56
    s_lshl_b32 s59, s3, 10
    s_add_u32 s56, s56, s59
    s_sub_u32 s59, 15, s15
    s_lshl_b32 s18, s59, 3
    s_add_u32 s18, s18, s3
    s_lshl_b32 s17, s15, 3
    s_add_u32 s17, s17, s3
    s_lshl_b32 s19, s15, 1
    s_add_u32 s19, s19, 2
    s_lshl_b32 s58, s14, 19
    s_add_u32 s58, s58, s55
    s_getpc_b64 s[22:23]
main_pc3:
    s_lshr_b32 s59, s2, 3
    s_lshl_b32 s59, s59, 2
    s_add_u32 s59, s59, s3
    s_lshl_b32 s59, s59, 7
    v_and_b32 v18, 3, v1
    v_lshlrev_b32 v18, 14, v18
    v_add_u32 v18, s59, v18
    v_min_u32 v18, main_tail2-main_pc3, v18
    v_mov_b32 v19, s23
    v_add_co_u32 v18, vcc, s22, v18
    s_nop 1
    v_addc_co_u32 v19, vcc, 0, v19, vcc
    global_load_dword v3, v[18:19], off
    s_add_u32 m0, s55, 114688
    s_xor_b32 s60, s54, 131072
    buffer_load_dwordx4 v20, s[64:67], s60 offen offset:0 lds
    buffer_load_dwordx4 v21, s[64:67], s60 offen offset:1024 lds
    buffer_load_dwordx4 v22, s[64:67], s60 offen offset:2048 lds
    buffer_load_dwordx4 v23, s[64:67], s60 offen offset:3072 lds
    buffer_load_dword v3, v24, s[68:71], 0 offen offset:256
    buffer_load_dword v3, v24, s[72:75], 0 offen offset:256
    s_waitcnt vmcnt(20)
    v_lshlrev_b32 v64, 16, v64
    v_mul_f32 v68, 0xbfb8aa3b, v64
    v_exp_f32 v68, v68
    s_nop 0
    v_add_f32 v68, 1.0, v68
    v_rcp_f32 v68, v68
    s_nop 0
    v_mul_f32 v64, v64, v68
    v_cvt_pk_bf16_f32 v64, v64, v64
    v_lshlrev_b32 v64, 16, v64
    v_lshlrev_b32 v28, 16, v72
    v_and_b32 v29, 0xffff0000, v72
    v_mul_f32 v88, v28, v64
    v_mul_f32 v89, v29, v64
    v_lshlrev_b32 v28, 16, v73
    v_and_b32 v29, 0xffff0000, v73
    v_mul_f32 v90, v28, v64
    v_mul_f32 v91, v29, v64
    v_lshlrev_b32 v28, 16, v74
    v_and_b32 v29, 0xffff0000, v74
    v_mul_f32 v92, v28, v64
    v_mul_f32 v93, v29, v64
    v_lshlrev_b32 v28, 16, v75
    v_and_b32 v29, 0xffff0000, v75
    v_mul_f32 v94, v28, v64
    v_mul_f32 v95, v29, v64
    v_add_f32_dpp v88, v88, v88 quad_perm:[2,3,0,1] row_mask:0xf bank_mask:0xf
    v_add_f32_dpp v89, v89, v89 quad_perm:[2,3,0,1] row_mask:0xf bank_mask:0xf
    v_add_f32_dpp v90, v90, v90 quad_perm:[2,3,0,1] row_mask:0xf bank_mask:0xf
    v_add_f32_dpp v91, v91, v91 quad_perm:[2,3,0,1] row_mask:0xf bank_mask:0xf
    v_add_f32_dpp v92, v92, v92 quad_perm:[2,3,0,1] row_mask:0xf bank_mask:0xf
    v_add_f32_dpp v93, v93, v93 quad_perm:[2,3,0,1] row_mask:0xf bank_mask:0xf
    v_add_f32_dpp v94, v94, v94 quad_perm:[2,3,0,1] row_mask:0xf bank_mask:0xf
    v_add_f32_dpp v95, v95, v95 quad_perm:[2,3,0,1] row_mask:0xf bank_mask:0xf
    v_add_f32_dpp v88, v88, v88 row_ror:4 row_mask:0xf bank_mask:0xf
    v_add_f32_dpp v89, v89, v89 row_ror:4 row_mask:0xf bank_mask:0xf
    v_add_f32_dpp v90, v90, v90 row_ror:4 row_mask:0xf bank_mask:0xf
    v_add_f32_dpp v91, v91, v91 row_ror:4 row_mask:0xf bank_mask:0xf
    v_add_f32_dpp v92, v92, v92 row_ror:4 row_mask:0xf bank_mask:0xf
    v_add_f32_dpp v93, v93, v93 row_ror:4 row_mask:0xf bank_mask:0xf
    v_add_f32_dpp v94, v94, v94 row_ror:4 row_mask:0xf bank_mask:0xf
    v_add_f32_dpp v95, v95, v95 row_ror:4 row_mask:0xf bank_mask:0xf
    v_add_f32_dpp v88, v88, v88 row_ror:8 row_mask:0xf bank_mask:0xf
    v_add_f32_dpp v89, v89, v89 row_ror:8 row_mask:0xf bank_mask:0xf
    v_add_f32_dpp v90, v90, v90 row_ror:8 row_mask:0xf bank_mask:0xf
    v_add_f32_dpp v91, v91, v91 row_ror:8 row_mask:0xf bank_mask:0xf
    v_add_f32_dpp v92, v92, v92 row_ror:8 row_mask:0xf bank_mask:0xf
    v_add_f32_dpp v93, v93, v93 row_ror:8 row_mask:0xf bank_mask:0xf
    v_add_f32_dpp v94, v94, v94 row_ror:8 row_mask:0xf bank_mask:0xf
    v_add_f32_dpp v95, v95, v95 row_ror:8 row_mask:0xf bank_mask:0xf
    v_lshrrev_b32 v28, 4, v0
    v_lshlrev_b32 v28, 6, v28
    v_and_b32 v29, 1, v0
    v_lshl_add_u32 v28, v29, 5, v28
    v_add_u32 v28, 0x8000, v28
    ds_write_b128 v28, v[88:91]
    ds_write_b128 v28, v[92:95] offset:16
    s_waitcnt lgkmcnt(0)
    s_barrier
    v_and_b32 v28, 15, v0
    v_lshlrev_b32 v28, 2, v28
    v_add_u32 v29, 0x8000, v28
    ds_read_b32 v72, v29 offset:0
    ds_read_b32 v73, v29 offset:64
    ds_read_b32 v74, v29 offset:128
    ds_read_b32 v75, v29 offset:192
    ds_read_b32 v76, v29 offset:256
    ds_read_b32 v77, v29 offset:320
    ds_read_b32 v78, v29 offset:384
    ds_read_b32 v79, v29 offset:448
    ds_read_b32 v80, v29 offset:512
    ds_read_b32 v81, v29 offset:576
    ds_read_b32 v82, v29 offset:640
    ds_read_b32 v83, v29 offset:704
    ds_read_b32 v84, v29 offset:768
    ds_read_b32 v85, v29 offset:832
    ds_read_b32 v86, v29 offset:896
    ds_read_b32 v87, v29 offset:960
    s_lshl_b32 s22, s21, 6
    s_lshl_b32 s23, s16, 12
    s_add_u32 s22, s22, s23
    s_add_u32 s22, s22, 16384
    s_cmp_eq_u32 s3, 0
    s_cselect_b32 s22, s22, 0x40000000
    s_waitcnt lgkmcnt(7)
    v_add_f32 v72, v72, v80
    s_waitcnt lgkmcnt(6)
    v_add_f32 v73, v73, v81
    s_waitcnt lgkmcnt(5)
    v_add_f32 v74, v74, v82
    s_waitcnt lgkmcnt(4)
    v_add_f32 v75, v75, v83
    s_waitcnt lgkmcnt(3)
    v_add_f32 v76, v76, v84
    s_waitcnt lgkmcnt(2)
    v_add_f32 v77, v77, v85
    s_waitcnt lgkmcnt(1)
    v_add_f32 v78, v78, v86
    s_waitcnt lgkmcnt(0)
    v_add_f32 v79, v79, v87
    v_add_f32 v72, v72, v76
    v_add_f32 v73, v73, v77
    v_add_f32 v74, v74, v78
    v_add_f32 v75, v75, v79
    v_add_f32 v72, v72, v74
    v_add_f32 v73, v73, v75
    v_add_f32 v72, v72, v73
    buffer_store_dword v72, v28, s[84:87], s22 offen sc1
    s_waitcnt vmcnt(9)
    s_barrier
    ds_read_b64_tr_b16 a[0:1], v8 offset:49152
    ds_read_b64_tr_b16 a[2:3], v8 offset:50176
    ds_read_b64_tr_b16 a[4:5], v9 offset:49152
    ds_read_b64_tr_b16 a[6:7], v9 offset:50176
    v_add_u32 v10, 0x10000, v10
    v_add_u32 v11, 0x10000, v11
    ds_read_b64_tr_b16 a[8:9], v10 offset:32768
    ds_read_b64_tr_b16 a[10:11], v10 offset:33792
    ds_read_b64_tr_b16 a[12:13], v11 offset:32768
    ds_read_b64_tr_b16 a[14:15], v11 offset:33792
    ds_read_b64_tr_b16 a[16:17], v8 offset:57344
    ds_read_b64_tr_b16 a[18:19], v8 offset:58368
    ds_read_b64_tr_b16 a[20:21], v9 offset:57344
    ds_read_b64_tr_b16 a[22:23], v9 offset:58368
    ds_read_b64_tr_b16 a[24:25], v10 offset:40960
    ds_read_b64_tr_b16 a[26:27], v10 offset:41984
    ds_read_b64_tr_b16 a[28:29], v11 offset:40960
    ds_read_b64_tr_b16 a[30:31], v11 offset:41984
    v_add_u32 v16, 0x10000, v16
    v_add_u32 v17, 0x10000, v17
    ds_read_b128 v[32:35], v16 offset:0
    ds_read_b128 v[36:39], v16 offset:512
    ds_read_b128 v[40:43], v16 offset:4096
    ds_read_b128 v[44:47], v16 offset:4608
    ds_read_b128 v[48:51], v16 offset:8192
    s_waitcnt lgkmcnt(4)
    v_mfma_f32_16x16x32_bf16 v[128:131], a[0:3], v[32:35], 0
    s_add_u32 m0, s55, 131072
    ds_read_b128 v[52:55], v16 offset:8704
    v_mfma_f32_16x16x32_bf16 v[132:135], a[4:7], v[32:35], 0
    s_xor_b32 s60, s52, 524288
    buffer_load_dwordx4 v4, s[68:71], s60 offen offset:0  lds
    v_mfma_f32_16x16x32_bf16 v[144:147], v[32:35], a[8:11], 0
    s_and_b32 s24, s2, 3
    s_lshl_b32 s24, s24, 3
    v_and_b32 v28, 7, v1
    v_mfma_f32_16x16x32_bf16 v[152:155], v[32:35], a[12:15], 0
    s_waitcnt lgkmcnt(4)
    v_add_u32 v28, s24, v28
    v_and_b32 v64, 4, v28
    v_mfma_f32_16x16x32_bf16 v[136:139], a[0:3], v[36:39], 0
    ds_read_b128 v[56:59], v16 offset:12288
    v_lshlrev_b32 v64, 1, v64
    v_mfma_f32_16x16x32_bf16 v[140:143], a[4:7], v[36:39], 0
    buffer_load_dwordx4 v5, s[68:71], s60 offen offset:1024  lds
    v_mfma_f32_16x16x32_bf16 v[148:151], v[36:39], a[8:11], 0
    v_and_b32 v29, 8, v28
    v_lshrrev_b32 v29, 1, v29
    v_mfma_f32_16x16x32_bf16 v[156:159], v[36:39], a[12:15], 0
    s_waitcnt lgkmcnt(4)
    v_or_b32 v64, v64, v29
    v_and_b32 v29, 0xfffffff3, v28
    v_mfma_f32_16x16x32_bf16 v[160:163], a[0:3], v[40:43], 0
    ds_read_b128 v[60:63], v16 offset:12800
    v_or_b32 v29, v29, v64
    v_mfma_f32_16x16x32_bf16 v[164:167], a[4:7], v[40:43], 0
    buffer_load_dwordx4 v6, s[68:71], s60 offen offset:2048  lds
    v_mfma_f32_16x16x32_bf16 v[176:179], v[40:43], a[8:11], 0
    v_lshlrev_b32 v29, 10, v29
    v_lshrrev_b32 v64, 3, v1
    v_mfma_f32_16x16x32_bf16 v[184:187], v[40:43], a[12:15], 0
    s_lshr_b32 s24, s2, 2
    s_waitcnt lgkmcnt(3)
    v_lshl_add_u32 v29, v64, 4, v29
    v_mfma_f32_16x16x32_bf16 v[168:171], a[0:3], v[44:47], 0
    s_lshl_b32 s24, s24, 15
    ds_read_b128 v[32:35], v17 offset:0
    v_mfma_f32_16x16x32_bf16 v[172:175], a[4:7], v[44:47], 0
    s_lshl_b32 s25, s3, 8
    buffer_load_dwordx4 v7, s[68:71], s60 offen offset:3072  lds
    v_mfma_f32_16x16x32_bf16 v[180:183], v[44:47], a[8:11], 0
    s_add_u32 m0, s55, 147456
    s_xor_b32 s60, s54, 128
    s_add_u32 s25, s25, s24
    v_mfma_f32_16x16x32_bf16 v[188:191], v[44:47], a[12:15], 0
    v_mfma_f32_16x16x32_bf16 v[192:195], a[0:3], v[48:51], 0
    ds_read_b128 v[36:39], v17 offset:512
    v_mfma_f32_16x16x32_bf16 v[196:199], a[4:7], v[48:51], 0
    buffer_load_dwordx4 v[68:71], v29, s[92:95], s25 offen
    v_mfma_f32_16x16x32_bf16 v[208:211], v[48:51], a[8:11], 0
    v_mfma_f32_16x16x32_bf16 v[216:219], v[48:51], a[12:15], 0
    s_waitcnt lgkmcnt(3)
    v_mfma_f32_16x16x32_bf16 v[200:203], a[0:3], v[52:55], 0
    ds_read_b128 v[40:43], v17 offset:4096
    v_mfma_f32_16x16x32_bf16 v[204:207], a[4:7], v[52:55], 0
    buffer_load_dwordx4 v[72:75], v29, s[92:95], s25 offen offset:128
    v_mfma_f32_16x16x32_bf16 v[212:215], v[52:55], a[8:11], 0
    v_and_b32 v29, 15, v28
    v_lshrrev_b32 v28, 4, v28
    v_mfma_f32_16x16x32_bf16 v[220:223], v[52:55], a[12:15], 0
    v_lshlrev_b32 v28, 14, v28
    v_lshl_add_u32 v28, v29, 4, v28
    v_mfma_f32_16x16x32_bf16 v[224:227], a[0:3], v[56:59], 0
    ds_read_b128 v[44:47], v17 offset:4608
    v_lshl_add_u32 v28, v64, 8, v28
    v_mfma_f32_16x16x32_bf16 v[228:231], a[4:7], v[56:59], 0
    s_add_u32 s24, s24, s55
    buffer_load_dwordx4 v20, s[64:67], s60 offen offset:0 lds
    v_mfma_f32_16x16x32_bf16 v[240:243], v[56:59], a[8:11], 0
    v_mfma_f32_16x16x32_bf16 v[248:251], v[56:59], a[12:15], 0
    s_waitcnt lgkmcnt(3)
    v_mfma_f32_16x16x32_bf16 v[232:235], a[0:3], v[60:63], 0
    ds_read_b128 v[48:51], v17 offset:8192
    v_mfma_f32_16x16x32_bf16 v[236:239], a[4:7], v[60:63], 0
    buffer_load_dwordx4 v21, s[64:67], s60 offen offset:1024 lds
    v_mfma_f32_16x16x32_bf16 v[244:247], v[60:63], a[8:11], 0
    v_mfma_f32_16x16x32_bf16 v[252:255], v[60:63], a[12:15], 0
    v_mfma_f32_16x16x32_bf16 v[128:131], a[16:19], v[32:35], v[128:131]
    ds_read_b128 v[52:55], v17 offset:8704
    v_mfma_f32_16x16x32_bf16 v[132:135], a[20:23], v[32:35], v[132:135]
    buffer_load_dwordx4 v22, s[64:67], s60 offen offset:2048 lds
    v_mfma_f32_16x16x32_bf16 v[144:147], v[32:35], a[24:27], v[144:147]
    v_mfma_f32_16x16x32_bf16 v[152:155], v[32:35], a[28:31], v[152:155]
    s_waitcnt lgkmcnt(3)
    v_mfma_f32_16x16x32_bf16 v[136:139], a[16:19], v[36:39], v[136:139]
    ds_read_b128 v[56:59], v17 offset:12288
    v_mfma_f32_16x16x32_bf16 v[140:143], a[20:23], v[36:39], v[140:143]
    buffer_load_dwordx4 v23, s[64:67], s60 offen offset:3072 lds
    v_mfma_f32_16x16x32_bf16 v[148:151], v[36:39], a[24:27], v[148:151]
    s_add_u32 m0, s55, 16384
    s_xor_b32 s60, s52, 524288
    v_mfma_f32_16x16x32_bf16 v[156:159], v[36:39], a[28:31], v[156:159]
    v_mfma_f32_16x16x32_bf16 v[160:163], a[16:19], v[40:43], v[160:163]
    ds_read_b128 v[60:63], v17 offset:12800
    v_mfma_f32_16x16x32_bf16 v[164:167], a[20:23], v[40:43], v[164:167]
    buffer_load_dwordx4 v4, s[72:75], s60 offen offset:0  lds
    v_mfma_f32_16x16x32_bf16 v[176:179], v[40:43], a[24:27], v[176:179]
    v_mfma_f32_16x16x32_bf16 v[184:187], v[40:43], a[28:31], v[184:187]
    s_waitcnt vmcnt(14)
    s_barrier
    s_waitcnt lgkmcnt(3)
    v_mfma_f32_16x16x32_bf16 v[168:171], a[16:19], v[44:47], v[168:171]
    s_waitcnt vmcnt(11)
    ds_read_b128 v[32:35], v16 offset:49152
    v_mov_b32 v27, 1
    v_mfma_f32_16x16x32_bf16 v[172:175], a[20:23], v[44:47], v[172:175]
    buffer_load_dwordx4 v5, s[72:75], s60 offen offset:1024  lds
    v_mfma_f32_16x16x32_bf16 v[180:183], v[44:47], a[24:27], v[180:183]
    s_cmp_lg_u32 s3, 0
    s_cbranch_scc1 main_skip4
    s_mov_b64 exec, 1
    buffer_atomic_add v27, off, s[88:91], s20 sc1
    s_mov_b64 exec, -1
main_skip4:
    s_nop 0
    v_mfma_f32_16x16x32_bf16 v[188:191], v[44:47], a[28:31], v[188:191]
    v_mfma_f32_16x16x32_bf16 v[192:195], a[16:19], v[48:51], v[192:195]
    ds_read_b128 v[36:39], v16 offset:49664
    v_mfma_f32_16x16x32_bf16 v[196:199], a[20:23], v[48:51], v[196:199]
    buffer_load_dwordx4 v6, s[72:75], s60 offen offset:2048  lds
    v_mfma_f32_16x16x32_bf16 v[208:211], v[48:51], a[24:27], v[208:211]
    v_mfma_f32_16x16x32_bf16 v[216:219], v[48:51], a[28:31], v[216:219]
    s_waitcnt lgkmcnt(2)
    v_mfma_f32_16x16x32_bf16 v[200:203], a[16:19], v[52:55], v[200:203]
    ds_read_b128 v[40:43], v16 offset:53248
    v_mfma_f32_16x16x32_bf16 v[204:207], a[20:23], v[52:55], v[204:207]
    buffer_load_dwordx4 v7, s[72:75], s60 offen offset:3072  lds
    v_mfma_f32_16x16x32_bf16 v[212:215], v[52:55], a[24:27], v[212:215]
    s_add_u32 m0, s55, 0
    s_xor_b32 s60, s54, 131200
    v_mfma_f32_16x16x32_bf16 v[220:223], v[52:55], a[28:31], v[220:223]
    v_mfma_f32_16x16x32_bf16 v[224:227], a[16:19], v[56:59], v[224:227]
    ds_read_b128 v[44:47], v16 offset:53760
    v_mfma_f32_16x16x32_bf16 v[228:231], a[20:23], v[56:59], v[228:231]
    buffer_load_dwordx4 v20, s[64:67], s60 offen offset:0 lds
    v_mfma_f32_16x16x32_bf16 v[240:243], v[56:59], a[24:27], v[240:243]
    v_mfma_f32_16x16x32_bf16 v[248:251], v[56:59], a[28:31], v[248:251]
    v_mfma_f32_16x16x32_bf16 v[232:235], a[16:19], v[60:63], v[232:235]
    ds_read_b128 v[48:51], v16 offset:57344
    v_mfma_f32_16x16x32_bf16 v[236:239], a[20:23], v[60:63], v[236:239]
    buffer_load_dwordx4 v21, s[64:67], s60 offen offset:1024 lds
    v_mfma_f32_16x16x32_bf16 v[244:247], v[60:63], a[24:27], v[244:247]
    v_mfma_f32_16x16x32_bf16 v[252:255], v[60:63], a[28:31], v[252:255]
    s_waitcnt lgkmcnt(3)
    v_mfma_f32_16x16x32_bf16 a[128:131], a[0:3], v[32:35], 0
    ds_read_b128 v[52:55], v16 offset:57856
    v_mfma_f32_16x16x32_bf16 a[132:135], a[4:7], v[32:35], 0
    buffer_load_dwordx4 v22, s[64:67], s60 offen offset:2048 lds
    v_mfma_f32_16x16x32_bf16 a[144:147], v[32:35], a[8:11], 0
    v_mfma_f32_16x16x32_bf16 a[152:155], v[32:35], a[12:15], 0
    v_mfma_f32_16x16x32_bf16 a[136:139], a[0:3], v[36:39], 0
    ds_read_b128 v[56:59], v16 offset:61440
    v_mfma_f32_16x16x32_bf16 a[140:143], a[4:7], v[36:39], 0
    buffer_load_dwordx4 v23, s[64:67], s60 offen offset:3072 lds
    v_mfma_f32_16x16x32_bf16 a[148:151], v[36:39], a[8:11], 0
    s_add_u32 m0, s55, 81920
    s_xor_b32 s60, s52, 1048576
    v_mfma_f32_16x16x32_bf16 a[156:159], v[36:39], a[12:15], 0
    s_waitcnt lgkmcnt(3)
    v_mfma_f32_16x16x32_bf16 a[160:163], a[0:3], v[40:43], 0
    ds_read_b128 v[60:63], v16 offset:61952
    v_mfma_f32_16x16x32_bf16 a[164:167], a[4:7], v[40:43], 0
    buffer_load_dwordx4 v4, s[68:71], s60 offen offset:0  lds
    v_mfma_f32_16x16x32_bf16 a[176:179], v[40:43], a[8:11], 0
    v_mfma_f32_16x16x32_bf16 a[184:187], v[40:43], a[12:15], 0
    v_mfma_f32_16x16x32_bf16 a[168:171], a[0:3], v[44:47], 0
    ds_read_b128 v[32:35], v17 offset:49152
    v_mfma_f32_16x16x32_bf16 a[172:175], a[4:7], v[44:47], 0
    buffer_load_dwordx4 v5, s[68:71], s60 offen offset:1024  lds
    v_mfma_f32_16x16x32_bf16 a[180:183], v[44:47], a[8:11], 0
    v_mfma_f32_16x16x32_bf16 a[188:191], v[44:47], a[12:15], 0
    s_waitcnt lgkmcnt(3)
    v_mfma_f32_16x16x32_bf16 a[192:195], a[0:3], v[48:51], 0
    ds_read_b128 v[36:39], v17 offset:49664
    v_mfma_f32_16x16x32_bf16 a[196:199], a[4:7], v[48:51], 0
    buffer_load_dwordx4 v6, s[68:71], s60 offen offset:2048  lds
    v_mfma_f32_16x16x32_bf16 a[208:211], v[48:51], a[8:11], 0
    v_mfma_f32_16x16x32_bf16 a[216:219], v[48:51], a[12:15], 0
    v_mfma_f32_16x16x32_bf16 a[200:203], a[0:3], v[52:55], 0
    ds_read_b128 v[40:43], v17 offset:53248
    v_mfma_f32_16x16x32_bf16 a[204:207], a[4:7], v[52:55], 0
    buffer_load_dwordx4 v7, s[68:71], s60 offen offset:3072  lds
    v_mfma_f32_16x16x32_bf16 a[212:215], v[52:55], a[8:11], 0
    s_add_u32 m0, s55, 32768
    s_xor_b32 s60, s54, 256
    v_mfma_f32_16x16x32_bf16 a[220:223], v[52:55], a[12:15], 0
    s_waitcnt lgkmcnt(3)
    v_mfma_f32_16x16x32_bf16 a[224:227], a[0:3], v[56:59], 0
    ds_read_b128 v[44:47], v17 offset:53760
    v_mfma_f32_16x16x32_bf16 a[228:231], a[4:7], v[56:59], 0
    buffer_load_dwordx4 v20, s[64:67], s60 offen offset:0 lds
    v_mfma_f32_16x16x32_bf16 a[240:243], v[56:59], a[8:11], 0
    v_mfma_f32_16x16x32_bf16 a[248:251], v[56:59], a[12:15], 0
    v_mfma_f32_16x16x32_bf16 a[232:235], a[0:3], v[60:63], 0
    ds_read_b128 v[48:51], v17 offset:57344
    v_mfma_f32_16x16x32_bf16 a[236:239], a[4:7], v[60:63], 0
    buffer_load_dwordx4 v21, s[64:67], s60 offen offset:1024 lds
    v_mfma_f32_16x16x32_bf16 a[244:247], v[60:63], a[8:11], 0
    v_mfma_f32_16x16x32_bf16 a[252:255], v[60:63], a[12:15], 0
    s_waitcnt lgkmcnt(3)
    v_mfma_f32_16x16x32_bf16 a[128:131], a[16:19], v[32:35], a[128:131]
    ds_read_b128 v[52:55], v17 offset:57856
    v_mfma_f32_16x16x32_bf16 a[132:135], a[20:23], v[32:35], a[132:135]
    buffer_load_dwordx4 v22, s[64:67], s60 offen offset:2048 lds
    v_mfma_f32_16x16x32_bf16 a[144:147], v[32:35], a[24:27], a[144:147]
    v_mfma_f32_16x16x32_bf16 a[152:155], v[32:35], a[28:31], a[152:155]
    v_mfma_f32_16x16x32_bf16 a[136:139], a[16:19], v[36:39], a[136:139]
    ds_read_b128 v[56:59], v17 offset:61440
    v_mfma_f32_16x16x32_bf16 a[140:143], a[20:23], v[36:39], a[140:143]
    buffer_load_dwordx4 v23, s[64:67], s60 offen offset:3072 lds
    v_mfma_f32_16x16x32_bf16 a[148:151], v[36:39], a[24:27], a[148:151]
    s_add_u32 m0, s55, 49152
    s_xor_b32 s60, s52, 1048576
    v_mfma_f32_16x16x32_bf16 a[156:159], v[36:39], a[28:31], a[156:159]
    s_waitcnt lgkmcnt(3)
    v_mfma_f32_16x16x32_bf16 a[160:163], a[16:19], v[40:43], a[160:163]
    ds_read_b128 v[60:63], v17 offset:61952
    v_mfma_f32_16x16x32_bf16 a[164:167], a[20:23], v[40:43], a[164:167]
    buffer_load_dwordx4 v4, s[72:75], s60 offen offset:0  lds
    v_mfma_f32_16x16x32_bf16 a[176:179], v[40:43], a[24:27], a[176:179]
    v_mfma_f32_16x16x32_bf16 a[184:187], v[40:43], a[28:31], a[184:187]
    s_waitcnt vmcnt(13)
    s_barrier
    v_mfma_f32_16x16x32_bf16 a[168:171], a[16:19], v[44:47], a[168:171]
    v_add_u32 v16, 0x10000, v16
    ds_read_b128 v[32:35], v16 offset:16384
    v_add_u32 v17, 0x10000, v17
    v_add_u32 v8, 0x20000, v8
    v_mfma_f32_16x16x32_bf16 a[172:175], a[20:23], v[44:47], a[172:175]
    buffer_load_dwordx4 v5, s[72:75], s60 offen offset:1024  lds
    v_mfma_f32_16x16x32_bf16 a[180:183], v[44:47], a[24:27], a[180:183]
    ds_read_b64_tr_b16 a[32:33], v8 offset:0
    v_add_u32 v9, 0x20000, v9
    v_mfma_f32_16x16x32_bf16 a[188:191], v[44:47], a[28:31], a[188:191]
    s_waitcnt lgkmcnt(4)
    ds_read_b64_tr_b16 a[34:35], v8 offset:1024
    ds_read_b64_tr_b16 a[36:37], v9 offset:0
    v_mfma_f32_16x16x32_bf16 a[192:195], a[16:19], v[48:51], a[192:195]
    s_nop 0
    ds_read_b128 v[36:39], v16 offset:16896
    ds_read_b64_tr_b16 a[38:39], v9 offset:1024
    v_mfma_f32_16x16x32_bf16 a[196:199], a[20:23], v[48:51], a[196:199]
    buffer_load_dwordx4 v6, s[72:75], s60 offen offset:2048  lds
    v_mfma_f32_16x16x32_bf16 a[208:211], v[48:51], a[24:27], a[208:211]
    v_add_u32 v10, 0xffff0000, v10
    v_add_u32 v11, 0xffff0000, v11
    v_mfma_f32_16x16x32_bf16 a[216:219], v[48:51], a[28:31], a[216:219]
    s_nop 0
    ds_read_b64_tr_b16 a[40:41], v10 offset:16384
    ds_read_b64_tr_b16 a[42:43], v10 offset:17408
    v_mfma_f32_16x16x32_bf16 a[200:203], a[16:19], v[52:55], a[200:203]
    s_nop 0
    ds_read_b128 v[40:43], v16 offset:20480
    ds_read_b64_tr_b16 a[44:45], v11 offset:16384
    v_mfma_f32_16x16x32_bf16 a[204:207], a[20:23], v[52:55], a[204:207]
    buffer_load_dwordx4 v7, s[72:75], s60 offen offset:3072  lds
    v_mfma_f32_16x16x32_bf16 a[212:215], v[52:55], a[24:27], a[212:215]
    s_add_u32 m0, s55, 98304
    s_xor_b32 s60, s52, 2097152
    ds_read_b64_tr_b16 a[46:47], v11 offset:17408
    v_mfma_f32_16x16x32_bf16 a[220:223], v[52:55], a[28:31], a[220:223]
    s_waitcnt lgkmcnt(11)
    ds_read_b64_tr_b16 a[48:49], v8 offset:8192
    ds_read_b64_tr_b16 a[50:51], v8 offset:9216
    v_mfma_f32_16x16x32_bf16 a[224:227], a[16:19], v[56:59], a[224:227]
    s_nop 0
    ds_read_b128 v[44:47], v16 offset:20992
    ds_read_b64_tr_b16 a[52:53], v9 offset:8192
    v_mfma_f32_16x16x32_bf16 a[228:231], a[20:23], v[56:59], a[228:231]
    buffer_load_dwordx4 v4, s[68:71], s60 offen offset:0  lds
    v_mfma_f32_16x16x32_bf16 a[240:243], v[56:59], a[24:27], a[240:243]
    s_nop 0
    ds_read_b64_tr_b16 a[54:55], v9 offset:9216
    ds_read_b64_tr_b16 a[56:57], v10 offset:24576
    v_mfma_f32_16x16x32_bf16 a[248:251], v[56:59], a[28:31], a[248:251]
    s_nop 0
    ds_read_b64_tr_b16 a[58:59], v10 offset:25600
    ds_read_b64_tr_b16 a[60:61], v11 offset:24576
    v_mfma_f32_16x16x32_bf16 a[232:235], a[16:19], v[60:63], a[232:235]
    s_nop 0
    ds_read_b128 v[48:51], v16 offset:24576
    ds_read_b64_tr_b16 a[62:63], v11 offset:25600
    v_mfma_f32_16x16x32_bf16 a[236:239], a[20:23], v[60:63], a[236:239]
    buffer_load_dwordx4 v5, s[68:71], s60 offen offset:1024  lds
    v_mfma_f32_16x16x32_bf16 a[244:247], v[60:63], a[24:27], a[244:247]
    v_mfma_f32_16x16x32_bf16 a[252:255], v[60:63], a[28:31], a[252:255]
    s_waitcnt lgkmcnt(13)
    v_mfma_f32_16x16x32_bf16 v[128:131], a[32:35], v[32:35], v[128:131]
    ds_read_b128 v[52:55], v16 offset:25088
    v_and_b32 v109, 0xffff0000, v68
    v_mfma_f32_16x16x32_bf16 v[132:135], a[36:39], v[32:35], v[132:135]
    buffer_load_dwordx4 v6, s[68:71], s60 offen offset:2048  lds
    v_mfma_f32_16x16x32_bf16 v[144:147], v[32:35], a[40:43], v[144:147]
    s_waitcnt lgkmcnt(11)
    v_lshlrev_b32 v108, 16, v68
    v_and_b32 v111, 0xffff0000, v69
    v_mfma_f32_16x16x32_bf16 v[152:155], v[32:35], a[44:47], v[152:155]
    v_lshlrev_b32 v110, 16, v69
    v_and_b32 v113, 0xffff0000, v70
    v_mfma_f32_16x16x32_bf16 v[136:139], a[32:35], v[36:39], v[136:139]
    ds_read_b128 v[56:59], v16 offset:28672
    v_lshlrev_b32 v112, 16, v70
    v_mfma_f32_16x16x32_bf16 v[140:143], a[36:39], v[36:39], v[140:143]
    buffer_load_dwordx4 v7, s[68:71], s60 offen offset:3072  lds
    v_mfma_f32_16x16x32_bf16 v[148:151], v[36:39], a[40:43], v[148:151]
    s_add_u32 m0, s55, 65536
    s_xor_b32 s60, s54, 131328
    v_and_b32 v115, 0xffff0000, v71
    v_mfma_f32_16x16x32_bf16 v[156:159], v[36:39], a[44:47], v[156:159]
    v_lshlrev_b32 v114, 16, v71
    v_and_b32 v117, 0xffff0000, v72
    v_mfma_f32_16x16x32_bf16 v[160:163], a[32:35], v[40:43], v[160:163]
    ds_read_b128 v[60:63], v16 offset:29184
    v_lshlrev_b32 v116, 16, v72
    v_mfma_f32_16x16x32_bf16 v[164:167], a[36:39], v[40:43], v[164:167]
    buffer_load_dwordx4 v20, s[64:67], s60 offen offset:0 lds
    v_mfma_f32_16x16x32_bf16 v[176:179], v[40:43], a[40:43], v[176:179]
    v_and_b32 v119, 0xffff0000, v73
    v_lshlrev_b32 v118, 16, v73
    v_mfma_f32_16x16x32_bf16 v[184:187], v[40:43], a[44:47], v[184:187]
    s_waitcnt lgkmcnt(3)
    v_and_b32 v121, 0xffff0000, v74
    v_lshlrev_b32 v120, 16, v74
    v_mfma_f32_16x16x32_bf16 v[168:171], a[32:35], v[44:47], v[168:171]
    ds_read_b128 v[32:35], v17 offset:16384
    v_and_b32 v123, 0xffff0000, v75
    v_mfma_f32_16x16x32_bf16 v[172:175], a[36:39], v[44:47], v[172:175]
    buffer_load_dwordx4 v21, s[64:67], s60 offen offset:1024 lds
    v_mfma_f32_16x16x32_bf16 v[180:183], v[44:47], a[40:43], v[180:183]
    v_lshlrev_b32 v122, 16, v75
    v_add_f32 v64, v108, v109
    v_mfma_f32_16x16x32_bf16 v[188:191], v[44:47], a[44:47], v[188:191]
    v_mul_f32 v65, v108, v108
    v_fmac_f32 v65, v109, v109
    v_mfma_f32_16x16x32_bf16 v[192:195], a[32:35], v[48:51], v[192:195]
    ds_read_b128 v[36:39], v17 offset:16896
    v_add_f32 v64, v64, v110
    v_mfma_f32_16x16x32_bf16 v[196:199], a[36:39], v[48:51], v[196:199]
    buffer_load_dwordx4 v22, s[64:67], s60 offen offset:2048 lds
    v_mfma_f32_16x16x32_bf16 v[208:211], v[48:51], a[40:43], v[208:211]
    v_fmac_f32 v65, v110, v110
    v_add_f32 v64, v64, v111
    v_mfma_f32_16x16x32_bf16 v[216:219], v[48:51], a[44:47], v[216:219]
    s_waitcnt lgkmcnt(3)
    v_fmac_f32 v65, v111, v111
    v_add_f32 v64, v64, v112
    v_mfma_f32_16x16x32_bf16 v[200:203], a[32:35], v[52:55], v[200:203]
    ds_read_b128 v[40:43], v17 offset:20480
    v_fmac_f32 v65, v112, v112
    v_mfma_f32_16x16x32_bf16 v[204:207], a[36:39], v[52:55], v[204:207]
    buffer_load_dwordx4 v23, s[64:67], s60 offen offset:3072 lds
    v_mfma_f32_16x16x32_bf16 v[212:215], v[52:55], a[40:43], v[212:215]
    v_add_f32 v64, v64, v113
    v_fmac_f32 v65, v113, v113
    v_mfma_f32_16x16x32_bf16 v[220:223], v[52:55], a[44:47], v[220:223]
    v_add_f32 v64, v64, v114
    v_fmac_f32 v65, v114, v114
    v_mfma_f32_16x16x32_bf16 v[224:227], a[32:35], v[56:59], v[224:227]
    ds_read_b128 v[44:47], v17 offset:20992
    v_add_f32 v64, v64, v115
    v_mfma_f32_16x16x32_bf16 v[228:231], a[36:39], v[56:59], v[228:231]
    v_fmac_f32 v65, v115, v115
    v_add_f32 v64, v64, v116
    v_mfma_f32_16x16x32_bf16 v[240:243], v[56:59], a[40:43], v[240:243]
    v_fmac_f32 v65, v116, v116
    v_add_f32 v64, v64, v117
    v_mfma_f32_16x16x32_bf16 v[248:251], v[56:59], a[44:47], v[248:251]
    s_waitcnt lgkmcnt(3)
    v_fmac_f32 v65, v117, v117
    v_add_f32 v64, v64, v118
    v_mfma_f32_16x16x32_bf16 v[232:235], a[32:35], v[60:63], v[232:235]
    ds_read_b128 v[48:51], v17 offset:24576
    v_fmac_f32 v65, v118, v118
    v_mfma_f32_16x16x32_bf16 v[236:239], a[36:39], v[60:63], v[236:239]
    v_add_f32 v64, v64, v119
    v_fmac_f32 v65, v119, v119
    v_mfma_f32_16x16x32_bf16 v[244:247], v[60:63], a[40:43], v[244:247]
    v_add_f32 v64, v64, v120
    v_fmac_f32 v65, v120, v120
    v_mfma_f32_16x16x32_bf16 v[252:255], v[60:63], a[44:47], v[252:255]
    v_add_f32 v64, v64, v121
    v_fmac_f32 v65, v121, v121
    v_mfma_f32_16x16x32_bf16 v[128:131], a[48:51], v[32:35], v[128:131]
    ds_read_b128 v[52:55], v17 offset:25088
    v_add_f32 v64, v64, v122
    v_mfma_f32_16x16x32_bf16 v[132:135], a[52:55], v[32:35], v[132:135]
    v_fmac_f32 v65, v122, v122
    v_add_f32 v64, v64, v123
    v_mfma_f32_16x16x32_bf16 v[144:147], v[32:35], a[56:59], v[144:147]
    v_fmac_f32 v65, v123, v123
    s_nop 0
    v_mfma_f32_16x16x32_bf16 v[152:155], v[32:35], a[60:63], v[152:155]
    s_waitcnt lgkmcnt(3)
    v_add_f32_dpp v64, v64, v64 row_ror:8 row_mask:0xf bank_mask:0xf
    v_add_f32_dpp v65, v65, v65 row_ror:8 row_mask:0xf bank_mask:0xf
    v_mfma_f32_16x16x32_bf16 v[136:139], a[48:51], v[36:39], v[136:139]
    ds_read_b128 v[56:59], v17 offset:28672
    v_mov_b32 v66, v64
    v_mfma_f32_16x16x32_bf16 v[140:143], a[52:55], v[36:39], v[140:143]
    v_mov_b32 v67, v65
    s_nop 0
    v_mfma_f32_16x16x32_bf16 v[148:151], v[36:39], a[56:59], v[148:151]
    v_permlane16_swap_b32 v64, v66
    v_permlane16_swap_b32 v65, v67
    v_mfma_f32_16x16x32_bf16 v[156:159], v[36:39], a[60:63], v[156:159]
    v_add_f32 v64, v64, v66
    v_add_f32 v65, v65, v67
    v_mfma_f32_16x16x32_bf16 v[160:163], a[48:51], v[40:43], v[160:163]
    ds_read_b128 v[60:63], v17 offset:29184
    v_mov_b32 v66, v64
    v_mfma_f32_16x16x32_bf16 v[164:167], a[52:55], v[40:43], v[164:167]
    v_mov_b32 v67, v65
    s_nop 0
    v_mfma_f32_16x16x32_bf16 v[176:179], v[40:43], a[56:59], v[176:179]
    v_permlane32_swap_b32 v64, v66
    v_permlane32_swap_b32 v65, v67
    v_mfma_f32_16x16x32_bf16 v[184:187], v[40:43], a[60:63], v[184:187]
    s_waitcnt vmcnt(20)
    v_add_f32 v64, v64, v66
    v_add_f32 v65, v65, v67
    s_barrier
    s_waitcnt lgkmcnt(3)
    v_mfma_f32_16x16x32_bf16 v[168:171], a[48:51], v[44:47], v[168:171]
    s_add_u32 m0, s55, 131072
    v_add_u32 v16, 0xfffe0000, v16
    ds_read_b128 v[32:35], v16 offset:0
    v_add_u32 v17, 0xfffe0000, v17
    v_mfma_f32_16x16x32_bf16 v[172:175], a[52:55], v[44:47], v[172:175]
    s_xor_b32 s60, s52, 2097152
    buffer_load_dwordx4 v4, s[72:75], s60 offen offset:0  lds
    v_mfma_f32_16x16x32_bf16 v[180:183], v[44:47], a[56:59], v[180:183]
    v_mfma_f32_16x16x32_bf16 v[188:191], v[44:47], a[60:63], v[188:191]
    v_mfma_f32_16x16x32_bf16 v[192:195], a[48:51], v[48:51], v[192:195]
    ds_read_b128 v[36:39], v16 offset:512
    v_mfma_f32_16x16x32_bf16 v[196:199], a[52:55], v[48:51], v[196:199]
    buffer_load_dwordx4 v5, s[72:75], s60 offen offset:1024  lds
    v_mfma_f32_16x16x32_bf16 v[208:211], v[48:51], a[56:59], v[208:211]
    v_mfma_f32_16x16x32_bf16 v[216:219], v[48:51], a[60:63], v[216:219]
    s_waitcnt lgkmcnt(2)
    v_mfma_f32_16x16x32_bf16 v[200:203], a[48:51], v[52:55], v[200:203]
    ds_read_b128 v[40:43], v16 offset:4096
    v_mfma_f32_16x16x32_bf16 v[204:207], a[52:55], v[52:55], v[204:207]
    buffer_load_dwordx4 v6, s[72:75], s60 offen offset:2048  lds
    v_mfma_f32_16x16x32_bf16 v[212:215], v[52:55], a[56:59], v[212:215]
    v_mfma_f32_16x16x32_bf16 v[220:223], v[52:55], a[60:63], v[220:223]
    v_mfma_f32_16x16x32_bf16 v[224:227], a[48:51], v[56:59], v[224:227]
    ds_read_b128 v[44:47], v16 offset:4608
    v_mfma_f32_16x16x32_bf16 v[228:231], a[52:55], v[56:59], v[228:231]
    buffer_load_dwordx4 v7, s[72:75], s60 offen offset:3072  lds
    v_mfma_f32_16x16x32_bf16 v[240:243], v[56:59], a[56:59], v[240:243]
    s_add_u32 m0, s55, 16384
    s_xor_b32 s60, s52, 1572864
    v_mfma_f32_16x16x32_bf16 v[248:251], v[56:59], a[60:63], v[248:251]
    v_mfma_f32_16x16x32_bf16 v[232:235], a[48:51], v[60:63], v[232:235]
    ds_read_b128 v[48:51], v16 offset:8192
    v_mfma_f32_16x16x32_bf16 v[236:239], a[52:55], v[60:63], v[236:239]
    buffer_load_dwordx4 v4, s[68:71], s60 offen offset:0  lds
    v_mfma_f32_16x16x32_bf16 v[244:247], v[60:63], a[56:59], v[244:247]
    v_mfma_f32_16x16x32_bf16 v[252:255], v[60:63], a[60:63], v[252:255]
    s_waitcnt lgkmcnt(3)
    v_mfma_f32_16x16x32_bf16 a[128:131], a[32:35], v[32:35], a[128:131]
    ds_read_b128 v[52:55], v16 offset:8704
    v_mfma_f32_16x16x32_bf16 a[132:135], a[36:39], v[32:35], a[132:135]
    buffer_load_dword v30, v26, s[88:91], 0 offen sc1
    v_mfma_f32_16x16x32_bf16 a[144:147], v[32:35], a[40:43], a[144:147]
    v_mfma_f32_16x16x32_bf16 a[152:155], v[32:35], a[44:47], a[152:155]
    v_mfma_f32_16x16x32_bf16 a[136:139], a[32:35], v[36:39], a[136:139]
    ds_read_b128 v[56:59], v16 offset:12288
    v_mfma_f32_16x16x32_bf16 a[140:143], a[36:39], v[36:39], a[140:143]
    buffer_load_dwordx4 v5, s[68:71], s60 offen offset:1024  lds
    v_mfma_f32_16x16x32_bf16 a[148:151], v[36:39], a[40:43], a[148:151]
    v_mfma_f32_16x16x32_bf16 a[156:159], v[36:39], a[44:47], a[156:159]
    s_waitcnt lgkmcnt(3)
    v_mfma_f32_16x16x32_bf16 a[160:163], a[32:35], v[40:43], a[160:163]
    ds_read_b128 v[60:63], v16 offset:12800
    v_mfma_f32_16x16x32_bf16 a[164:167], a[36:39], v[40:43], a[164:167]
    buffer_load_dwordx4 v6, s[68:71], s60 offen offset:2048  lds
    v_mfma_f32_16x16x32_bf16 a[176:179], v[40:43], a[40:43], a[176:179]
    v_mfma_f32_16x16x32_bf16 a[184:187], v[40:43], a[44:47], a[184:187]
    v_mfma_f32_16x16x32_bf16 a[168:171], a[32:35], v[44:47], a[168:171]
    ds_read_b128 v[32:35], v17 offset:0
    v_mfma_f32_16x16x32_bf16 a[172:175], a[36:39], v[44:47], a[172:175]
    buffer_load_dwordx4 v7, s[68:71], s60 offen offset:3072  lds
    v_mfma_f32_16x16x32_bf16 a[180:183], v[44:47], a[40:43], a[180:183]
    s_add_u32 m0, s55, 114688
    s_xor_b32 s60, s54, 384
    v_mfma_f32_16x16x32_bf16 a[188:191], v[44:47], a[44:47], a[188:191]
    s_waitcnt lgkmcnt(3)
    v_mfma_f32_16x16x32_bf16 a[192:195], a[32:35], v[48:51], a[192:195]
    ds_read_b128 v[36:39], v17 offset:512
    v_mfma_f32_16x16x32_bf16 a[196:199], a[36:39], v[48:51], a[196:199]
    buffer_load_dwordx4 v20, s[64:67], s60 offen offset:0 lds
    v_mfma_f32_16x16x32_bf16 a[208:211], v[48:51], a[40:43], a[208:211]
    v_mfma_f32_16x16x32_bf16 a[216:219], v[48:51], a[44:47], a[216:219]
    v_mfma_f32_16x16x32_bf16 a[200:203], a[32:35], v[52:55], a[200:203]
    ds_read_b128 v[40:43], v17 offset:4096
    v_mfma_f32_16x16x32_bf16 a[204:207], a[36:39], v[52:55], a[204:207]
    buffer_load_dwordx4 v21, s[64:67], s60 offen offset:1024 lds
    v_mfma_f32_16x16x32_bf16 a[212:215], v[52:55], a[40:43], a[212:215]
    v_mfma_f32_16x16x32_bf16 a[220:223], v[52:55], a[44:47], a[220:223]
    s_waitcnt lgkmcnt(3)
    v_mfma_f32_16x16x32_bf16 a[224:227], a[32:35], v[56:59], a[224:227]
    ds_read_b128 v[44:47], v17 offset:4608
    v_mfma_f32_16x16x32_bf16 a[228:231], a[36:39], v[56:59], a[228:231]
    buffer_load_dwordx4 v22, s[64:67], s60 offen offset:2048 lds
    v_mfma_f32_16x16x32_bf16 a[240:243], v[56:59], a[40:43], a[240:243]
    v_mfma_f32_16x16x32_bf16 a[248:251], v[56:59], a[44:47], a[248:251]
    v_mfma_f32_16x16x32_bf16 a[232:235], a[32:35], v[60:63], a[232:235]
    ds_read_b128 v[48:51], v17 offset:8192
    v_mfma_f32_16x16x32_bf16 a[236:239], a[36:39], v[60:63], a[236:239]
    buffer_load_dwordx4 v23, s[64:67], s60 offen offset:3072 lds
    v_mfma_f32_16x16x32_bf16 a[244:247], v[60:63], a[40:43], a[244:247]
    v_mfma_f32_16x16x32_bf16 a[252:255], v[60:63], a[44:47], a[252:255]
    s_waitcnt lgkmcnt(3)
    v_mfma_f32_16x16x32_bf16 a[128:131], a[48:51], v[32:35], a[128:131]
    ds_read_b128 v[52:55], v17 offset:8704
    v_mfma_f32_16x16x32_bf16 a[132:135], a[52:55], v[32:35], a[132:135]
    v_mfma_f32_16x16x32_bf16 a[144:147], v[32:35], a[56:59], a[144:147]
    v_mfma_f32_16x16x32_bf16 a[152:155], v[32:35], a[60:63], a[152:155]
    v_mfma_f32_16x16x32_bf16 a[136:139], a[48:51], v[36:39], a[136:139]
    ds_read_b128 v[56:59], v17 offset:12288
    v_mfma_f32_16x16x32_bf16 a[140:143], a[52:55], v[36:39], a[140:143]
    v_mfma_f32_16x16x32_bf16 a[148:151], v[36:39], a[56:59], a[148:151]
    v_mfma_f32_16x16x32_bf16 a[156:159], v[36:39], a[60:63], a[156:159]
    s_waitcnt lgkmcnt(3)
    v_mfma_f32_16x16x32_bf16 a[160:163], a[48:51], v[40:43], a[160:163]
    ds_read_b128 v[60:63], v17 offset:12800
    v_mfma_f32_16x16x32_bf16 a[164:167], a[52:55], v[40:43], a[164:167]
    v_mfma_f32_16x16x32_bf16 a[176:179], v[40:43], a[56:59], a[176:179]
    v_mfma_f32_16x16x32_bf16 a[184:187], v[40:43], a[60:63], a[184:187]
    s_waitcnt vmcnt(21)
    s_barrier
    v_mfma_f32_16x16x32_bf16 a[168:171], a[48:51], v[44:47], a[168:171]
    ds_read_b128 v[32:35], v16 offset:32768
    v_add_u32 v8, 0xffff0000, v8
    v_mfma_f32_16x16x32_bf16 a[172:175], a[52:55], v[44:47], a[172:175]
    ds_read_b64_tr_b16 a[64:65], v8 offset:16384
    v_add_u32 v9, 0xffff0000, v9
    v_mfma_f32_16x16x32_bf16 a[180:183], v[44:47], a[56:59], a[180:183]
    s_nop 0
    ds_read_b64_tr_b16 a[66:67], v8 offset:17408
    ds_read_b64_tr_b16 a[68:69], v9 offset:16384
    v_mfma_f32_16x16x32_bf16 a[188:191], v[44:47], a[60:63], a[188:191]
    s_waitcnt lgkmcnt(6)
    ds_read_b64_tr_b16 a[70:71], v9 offset:17408
    ds_read_b64_tr_b16 a[72:73], v10 offset:49152
    v_mfma_f32_16x16x32_bf16 a[192:195], a[48:51], v[48:51], a[192:195]
    s_nop 0
    ds_read_b128 v[36:39], v16 offset:33280
    ds_read_b64_tr_b16 a[74:75], v10 offset:50176
    v_mfma_f32_16x16x32_bf16 a[196:199], a[52:55], v[48:51], a[196:199]
    s_nop 0
    ds_read_b64_tr_b16 a[76:77], v11 offset:49152
    ds_read_b64_tr_b16 a[78:79], v11 offset:50176
    v_mfma_f32_16x16x32_bf16 a[208:211], v[48:51], a[56:59], a[208:211]
    s_nop 0
    ds_read_b64_tr_b16 a[80:81], v8 offset:24576
    ds_read_b64_tr_b16 a[82:83], v8 offset:25600
    v_mfma_f32_16x16x32_bf16 a[216:219], v[48:51], a[60:63], a[216:219]
    s_nop 0
    ds_read_b64_tr_b16 a[84:85], v9 offset:24576
    ds_read_b64_tr_b16 a[86:87], v9 offset:25600
    v_mfma_f32_16x16x32_bf16 a[200:203], a[48:51], v[52:55], a[200:203]
    s_nop 0
    ds_read_b128 v[40:43], v16 offset:36864
    ds_read_b64_tr_b16 a[88:89], v10 offset:57344
    v_mfma_f32_16x16x32_bf16 a[204:207], a[52:55], v[52:55], a[204:207]
    s_nop 0
    ds_read_b64_tr_b16 a[90:91], v10 offset:58368
    ds_read_b64_tr_b16 a[92:93], v11 offset:57344
    v_mfma_f32_16x16x32_bf16 a[212:215], v[52:55], a[56:59], a[212:215]
    s_waitcnt vmcnt(7)
    ds_read_b64_tr_b16 a[94:95], v11 offset:58368
    v_cmp_gt_u32 vcc, 64, v30
    v_mfma_f32_16x16x32_bf16 a[220:223], v[52:55], a[60:63], a[220:223]
    s_nop 0
    s_nop 0
    s_nop 0
    s_cbranch_vccnz main_spin5
main_back6:
    s_waitcnt lgkmcnt(15)
    v_mfma_f32_16x16x32_bf16 a[224:227], a[48:51], v[56:59], a[224:227]
    ds_read_b128 v[44:47], v16 offset:37376
    v_lshlrev_b32 v29, 4, v0
    v_mfma_f32_16x16x32_bf16 a[228:231], a[52:55], v[56:59], a[228:231]
    s_movk_i32 s23, 0x4000
    buffer_load_dwordx4 v[76:79], v29, s[84:87], s23 offen sc1
    v_mfma_f32_16x16x32_bf16 a[240:243], v[56:59], a[56:59], a[240:243]
    s_movk_i32 s23, 0x5000
    v_and_b32 v66, 7, v1
    v_lshlrev_b32 v66, 5, v66
    v_mfma_f32_16x16x32_bf16 a[248:251], v[56:59], a[60:63], a[248:251]
    s_lshl_b32 s25, s3, 3
    v_add_u32 v66, 0x25000, v66
    v_mfma_f32_16x16x32_bf16 a[232:235], a[48:51], v[60:63], a[232:235]
    ds_read_b128 v[48:51], v16 offset:40960
    v_add_u32 v67, s25, v66
    v_mfma_f32_16x16x32_bf16 a[236:239], a[52:55], v[60:63], a[236:239]
    buffer_load_dwordx4 v[80:83], v29, s[84:87], s23 offen sc1
    v_mfma_f32_16x16x32_bf16 a[244:247], v[60:63], a[56:59], a[244:247]
    s_movk_i32 s23, 0x6000
    ds_write_b64 v67, v[64:65]
    v_mfma_f32_16x16x32_bf16 a[252:255], v[60:63], a[60:63], a[252:255]
    v_mfma_f32_16x16x32_bf16 v[128:131], a[64:67], v[32:35], v[128:131]
    s_waitcnt lgkmcnt(5)
    ds_read_b128 v[52:55], v16 offset:41472
    v_mfma_f32_16x16x32_bf16 v[132:135], a[68:71], v[32:35], v[132:135]
    buffer_load_dwordx4 v[84:87], v29, s[84:87], s23 offen sc1
    v_mfma_f32_16x16x32_bf16 v[144:147], v[32:35], a[72:75], v[144:147]
    s_movk_i32 s23, 0x7000
    v_mfma_f32_16x16x32_bf16 v[152:155], v[32:35], a[76:79], v[152:155]
    v_mfma_f32_16x16x32_bf16 v[136:139], a[64:67], v[36:39], v[136:139]
    ds_read_b128 v[56:59], v16 offset:45056
    v_mfma_f32_16x16x32_bf16 v[140:143], a[68:71], v[36:39], v[140:143]
    buffer_load_dwordx4 v[88:91], v29, s[84:87], s23 offen sc1
    v_mfma_f32_16x16x32_bf16 v[148:151], v[36:39], a[72:75], v[148:151]
    v_mfma_f32_16x16x32_bf16 v[156:159], v[36:39], a[76:79], v[156:159]
    v_mfma_f32_16x16x32_bf16 v[160:163], a[64:67], v[40:43], v[160:163]
    ds_read_b128 v[60:63], v16 offset:45568
    v_mfma_f32_16x16x32_bf16 v[164:167], a[68:71], v[40:43], v[164:167]
    buffer_load_dword v3, v24, s[28:31], 0 offen offset:256
    v_mfma_f32_16x16x32_bf16 v[176:179], v[40:43], a[72:75], v[176:179]
    v_mfma_f32_16x16x32_bf16 v[184:187], v[40:43], a[76:79], v[184:187]
    s_waitcnt lgkmcnt(3)
    v_mfma_f32_16x16x32_bf16 v[168:171], a[64:67], v[44:47], v[168:171]
    ds_read_b128 v[32:35], v17 offset:32768
    v_mfma_f32_16x16x32_bf16 v[172:175], a[68:71], v[44:47], v[172:175]
    buffer_load_dword v3, v24, s[28:31], 0 offen offset:768
    v_mfma_f32_16x16x32_bf16 v[180:183], v[44:47], a[72:75], v[180:183]
    v_mfma_f32_16x16x32_bf16 v[188:191], v[44:47], a[76:79], v[188:191]
    v_mfma_f32_16x16x32_bf16 v[192:195], a[64:67], v[48:51], v[192:195]
    ds_read_b128 v[36:39], v17 offset:33280
    v_mfma_f32_16x16x32_bf16 v[196:199], a[68:71], v[48:51], v[196:199]
    v_mfma_f32_16x16x32_bf16 v[208:211], v[48:51], a[72:75], v[208:211]
    v_mfma_f32_16x16x32_bf16 v[216:219], v[48:51], a[76:79], v[216:219]
    s_waitcnt lgkmcnt(3)
    v_mfma_f32_16x16x32_bf16 v[200:203], a[64:67], v[52:55], v[200:203]
    ds_read_b128 v[40:43], v17 offset:36864
    v_mfma_f32_16x16x32_bf16 v[204:207], a[68:71], v[52:55], v[204:207]
    v_mfma_f32_16x16x32_bf16 v[212:215], v[52:55], a[72:75], v[212:215]
    v_mfma_f32_16x16x32_bf16 v[220:223], v[52:55], a[76:79], v[220:223]
    v_mfma_f32_16x16x32_bf16 v[224:227], a[64:67], v[56:59], v[224:227]
    s_waitcnt vmcnt(3)
    ds_read_b128 v[44:47], v17 offset:37376
    v_add_f32 v76, v76, v84
    v_mfma_f32_16x16x32_bf16 v[228:231], a[68:71], v[56:59], v[228:231]
    v_add_f32 v77, v77, v85
    v_add_f32 v78, v78, v86
    v_mfma_f32_16x16x32_bf16 v[240:243], v[56:59], a[72:75], v[240:243]
    s_waitcnt vmcnt(2)
    v_add_f32 v79, v79, v87
    v_add_f32 v80, v80, v88
    v_mfma_f32_16x16x32_bf16 v[248:251], v[56:59], a[76:79], v[248:251]
    s_waitcnt lgkmcnt(3)
    v_add_f32 v81, v81, v89
    v_add_f32 v82, v82, v90
    v_mfma_f32_16x16x32_bf16 v[232:235], a[64:67], v[60:63], v[232:235]
    ds_read_b128 v[48:51], v17 offset:40960
    v_add_f32 v83, v83, v91
    v_mfma_f32_16x16x32_bf16 v[236:239], a[68:71], v[60:63], v[236:239]
    v_add_f32 v76, v76, v80
    v_add_f32 v77, v77, v81
    v_mfma_f32_16x16x32_bf16 v[244:247], v[60:63], a[72:75], v[244:247]
    v_add_f32 v78, v78, v82
    v_add_f32 v79, v79, v83
    v_mfma_f32_16x16x32_bf16 v[252:255], v[60:63], a[76:79], v[252:255]
    s_cmp_ge_u32 s3, 2
    s_cselect_b32 s23, 1.0, 0
    v_cvt_pk_bf16_f32 v80, v76, v77
    v_cvt_pk_bf16_f32 v81, v78, v79
    v_mfma_f32_16x16x32_bf16 v[128:131], a[80:83], v[32:35], v[128:131]
    ds_read_b128 v[52:55], v17 offset:41472
    v_lshlrev_b32 v76, 16, v80
    v_mfma_f32_16x16x32_bf16 v[132:135], a[84:87], v[32:35], v[132:135]
    v_and_b32 v77, 0xffff0000, v80
    v_lshlrev_b32 v78, 16, v81
    v_mfma_f32_16x16x32_bf16 v[144:147], v[32:35], a[88:91], v[144:147]
    v_and_b32 v79, 0xffff0000, v81
    v_add_f32 v76, s23, v76
    v_mfma_f32_16x16x32_bf16 v[152:155], v[32:35], a[92:95], v[152:155]
    s_waitcnt lgkmcnt(3)
    v_add_f32 v77, s23, v77
    v_add_f32 v78, s23, v78
    v_mfma_f32_16x16x32_bf16 v[136:139], a[80:83], v[36:39], v[136:139]
    ds_read_b128 v[56:59], v17 offset:45056
    v_add_f32 v79, s23, v79
    v_mfma_f32_16x16x32_bf16 v[140:143], a[84:87], v[36:39], v[140:143]
    v_cvt_pk_bf16_f32 v80, v76, v77
    v_cvt_pk_bf16_f32 v81, v78, v79
    v_mfma_f32_16x16x32_bf16 v[148:151], v[36:39], a[88:91], v[148:151]
    v_lshlrev_b32 v76, 16, v80
    v_and_b32 v77, 0xffff0000, v80
    v_mfma_f32_16x16x32_bf16 v[156:159], v[36:39], a[92:95], v[156:159]
    v_lshlrev_b32 v78, 16, v81
    v_and_b32 v79, 0xffff0000, v81
    v_mfma_f32_16x16x32_bf16 v[160:163], a[80:83], v[40:43], v[160:163]
    ds_read_b128 v[60:63], v17 offset:45568
    v_mul_f32 v76, 0x3e0293ee, v76
    v_mfma_f32_16x16x32_bf16 v[164:167], a[84:87], v[40:43], v[164:167]
    v_mul_f32 v77, 0x3e0293ee, v77
    v_mul_f32 v78, 0x3e0293ee, v78
    v_mfma_f32_16x16x32_bf16 v[176:179], v[40:43], a[88:91], v[176:179]
    v_mul_f32 v79, 0x3e0293ee, v79
    v_add_u32 v29, 0x24000, v29
    v_mfma_f32_16x16x32_bf16 v[184:187], v[40:43], a[92:95], v[184:187]
    ds_write_b128 v29, v[76:79]
    s_waitcnt lgkmcnt(0)
    buffer_load_dword v3, v24, s[28:31], 0 offen offset:0
    s_barrier
    v_mfma_f32_16x16x32_bf16 v[168:171], a[80:83], v[44:47], v[168:171]
    s_add_u32 m0, s55, 81920
    v_add_u32 v16, 0x10000, v16
    ds_read_b128 v[32:35], v16 offset:0
    v_add_u32 v17, 0x10000, v17
    v_mfma_f32_16x16x32_bf16 v[172:175], a[84:87], v[44:47], v[172:175]
    s_xor_b32 s60, s52, 1572864
    buffer_load_dwordx4 v4, s[72:75], s60 offen offset:0  lds
    v_mfma_f32_16x16x32_bf16 v[180:183], v[44:47], a[88:91], v[180:183]
    s_nop 0
    ds_read_b64_tr_b16 a[0:1], v8 offset:32768
    ds_read_b64_tr_b16 a[2:3], v8 offset:33792
    v_mfma_f32_16x16x32_bf16 v[188:191], v[44:47], a[92:95], v[188:191]
    s_nop 0
    ds_read_b64_tr_b16 a[4:5], v9 offset:32768
    ds_read_b64_tr_b16 a[6:7], v9 offset:33792
    v_mfma_f32_16x16x32_bf16 v[192:195], a[80:83], v[48:51], v[192:195]
    ds_read_b128 v[36:39], v16 offset:512
    v_add_u32 v10, 0x20000, v10
    v_mfma_f32_16x16x32_bf16 v[196:199], a[84:87], v[48:51], v[196:199]
    buffer_load_dwordx4 v5, s[72:75], s60 offen offset:1024  lds
    v_mfma_f32_16x16x32_bf16 v[208:211], v[48:51], a[88:91], v[208:211]
    ds_read_b64_tr_b16 a[8:9], v10 offset:0
    v_add_u32 v11, 0x20000, v11
    v_mfma_f32_16x16x32_bf16 v[216:219], v[48:51], a[92:95], v[216:219]
    s_nop 0
    ds_read_b64_tr_b16 a[10:11], v10 offset:1024
    ds_read_b64_tr_b16 a[12:13], v11 offset:0
    v_mfma_f32_16x16x32_bf16 v[200:203], a[80:83], v[52:55], v[200:203]
    s_nop 0
    ds_read_b128 v[40:43], v16 offset:4096
    ds_read_b64_tr_b16 a[14:15], v11 offset:1024
    v_mfma_f32_16x16x32_bf16 v[204:207], a[84:87], v[52:55], v[204:207]
    buffer_load_dwordx4 v6, s[72:75], s60 offen offset:2048  lds
    v_mfma_f32_16x16x32_bf16 v[212:215], v[52:55], a[88:91], v[212:215]
    s_nop 0
    ds_read_b64_tr_b16 a[16:17], v8 offset:40960
    ds_read_b64_tr_b16 a[18:19], v8 offset:41984
    v_mfma_f32_16x16x32_bf16 v[220:223], v[52:55], a[92:95], v[220:223]
    s_nop 0
    ds_read_b64_tr_b16 a[20:21], v9 offset:40960
    ds_read_b64_tr_b16 a[22:23], v9 offset:41984
    v_mfma_f32_16x16x32_bf16 v[224:227], a[80:83], v[56:59], v[224:227]
    s_nop 0
    ds_read_b128 v[44:47], v16 offset:4608
    ds_read_b64_tr_b16 a[24:25], v10 offset:8192
    v_mfma_f32_16x16x32_bf16 v[228:231], a[84:87], v[56:59], v[228:231]
    buffer_load_dwordx4 v7, s[72:75], s60 offen offset:3072  lds
    v_mfma_f32_16x16x32_bf16 v[240:243], v[56:59], a[88:91], v[240:243]
    s_add_u32 m0, s55, 49152
    s_xor_b32 s60, s52, 2621440
    ds_read_b64_tr_b16 a[26:27], v10 offset:9216
    v_mfma_f32_16x16x32_bf16 v[248:251], v[56:59], a[92:95], v[248:251]
    s_nop 0
    ds_read_b64_tr_b16 a[28:29], v11 offset:8192
    ds_read_b64_tr_b16 a[30:31], v11 offset:9216
    v_mfma_f32_16x16x32_bf16 v[232:235], a[80:83], v[60:63], v[232:235]
    s_nop 0
    ds_read_b128 v[48:51], v16 offset:8192
    ds_read_b128 v[68:71], v66
    v_mfma_f32_16x16x32_bf16 v[236:239], a[84:87], v[60:63], v[236:239]
    buffer_load_dword v3, v24, s[28:31], 0 offen offset:512
    v_mfma_f32_16x16x32_bf16 v[244:247], v[60:63], a[88:91], v[244:247]
    s_lshl_b32 s25, s3, 9
    ds_read_b128 v[72:75], v66 offset:16
    v_mfma_f32_16x16x32_bf16 v[252:255], v[60:63], a[92:95], v[252:255]
    s_add_u32 s25, s25, 0x24000
    s_waitcnt lgkmcnt(14)
    v_lshrrev_b32 v29, 3, v1
    v_lshlrev_b32 v29, 5, v29
    v_mfma_f32_16x16x32_bf16 a[128:131], a[64:67], v[32:35], a[128:131]
    ds_read_b128 v[52:55], v16 offset:8704
    v_add_u32 v29, s25, v29
    v_mfma_f32_16x16x32_bf16 a[132:135], a[68:71], v[32:35], a[132:135]
    buffer_load_dwordx4 v4, s[68:71], s60 offen offset:0  lds
    v_mfma_f32_16x16x32_bf16 a[144:147], v[32:35], a[72:75], a[144:147]
    s_nop 0
    ds_read_b128 v[92:95], v29 offset:0
    ds_read_b128 v[76:79], v29 offset:2048
    v_mfma_f32_16x16x32_bf16 a[152:155], v[32:35], a[76:79], a[152:155]
    s_nop 0
    ds_read_b128 v[96:99], v29 offset:16
    ds_read_b128 v[80:83], v29 offset:2064
    v_mfma_f32_16x16x32_bf16 a[136:139], a[64:67], v[36:39], a[136:139]
    s_nop 0
    ds_read_b128 v[56:59], v16 offset:12288
    ds_read_b128 v[100:103], v29 offset:256
    v_mfma_f32_16x16x32_bf16 a[140:143], a[68:71], v[36:39], a[140:143]
    buffer_load_dwordx4 v5, s[68:71], s60 offen offset:1024  lds
    v_mfma_f32_16x16x32_bf16 a[148:151], v[36:39], a[72:75], a[148:151]
    s_nop 0
    ds_read_b128 v[84:87], v29 offset:2304
    ds_read_b128 v[104:107], v29 offset:272
    v_mfma_f32_16x16x32_bf16 a[156:159], v[36:39], a[76:79], a[156:159]
    s_waitcnt lgkmcnt(10)
    ds_read_b128 v[88:91], v29 offset:2320
    v_add_f32 v68, v68, v70
    v_mfma_f32_16x16x32_bf16 a[160:163], a[64:67], v[40:43], a[160:163]
    s_waitcnt lgkmcnt(10)
    ds_read_b128 v[60:63], v16 offset:12800
    v_add_f32 v72, v72, v74
    v_mfma_f32_16x16x32_bf16 a[164:167], a[68:71], v[40:43], a[164:167]
    buffer_load_dwordx4 v6, s[68:71], s60 offen offset:2048  lds
    v_mfma_f32_16x16x32_bf16 a[176:179], v[40:43], a[72:75], a[176:179]
    v_add_f32 v69, v69, v71
    v_add_f32 v73, v73, v75
    v_mfma_f32_16x16x32_bf16 a[184:187], v[40:43], a[76:79], a[184:187]
    v_add_f32 v64, v68, v72
    v_add_f32 v65, v69, v73
    v_mfma_f32_16x16x32_bf16 a[168:171], a[64:67], v[44:47], a[168:171]
    ds_read_b128 v[32:35], v17 offset:0
    v_mul_f32 v64, 0x3b000000, v64
    v_mfma_f32_16x16x32_bf16 a[172:175], a[68:71], v[44:47], a[172:175]
    buffer_load_dwordx4 v7, s[68:71], s60 offen offset:3072  lds
    v_mfma_f32_16x16x32_bf16 a[180:183], v[44:47], a[72:75], a[180:183]
    s_add_u32 m0, s55, 0
    s_xor_b32 s60, s54, 131456
    v_mul_f32 v65, 0x3b000000, v65
    v_mfma_f32_16x16x32_bf16 a[188:191], v[44:47], a[76:79], a[188:191]
    v_fma_f32 v65, -v64, v64, v65
    v_max_f32 v65, 0, v65
    v_mfma_f32_16x16x32_bf16 a[192:195], a[64:67], v[48:51], a[192:195]
    ds_read_b128 v[36:39], v17 offset:512
    v_add_f32 v65, 0x3727c5ac, v65
    v_mfma_f32_16x16x32_bf16 a[196:199], a[68:71], v[48:51], a[196:199]
    buffer_load_dwordx4 v20, s[64:67], s60 offen offset:0 lds
    v_mfma_f32_16x16x32_bf16 a[208:211], v[48:51], a[72:75], a[208:211]
    v_rsq_f32 v65, v65
    v_mfma_f32_16x16x32_bf16 a[216:219], v[48:51], a[76:79], a[216:219]
    s_waitcnt lgkmcnt(3)
    v_sub_f32 v108, v108, v64
    v_sub_f32 v109, v109, v64
    v_mfma_f32_16x16x32_bf16 a[200:203], a[64:67], v[52:55], a[200:203]
    ds_read_b128 v[40:43], v17 offset:4096
    v_sub_f32 v110, v110, v64
    v_mfma_f32_16x16x32_bf16 a[204:207], a[68:71], v[52:55], a[204:207]
    buffer_load_dwordx4 v21, s[64:67], s60 offen offset:1024 lds
    v_mfma_f32_16x16x32_bf16 a[212:215], v[52:55], a[72:75], a[212:215]
    v_sub_f32 v111, v111, v64
    v_sub_f32 v112, v112, v64
    v_mfma_f32_16x16x32_bf16 a[220:223], v[52:55], a[76:79], a[220:223]
    v_sub_f32 v113, v113, v64
    v_sub_f32 v114, v114, v64
    v_mfma_f32_16x16x32_bf16 a[224:227], a[64:67], v[56:59], a[224:227]
    ds_read_b128 v[44:47], v17 offset:4608
    v_sub_f32 v115, v115, v64
    v_mfma_f32_16x16x32_bf16 a[228:231], a[68:71], v[56:59], a[228:231]
    buffer_load_dwordx4 v22, s[64:67], s60 offen offset:2048 lds
    v_mfma_f32_16x16x32_bf16 a[240:243], v[56:59], a[72:75], a[240:243]
    v_sub_f32 v116, v116, v64
    v_sub_f32 v117, v117, v64
    v_mfma_f32_16x16x32_bf16 a[248:251], v[56:59], a[76:79], a[248:251]
    s_waitcnt lgkmcnt(3)
    v_sub_f32 v118, v118, v64
    v_sub_f32 v119, v119, v64
    v_mfma_f32_16x16x32_bf16 a[232:235], a[64:67], v[60:63], a[232:235]
    ds_read_b128 v[48:51], v17 offset:8192
    v_sub_f32 v120, v120, v64
    v_mfma_f32_16x16x32_bf16 a[236:239], a[68:71], v[60:63], a[236:239]
    buffer_load_dwordx4 v23, s[64:67], s60 offen offset:3072 lds
    v_mfma_f32_16x16x32_bf16 a[244:247], v[60:63], a[72:75], a[244:247]
    v_sub_f32 v121, v121, v64
    v_sub_f32 v122, v122, v64
    v_mfma_f32_16x16x32_bf16 a[252:255], v[60:63], a[76:79], a[252:255]
    v_sub_f32 v123, v123, v64
    v_mul_f32 v76, v76, v65
    v_mfma_f32_16x16x32_bf16 a[128:131], a[80:83], v[32:35], a[128:131]
    ds_read_b128 v[52:55], v17 offset:8704
    v_mul_f32 v77, v77, v65
    v_mfma_f32_16x16x32_bf16 a[132:135], a[84:87], v[32:35], a[132:135]
    v_mul_f32 v78, v78, v65
    v_mul_f32 v79, v79, v65
    v_mfma_f32_16x16x32_bf16 a[144:147], v[32:35], a[88:91], a[144:147]
    v_mul_f32 v80, v80, v65
    v_mul_f32 v81, v81, v65
    v_mfma_f32_16x16x32_bf16 a[152:155], v[32:35], a[92:95], a[152:155]
    s_waitcnt lgkmcnt(3)
    v_mul_f32 v82, v82, v65
    v_mul_f32 v83, v83, v65
    v_mfma_f32_16x16x32_bf16 a[136:139], a[80:83], v[36:39], a[136:139]
    ds_read_b128 v[56:59], v17 offset:12288
    v_mul_f32 v84, v84, v65
    v_mfma_f32_16x16x32_bf16 a[140:143], a[84:87], v[36:39], a[140:143]
    v_mul_f32 v85, v85, v65
    v_mul_f32 v86, v86, v65
    v_mfma_f32_16x16x32_bf16 a[148:151], v[36:39], a[88:91], a[148:151]
    v_mul_f32 v87, v87, v65
    v_mul_f32 v88, v88, v65
    v_mfma_f32_16x16x32_bf16 a[156:159], v[36:39], a[92:95], a[156:159]
    v_mul_f32 v89, v89, v65
    v_mul_f32 v90, v90, v65
    v_mfma_f32_16x16x32_bf16 a[160:163], a[80:83], v[40:43], a[160:163]
    ds_read_b128 v[60:63], v17 offset:12800
    v_mul_f32 v91, v91, v65
    v_mfma_f32_16x16x32_bf16 a[164:167], a[84:87], v[40:43], a[164:167]
    v_fma_f32 v108, v108, v76, v92
    v_fma_f32 v109, v109, v77, v93
    v_mfma_f32_16x16x32_bf16 a[176:179], v[40:43], a[88:91], a[176:179]
    v_fma_f32 v110, v110, v78, v94
    v_fma_f32 v111, v111, v79, v95
    v_mfma_f32_16x16x32_bf16 a[184:187], v[40:43], a[92:95], a[184:187]
    v_fma_f32 v112, v112, v80, v96
    v_fma_f32 v113, v113, v81, v97
    v_fma_f32 v114, v114, v82, v98
    v_fma_f32 v115, v115, v83, v99
    v_fma_f32 v116, v116, v84, v100
    v_fma_f32 v117, v117, v85, v101
    v_fma_f32 v118, v118, v86, v102
    v_fma_f32 v119, v119, v87, v103
    v_fma_f32 v120, v120, v88, v104
    v_fma_f32 v121, v121, v89, v105
    v_fma_f32 v122, v122, v90, v106
    v_fma_f32 v123, v123, v91, v107
    v_cvt_pk_bf16_f32 v68, v108, v109
    v_cvt_pk_bf16_f32 v69, v110, v111
    v_cvt_pk_bf16_f32 v70, v112, v113
    v_cvt_pk_bf16_f32 v71, v114, v115
    v_cvt_pk_bf16_f32 v72, v116, v117
    v_cvt_pk_bf16_f32 v73, v118, v119
    v_cvt_pk_bf16_f32 v74, v120, v121
    v_cvt_pk_bf16_f32 v75, v122, v123
    buffer_store_dwordx4 v[68:71], v28, s[40:43], s24 offen sc1
    buffer_store_dwordx4 v[72:75], v28, s[40:43], s24 offen offset:2048 sc1
    s_lshr_b32 s35, s2, 4
    s_lshl_b32 s35, s35, 7
    s_add_u32 s35, s35, 65536
    s_waitcnt vmcnt(11)
    s_waitcnt lgkmcnt(4)
    s_barrier
    v_mfma_f32_16x16x32_bf16 a[168:171], a[80:83], v[44:47], a[168:171]
    s_add_u32 m0, s55, 98304
    ds_read_b128 v[32:35], v16 offset:49152
    v_mfma_f32_16x16x32_bf16 a[172:175], a[84:87], v[44:47], a[172:175]
    s_xor_b32 s60, s52, 2621440
    buffer_load_dwordx4 v4, s[72:75], s60 offen offset:0  lds
    v_mfma_f32_16x16x32_bf16 a[180:183], v[44:47], a[88:91], a[180:183]
    v_add_u32 v8, 0xffff0000, v8
    v_add_u32 v9, 0xffff0000, v9
    v_mfma_f32_16x16x32_bf16 a[188:191], v[44:47], a[92:95], a[188:191]
    s_waitcnt lgkmcnt(1)
    ds_read_b64_tr_b16 a[96:97], v8 offset:16384
    ds_read_b64_tr_b16 a[98:99], v8 offset:17408
    v_mfma_f32_16x16x32_bf16 a[192:195], a[80:83], v[48:51], a[192:195]
    s_nop 0
    ds_read_b128 v[36:39], v16 offset:49664
    ds_read_b64_tr_b16 a[100:101], v9 offset:16384
    v_mfma_f32_16x16x32_bf16 a[196:199], a[84:87], v[48:51], a[196:199]
    buffer_load_dwordx4 v5, s[72:75], s60 offen offset:1024  lds
    v_mfma_f32_16x16x32_bf16 a[208:211], v[48:51], a[88:91], a[208:211]
    ds_read_b64_tr_b16 a[102:103], v9 offset:17408
    v_add_u32 v10, 0xffff0000, v10
    v_mfma_f32_16x16x32_bf16 a[216:219], v[48:51], a[92:95], a[216:219]
    ds_read_b64_tr_b16 a[104:105], v10 offset:16384
    v_add_u32 v11, 0xffff0000, v11
    v_mfma_f32_16x16x32_bf16 a[200:203], a[80:83], v[52:55], a[200:203]
    s_nop 0
    ds_read_b128 v[40:43], v16 offset:53248
    ds_read_b64_tr_b16 a[106:107], v10 offset:17408
    v_mfma_f32_16x16x32_bf16 a[204:207], a[84:87], v[52:55], a[204:207]
    buffer_load_dwordx4 v6, s[72:75], s60 offen offset:2048  lds
    v_mfma_f32_16x16x32_bf16 a[212:215], v[52:55], a[88:91], a[212:215]
    s_nop 0
    ds_read_b64_tr_b16 a[108:109], v11 offset:16384
    ds_read_b64_tr_b16 a[110:111], v11 offset:17408
    v_mfma_f32_16x16x32_bf16 a[220:223], v[52:55], a[92:95], a[220:223]
    s_nop 0
    ds_read_b64_tr_b16 a[112:113], v8 offset:24576
    ds_read_b64_tr_b16 a[114:115], v8 offset:25600
    v_mfma_f32_16x16x32_bf16 a[224:227], a[80:83], v[56:59], a[224:227]
    s_nop 0
    ds_read_b128 v[44:47], v16 offset:53760
    ds_read_b64_tr_b16 a[116:117], v9 offset:24576
    v_mfma_f32_16x16x32_bf16 a[228:231], a[84:87], v[56:59], a[228:231]
    buffer_load_dwordx4 v7, s[72:75], s60 offen offset:3072  lds
    v_mfma_f32_16x16x32_bf16 a[240:243], v[56:59], a[88:91], a[240:243]
    s_add_u32 m0, s55, 131072
    s_xor_b32 s60, s52, 3145728
    ds_read_b64_tr_b16 a[118:119], v9 offset:25600
    v_mfma_f32_16x16x32_bf16 a[248:251], v[56:59], a[92:95], a[248:251]
    s_nop 0
    ds_read_b64_tr_b16 a[120:121], v10 offset:24576
    ds_read_b64_tr_b16 a[122:123], v10 offset:25600
    v_mfma_f32_16x16x32_bf16 a[232:235], a[80:83], v[60:63], a[232:235]
    s_nop 0
    ds_read_b128 v[48:51], v16 offset:57344
    ds_read_b64_tr_b16 a[124:125], v11 offset:24576
    v_mfma_f32_16x16x32_bf16 a[236:239], a[84:87], v[60:63], a[236:239]
    buffer_load_dwordx4 v4, s[68:71], s60 offen offset:0  lds
    v_mfma_f32_16x16x32_bf16 a[244:247], v[60:63], a[88:91], a[244:247]
    ds_read_b64_tr_b16 a[126:127], v11 offset:25600
    v_mfma_f32_16x16x32_bf16 a[252:255], v[60:63], a[92:95], a[252:255]
    s_waitcnt lgkmcnt(14)
    v_mfma_f32_16x16x32_bf16 v[128:131], a[96:99], v[32:35], v[128:131]
    s_lshr_b32 s22, s2, 3
    ds_read_b128 v[52:55], v16 offset:57856
    v_mfma_f32_16x16x32_bf16 v[132:135], a[100:103], v[32:35], v[132:135]
    s_lshl_b32 s22, s22, 2
    s_waitcnt lgkmcnt(13)
    buffer_load_dwordx4 v5, s[68:71], s60 offen offset:1024  lds
    v_mfma_f32_16x16x32_bf16 v[144:147], v[32:35], a[104:107], v[144:147]
    s_add_u32 s22, s22, s3
    s_mul_i32 s22, s22, 24576
    s_and_b32 s33, s2, 7
    s_waitcnt lgkmcnt(11)
    v_mfma_f32_16x16x32_bf16 v[152:155], v[32:35], a[108:111], v[152:155]
    s_lshl_b32 s33, s33, 8
    s_add_u32 s22, s22, s33
    v_lshrrev_b32 v25, 4, v1
    v_mfma_f32_16x16x32_bf16 v[136:139], a[96:99], v[36:39], v[136:139]
    ds_read_b128 v[56:59], v16 offset:61440
    v_mul_u32_u24 v25, 6144, v25
    v_mfma_f32_16x16x32_bf16 v[140:143], a[100:103], v[36:39], v[140:143]
    buffer_load_dwordx4 v6, s[68:71], s60 offen offset:2048  lds
    v_mfma_f32_16x16x32_bf16 v[148:151], v[36:39], a[104:107], v[148:151]
    v_bfe_u32 v18, v1, 3, 1
    v_lshl_add_u32 v25, v18, 11, v25
    v_mfma_f32_16x16x32_bf16 v[156:159], v[36:39], a[108:111], v[156:159]
    v_bfe_u32 v18, v1, 2, 1
    v_lshl_add_u32 v25, v18, 7, v25
    v_mfma_f32_16x16x32_bf16 v[160:163], a[96:99], v[40:43], v[160:163]
    ds_read_b128 v[60:63], v16 offset:61952
    v_mfma_f32_16x16x32_bf16 v[164:167], a[100:103], v[40:43], v[164:167]
    buffer_load_dword v3, v25, s[80:83], s22 offen offset:2048
    v_mfma_f32_16x16x32_bf16 v[176:179], v[40:43], a[104:107], v[176:179]
    v_mfma_f32_16x16x32_bf16 v[184:187], v[40:43], a[108:111], v[184:187]
    s_waitcnt lgkmcnt(3)
    v_mfma_f32_16x16x32_bf16 v[168:171], a[96:99], v[44:47], v[168:171]
    ds_read_b128 v[32:35], v17 offset:49152
    v_mfma_f32_16x16x32_bf16 v[172:175], a[100:103], v[44:47], v[172:175]
    v_mfma_f32_16x16x32_bf16 v[180:183], v[44:47], a[104:107], v[180:183]
    v_mfma_f32_16x16x32_bf16 v[188:191], v[44:47], a[108:111], v[188:191]
    v_mfma_f32_16x16x32_bf16 v[192:195], a[96:99], v[48:51], v[192:195]
    ds_read_b128 v[36:39], v17 offset:49664
    v_mfma_f32_16x16x32_bf16 v[196:199], a[100:103], v[48:51], v[196:199]
    v_mfma_f32_16x16x32_bf16 v[208:211], v[48:51], a[104:107], v[208:211]
    v_mfma_f32_16x16x32_bf16 v[216:219], v[48:51], a[108:111], v[216:219]
    s_waitcnt lgkmcnt(3)
    buffer_load_dwordx4 v7, s[68:71], s60 offen offset:3072  lds
    v_mfma_f32_16x16x32_bf16 v[200:203], a[96:99], v[52:55], v[200:203]
    s_add_u32 m0, s55, 32768
    ds_read_b128 v[40:43], v17 offset:53248
    v_mfma_f32_16x16x32_bf16 v[204:207], a[100:103], v[52:55], v[204:207]
    s_xor_b32 s60, s53, 512
    v_mfma_f32_16x16x32_bf16 v[212:215], v[52:55], a[104:107], v[212:215]
    v_mfma_f32_16x16x32_bf16 v[220:223], v[52:55], a[108:111], v[220:223]
    buffer_load_dwordx4 v20, s[64:67], s60 offen offset:0 lds
    v_mfma_f32_16x16x32_bf16 v[224:227], a[96:99], v[56:59], v[224:227]
    s_waitcnt vmcnt(10)
    ds_read_b128 v[44:47], v17 offset:53760
    v_mov_b32 v27, 1
    v_mfma_f32_16x16x32_bf16 v[228:231], a[100:103], v[56:59], v[228:231]
    s_mov_b64 exec, 1
    buffer_atomic_add v27, off, s[84:87], s35 sc1
    s_mov_b64 exec, -1
    s_nop 0
    v_mfma_f32_16x16x32_bf16 v[240:243], v[56:59], a[104:107], v[240:243]
    v_mfma_f32_16x16x32_bf16 v[248:251], v[56:59], a[108:111], v[248:251]
    s_waitcnt lgkmcnt(3)
    buffer_load_dwordx4 v21, s[64:67], s60 offen offset:1024 lds
    v_mfma_f32_16x16x32_bf16 v[232:235], a[96:99], v[60:63], v[232:235]
    ds_read_b128 v[48:51], v17 offset:57344
    v_mfma_f32_16x16x32_bf16 v[236:239], a[100:103], v[60:63], v[236:239]
    v_mfma_f32_16x16x32_bf16 v[244:247], v[60:63], a[104:107], v[244:247]
    v_mfma_f32_16x16x32_bf16 v[252:255], v[60:63], a[108:111], v[252:255]
    buffer_load_dwordx4 v22, s[64:67], s60 offen offset:2048 lds
    v_mfma_f32_16x16x32_bf16 v[128:131], a[112:115], v[32:35], v[128:131]
    ds_read_b128 v[52:55], v17 offset:57856
    v_mfma_f32_16x16x32_bf16 v[132:135], a[116:119], v[32:35], v[132:135]
    v_mfma_f32_16x16x32_bf16 v[144:147], v[32:35], a[120:123], v[144:147]
    v_mfma_f32_16x16x32_bf16 v[152:155], v[32:35], a[124:127], v[152:155]
    s_waitcnt lgkmcnt(3)
    buffer_load_dwordx4 v23, s[64:67], s60 offen offset:3072 lds
    v_mfma_f32_16x16x32_bf16 v[136:139], a[112:115], v[36:39], v[136:139]
    s_add_u32 m0, s55, 147456
    ds_read_b128 v[56:59], v17 offset:61440
    v_mfma_f32_16x16x32_bf16 v[140:143], a[116:119], v[36:39], v[140:143]
    s_xor_b32 s60, s52, 3145728
    v_mfma_f32_16x16x32_bf16 v[148:151], v[36:39], a[120:123], v[148:151]
    v_mfma_f32_16x16x32_bf16 v[156:159], v[36:39], a[124:127], v[156:159]
    buffer_load_dwordx4 v4, s[72:75], s60 offen offset:0  lds
    v_mfma_f32_16x16x32_bf16 v[160:163], a[112:115], v[40:43], v[160:163]
    ds_read_b128 v[60:63], v17 offset:61952
    v_mfma_f32_16x16x32_bf16 v[164:167], a[116:119], v[40:43], v[164:167]
    v_mfma_f32_16x16x32_bf16 v[176:179], v[40:43], a[120:123], v[176:179]
    v_mfma_f32_16x16x32_bf16 v[184:187], v[40:43], a[124:127], v[184:187]
    s_waitcnt vmcnt(10)
    buffer_load_dwordx4 v5, s[72:75], s60 offen offset:1024  lds
    s_barrier
    s_waitcnt lgkmcnt(3)
    v_mfma_f32_16x16x32_bf16 v[168:171], a[112:115], v[44:47], v[168:171]
    v_add_u32 v16, 0xffff0000, v16
    ds_read_b128 v[32:35], v16 offset:0
    ds_read_b64_tr_b16 a[32:33], v8 offset:49152
    v_add_u32 v17, 0xffff0000, v17
    v_mfma_f32_16x16x32_bf16 v[172:175], a[116:119], v[44:47], v[172:175]
    s_nop 0
    ds_read_b64_tr_b16 a[34:35], v8 offset:50176
    ds_read_b64_tr_b16 a[36:37], v9 offset:49152
    v_mfma_f32_16x16x32_bf16 v[180:183], v[44:47], a[120:123], v[180:183]
    s_nop 0
    ds_read_b64_tr_b16 a[38:39], v9 offset:50176
    ds_read_b64_tr_b16 a[40:41], v10 offset:32768
    v_mfma_f32_16x16x32_bf16 v[188:191], v[44:47], a[124:127], v[188:191]
    buffer_load_dwordx4 v6, s[72:75], s60 offen offset:2048  lds
    v_mfma_f32_16x16x32_bf16 v[192:195], a[112:115], v[48:51], v[192:195]
    s_nop 0
    ds_read_b128 v[36:39], v16 offset:512
    ds_read_b64_tr_b16 a[42:43], v10 offset:33792
    v_mfma_f32_16x16x32_bf16 v[196:199], a[116:119], v[48:51], v[196:199]
    s_nop 0
    ds_read_b64_tr_b16 a[44:45], v11 offset:32768
    ds_read_b64_tr_b16 a[46:47], v11 offset:33792
    v_mfma_f32_16x16x32_bf16 v[208:211], v[48:51], a[120:123], v[208:211]
    s_nop 0
    ds_read_b64_tr_b16 a[48:49], v8 offset:57344
    ds_read_b64_tr_b16 a[50:51], v8 offset:58368
    v_mfma_f32_16x16x32_bf16 v[216:219], v[48:51], a[124:127], v[216:219]
    s_waitcnt lgkmcnt(13)
    buffer_load_dwordx4 v7, s[72:75], s60 offen offset:3072  lds
    v_mfma_f32_16x16x32_bf16 v[200:203], a[112:115], v[52:55], v[200:203]
    s_add_u32 m0, s55, 16384
    ds_read_b128 v[40:43], v16 offset:4096
    v_mfma_f32_16x16x32_bf16 v[204:207], a[116:119], v[52:55], v[204:207]
    s_xor_b32 s60, s52, 3670016
    ds_read_b64_tr_b16 a[52:53], v9 offset:57344
    ds_read_b64_tr_b16 a[54:55], v9 offset:58368
    v_mfma_f32_16x16x32_bf16 v[212:215], v[52:55], a[120:123], v[212:215]
    s_nop 0
    ds_read_b64_tr_b16 a[56:57], v10 offset:40960
    ds_read_b64_tr_b16 a[58:59], v10 offset:41984
    v_mfma_f32_16x16x32_bf16 v[220:223], v[52:55], a[124:127], v[220:223]
    buffer_load_dwordx4 v4, s[68:71], s60 offen offset:0  lds
    v_mfma_f32_16x16x32_bf16 v[224:227], a[112:115], v[56:59], v[224:227]
    s_nop 0
    ds_read_b128 v[44:47], v16 offset:4608
    ds_read_b64_tr_b16 a[60:61], v11 offset:40960
    v_mfma_f32_16x16x32_bf16 v[228:231], a[116:119], v[56:59], v[228:231]
    ds_read_b64_tr_b16 a[62:63], v11 offset:41984
    v_mfma_f32_16x16x32_bf16 v[240:243], v[56:59], a[120:123], v[240:243]
    v_mfma_f32_16x16x32_bf16 v[248:251], v[56:59], a[124:127], v[248:251]
    s_waitcnt lgkmcnt(14)
    buffer_load_dwordx4 v5, s[68:71], s60 offen offset:1024  lds
    v_mfma_f32_16x16x32_bf16 v[232:235], a[112:115], v[60:63], v[232:235]
    ds_read_b128 v[48:51], v16 offset:8192
    v_mfma_f32_16x16x32_bf16 v[236:239], a[116:119], v[60:63], v[236:239]
    v_mfma_f32_16x16x32_bf16 v[244:247], v[60:63], a[120:123], v[244:247]
    v_mfma_f32_16x16x32_bf16 v[252:255], v[60:63], a[124:127], v[252:255]
    buffer_load_dwordx4 v6, s[68:71], s60 offen offset:2048  lds
    v_mfma_f32_16x16x32_bf16 a[128:131], a[96:99], v[32:35], a[128:131]
    ds_read_b128 v[52:55], v16 offset:8704
    v_mfma_f32_16x16x32_bf16 a[132:135], a[100:103], v[32:35], a[132:135]
    v_mfma_f32_16x16x32_bf16 a[144:147], v[32:35], a[104:107], a[144:147]
    v_mfma_f32_16x16x32_bf16 a[152:155], v[32:35], a[108:111], a[152:155]
    s_waitcnt lgkmcnt(5)
    buffer_load_dwordx4 v7, s[68:71], s60 offen offset:3072  lds
    v_mfma_f32_16x16x32_bf16 a[136:139], a[96:99], v[36:39], a[136:139]
    s_add_u32 m0, s55, 81920
    ds_read_b128 v[56:59], v16 offset:12288
    v_mfma_f32_16x16x32_bf16 a[140:143], a[100:103], v[36:39], a[140:143]
    s_xor_b32 s60, s53, 768
    v_mfma_f32_16x16x32_bf16 a[148:151], v[36:39], a[104:107], a[148:151]
    v_mfma_f32_16x16x32_bf16 a[156:159], v[36:39], a[108:111], a[156:159]
    buffer_load_dwordx4 v20, s[64:67], s60 offen offset:0 lds
    v_mfma_f32_16x16x32_bf16 a[160:163], a[96:99], v[40:43], a[160:163]
    ds_read_b128 v[60:63], v16 offset:12800
    v_mfma_f32_16x16x32_bf16 a[164:167], a[100:103], v[40:43], a[164:167]
    v_mfma_f32_16x16x32_bf16 a[176:179], v[40:43], a[104:107], a[176:179]
    v_mfma_f32_16x16x32_bf16 a[184:187], v[40:43], a[108:111], a[184:187]
    s_waitcnt lgkmcnt(3)
    buffer_load_dwordx4 v21, s[64:67], s60 offen offset:1024 lds
    v_mfma_f32_16x16x32_bf16 a[168:171], a[96:99], v[44:47], a[168:171]
    ds_read_b128 v[32:35], v17 offset:0
    v_mfma_f32_16x16x32_bf16 a[172:175], a[100:103], v[44:47], a[172:175]
    v_mfma_f32_16x16x32_bf16 a[180:183], v[44:47], a[104:107], a[180:183]
    v_mfma_f32_16x16x32_bf16 a[188:191], v[44:47], a[108:111], a[188:191]
    buffer_load_dwordx4 v22, s[64:67], s60 offen offset:2048 lds
    v_mfma_f32_16x16x32_bf16 a[192:195], a[96:99], v[48:51], a[192:195]
    ds_read_b128 v[36:39], v17 offset:512
    v_mfma_f32_16x16x32_bf16 a[196:199], a[100:103], v[48:51], a[196:199]
    v_mfma_f32_16x16x32_bf16 a[208:211], v[48:51], a[104:107], a[208:211]
    v_mfma_f32_16x16x32_bf16 a[216:219], v[48:51], a[108:111], a[216:219]
    s_waitcnt lgkmcnt(3)
    buffer_load_dwordx4 v23, s[64:67], s60 offen offset:3072 lds
    v_mfma_f32_16x16x32_bf16 a[200:203], a[96:99], v[52:55], a[200:203]
    s_add_u32 m0, s55, 65536
    ds_read_b128 v[40:43], v17 offset:4096
    v_mfma_f32_16x16x32_bf16 a[204:207], a[100:103], v[52:55], a[204:207]
    s_xor_b32 s60, s52, 3670016
    v_mfma_f32_16x16x32_bf16 a[212:215], v[52:55], a[104:107], a[212:215]
    v_mfma_f32_16x16x32_bf16 a[220:223], v[52:55], a[108:111], a[220:223]
    buffer_load_dwordx4 v4, s[72:75], s60 offen offset:0  lds
    v_mfma_f32_16x16x32_bf16 a[224:227], a[96:99], v[56:59], a[224:227]
    ds_read_b128 v[44:47], v17 offset:4608
    v_mfma_f32_16x16x32_bf16 a[228:231], a[100:103], v[56:59], a[228:231]
    v_mfma_f32_16x16x32_bf16 a[240:243], v[56:59], a[104:107], a[240:243]
    v_mfma_f32_16x16x32_bf16 a[248:251], v[56:59], a[108:111], a[248:251]
    s_waitcnt lgkmcnt(3)
    buffer_load_dwordx4 v5, s[72:75], s60 offen offset:1024  lds
    v_mfma_f32_16x16x32_bf16 a[232:235], a[96:99], v[60:63], a[232:235]
    ds_read_b128 v[48:51], v17 offset:8192
    v_mfma_f32_16x16x32_bf16 a[236:239], a[100:103], v[60:63], a[236:239]
    v_mfma_f32_16x16x32_bf16 a[244:247], v[60:63], a[104:107], a[244:247]
    v_mfma_f32_16x16x32_bf16 a[252:255], v[60:63], a[108:111], a[252:255]
    buffer_load_dwordx4 v6, s[72:75], s60 offen offset:2048  lds
    v_mfma_f32_16x16x32_bf16 a[128:131], a[112:115], v[32:35], a[128:131]
    ds_read_b128 v[52:55], v17 offset:8704
    v_mfma_f32_16x16x32_bf16 a[132:135], a[116:119], v[32:35], a[132:135]
    v_mfma_f32_16x16x32_bf16 a[144:147], v[32:35], a[120:123], a[144:147]
    v_mfma_f32_16x16x32_bf16 a[152:155], v[32:35], a[124:127], a[152:155]
    s_waitcnt lgkmcnt(3)
    buffer_load_dwordx4 v7, s[72:75], s60 offen offset:3072  lds
    v_mfma_f32_16x16x32_bf16 a[136:139], a[112:115], v[36:39], a[136:139]
    ds_read_b128 v[56:59], v17 offset:12288
    v_mfma_f32_16x16x32_bf16 a[140:143], a[116:119], v[36:39], a[140:143]
    v_mfma_f32_16x16x32_bf16 a[148:151], v[36:39], a[120:123], a[148:151]
    v_mfma_f32_16x16x32_bf16 a[156:159], v[36:39], a[124:127], a[156:159]
    v_mfma_f32_16x16x32_bf16 a[160:163], a[112:115], v[40:43], a[160:163]
    ds_read_b128 v[60:63], v17 offset:12800
    v_mfma_f32_16x16x32_bf16 a[164:167], a[116:119], v[40:43], a[164:167]
    v_mfma_f32_16x16x32_bf16 a[176:179], v[40:43], a[120:123], a[176:179]
    v_mfma_f32_16x16x32_bf16 a[184:187], v[40:43], a[124:127], a[184:187]
    s_waitcnt vmcnt(12)
    s_waitcnt lgkmcnt(4)
    s_barrier
    v_mfma_f32_16x16x32_bf16 a[168:171], a[112:115], v[44:47], a[168:171]
    s_add_u32 m0, s55, 49152
    ds_read_b128 v[32:35], v16 offset:32768
    v_mfma_f32_16x16x32_bf16 a[172:175], a[116:119], v[44:47], a[172:175]
    s_xor_b32 s60, s53, 66048
    buffer_load_dwordx4 v20, s[64:67], s60 offen offset:0 lds
    v_mfma_f32_16x16x32_bf16 a[180:183], v[44:47], a[120:123], a[180:183]
    v_add_u32 v8, 0x20000, v8
    v_add_u32 v9, 0x20000, v9
    v_mfma_f32_16x16x32_bf16 a[188:191], v[44:47], a[124:127], a[188:191]
    s_waitcnt lgkmcnt(3)
    ds_read_b64_tr_b16 a[64:65], v8 offset:0
    ds_read_b64_tr_b16 a[66:67], v8 offset:1024
    v_mfma_f32_16x16x32_bf16 a[192:195], a[112:115], v[48:51], a[192:195]
    s_nop 0
    ds_read_b128 v[36:39], v16 offset:33280
    ds_read_b64_tr_b16 a[68:69], v9 offset:0
    v_mfma_f32_16x16x32_bf16 a[196:199], a[116:119], v[48:51], a[196:199]
    buffer_load_dwordx4 v21, s[64:67], s60 offen offset:1024 lds
    v_mfma_f32_16x16x32_bf16 a[208:211], v[48:51], a[120:123], a[208:211]
    ds_read_b64_tr_b16 a[70:71], v9 offset:1024
    v_add_u32 v10, 0x10000, v10
    v_mfma_f32_16x16x32_bf16 a[216:219], v[48:51], a[124:127], a[216:219]
    ds_read_b64_tr_b16 a[72:73], v10 offset:16384
    v_add_u32 v11, 0x10000, v11
    v_mfma_f32_16x16x32_bf16 a[200:203], a[112:115], v[52:55], a[200:203]
    s_nop 0
    ds_read_b128 v[40:43], v16 offset:36864
    ds_read_b64_tr_b16 a[74:75], v10 offset:17408
    v_mfma_f32_16x16x32_bf16 a[204:207], a[116:119], v[52:55], a[204:207]
    buffer_load_dwordx4 v22, s[64:67], s60 offen offset:2048 lds
    v_mfma_f32_16x16x32_bf16 a[212:215], v[52:55], a[120:123], a[212:215]
    s_nop 0
    ds_read_b64_tr_b16 a[76:77], v11 offset:16384
    ds_read_b64_tr_b16 a[78:79], v11 offset:17408
    v_mfma_f32_16x16x32_bf16 a[220:223], v[52:55], a[124:127], a[220:223]
    s_waitcnt lgkmcnt(11)
    ds_read_b64_tr_b16 a[80:81], v8 offset:8192
    ds_read_b64_tr_b16 a[82:83], v8 offset:9216
    v_mfma_f32_16x16x32_bf16 a[224:227], a[112:115], v[56:59], a[224:227]
    s_nop 0
    ds_read_b128 v[44:47], v16 offset:37376
    ds_read_b64_tr_b16 a[84:85], v9 offset:8192
    v_mfma_f32_16x16x32_bf16 a[228:231], a[116:119], v[56:59], a[228:231]
    buffer_load_dwordx4 v23, s[64:67], s60 offen offset:3072 lds
    v_mfma_f32_16x16x32_bf16 a[240:243], v[56:59], a[120:123], a[240:243]
    s_add_u32 m0, s55, 98304
    s_xor_b32 s60, s53, 66304
    ds_read_b64_tr_b16 a[86:87], v9 offset:9216
    v_mfma_f32_16x16x32_bf16 a[248:251], v[56:59], a[124:127], a[248:251]
    s_nop 0
    ds_read_b64_tr_b16 a[88:89], v10 offset:24576
    ds_read_b64_tr_b16 a[90:91], v10 offset:25600
    v_mfma_f32_16x16x32_bf16 a[232:235], a[112:115], v[60:63], a[232:235]
    s_nop 0
    ds_read_b128 v[48:51], v17 offset:32768
    ds_read_b64_tr_b16 a[92:93], v11 offset:24576
    v_mfma_f32_16x16x32_bf16 a[236:239], a[116:119], v[60:63], a[236:239]
    buffer_load_dwordx4 v20, s[64:67], s60 offen offset:0 lds
    v_mfma_f32_16x16x32_bf16 a[244:247], v[60:63], a[120:123], a[244:247]
    ds_read_b64_tr_b16 a[94:95], v11 offset:25600
    v_mfma_f32_16x16x32_bf16 a[252:255], v[60:63], a[124:127], a[252:255]
    s_waitcnt lgkmcnt(14)
    v_mfma_f32_16x16x32_bf16 v[128:131], a[0:3], v[32:35], v[128:131]
    s_lshr_b32 s24, s17, 3
    ds_read_b128 v[52:55], v17 offset:33280
    v_mfma_f32_16x16x32_bf16 v[132:135], a[4:7], v[32:35], v[132:135]
    s_lshl_b32 s24, s24, 7
    buffer_load_dwordx4 v21, s[64:67], s60 offen offset:1024 lds
    v_mfma_f32_16x16x32_bf16 v[144:147], v[32:35], a[8:11], v[144:147]
    s_add_u32 s24, s24, 65536
    s_lshr_b32 s25, s18, 3
    s_lshl_b32 s25, s25, 7
    v_mfma_f32_16x16x32_bf16 v[152:155], v[32:35], a[12:15], v[152:155]
    s_add_u32 s25, s25, 65536
    v_mfma_f32_16x16x32_bf16 v[136:139], a[0:3], v[36:39], v[136:139]
    ds_read_b128 v[56:59], v17 offset:36864
    v_mfma_f32_16x16x32_bf16 v[140:143], a[4:7], v[36:39], v[140:143]
    buffer_load_dword v29, off, s[84:87], s24 sc1
    v_mfma_f32_16x16x32_bf16 v[148:151], v[36:39], a[8:11], v[148:151]
    v_mfma_f32_16x16x32_bf16 v[156:159], v[36:39], a[12:15], v[156:159]
    s_waitcnt lgkmcnt(5)
    v_mfma_f32_16x16x32_bf16 v[160:163], a[0:3], v[40:43], v[160:163]
    ds_read_b128 v[60:63], v17 offset:37376
    v_mfma_f32_16x16x32_bf16 v[164:167], a[4:7], v[40:43], v[164:167]
    buffer_load_dword v30, off, s[84:87], s25 sc1
    v_mfma_f32_16x16x32_bf16 v[176:179], v[40:43], a[8:11], v[176:179]
    v_mfma_f32_16x16x32_bf16 v[184:187], v[40:43], a[12:15], v[184:187]
    v_mfma_f32_16x16x32_bf16 v[168:171], a[0:3], v[44:47], v[168:171]
    ds_read_b128 v[32:35], v16 offset:40960
    v_mfma_f32_16x16x32_bf16 v[172:175], a[4:7], v[44:47], v[172:175]
    buffer_load_dwordx4 v22, s[64:67], s60 offen offset:2048 lds
    v_mfma_f32_16x16x32_bf16 v[180:183], v[44:47], a[8:11], v[180:183]
    v_mfma_f32_16x16x32_bf16 v[188:191], v[44:47], a[12:15], v[188:191]
    s_waitcnt lgkmcnt(3)
    v_mfma_f32_16x16x32_bf16 v[128:131], a[16:19], v[48:51], v[128:131]
    ds_read_b128 v[36:39], v16 offset:41472
    v_mfma_f32_16x16x32_bf16 v[132:135], a[20:23], v[48:51], v[132:135]
    buffer_load_dwordx4 v23, s[64:67], s60 offen offset:3072 lds
    v_mfma_f32_16x16x32_bf16 v[144:147], v[48:51], a[24:27], v[144:147]
    s_add_u32 m0, s55, 114688
    s_xor_b32 s60, s53, 131584
    v_mfma_f32_16x16x32_bf16 v[152:155], v[48:51], a[28:31], v[152:155]
    v_mfma_f32_16x16x32_bf16 v[136:139], a[16:19], v[52:55], v[136:139]
    ds_read_b128 v[40:43], v16 offset:45056
    v_mfma_f32_16x16x32_bf16 v[140:143], a[20:23], v[52:55], v[140:143]
    buffer_load_dwordx4 v20, s[64:67], s60 offen offset:0 lds
    v_mfma_f32_16x16x32_bf16 v[148:151], v[52:55], a[24:27], v[148:151]
    v_mfma_f32_16x16x32_bf16 v[156:159], v[52:55], a[28:31], v[156:159]
    s_waitcnt lgkmcnt(3)
    v_mfma_f32_16x16x32_bf16 v[160:163], a[16:19], v[56:59], v[160:163]
    ds_read_b128 v[44:47], v16 offset:45568
    v_mfma_f32_16x16x32_bf16 v[164:167], a[20:23], v[56:59], v[164:167]
    buffer_load_dwordx4 v21, s[64:67], s60 offen offset:1024 lds
    v_mfma_f32_16x16x32_bf16 v[176:179], v[56:59], a[24:27], v[176:179]
    v_mfma_f32_16x16x32_bf16 v[184:187], v[56:59], a[28:31], v[184:187]
    v_mfma_f32_16x16x32_bf16 v[168:171], a[16:19], v[60:63], v[168:171]
    ds_read_b128 v[48:51], v17 offset:40960
    v_mfma_f32_16x16x32_bf16 v[172:175], a[20:23], v[60:63], v[172:175]
    buffer_load_dwordx4 v22, s[64:67], s60 offen offset:2048 lds
    v_mfma_f32_16x16x32_bf16 v[180:183], v[60:63], a[24:27], v[180:183]
    v_mfma_f32_16x16x32_bf16 v[188:191], v[60:63], a[28:31], v[188:191]
    s_waitcnt lgkmcnt(3)
    v_mfma_f32_16x16x32_bf16 v[128:131], a[32:35], v[32:35], v[128:131]
    ds_read_b128 v[52:55], v17 offset:41472
    v_mfma_f32_16x16x32_bf16 v[132:135], a[36:39], v[32:35], v[132:135]
    buffer_load_dwordx4 v23, s[64:67], s60 offen offset:3072 lds
    v_mfma_f32_16x16x32_bf16 v[144:147], v[32:35], a[40:43], v[144:147]
    v_mfma_f32_16x16x32_bf16 v[152:155], v[32:35], a[44:47], v[152:155]
    v_mfma_f32_16x16x32_bf16 v[136:139], a[32:35], v[36:39], v[136:139]
    ds_read_b128 v[56:59], v17 offset:45056
    v_mfma_f32_16x16x32_bf16 v[140:143], a[36:39], v[36:39], v[140:143]
    v_mfma_f32_16x16x32_bf16 v[148:151], v[36:39], a[40:43], v[148:151]
    v_mfma_f32_16x16x32_bf16 v[156:159], v[36:39], a[44:47], v[156:159]
    s_waitcnt lgkmcnt(3)
    v_mfma_f32_16x16x32_bf16 v[160:163], a[32:35], v[40:43], v[160:163]
    ds_read_b128 v[60:63], v17 offset:45568
    v_mfma_f32_16x16x32_bf16 v[164:167], a[36:39], v[40:43], v[164:167]
    v_mfma_f32_16x16x32_bf16 v[176:179], v[40:43], a[40:43], v[176:179]
    v_mfma_f32_16x16x32_bf16 v[184:187], v[40:43], a[44:47], v[184:187]
    s_waitcnt vmcnt(14)
    s_waitcnt lgkmcnt(4)
    s_barrier
    v_mfma_f32_16x16x32_bf16 v[168:171], a[32:35], v[44:47], v[168:171]
    s_add_u32 m0, s55, 131072
    v_add_u32 v16, 0x10000, v16
    ds_read_b128 v[32:35], v16 offset:16384
    v_add_u32 v17, 0x10000, v17
    v_mfma_f32_16x16x32_bf16 v[172:175], a[36:39], v[44:47], v[172:175]
    s_xor_b32 s60, s53, 131840
    buffer_load_dwordx4 v20, s[64:67], s60 offen offset:0 lds
    v_mfma_f32_16x16x32_bf16 v[180:183], v[44:47], a[40:43], v[180:183]
    v_add_u32 v8, 0xfffe0000, v8
    v_add_u32 v9, 0xfffe0000, v9
    v_mfma_f32_16x16x32_bf16 v[188:191], v[44:47], a[44:47], v[188:191]
    s_waitcnt lgkmcnt(3)
    ds_read_b64_tr_b16 a[96:97], v8 offset:16384
    ds_read_b64_tr_b16 a[98:99], v8 offset:17408
    v_mfma_f32_16x16x32_bf16 v[128:131], a[48:51], v[48:51], v[128:131]
    s_nop 0
    ds_read_b128 v[36:39], v16 offset:16896
    ds_read_b64_tr_b16 a[100:101], v9 offset:16384
    v_mfma_f32_16x16x32_bf16 v[132:135], a[52:55], v[48:51], v[132:135]
    buffer_load_dwordx4 v21, s[64:67], s60 offen offset:1024 lds
    v_mfma_f32_16x16x32_bf16 v[144:147], v[48:51], a[56:59], v[144:147]
    ds_read_b64_tr_b16 a[102:103], v9 offset:17408
    v_add_u32 v10, 0xffff0000, v10
    v_mfma_f32_16x16x32_bf16 v[152:155], v[48:51], a[60:63], v[152:155]
    ds_read_b64_tr_b16 a[104:105], v10 offset:0
    v_add_u32 v11, 0xffff0000, v11
    v_mfma_f32_16x16x32_bf16 v[136:139], a[48:51], v[52:55], v[136:139]
    s_nop 0
    ds_read_b128 v[40:43], v16 offset:20480
    ds_read_b64_tr_b16 a[106:107], v10 offset:1024
    v_mfma_f32_16x16x32_bf16 v[140:143], a[52:55], v[52:55], v[140:143]
    buffer_load_dwordx4 v22, s[64:67], s60 offen offset:2048 lds
    v_mfma_f32_16x16x32_bf16 v[148:151], v[52:55], a[56:59], v[148:151]
    s_nop 0
    ds_read_b64_tr_b16 a[108:109], v11 offset:0
    ds_read_b64_tr_b16 a[110:111], v11 offset:1024
    v_mfma_f32_16x16x32_bf16 v[156:159], v[52:55], a[60:63], v[156:159]
    s_waitcnt lgkmcnt(11)
    ds_read_b64_tr_b16 a[112:113], v8 offset:24576
    ds_read_b64_tr_b16 a[114:115], v8 offset:25600
    v_mfma_f32_16x16x32_bf16 v[160:163], a[48:51], v[56:59], v[160:163]
    s_nop 0
    ds_read_b128 v[44:47], v16 offset:20992
    ds_read_b64_tr_b16 a[116:117], v9 offset:24576
    v_mfma_f32_16x16x32_bf16 v[164:167], a[52:55], v[56:59], v[164:167]
    buffer_load_dwordx4 v23, s[64:67], s60 offen offset:3072 lds
    v_mfma_f32_16x16x32_bf16 v[176:179], v[56:59], a[56:59], v[176:179]
    s_add_u32 m0, s55, 147456
    s_xor_b32 s60, s53, 197120
    ds_read_b64_tr_b16 a[118:119], v9 offset:25600
    v_mfma_f32_16x16x32_bf16 v[184:187], v[56:59], a[60:63], v[184:187]
    s_nop 0
    ds_read_b64_tr_b16 a[120:121], v10 offset:8192
    ds_read_b64_tr_b16 a[122:123], v10 offset:9216
    v_mfma_f32_16x16x32_bf16 v[168:171], a[48:51], v[60:63], v[168:171]
    s_nop 0
    ds_read_b128 v[48:51], v17 offset:16384
    ds_read_b64_tr_b16 a[124:125], v11 offset:8192
    v_mfma_f32_16x16x32_bf16 v[172:175], a[52:55], v[60:63], v[172:175]
    buffer_load_dwordx4 v20, s[64:67], s60 offen offset:0 lds
    v_mfma_f32_16x16x32_bf16 v[180:183], v[60:63], a[56:59], v[180:183]
    s_waitcnt vmcnt(12)
    ds_read_b64_tr_b16 a[126:127], v11 offset:9216
    v_cmp_gt_u32 vcc, 64, v29
    v_mfma_f32_16x16x32_bf16 v[188:191], v[60:63], a[60:63], v[188:191]
    s_nop 0
    s_nop 0
    s_nop 0
    s_cbranch_vccnz main_spin7
main_back8:
    s_waitcnt lgkmcnt(13)
    v_mfma_f32_16x16x32_bf16 v[128:131], a[64:67], v[32:35], v[128:131]
    s_waitcnt vmcnt(11)
    ds_read_b128 v[52:55], v17 offset:16896
    v_cmp_gt_u32 vcc, 64, v30
    v_mfma_f32_16x16x32_bf16 v[132:135], a[68:71], v[32:35], v[132:135]
    s_nop 0
    buffer_load_dwordx4 v21, s[64:67], s60 offen offset:1024 lds
    v_mfma_f32_16x16x32_bf16 v[144:147], v[32:35], a[72:75], v[144:147]
    s_nop 0
    s_nop 0
    s_cbranch_vccnz main_spin9
main_back10:
    s_lshl_b32 s24, s17, 14
    v_mfma_f32_16x16x32_bf16 v[152:155], v[32:35], a[76:79], v[152:155]
    s_lshl_b32 s25, s18, 14
    s_lshl_b32 s23, s26, 11
    s_add_u32 s24, s24, s23
    v_mfma_f32_16x16x32_bf16 v[136:139], a[64:67], v[36:39], v[136:139]
    s_add_u32 s25, s25, s23
    ds_read_b128 v[56:59], v17 offset:20480
    v_mfma_f32_16x16x32_bf16 v[140:143], a[68:71], v[36:39], v[140:143]
    s_lshl_b32 s23, s3, 15
    buffer_load_dwordx4 v22, s[64:67], s60 offen offset:2048 lds
    v_mfma_f32_16x16x32_bf16 v[148:151], v[36:39], a[72:75], v[148:151]
    s_sub_u32 s23, 0x1c000, s23
    v_add_u32 v26, s23, v2
    v_mfma_f32_16x16x32_bf16 v[156:159], v[36:39], a[76:79], v[156:159]
    v_mfma_f32_16x16x32_bf16 v[160:163], a[64:67], v[40:43], v[160:163]
    ds_read_b128 v[60:63], v17 offset:20992
    v_mfma_f32_16x16x32_bf16 v[164:167], a[68:71], v[40:43], v[164:167]
    buffer_load_dwordx4 v23, s[64:67], s60 offen offset:3072 lds
    v_mfma_f32_16x16x32_bf16 v[176:179], v[40:43], a[72:75], v[176:179]
    s_add_u32 m0, s55, 0
    s_xor_b32 s60, s53, 197376
    v_mfma_f32_16x16x32_bf16 v[184:187], v[40:43], a[76:79], v[184:187]
    s_waitcnt lgkmcnt(2)
    v_mfma_f32_16x16x32_bf16 v[168:171], a[64:67], v[44:47], v[168:171]
    ds_read_b128 v[32:35], v16 offset:24576
    v_mfma_f32_16x16x32_bf16 v[172:175], a[68:71], v[44:47], v[172:175]
    buffer_load_dwordx4 v20, s[64:67], s60 offen offset:0 lds
    v_mfma_f32_16x16x32_bf16 v[180:183], v[44:47], a[72:75], v[180:183]
    v_mfma_f32_16x16x32_bf16 v[188:191], v[44:47], a[76:79], v[188:191]
    v_mfma_f32_16x16x32_bf16 v[128:131], a[80:83], v[48:51], v[128:131]
    ds_read_b128 v[36:39], v16 offset:25088
    v_mfma_f32_16x16x32_bf16 v[132:135], a[84:87], v[48:51], v[132:135]
    buffer_load_dwordx4 v21, s[64:67], s60 offen offset:1024 lds
    v_mfma_f32_16x16x32_bf16 v[144:147], v[48:51], a[88:91], v[144:147]
    v_mfma_f32_16x16x32_bf16 v[152:155], v[48:51], a[92:95], v[152:155]
    v_mfma_f32_16x16x32_bf16 v[136:139], a[80:83], v[52:55], v[136:139]
    ds_read_b128 v[40:43], v16 offset:28672
    v_mfma_f32_16x16x32_bf16 v[140:143], a[84:87], v[52:55], v[140:143]
    buffer_load_dwordx4 v22, s[64:67], s60 offen offset:2048 lds
    v_mfma_f32_16x16x32_bf16 v[148:151], v[52:55], a[88:91], v[148:151]
    v_mfma_f32_16x16x32_bf16 v[156:159], v[52:55], a[92:95], v[156:159]
    s_waitcnt lgkmcnt(3)
    v_mfma_f32_16x16x32_bf16 v[160:163], a[80:83], v[56:59], v[160:163]
    s_xor_b32 s61, s24, 0
    ds_read_b128 v[44:47], v16 offset:29184
    v_mfma_f32_16x16x32_bf16 v[164:167], a[84:87], v[56:59], v[164:167]
    s_xor_b32 s62, s25, 0
    buffer_load_dwordx4 v[64:67], v2, s[40:43], s61 offen offset:0 sc1
    v_mfma_f32_16x16x32_bf16 v[176:179], v[56:59], a[88:91], v[176:179]
    v_mfma_f32_16x16x32_bf16 v[184:187], v[56:59], a[92:95], v[184:187]
    v_mfma_f32_16x16x32_bf16 v[168:171], a[80:83], v[60:63], v[168:171]
    ds_read_b128 v[48:51], v17 offset:24576
    v_mfma_f32_16x16x32_bf16 v[172:175], a[84:87], v[60:63], v[172:175]
    buffer_load_dwordx4 v23, s[64:67], s60 offen offset:3072 lds
    v_mfma_f32_16x16x32_bf16 v[180:183], v[60:63], a[88:91], v[180:183]
    v_mfma_f32_16x16x32_bf16 v[188:191], v[60:63], a[92:95], v[188:191]
    s_waitcnt lgkmcnt(3)
    v_mfma_f32_16x16x32_bf16 v[128:131], a[96:99], v[32:35], v[128:131]
    ds_read_b128 v[52:55], v17 offset:25088
    v_mfma_f32_16x16x32_bf16 v[132:135], a[100:103], v[32:35], v[132:135]
    v_mfma_f32_16x16x32_bf16 v[144:147], v[32:35], a[104:107], v[144:147]
    v_mfma_f32_16x16x32_bf16 v[152:155], v[32:35], a[108:111], v[152:155]
    v_mfma_f32_16x16x32_bf16 v[136:139], a[96:99], v[36:39], v[136:139]
    ds_read_b128 v[56:59], v17 offset:28672
    v_mfma_f32_16x16x32_bf16 v[140:143], a[100:103], v[36:39], v[140:143]
    v_mfma_f32_16x16x32_bf16 v[148:151], v[36:39], a[104:107], v[148:151]
    v_mfma_f32_16x16x32_bf16 v[156:159], v[36:39], a[108:111], v[156:159]
    s_waitcnt lgkmcnt(3)
    v_mfma_f32_16x16x32_bf16 v[160:163], a[96:99], v[40:43], v[160:163]
    ds_read_b128 v[60:63], v17 offset:29184
    v_mfma_f32_16x16x32_bf16 v[164:167], a[100:103], v[40:43], v[164:167]
    v_mfma_f32_16x16x32_bf16 v[176:179], v[40:43], a[104:107], v[176:179]
    v_mfma_f32_16x16x32_bf16 v[184:187], v[40:43], a[108:111], v[184:187]
    s_waitcnt lgkmcnt(4)
    s_barrier
    v_mfma_f32_16x16x32_bf16 v[168:171], a[96:99], v[44:47], v[168:171]
    s_add_u32 m0, s55, 16384
    v_add_u32 v16, 0xffff0000, v16
    ds_read_b128 v[32:35], v16 offset:49152
    v_add_u32 v17, 0xffff0000, v17
    v_mfma_f32_16x16x32_bf16 v[172:175], a[100:103], v[44:47], v[172:175]
    s_xor_b32 s60, s27, 0
    buffer_load_dwordx4 v[68:71], v26, s[40:43], s61 offen offset:0 sc1
    v_mfma_f32_16x16x32_bf16 v[180:183], v[44:47], a[104:107], v[180:183]
    v_mfma_f32_16x16x32_bf16 v[188:191], v[44:47], a[108:111], v[188:191]
    s_waitcnt lgkmcnt(3)
    v_mfma_f32_16x16x32_bf16 v[128:131], a[112:115], v[48:51], v[128:131]
    ds_read_b128 v[36:39], v16 offset:49664
    v_mfma_f32_16x16x32_bf16 v[132:135], a[116:119], v[48:51], v[132:135]
    buffer_load_dwordx4 v4, s[28:31], s60 offen offset:0  lds
    v_mfma_f32_16x16x32_bf16 v[144:147], v[48:51], a[120:123], v[144:147]
    v_mfma_f32_16x16x32_bf16 v[152:155], v[48:51], a[124:127], v[152:155]
    v_mfma_f32_16x16x32_bf16 v[136:139], a[112:115], v[52:55], v[136:139]
    ds_read_b128 v[40:43], v16 offset:53248
    v_mfma_f32_16x16x32_bf16 v[140:143], a[116:119], v[52:55], v[140:143]
    buffer_load_dwordx4 v5, s[28:31], s60 offen offset:1024  lds
    v_mfma_f32_16x16x32_bf16 v[148:151], v[52:55], a[120:123], v[148:151]
    v_mfma_f32_16x16x32_bf16 v[156:159], v[52:55], a[124:127], v[156:159]
    s_waitcnt lgkmcnt(3)
    v_mfma_f32_16x16x32_bf16 v[160:163], a[112:115], v[56:59], v[160:163]
    ds_read_b128 v[44:47], v16 offset:53760
    v_mfma_f32_16x16x32_bf16 v[164:167], a[116:119], v[56:59], v[164:167]
    buffer_load_dwordx4 v6, s[28:31], s60 offen offset:2048  lds
    v_mfma_f32_16x16x32_bf16 v[176:179], v[56:59], a[120:123], v[176:179]
    v_mfma_f32_16x16x32_bf16 v[184:187], v[56:59], a[124:127], v[184:187]
    v_mfma_f32_16x16x32_bf16 v[168:171], a[112:115], v[60:63], v[168:171]
    ds_read_b128 v[48:51], v17 offset:49152
    v_mfma_f32_16x16x32_bf16 v[172:175], a[116:119], v[60:63], v[172:175]
    buffer_load_dwordx4 v7, s[28:31], s60 offen offset:3072  lds
    v_mfma_f32_16x16x32_bf16 v[180:183], v[60:63], a[120:123], v[180:183]
    s_add_u32 m0, s55, 65536
    s_xor_b32 s60, s27, 524288
    v_mfma_f32_16x16x32_bf16 v[188:191], v[60:63], a[124:127], v[188:191]
    s_waitcnt lgkmcnt(3)
    v_mfma_f32_16x16x32_bf16 v[192:195], a[0:3], v[32:35], v[192:195]
    ds_read_b128 v[52:55], v17 offset:49664
    v_mfma_f32_16x16x32_bf16 v[196:199], a[4:7], v[32:35], v[196:199]
    buffer_load_dwordx4 v[72:75], v2, s[40:43], s62 offen offset:0 sc1
    v_mfma_f32_16x16x32_bf16 v[208:211], v[32:35], a[8:11], v[208:211]
    v_mfma_f32_16x16x32_bf16 v[216:219], v[32:35], a[12:15], v[216:219]
    v_mfma_f32_16x16x32_bf16 v[200:203], a[0:3], v[36:39], v[200:203]
    ds_read_b128 v[56:59], v17 offset:53248
    v_mfma_f32_16x16x32_bf16 v[204:207], a[4:7], v[36:39], v[204:207]
    buffer_load_dwordx4 v4, s[28:31], s60 offen offset:0  lds
    v_mfma_f32_16x16x32_bf16 v[212:215], v[36:39], a[8:11], v[212:215]
    v_mfma_f32_16x16x32_bf16 v[220:223], v[36:39], a[12:15], v[220:223]
    s_waitcnt lgkmcnt(3)
    v_mfma_f32_16x16x32_bf16 v[224:227], a[0:3], v[40:43], v[224:227]
    ds_read_b128 v[60:63], v17 offset:53760
    v_cvt_pk_bf16_f32 v128, v128, v129
    v_mfma_f32_16x16x32_bf16 v[228:231], a[4:7], v[40:43], v[228:231]
    buffer_load_dwordx4 v5, s[28:31], s60 offen offset:1024  lds
    v_mfma_f32_16x16x32_bf16 v[240:243], v[40:43], a[8:11], v[240:243]
    v_cvt_pk_bf16_f32 v129, v130, v131
    v_cvt_pk_bf16_f32 v130, v132, v133
    v_mfma_f32_16x16x32_bf16 v[248:251], v[40:43], a[12:15], v[248:251]
    s_add_u32 s63, s56, 0
    v_cvt_pk_bf16_f32 v131, v134, v135
    v_mfma_f32_16x16x32_bf16 v[232:235], a[0:3], v[44:47], v[232:235]
    ds_read_b128 v[32:35], v16 offset:57344
    v_mfma_f32_16x16x32_bf16 v[236:239], a[4:7], v[44:47], v[236:239]
    buffer_store_dwordx4 v[128:131], v2, s[44:47], s63 offen sc1
    v_mfma_f32_16x16x32_bf16 v[244:247], v[44:47], a[8:11], v[244:247]
    v_mfma_f32_16x16x32_bf16 v[252:255], v[44:47], a[12:15], v[252:255]
    s_waitcnt lgkmcnt(3)
    v_mfma_f32_16x16x32_bf16 v[192:195], a[16:19], v[48:51], v[192:195]
    ds_read_b128 v[36:39], v16 offset:57856
    v_mfma_f32_16x16x32_bf16 v[196:199], a[20:23], v[48:51], v[196:199]
    buffer_load_dwordx4 v6, s[28:31], s60 offen offset:2048  lds
    v_mfma_f32_16x16x32_bf16 v[208:211], v[48:51], a[24:27], v[208:211]
    v_mfma_f32_16x16x32_bf16 v[216:219], v[48:51], a[28:31], v[216:219]
    v_mfma_f32_16x16x32_bf16 v[200:203], a[16:19], v[52:55], v[200:203]
    ds_read_b128 v[40:43], v16 offset:61440
    v_mfma_f32_16x16x32_bf16 v[204:207], a[20:23], v[52:55], v[204:207]
    buffer_load_dwordx4 v[76:79], v26, s[40:43], s62 offen offset:0 sc1
    v_mfma_f32_16x16x32_bf16 v[212:215], v[52:55], a[24:27], v[212:215]
    v_mfma_f32_16x16x32_bf16 v[220:223], v[52:55], a[28:31], v[220:223]
    s_waitcnt lgkmcnt(3)
    v_mfma_f32_16x16x32_bf16 v[224:227], a[16:19], v[56:59], v[224:227]
    ds_read_b128 v[44:47], v16 offset:61952
    v_mfma_f32_16x16x32_bf16 v[228:231], a[20:23], v[56:59], v[228:231]
    buffer_load_dwordx4 v7, s[28:31], s60 offen offset:3072  lds
    v_mfma_f32_16x16x32_bf16 v[240:243], v[56:59], a[24:27], v[240:243]
    s_add_u32 m0, s55, 32768
    s_xor_b32 s60, s27, 1048576
    v_mfma_f32_16x16x32_bf16 v[248:251], v[56:59], a[28:31], v[248:251]
    v_mfma_f32_16x16x32_bf16 v[232:235], a[16:19], v[60:63], v[232:235]
    ds_read_b128 v[48:51], v17 offset:57344
    v_cvt_pk_bf16_f32 v136, v136, v137
    v_mfma_f32_16x16x32_bf16 v[236:239], a[20:23], v[60:63], v[236:239]
    buffer_load_dwordx4 v4, s[28:31], s60 offen offset:0  lds
    v_mfma_f32_16x16x32_bf16 v[244:247], v[60:63], a[24:27], v[244:247]
    v_cvt_pk_bf16_f32 v137, v138, v139
    v_cvt_pk_bf16_f32 v138, v140, v141
    v_mfma_f32_16x16x32_bf16 v[252:255], v[60:63], a[28:31], v[252:255]
    s_add_u32 s63, s56, 4096
    s_waitcnt lgkmcnt(3)
    v_cvt_pk_bf16_f32 v139, v142, v143
    v_mfma_f32_16x16x32_bf16 v[192:195], a[32:35], v[32:35], v[192:195]
    ds_read_b128 v[52:55], v17 offset:57856
    v_mfma_f32_16x16x32_bf16 v[196:199], a[36:39], v[32:35], v[196:199]
    buffer_store_dwordx4 v[136:139], v2, s[44:47], s63 offen sc1
    v_mfma_f32_16x16x32_bf16 v[208:211], v[32:35], a[40:43], v[208:211]
    v_mfma_f32_16x16x32_bf16 v[216:219], v[32:35], a[44:47], v[216:219]
    v_mfma_f32_16x16x32_bf16 v[200:203], a[32:35], v[36:39], v[200:203]
    ds_read_b128 v[56:59], v17 offset:61440
    v_mfma_f32_16x16x32_bf16 v[204:207], a[36:39], v[36:39], v[204:207]
    buffer_load_dwordx4 v5, s[28:31], s60 offen offset:1024  lds
    v_mfma_f32_16x16x32_bf16 v[212:215], v[36:39], a[40:43], v[212:215]
    v_mfma_f32_16x16x32_bf16 v[220:223], v[36:39], a[44:47], v[220:223]
    s_waitcnt lgkmcnt(3)
    v_mfma_f32_16x16x32_bf16 v[224:227], a[32:35], v[40:43], v[224:227]
    ds_read_b128 v[60:63], v17 offset:61952
    v_mfma_f32_16x16x32_bf16 v[228:231], a[36:39], v[40:43], v[228:231]
    buffer_load_dwordx4 v[80:83], v2, s[40:43], s61 offen offset:1024 sc1
    v_mfma_f32_16x16x32_bf16 v[240:243], v[40:43], a[40:43], v[240:243]
    v_mfma_f32_16x16x32_bf16 v[248:251], v[40:43], a[44:47], v[248:251]
    s_waitcnt vmcnt(33)
    s_barrier
    v_mfma_f32_16x16x32_bf16 v[232:235], a[32:35], v[44:47], v[232:235]
    v_add_u32 v16, 0x10000, v16
    ds_read_b128 v[32:35], v16 offset:32768
    v_add_u32 v17, 0x10000, v17
    v_mfma_f32_16x16x32_bf16 v[236:239], a[36:39], v[44:47], v[236:239]
    buffer_load_dwordx4 v6, s[28:31], s60 offen offset:2048  lds
    v_mfma_f32_16x16x32_bf16 v[244:247], v[44:47], a[40:43], v[244:247]
    v_mfma_f32_16x16x32_bf16 v[252:255], v[44:47], a[44:47], v[252:255]
    s_waitcnt lgkmcnt(3)
    v_mfma_f32_16x16x32_bf16 v[192:195], a[48:51], v[48:51], v[192:195]
    ds_read_b128 v[36:39], v16 offset:33280
    v_cvt_pk_bf16_f32 v144, v144, v145
    v_mfma_f32_16x16x32_bf16 v[196:199], a[52:55], v[48:51], v[196:199]
    buffer_load_dwordx4 v7, s[28:31], s60 offen offset:3072  lds
    v_mfma_f32_16x16x32_bf16 v[208:211], v[48:51], a[56:59], v[208:211]
    s_add_u32 m0, s55, 81920
    s_xor_b32 s60, s27, 1572864
    v_cvt_pk_bf16_f32 v145, v146, v147
    v_mfma_f32_16x16x32_bf16 v[216:219], v[48:51], a[60:63], v[216:219]
    v_cvt_pk_bf16_f32 v146, v148, v149
    v_cvt_pk_bf16_f32 v147, v150, v151
    v_mfma_f32_16x16x32_bf16 v[200:203], a[48:51], v[52:55], v[200:203]
    s_add_u32 s63, s57, 0
    ds_read_b128 v[40:43], v16 offset:36864
    v_mfma_f32_16x16x32_bf16 v[204:207], a[52:55], v[52:55], v[204:207]
    buffer_store_dwordx4 v[144:147], v2, s[48:51], s63 offen sc1
    v_mfma_f32_16x16x32_bf16 v[212:215], v[52:55], a[56:59], v[212:215]
    v_mfma_f32_16x16x32_bf16 v[220:223], v[52:55], a[60:63], v[220:223]
    s_waitcnt lgkmcnt(3)
    v_mfma_f32_16x16x32_bf16 v[224:227], a[48:51], v[56:59], v[224:227]
    ds_read_b128 v[44:47], v16 offset:37376
    v_mfma_f32_16x16x32_bf16 v[228:231], a[52:55], v[56:59], v[228:231]
    buffer_load_dwordx4 v4, s[28:31], s60 offen offset:0  lds
    v_mfma_f32_16x16x32_bf16 v[240:243], v[56:59], a[56:59], v[240:243]
    v_mfma_f32_16x16x32_bf16 v[248:251], v[56:59], a[60:63], v[248:251]
    v_mfma_f32_16x16x32_bf16 v[232:235], a[48:51], v[60:63], v[232:235]
    ds_read_b128 v[48:51], v17 offset:32768
    v_mfma_f32_16x16x32_bf16 v[236:239], a[52:55], v[60:63], v[236:239]
    buffer_load_dwordx4 v[84:87], v26, s[40:43], s61 offen offset:1024 sc1
    v_mfma_f32_16x16x32_bf16 v[244:247], v[60:63], a[56:59], v[244:247]
    v_mfma_f32_16x16x32_bf16 v[252:255], v[60:63], a[60:63], v[252:255]
    s_waitcnt lgkmcnt(3)
    v_mfma_f32_16x16x32_bf16 v[192:195], a[64:67], v[32:35], v[192:195]
    ds_read_b128 v[52:55], v17 offset:33280
    v_mfma_f32_16x16x32_bf16 v[196:199], a[68:71], v[32:35], v[196:199]
    buffer_load_dwordx4 v5, s[28:31], s60 offen offset:1024  lds
    v_mfma_f32_16x16x32_bf16 v[208:211], v[32:35], a[72:75], v[208:211]
    v_mfma_f32_16x16x32_bf16 v[216:219], v[32:35], a[76:79], v[216:219]
    v_mfma_f32_16x16x32_bf16 v[200:203], a[64:67], v[36:39], v[200:203]
    ds_read_b128 v[56:59], v17 offset:36864
    v_cvt_pk_bf16_f32 v152, v152, v153
    v_mfma_f32_16x16x32_bf16 v[204:207], a[68:71], v[36:39], v[204:207]
    buffer_load_dwordx4 v6, s[28:31], s60 offen offset:2048  lds
    v_mfma_f32_16x16x32_bf16 v[212:215], v[36:39], a[72:75], v[212:215]
    v_cvt_pk_bf16_f32 v153, v154, v155
    v_cvt_pk_bf16_f32 v154, v156, v157
    v_mfma_f32_16x16x32_bf16 v[220:223], v[36:39], a[76:79], v[220:223]
    s_add_u32 s63, s57, 1024
    s_waitcnt lgkmcnt(3)
    v_cvt_pk_bf16_f32 v155, v158, v159
    v_mfma_f32_16x16x32_bf16 v[224:227], a[64:67], v[40:43], v[224:227]
    ds_read_b128 v[60:63], v17 offset:37376
    v_mfma_f32_16x16x32_bf16 v[228:231], a[68:71], v[40:43], v[228:231]
    buffer_store_dwordx4 v[152:155], v2, s[48:51], s63 offen sc1
    v_mfma_f32_16x16x32_bf16 v[240:243], v[40:43], a[72:75], v[240:243]
    v_mfma_f32_16x16x32_bf16 v[248:251], v[40:43], a[76:79], v[248:251]
    v_mfma_f32_16x16x32_bf16 v[232:235], a[64:67], v[44:47], v[232:235]
    ds_read_b128 v[32:35], v16 offset:40960
    v_mfma_f32_16x16x32_bf16 v[236:239], a[68:71], v[44:47], v[236:239]
    buffer_load_dwordx4 v7, s[28:31], s60 offen offset:3072  lds
    v_mfma_f32_16x16x32_bf16 v[244:247], v[44:47], a[72:75], v[244:247]
    v_mfma_f32_16x16x32_bf16 v[252:255], v[44:47], a[76:79], v[252:255]
    s_waitcnt lgkmcnt(3)
    v_mfma_f32_16x16x32_bf16 v[192:195], a[80:83], v[48:51], v[192:195]
    ds_read_b128 v[36:39], v16 offset:41472
    v_mfma_f32_16x16x32_bf16 v[196:199], a[84:87], v[48:51], v[196:199]
    buffer_load_dwordx4 v[88:91], v2, s[40:43], s62 offen offset:1024 sc1
    v_mfma_f32_16x16x32_bf16 v[208:211], v[48:51], a[88:91], v[208:211]
    v_mfma_f32_16x16x32_bf16 v[216:219], v[48:51], a[92:95], v[216:219]
    v_mfma_f32_16x16x32_bf16 v[200:203], a[80:83], v[52:55], v[200:203]
    ds_read_b128 v[40:43], v16 offset:45056
    v_mfma_f32_16x16x32_bf16 v[204:207], a[84:87], v[52:55], v[204:207]
    v_mfma_f32_16x16x32_bf16 v[212:215], v[52:55], a[88:91], v[212:215]
    v_mfma_f32_16x16x32_bf16 v[220:223], v[52:55], a[92:95], v[220:223]
    s_waitcnt lgkmcnt(3)
    v_mfma_f32_16x16x32_bf16 v[224:227], a[80:83], v[56:59], v[224:227]
    ds_read_b128 v[44:47], v16 offset:45568
    v_cvt_pk_bf16_f32 v160, v160, v161
    v_mfma_f32_16x16x32_bf16 v[228:231], a[84:87], v[56:59], v[228:231]
    v_cvt_pk_bf16_f32 v161, v162, v163
    v_cvt_pk_bf16_f32 v162, v164, v165
    v_mfma_f32_16x16x32_bf16 v[240:243], v[56:59], a[88:91], v[240:243]
    s_add_u32 s63, s56, 8192
    v_cvt_pk_bf16_f32 v163, v166, v167
    v_mfma_f32_16x16x32_bf16 v[248:251], v[56:59], a[92:95], v[248:251]
    buffer_store_dwordx4 v[160:163], v2, s[44:47], s63 offen sc1
    v_mfma_f32_16x16x32_bf16 v[232:235], a[80:83], v[60:63], v[232:235]
    ds_read_b128 v[48:51], v17 offset:40960
    v_mfma_f32_16x16x32_bf16 v[236:239], a[84:87], v[60:63], v[236:239]
    v_mfma_f32_16x16x32_bf16 v[244:247], v[60:63], a[88:91], v[244:247]
    v_mfma_f32_16x16x32_bf16 v[252:255], v[60:63], a[92:95], v[252:255]
    s_waitcnt lgkmcnt(3)
    v_mfma_f32_16x16x32_bf16 v[192:195], a[96:99], v[32:35], v[192:195]
    ds_read_b128 v[52:55], v17 offset:41472
    v_mfma_f32_16x16x32_bf16 v[196:199], a[100:103], v[32:35], v[196:199]
    v_mfma_f32_16x16x32_bf16 v[208:211], v[32:35], a[104:107], v[208:211]
    v_mfma_f32_16x16x32_bf16 v[216:219], v[32:35], a[108:111], v[216:219]
    v_mfma_f32_16x16x32_bf16 v[200:203], a[96:99], v[36:39], v[200:203]
    ds_read_b128 v[56:59], v17 offset:45056
    v_mfma_f32_16x16x32_bf16 v[204:207], a[100:103], v[36:39], v[204:207]
    buffer_load_dwordx4 v[92:95], v26, s[40:43], s62 offen offset:1024 sc1
    v_mfma_f32_16x16x32_bf16 v[212:215], v[36:39], a[104:107], v[212:215]
    v_mfma_f32_16x16x32_bf16 v[220:223], v[36:39], a[108:111], v[220:223]
    s_waitcnt lgkmcnt(3)
    v_mfma_f32_16x16x32_bf16 v[224:227], a[96:99], v[40:43], v[224:227]
    ds_read_b128 v[60:63], v17 offset:45568
    v_mfma_f32_16x16x32_bf16 v[228:231], a[100:103], v[40:43], v[228:231]
    v_mfma_f32_16x16x32_bf16 v[240:243], v[40:43], a[104:107], v[240:243]
    v_mfma_f32_16x16x32_bf16 v[248:251], v[40:43], a[108:111], v[248:251]
    v_cvt_pk_bf16_f32 v168, v168, v169
    v_cvt_pk_bf16_f32 v169, v170, v171
    v_cvt_pk_bf16_f32 v170, v172, v173
    v_cvt_pk_bf16_f32 v171, v174, v175
    s_add_u32 s63, s56, 12288
    buffer_store_dwordx4 v[168:171], v2, s[44:47], s63 offen sc1
    s_waitcnt vmcnt(42)
    s_barrier
    v_mfma_f32_16x16x32_bf16 v[232:235], a[96:99], v[44:47], v[232:235]
    s_add_u32 m0, s55, 49152
    ds_read_b128 v[32:35], v16 offset:49152
    v_mfma_f32_16x16x32_bf16 v[236:239], a[100:103], v[44:47], v[236:239]
    s_xor_b32 s60, s27, 2097152
    buffer_load_dwordx4 v4, s[28:31], s60 offen offset:0  lds
    v_mfma_f32_16x16x32_bf16 v[244:247], v[44:47], a[104:107], v[244:247]
    v_mfma_f32_16x16x32_bf16 v[252:255], v[44:47], a[108:111], v[252:255]
    s_waitcnt lgkmcnt(2)
    v_mfma_f32_16x16x32_bf16 v[192:195], a[112:115], v[48:51], v[192:195]
    ds_read_b128 v[36:39], v16 offset:49664
    v_mfma_f32_16x16x32_bf16 v[196:199], a[116:119], v[48:51], v[196:199]
    buffer_load_dwordx4 v5, s[28:31], s60 offen offset:1024  lds
    v_mfma_f32_16x16x32_bf16 v[208:211], v[48:51], a[120:123], v[208:211]
    v_mfma_f32_16x16x32_bf16 v[216:219], v[48:51], a[124:127], v[216:219]
    v_mfma_f32_16x16x32_bf16 v[200:203], a[112:115], v[52:55], v[200:203]
    ds_read_b128 v[40:43], v16 offset:53248
    v_mfma_f32_16x16x32_bf16 v[204:207], a[116:119], v[52:55], v[204:207]
    buffer_load_dwordx4 v6, s[28:31], s60 offen offset:2048  lds
    v_mfma_f32_16x16x32_bf16 v[212:215], v[52:55], a[120:123], v[212:215]
    v_mfma_f32_16x16x32_bf16 v[220:223], v[52:55], a[124:127], v[220:223]
    v_mfma_f32_16x16x32_bf16 v[224:227], a[112:115], v[56:59], v[224:227]
    s_xor_b32 s61, s24, 2048
    ds_read_b128 v[44:47], v16 offset:53760
    v_mfma_f32_16x16x32_bf16 v[228:231], a[116:119], v[56:59], v[228:231]
    s_xor_b32 s62, s25, 2048
    buffer_load_dwordx4 v[96:99], v2, s[40:43], s61 offen offset:0 sc1
    v_mfma_f32_16x16x32_bf16 v[240:243], v[56:59], a[120:123], v[240:243]
    v_mfma_f32_16x16x32_bf16 v[248:251], v[56:59], a[124:127], v[248:251]
    s_waitcnt lgkmcnt(3)
    v_mfma_f32_16x16x32_bf16 v[232:235], a[112:115], v[60:63], v[232:235]
    ds_read_b128 v[48:51], v17 offset:49152
    v_mfma_f32_16x16x32_bf16 v[236:239], a[116:119], v[60:63], v[236:239]
    buffer_load_dwordx4 v7, s[28:31], s60 offen offset:3072  lds
    v_mfma_f32_16x16x32_bf16 v[244:247], v[60:63], a[120:123], v[244:247]
    v_mfma_f32_16x16x32_bf16 v[252:255], v[60:63], a[124:127], v[252:255]
    v_mfma_f32_16x16x32_bf16 a[128:131], a[0:3], v[32:35], a[128:131]
    ds_read_b128 v[52:55], v17 offset:49664
    v_cvt_pk_bf16_f32 v176, v176, v177
    v_mfma_f32_16x16x32_bf16 a[132:135], a[4:7], v[32:35], a[132:135]
    v_cvt_pk_bf16_f32 v177, v178, v179
    v_cvt_pk_bf16_f32 v178, v180, v181
    v_mfma_f32_16x16x32_bf16 a[144:147], v[32:35], a[8:11], a[144:147]
    s_add_u32 s63, s57, 8192
    v_cvt_pk_bf16_f32 v179, v182, v183
    v_mfma_f32_16x16x32_bf16 a[152:155], v[32:35], a[12:15], a[152:155]
    s_waitcnt lgkmcnt(3)
    buffer_store_dwordx4 v[176:179], v2, s[48:51], s63 offen sc1
    v_mfma_f32_16x16x32_bf16 a[136:139], a[0:3], v[36:39], a[136:139]
    ds_read_b128 v[56:59], v17 offset:53248
    v_mfma_f32_16x16x32_bf16 a[140:143], a[4:7], v[36:39], a[140:143]
    v_mfma_f32_16x16x32_bf16 a[148:151], v[36:39], a[8:11], a[148:151]
    v_mfma_f32_16x16x32_bf16 a[156:159], v[36:39], a[12:15], a[156:159]
    v_mfma_f32_16x16x32_bf16 a[160:163], a[0:3], v[40:43], a[160:163]
    ds_read_b128 v[60:63], v17 offset:53760
    v_mfma_f32_16x16x32_bf16 a[164:167], a[4:7], v[40:43], a[164:167]
    v_mfma_f32_16x16x32_bf16 a[176:179], v[40:43], a[8:11], a[176:179]
    v_mfma_f32_16x16x32_bf16 a[184:187], v[40:43], a[12:15], a[184:187]
    s_waitcnt lgkmcnt(3)
    v_mfma_f32_16x16x32_bf16 a[168:171], a[0:3], v[44:47], a[168:171]
    ds_read_b128 v[32:35], v16 offset:57344
    v_mfma_f32_16x16x32_bf16 a[172:175], a[4:7], v[44:47], a[172:175]
    buffer_load_dwordx4 v[100:103], v26, s[40:43], s61 offen offset:0 sc1
    v_mfma_f32_16x16x32_bf16 a[180:183], v[44:47], a[8:11], a[180:183]
    v_mfma_f32_16x16x32_bf16 a[188:191], v[44:47], a[12:15], a[188:191]
    v_mfma_f32_16x16x32_bf16 a[128:131], a[16:19], v[48:51], a[128:131]
    ds_read_b128 v[36:39], v16 offset:57856
    v_mfma_f32_16x16x32_bf16 a[132:135], a[20:23], v[48:51], a[132:135]
    v_mfma_f32_16x16x32_bf16 a[144:147], v[48:51], a[24:27], a[144:147]
    v_mfma_f32_16x16x32_bf16 a[152:155], v[48:51], a[28:31], a[152:155]
    s_waitcnt lgkmcnt(3)
    v_mfma_f32_16x16x32_bf16 a[136:139], a[16:19], v[52:55], a[136:139]
    ds_read_b128 v[40:43], v16 offset:61440
    v_cvt_pk_bf16_f32 v184, v184, v185
    v_mfma_f32_16x16x32_bf16 a[140:143], a[20:23], v[52:55], a[140:143]
    v_cvt_pk_bf16_f32 v185, v186, v187
    v_cvt_pk_bf16_f32 v186, v188, v189
    v_mfma_f32_16x16x32_bf16 a[148:151], v[52:55], a[24:27], a[148:151]
    s_add_u32 s63, s57, 9216
    v_cvt_pk_bf16_f32 v187, v190, v191
    v_mfma_f32_16x16x32_bf16 a[156:159], v[52:55], a[28:31], a[156:159]
    buffer_store_dwordx4 v[184:187], v2, s[48:51], s63 offen sc1
    v_mfma_f32_16x16x32_bf16 a[160:163], a[16:19], v[56:59], a[160:163]
    ds_read_b128 v[44:47], v16 offset:61952
    v_mfma_f32_16x16x32_bf16 a[164:167], a[20:23], v[56:59], a[164:167]
    v_mfma_f32_16x16x32_bf16 a[176:179], v[56:59], a[24:27], a[176:179]
    v_mfma_f32_16x16x32_bf16 a[184:187], v[56:59], a[28:31], a[184:187]
    s_waitcnt lgkmcnt(3)
    v_mfma_f32_16x16x32_bf16 a[168:171], a[16:19], v[60:63], a[168:171]
    ds_read_b128 v[48:51], v17 offset:57344
    v_mfma_f32_16x16x32_bf16 a[172:175], a[20:23], v[60:63], a[172:175]
    v_mfma_f32_16x16x32_bf16 a[180:183], v[60:63], a[24:27], a[180:183]
    v_mfma_f32_16x16x32_bf16 a[188:191], v[60:63], a[28:31], a[188:191]
    v_mfma_f32_16x16x32_bf16 a[128:131], a[32:35], v[32:35], a[128:131]
    ds_read_b128 v[52:55], v17 offset:57856
    v_mfma_f32_16x16x32_bf16 a[132:135], a[36:39], v[32:35], a[132:135]
    buffer_load_dwordx4 v[104:107], v2, s[40:43], s62 offen offset:0 sc1
    v_mfma_f32_16x16x32_bf16 a[144:147], v[32:35], a[40:43], a[144:147]
    v_mfma_f32_16x16x32_bf16 a[152:155], v[32:35], a[44:47], a[152:155]
    s_waitcnt lgkmcnt(3)
    v_mfma_f32_16x16x32_bf16 a[136:139], a[32:35], v[36:39], a[136:139]
    ds_read_b128 v[56:59], v17 offset:61440
    v_mfma_f32_16x16x32_bf16 a[140:143], a[36:39], v[36:39], a[140:143]
    v_mfma_f32_16x16x32_bf16 a[148:151], v[36:39], a[40:43], a[148:151]
    v_mfma_f32_16x16x32_bf16 a[156:159], v[36:39], a[44:47], a[156:159]
    v_mfma_f32_16x16x32_bf16 a[160:163], a[32:35], v[40:43], a[160:163]
    ds_read_b128 v[60:63], v17 offset:61952
    v_cvt_pk_bf16_f32 v192, v192, v193
    v_mfma_f32_16x16x32_bf16 a[164:167], a[36:39], v[40:43], a[164:167]
    v_cvt_pk_bf16_f32 v193, v194, v195
    v_cvt_pk_bf16_f32 v194, v196, v197
    v_mfma_f32_16x16x32_bf16 a[176:179], v[40:43], a[40:43], a[176:179]
    s_add_u32 s63, s56, 16384
    v_cvt_pk_bf16_f32 v195, v198, v199
    v_mfma_f32_16x16x32_bf16 a[184:187], v[40:43], a[44:47], a[184:187]
    s_waitcnt vmcnt(47)
    buffer_store_dwordx4 v[192:195], v2, s[44:47], s63 offen sc1
    s_barrier
    s_waitcnt lgkmcnt(3)
    v_mfma_f32_16x16x32_bf16 a[168:171], a[32:35], v[44:47], a[168:171]
    s_add_u32 m0, s55, 98304
    v_add_u32 v16, 0x10000, v16
    ds_read_b128 v[32:35], v16 offset:0
    v_add_u32 v17, 0x10000, v17
    v_mfma_f32_16x16x32_bf16 a[172:175], a[36:39], v[44:47], a[172:175]
    s_xor_b32 s60, s27, 2621440
    v_mfma_f32_16x16x32_bf16 a[180:183], v[44:47], a[40:43], a[180:183]
    v_mfma_f32_16x16x32_bf16 a[188:191], v[44:47], a[44:47], a[188:191]
    buffer_load_dwordx4 v4, s[28:31], s60 offen offset:0  lds
    v_mfma_f32_16x16x32_bf16 a[128:131], a[48:51], v[48:51], a[128:131]
    ds_read_b128 v[36:39], v16 offset:512
    v_mfma_f32_16x16x32_bf16 a[132:135], a[52:55], v[48:51], a[132:135]
    v_mfma_f32_16x16x32_bf16 a[144:147], v[48:51], a[56:59], a[144:147]
    v_mfma_f32_16x16x32_bf16 a[152:155], v[48:51], a[60:63], a[152:155]
    s_waitcnt lgkmcnt(3)
    buffer_load_dwordx4 v5, s[28:31], s60 offen offset:1024  lds
    v_mfma_f32_16x16x32_bf16 a[136:139], a[48:51], v[52:55], a[136:139]
    ds_read_b128 v[40:43], v16 offset:4096
    v_mfma_f32_16x16x32_bf16 a[140:143], a[52:55], v[52:55], a[140:143]
    v_mfma_f32_16x16x32_bf16 a[148:151], v[52:55], a[56:59], a[148:151]
    v_mfma_f32_16x16x32_bf16 a[156:159], v[52:55], a[60:63], a[156:159]
    buffer_load_dwordx4 v[108:111], v26, s[40:43], s62 offen offset:0 sc1
    v_mfma_f32_16x16x32_bf16 a[160:163], a[48:51], v[56:59], a[160:163]
    ds_read_b128 v[44:47], v16 offset:4608
    v_mfma_f32_16x16x32_bf16 a[164:167], a[52:55], v[56:59], a[164:167]
    v_mfma_f32_16x16x32_bf16 a[176:179], v[56:59], a[56:59], a[176:179]
    v_mfma_f32_16x16x32_bf16 a[184:187], v[56:59], a[60:63], a[184:187]
    s_waitcnt lgkmcnt(3)
    buffer_load_dwordx4 v6, s[28:31], s60 offen offset:2048  lds
    v_mfma_f32_16x16x32_bf16 a[168:171], a[48:51], v[60:63], a[168:171]
    ds_read_b128 v[48:51], v17 offset:0
    v_cvt_pk_bf16_f32 v200, v200, v201
    v_mfma_f32_16x16x32_bf16 a[172:175], a[52:55], v[60:63], a[172:175]
    v_cvt_pk_bf16_f32 v201, v202, v203
    v_cvt_pk_bf16_f32 v202, v204, v205
    v_mfma_f32_16x16x32_bf16 a[180:183], v[60:63], a[56:59], a[180:183]
    s_add_u32 s63, s56, 20480
    v_cvt_pk_bf16_f32 v203, v206, v207
    v_mfma_f32_16x16x32_bf16 a[188:191], v[60:63], a[60:63], a[188:191]
    buffer_store_dwordx4 v[200:203], v2, s[44:47], s63 offen sc1
    v_mfma_f32_16x16x32_bf16 a[128:131], a[64:67], v[32:35], a[128:131]
    ds_read_b128 v[52:55], v17 offset:512
    v_mfma_f32_16x16x32_bf16 a[132:135], a[68:71], v[32:35], a[132:135]
    v_mfma_f32_16x16x32_bf16 a[144:147], v[32:35], a[72:75], a[144:147]
    v_mfma_f32_16x16x32_bf16 a[152:155], v[32:35], a[76:79], a[152:155]
    s_waitcnt lgkmcnt(3)
    buffer_load_dwordx4 v7, s[28:31], s60 offen offset:3072  lds
    v_mfma_f32_16x16x32_bf16 a[136:139], a[64:67], v[36:39], a[136:139]
    ds_read_b128 v[56:59], v17 offset:4096
    v_mfma_f32_16x16x32_bf16 a[140:143], a[68:71], v[36:39], a[140:143]
    v_mfma_f32_16x16x32_bf16 a[148:151], v[36:39], a[72:75], a[148:151]
    v_mfma_f32_16x16x32_bf16 a[156:159], v[36:39], a[76:79], a[156:159]
    v_mfma_f32_16x16x32_bf16 a[160:163], a[64:67], v[40:43], a[160:163]
    ds_read_b128 v[60:63], v17 offset:4608
    v_mfma_f32_16x16x32_bf16 a[164:167], a[68:71], v[40:43], a[164:167]
    buffer_load_dwordx4 v[112:115], v2, s[40:43], s61 offen offset:1024 sc1
    v_mfma_f32_16x16x32_bf16 a[176:179], v[40:43], a[72:75], a[176:179]
    v_mfma_f32_16x16x32_bf16 a[184:187], v[40:43], a[76:79], a[184:187]
    s_waitcnt lgkmcnt(3)
    v_mfma_f32_16x16x32_bf16 a[168:171], a[64:67], v[44:47], a[168:171]
    ds_read_b128 v[32:35], v16 offset:8192
    v_mfma_f32_16x16x32_bf16 a[172:175], a[68:71], v[44:47], a[172:175]
    v_mfma_f32_16x16x32_bf16 a[180:183], v[44:47], a[72:75], a[180:183]
    v_mfma_f32_16x16x32_bf16 a[188:191], v[44:47], a[76:79], a[188:191]
    v_mfma_f32_16x16x32_bf16 a[128:131], a[80:83], v[48:51], a[128:131]
    ds_read_b128 v[36:39], v16 offset:8704
    v_cvt_pk_bf16_f32 v208, v208, v209
    v_mfma_f32_16x16x32_bf16 a[132:135], a[84:87], v[48:51], a[132:135]
    v_cvt_pk_bf16_f32 v209, v210, v211
    v_cvt_pk_bf16_f32 v210, v212, v213
    v_mfma_f32_16x16x32_bf16 a[144:147], v[48:51], a[88:91], a[144:147]
    s_add_u32 s63, s57, 16384
    v_cvt_pk_bf16_f32 v211, v214, v215
    v_mfma_f32_16x16x32_bf16 a[152:155], v[48:51], a[92:95], a[152:155]
    s_waitcnt lgkmcnt(3)
    buffer_store_dwordx4 v[208:211], v2, s[48:51], s63 offen sc1
    v_mfma_f32_16x16x32_bf16 a[136:139], a[80:83], v[52:55], a[136:139]
    ds_read_b128 v[40:43], v16 offset:12288
    v_mfma_f32_16x16x32_bf16 a[140:143], a[84:87], v[52:55], a[140:143]
    v_mfma_f32_16x16x32_bf16 a[148:151], v[52:55], a[88:91], a[148:151]
    v_mfma_f32_16x16x32_bf16 a[156:159], v[52:55], a[92:95], a[156:159]
    v_mfma_f32_16x16x32_bf16 a[160:163], a[80:83], v[56:59], a[160:163]
    ds_read_b128 v[44:47], v16 offset:12800
    v_mfma_f32_16x16x32_bf16 a[164:167], a[84:87], v[56:59], a[164:167]
    v_mfma_f32_16x16x32_bf16 a[176:179], v[56:59], a[88:91], a[176:179]
    v_mfma_f32_16x16x32_bf16 a[184:187], v[56:59], a[92:95], a[184:187]
    s_waitcnt lgkmcnt(3)
    v_mfma_f32_16x16x32_bf16 a[168:171], a[80:83], v[60:63], a[168:171]
    ds_read_b128 v[48:51], v17 offset:8192
    v_mfma_f32_16x16x32_bf16 a[172:175], a[84:87], v[60:63], a[172:175]
    buffer_load_dwordx4 v[116:119], v26, s[40:43], s61 offen offset:1024 sc1
    v_mfma_f32_16x16x32_bf16 a[180:183], v[60:63], a[88:91], a[180:183]
    v_mfma_f32_16x16x32_bf16 a[188:191], v[60:63], a[92:95], a[188:191]
    v_mfma_f32_16x16x32_bf16 a[128:131], a[96:99], v[32:35], a[128:131]
    ds_read_b128 v[52:55], v17 offset:8704
    v_mfma_f32_16x16x32_bf16 a[132:135], a[100:103], v[32:35], a[132:135]
    v_mfma_f32_16x16x32_bf16 a[144:147], v[32:35], a[104:107], a[144:147]
    v_mfma_f32_16x16x32_bf16 a[152:155], v[32:35], a[108:111], a[152:155]
    s_waitcnt lgkmcnt(3)
    v_mfma_f32_16x16x32_bf16 a[136:139], a[96:99], v[36:39], a[136:139]
    ds_read_b128 v[56:59], v17 offset:12288
    v_cvt_pk_bf16_f32 v216, v216, v217
    v_mfma_f32_16x16x32_bf16 a[140:143], a[100:103], v[36:39], a[140:143]
    v_cvt_pk_bf16_f32 v217, v218, v219
    v_cvt_pk_bf16_f32 v218, v220, v221
    v_mfma_f32_16x16x32_bf16 a[148:151], v[36:39], a[104:107], a[148:151]
    s_add_u32 s63, s57, 17408
    v_cvt_pk_bf16_f32 v219, v222, v223
    v_mfma_f32_16x16x32_bf16 a[156:159], v[36:39], a[108:111], a[156:159]
    buffer_store_dwordx4 v[216:219], v2, s[48:51], s63 offen sc1
    v_mfma_f32_16x16x32_bf16 a[160:163], a[96:99], v[40:43], a[160:163]
    ds_read_b128 v[60:63], v17 offset:12800
    v_mfma_f32_16x16x32_bf16 a[164:167], a[100:103], v[40:43], a[164:167]
    v_mfma_f32_16x16x32_bf16 a[176:179], v[40:43], a[104:107], a[176:179]
    v_mfma_f32_16x16x32_bf16 a[184:187], v[40:43], a[108:111], a[184:187]
    s_waitcnt vmcnt(54)
    s_barrier
    s_waitcnt lgkmcnt(3)
    v_mfma_f32_16x16x32_bf16 a[168:171], a[96:99], v[44:47], a[168:171]
    s_add_u32 m0, s55, 114688
    ds_read_b128 v[32:35], v16 offset:16384
    v_mfma_f32_16x16x32_bf16 a[172:175], a[100:103], v[44:47], a[172:175]
    s_xor_b32 s60, s27, 3145728
    buffer_load_dwordx4 v4, s[28:31], s60 offen offset:0  lds
    v_mfma_f32_16x16x32_bf16 a[180:183], v[44:47], a[104:107], a[180:183]
    v_mfma_f32_16x16x32_bf16 a[188:191], v[44:47], a[108:111], a[188:191]
    v_mfma_f32_16x16x32_bf16 a[128:131], a[112:115], v[48:51], a[128:131]
    ds_read_b128 v[36:39], v16 offset:16896
    v_mfma_f32_16x16x32_bf16 a[132:135], a[116:119], v[48:51], a[132:135]
    buffer_load_dwordx4 v[120:123], v2, s[40:43], s62 offen offset:1024 sc1
    v_mfma_f32_16x16x32_bf16 a[144:147], v[48:51], a[120:123], a[144:147]
    v_mfma_f32_16x16x32_bf16 a[152:155], v[48:51], a[124:127], a[152:155]
    s_waitcnt lgkmcnt(3)
    v_mfma_f32_16x16x32_bf16 a[136:139], a[112:115], v[52:55], a[136:139]
    ds_read_b128 v[40:43], v16 offset:20480
    v_mfma_f32_16x16x32_bf16 a[140:143], a[116:119], v[52:55], a[140:143]
    buffer_load_dwordx4 v5, s[28:31], s60 offen offset:1024  lds
    v_mfma_f32_16x16x32_bf16 a[148:151], v[52:55], a[120:123], a[148:151]
    v_mfma_f32_16x16x32_bf16 a[156:159], v[52:55], a[124:127], a[156:159]
    v_mfma_f32_16x16x32_bf16 a[160:163], a[112:115], v[56:59], a[160:163]
    ds_read_b128 v[44:47], v16 offset:20992
    v_cvt_pk_bf16_f32 v224, v224, v225
    v_mfma_f32_16x16x32_bf16 a[164:167], a[116:119], v[56:59], a[164:167]
    buffer_load_dwordx4 v6, s[28:31], s60 offen offset:2048  lds
    v_mfma_f32_16x16x32_bf16 a[176:179], v[56:59], a[120:123], a[176:179]
    v_cvt_pk_bf16_f32 v225, v226, v227
    v_cvt_pk_bf16_f32 v226, v228, v229
    v_mfma_f32_16x16x32_bf16 a[184:187], v[56:59], a[124:127], a[184:187]
    s_add_u32 s63, s56, 24576
    s_waitcnt lgkmcnt(3)
    v_cvt_pk_bf16_f32 v227, v230, v231
    v_mfma_f32_16x16x32_bf16 a[168:171], a[112:115], v[60:63], a[168:171]
    ds_read_b128 v[48:51], v17 offset:16384
    v_mfma_f32_16x16x32_bf16 a[172:175], a[116:119], v[60:63], a[172:175]
    buffer_store_dwordx4 v[224:227], v2, s[44:47], s63 offen sc1
    v_mfma_f32_16x16x32_bf16 a[180:183], v[60:63], a[120:123], a[180:183]
    v_mfma_f32_16x16x32_bf16 a[188:191], v[60:63], a[124:127], a[188:191]
    v_mfma_f32_16x16x32_bf16 a[192:195], a[0:3], v[32:35], a[192:195]
    ds_read_b128 v[52:55], v17 offset:16896
    v_mfma_f32_16x16x32_bf16 a[196:199], a[4:7], v[32:35], a[196:199]
    buffer_load_dwordx4 v7, s[28:31], s60 offen offset:3072  lds
    v_mfma_f32_16x16x32_bf16 a[208:211], v[32:35], a[8:11], a[208:211]
    v_mfma_f32_16x16x32_bf16 a[216:219], v[32:35], a[12:15], a[216:219]
    s_waitcnt lgkmcnt(3)
    v_mfma_f32_16x16x32_bf16 a[200:203], a[0:3], v[36:39], a[200:203]
    ds_read_b128 v[56:59], v17 offset:20480
    v_mfma_f32_16x16x32_bf16 a[204:207], a[4:7], v[36:39], a[204:207]
    buffer_load_dwordx4 v[124:127], v26, s[40:43], s62 offen offset:1024 sc1
    v_mfma_f32_16x16x32_bf16 a[212:215], v[36:39], a[8:11], a[212:215]
    v_mfma_f32_16x16x32_bf16 a[220:223], v[36:39], a[12:15], a[220:223]
    v_mfma_f32_16x16x32_bf16 a[224:227], a[0:3], v[40:43], a[224:227]
    ds_read_b128 v[60:63], v17 offset:20992
    v_mfma_f32_16x16x32_bf16 a[228:231], a[4:7], v[40:43], a[228:231]
    v_mfma_f32_16x16x32_bf16 a[240:243], v[40:43], a[8:11], a[240:243]
    v_mfma_f32_16x16x32_bf16 a[248:251], v[40:43], a[12:15], a[248:251]
    s_waitcnt lgkmcnt(3)
    v_mfma_f32_16x16x32_bf16 a[232:235], a[0:3], v[44:47], a[232:235]
    ds_read_b128 v[32:35], v16 offset:24576
    v_cvt_pk_bf16_f32 v232, v232, v233
    v_mfma_f32_16x16x32_bf16 a[236:239], a[4:7], v[44:47], a[236:239]
    v_cvt_pk_bf16_f32 v233, v234, v235
    v_cvt_pk_bf16_f32 v234, v236, v237
    v_mfma_f32_16x16x32_bf16 a[244:247], v[44:47], a[8:11], a[244:247]
    s_add_u32 s63, s56, 28672
    v_cvt_pk_bf16_f32 v235, v238, v239
    v_mfma_f32_16x16x32_bf16 a[252:255], v[44:47], a[12:15], a[252:255]
    buffer_store_dwordx4 v[232:235], v2, s[44:47], s63 offen sc1
    v_mfma_f32_16x16x32_bf16 a[192:195], a[16:19], v[48:51], a[192:195]
    ds_read_b128 v[36:39], v16 offset:25088
    v_mfma_f32_16x16x32_bf16 a[196:199], a[20:23], v[48:51], a[196:199]
    v_mfma_f32_16x16x32_bf16 a[208:211], v[48:51], a[24:27], a[208:211]
    v_mfma_f32_16x16x32_bf16 a[216:219], v[48:51], a[28:31], a[216:219]
    s_waitcnt lgkmcnt(3)
    v_mfma_f32_16x16x32_bf16 a[200:203], a[16:19], v[52:55], a[200:203]
    ds_read_b128 v[40:43], v16 offset:28672
    v_mfma_f32_16x16x32_bf16 a[204:207], a[20:23], v[52:55], a[204:207]
    v_mfma_f32_16x16x32_bf16 a[212:215], v[52:55], a[24:27], a[212:215]
    v_mfma_f32_16x16x32_bf16 a[220:223], v[52:55], a[28:31], a[220:223]
    v_mfma_f32_16x16x32_bf16 a[224:227], a[16:19], v[56:59], a[224:227]
    ds_read_b128 v[44:47], v16 offset:29184
    v_mfma_f32_16x16x32_bf16 a[228:231], a[20:23], v[56:59], a[228:231]
    v_mfma_f32_16x16x32_bf16 a[240:243], v[56:59], a[24:27], a[240:243]
    v_mfma_f32_16x16x32_bf16 a[248:251], v[56:59], a[28:31], a[248:251]
    s_waitcnt lgkmcnt(3)
    v_mfma_f32_16x16x32_bf16 a[232:235], a[16:19], v[60:63], a[232:235]
    ds_read_b128 v[48:51], v17 offset:24576
    v_mfma_f32_16x16x32_bf16 a[236:239], a[20:23], v[60:63], a[236:239]
    v_mfma_f32_16x16x32_bf16 a[244:247], v[60:63], a[24:27], a[244:247]
    v_mfma_f32_16x16x32_bf16 a[252:255], v[60:63], a[28:31], a[252:255]
    v_mfma_f32_16x16x32_bf16 a[192:195], a[32:35], v[32:35], a[192:195]
    ds_read_b128 v[52:55], v17 offset:25088
    v_cvt_pk_bf16_f32 v240, v240, v241
    v_mfma_f32_16x16x32_bf16 a[196:199], a[36:39], v[32:35], a[196:199]
    v_cvt_pk_bf16_f32 v241, v242, v243
    v_cvt_pk_bf16_f32 v242, v244, v245
    v_mfma_f32_16x16x32_bf16 a[208:211], v[32:35], a[40:43], a[208:211]
    s_add_u32 s63, s57, 24576
    v_cvt_pk_bf16_f32 v243, v246, v247
    v_mfma_f32_16x16x32_bf16 a[216:219], v[32:35], a[44:47], a[216:219]
    s_waitcnt lgkmcnt(3)
    buffer_store_dwordx4 v[240:243], v2, s[48:51], s63 offen sc1
    v_mfma_f32_16x16x32_bf16 a[200:203], a[32:35], v[36:39], a[200:203]
    ds_read_b128 v[56:59], v17 offset:28672
    v_mfma_f32_16x16x32_bf16 a[204:207], a[36:39], v[36:39], a[204:207]
    v_mfma_f32_16x16x32_bf16 a[212:215], v[36:39], a[40:43], a[212:215]
    v_mfma_f32_16x16x32_bf16 a[220:223], v[36:39], a[44:47], a[220:223]
    v_mfma_f32_16x16x32_bf16 a[224:227], a[32:35], v[40:43], a[224:227]
    ds_read_b128 v[60:63], v17 offset:29184
    v_mfma_f32_16x16x32_bf16 a[228:231], a[36:39], v[40:43], a[228:231]
    v_mfma_f32_16x16x32_bf16 a[240:243], v[40:43], a[40:43], a[240:243]
    v_mfma_f32_16x16x32_bf16 a[248:251], v[40:43], a[44:47], a[248:251]
    s_waitcnt vmcnt(58)
    s_barrier
    s_waitcnt lgkmcnt(3)
    v_mfma_f32_16x16x32_bf16 a[232:235], a[32:35], v[44:47], a[232:235]
    s_add_u32 m0, s55, 131072
    v_add_u32 v16, 0xfffe0000, v16
    ds_read_b128 v[32:35], v16 offset:0
    v_add_u32 v17, 0xfffe0000, v17
    v_mfma_f32_16x16x32_bf16 a[236:239], a[36:39], v[44:47], a[236:239]
    s_xor_b32 s60, s27, 3670016
    buffer_load_dwordx4 v4, s[28:31], s60 offen offset:0  lds
    v_mfma_f32_16x16x32_bf16 a[244:247], v[44:47], a[40:43], a[244:247]
    v_mfma_f32_16x16x32_bf16 a[252:255], v[44:47], a[44:47], a[252:255]
    v_mfma_f32_16x16x32_bf16 a[192:195], a[48:51], v[48:51], a[192:195]
    ds_read_b128 v[36:39], v16 offset:512
    v_mfma_f32_16x16x32_bf16 a[196:199], a[52:55], v[48:51], a[196:199]
    buffer_load_dwordx4 v5, s[28:31], s60 offen offset:1024  lds
    v_mfma_f32_16x16x32_bf16 a[208:211], v[48:51], a[56:59], a[208:211]
    v_mfma_f32_16x16x32_bf16 a[216:219], v[48:51], a[60:63], a[216:219]
    s_waitcnt lgkmcnt(3)
    v_mfma_f32_16x16x32_bf16 a[200:203], a[48:51], v[52:55], a[200:203]
    ds_read_b128 v[40:43], v16 offset:4096
    v_cvt_pk_bf16_f32 v248, v248, v249
    v_mfma_f32_16x16x32_bf16 a[204:207], a[52:55], v[52:55], a[204:207]
    buffer_load_dwordx4 v6, s[28:31], s60 offen offset:2048  lds
    v_mfma_f32_16x16x32_bf16 a[212:215], v[52:55], a[56:59], a[212:215]
    v_cvt_pk_bf16_f32 v249, v250, v251
    v_cvt_pk_bf16_f32 v250, v252, v253
    v_mfma_f32_16x16x32_bf16 a[220:223], v[52:55], a[60:63], a[220:223]
    s_add_u32 s63, s57, 25600
    v_cvt_pk_bf16_f32 v251, v254, v255
    v_mfma_f32_16x16x32_bf16 a[224:227], a[48:51], v[56:59], a[224:227]
    ds_read_b128 v[44:47], v16 offset:4608
    v_mfma_f32_16x16x32_bf16 a[228:231], a[52:55], v[56:59], a[228:231]
    buffer_store_dwordx4 v[248:251], v2, s[48:51], s63 offen sc1
    v_mfma_f32_16x16x32_bf16 a[240:243], v[56:59], a[56:59], a[240:243]
    v_mfma_f32_16x16x32_bf16 a[248:251], v[56:59], a[60:63], a[248:251]
    s_waitcnt lgkmcnt(3)
    v_mfma_f32_16x16x32_bf16 a[232:235], a[48:51], v[60:63], a[232:235]
    ds_read_b128 v[48:51], v17 offset:0
    v_mfma_f32_16x16x32_bf16 a[236:239], a[52:55], v[60:63], a[236:239]
    buffer_load_dwordx4 v7, s[28:31], s60 offen offset:3072  lds
    v_mfma_f32_16x16x32_bf16 a[244:247], v[60:63], a[56:59], a[244:247]
    v_mfma_f32_16x16x32_bf16 a[252:255], v[60:63], a[60:63], a[252:255]
    v_mfma_f32_16x16x32_bf16 a[192:195], a[64:67], v[32:35], a[192:195]
    s_xor_b32 s61, s24, 4096
    ds_read_b128 v[52:55], v17 offset:512
    v_mfma_f32_16x16x32_bf16 a[196:199], a[68:71], v[32:35], a[196:199]
    s_xor_b32 s62, s25, 4096
    buffer_load_dwordx4 a[0:3], v2, s[40:43], s61 offen offset:0 sc1
    v_mfma_f32_16x16x32_bf16 a[208:211], v[32:35], a[72:75], a[208:211]
    v_mfma_f32_16x16x32_bf16 a[216:219], v[32:35], a[76:79], a[216:219]
    s_waitcnt lgkmcnt(3)
    v_mfma_f32_16x16x32_bf16 a[200:203], a[64:67], v[36:39], a[200:203]
    ds_read_b128 v[56:59], v17 offset:4096
    v_mfma_f32_16x16x32_bf16 a[204:207], a[68:71], v[36:39], a[204:207]
    buffer_load_dwordx4 a[4:7], v26, s[40:43], s61 offen offset:0 sc1
    v_mfma_f32_16x16x32_bf16 a[212:215], v[36:39], a[72:75], a[212:215]
    v_mfma_f32_16x16x32_bf16 a[220:223], v[36:39], a[76:79], a[220:223]
    v_mfma_f32_16x16x32_bf16 a[224:227], a[64:67], v[40:43], a[224:227]
    ds_read_b128 v[60:63], v17 offset:4608
    v_accvgpr_read_b32 v18, a128
    v_mfma_f32_16x16x32_bf16 a[228:231], a[68:71], v[40:43], a[228:231]
    buffer_load_dwordx4 a[8:11], v2, s[40:43], s62 offen offset:0 sc1
    v_mfma_f32_16x16x32_bf16 a[240:243], v[40:43], a[72:75], a[240:243]
    v_accvgpr_read_b32 v19, a129
    v_cvt_pk_bf16_f32 v20, v18, v19
    v_mfma_f32_16x16x32_bf16 a[248:251], v[40:43], a[76:79], a[248:251]
    s_waitcnt lgkmcnt(3)
    v_accvgpr_read_b32 v18, a130
    v_accvgpr_read_b32 v19, a131
    v_mfma_f32_16x16x32_bf16 a[232:235], a[64:67], v[44:47], a[232:235]
    ds_read_b128 v[32:35], v16 offset:8192
    v_cvt_pk_bf16_f32 v21, v18, v19
    v_mfma_f32_16x16x32_bf16 a[236:239], a[68:71], v[44:47], a[236:239]
    buffer_load_dwordx4 a[12:15], v26, s[40:43], s62 offen offset:0 sc1
    v_mfma_f32_16x16x32_bf16 a[244:247], v[44:47], a[72:75], a[244:247]
    v_accvgpr_read_b32 v18, a132
    v_accvgpr_read_b32 v19, a133
    v_mfma_f32_16x16x32_bf16 a[252:255], v[44:47], a[76:79], a[252:255]
    v_cvt_pk_bf16_f32 v22, v18, v19
    v_accvgpr_read_b32 v18, a134
    v_mfma_f32_16x16x32_bf16 a[192:195], a[80:83], v[48:51], a[192:195]
    ds_read_b128 v[36:39], v16 offset:8704
    v_accvgpr_read_b32 v19, a135
    v_mfma_f32_16x16x32_bf16 a[196:199], a[84:87], v[48:51], a[196:199]
    buffer_load_dwordx4 a[16:19], v2, s[40:43], s61 offen offset:1024 sc1
    v_mfma_f32_16x16x32_bf16 a[208:211], v[48:51], a[88:91], a[208:211]
    s_add_u32 s63, s56, 32768
    v_cvt_pk_bf16_f32 v23, v18, v19
    v_mfma_f32_16x16x32_bf16 a[216:219], v[48:51], a[92:95], a[216:219]
    s_waitcnt lgkmcnt(3)
    v_mfma_f32_16x16x32_bf16 a[200:203], a[80:83], v[52:55], a[200:203]
    ds_read_b128 v[40:43], v16 offset:12288
    v_mfma_f32_16x16x32_bf16 a[204:207], a[84:87], v[52:55], a[204:207]
    buffer_store_dwordx4 v[20:23], v2, s[44:47], s63 offen sc1
    v_mfma_f32_16x16x32_bf16 a[212:215], v[52:55], a[88:91], a[212:215]
    v_mfma_f32_16x16x32_bf16 a[220:223], v[52:55], a[92:95], a[220:223]
    v_mfma_f32_16x16x32_bf16 a[224:227], a[80:83], v[56:59], a[224:227]
    ds_read_b128 v[44:47], v16 offset:12800
    v_mfma_f32_16x16x32_bf16 a[228:231], a[84:87], v[56:59], a[228:231]
    buffer_load_dwordx4 a[20:23], v26, s[40:43], s61 offen offset:1024 sc1
    v_mfma_f32_16x16x32_bf16 a[240:243], v[56:59], a[88:91], a[240:243]
    v_mfma_f32_16x16x32_bf16 a[248:251], v[56:59], a[92:95], a[248:251]
    s_waitcnt lgkmcnt(3)
    v_mfma_f32_16x16x32_bf16 a[232:235], a[80:83], v[60:63], a[232:235]
    ds_read_b128 v[48:51], v17 offset:8192
    v_accvgpr_read_b32 v18, a136
    v_mfma_f32_16x16x32_bf16 a[236:239], a[84:87], v[60:63], a[236:239]
    buffer_load_dwordx4 a[24:27], v2, s[40:43], s62 offen offset:1024 sc1
    v_mfma_f32_16x16x32_bf16 a[244:247], v[60:63], a[88:91], a[244:247]
    v_accvgpr_read_b32 v19, a137
    v_cvt_pk_bf16_f32 v20, v18, v19
    v_mfma_f32_16x16x32_bf16 a[252:255], v[60:63], a[92:95], a[252:255]
    v_accvgpr_read_b32 v18, a138
    v_accvgpr_read_b32 v19, a139
    v_mfma_f32_16x16x32_bf16 a[192:195], a[96:99], v[32:35], a[192:195]
    ds_read_b128 v[52:55], v17 offset:8704
    v_cvt_pk_bf16_f32 v21, v18, v19
    v_mfma_f32_16x16x32_bf16 a[196:199], a[100:103], v[32:35], a[196:199]
    buffer_load_dwordx4 a[28:31], v26, s[40:43], s62 offen offset:1024 sc1
    v_mfma_f32_16x16x32_bf16 a[208:211], v[32:35], a[104:107], a[208:211]
    s_xor_b32 s61, s24, 6144
    v_accvgpr_read_b32 v18, a140
    v_accvgpr_read_b32 v19, a141
    v_mfma_f32_16x16x32_bf16 a[216:219], v[32:35], a[108:111], a[216:219]
    s_xor_b32 s62, s25, 6144
    s_waitcnt lgkmcnt(3)
    v_cvt_pk_bf16_f32 v22, v18, v19
    v_accvgpr_read_b32 v18, a142
    v_mfma_f32_16x16x32_bf16 a[200:203], a[96:99], v[36:39], a[200:203]
    ds_read_b128 v[56:59], v17 offset:12288
    v_accvgpr_read_b32 v19, a143
    v_mfma_f32_16x16x32_bf16 a[204:207], a[100:103], v[36:39], a[204:207]
    buffer_load_dwordx4 a[32:35], v2, s[40:43], s61 offen offset:0 sc1
    v_mfma_f32_16x16x32_bf16 a[212:215], v[36:39], a[104:107], a[212:215]
    s_add_u32 s63, s56, 36864
    v_cvt_pk_bf16_f32 v23, v18, v19
    v_mfma_f32_16x16x32_bf16 a[220:223], v[36:39], a[108:111], a[220:223]
    v_mfma_f32_16x16x32_bf16 a[224:227], a[96:99], v[40:43], a[224:227]
    ds_read_b128 v[60:63], v17 offset:12800
    v_mfma_f32_16x16x32_bf16 a[228:231], a[100:103], v[40:43], a[228:231]
    buffer_store_dwordx4 v[20:23], v2, s[44:47], s63 offen sc1
    v_mfma_f32_16x16x32_bf16 a[240:243], v[40:43], a[104:107], a[240:243]
    v_mfma_f32_16x16x32_bf16 a[248:251], v[40:43], a[108:111], a[248:251]
    s_waitcnt vmcnt(63)
    s_barrier
    s_waitcnt lgkmcnt(3)
    v_mfma_f32_16x16x32_bf16 a[232:235], a[96:99], v[44:47], a[232:235]
    v_mfma_f32_16x16x32_bf16 a[236:239], a[100:103], v[44:47], a[236:239]
    buffer_load_dwordx4 a[36:39], v26, s[40:43], s61 offen offset:0 sc1
    v_mfma_f32_16x16x32_bf16 a[244:247], v[44:47], a[104:107], a[244:247]
    v_mfma_f32_16x16x32_bf16 a[252:255], v[44:47], a[108:111], a[252:255]
    v_mfma_f32_16x16x32_bf16 a[192:195], a[112:115], v[48:51], a[192:195]
    v_accvgpr_read_b32 v18, a144
    v_accvgpr_read_b32 v19, a145
    v_mfma_f32_16x16x32_bf16 a[196:199], a[116:119], v[48:51], a[196:199]
    buffer_load_dwordx4 a[40:43], v2, s[40:43], s62 offen offset:0 sc1
    v_mfma_f32_16x16x32_bf16 a[208:211], v[48:51], a[120:123], a[208:211]
    v_cvt_pk_bf16_f32 v20, v18, v19
    v_accvgpr_read_b32 v18, a146
    v_mfma_f32_16x16x32_bf16 a[216:219], v[48:51], a[124:127], a[216:219]
    s_waitcnt lgkmcnt(1)
    v_accvgpr_read_b32 v19, a147
    v_cvt_pk_bf16_f32 v21, v18, v19
    v_mfma_f32_16x16x32_bf16 a[200:203], a[112:115], v[52:55], a[200:203]
    v_accvgpr_read_b32 v18, a148
    v_accvgpr_read_b32 v19, a149
    v_mfma_f32_16x16x32_bf16 a[204:207], a[116:119], v[52:55], a[204:207]
    buffer_load_dwordx4 a[44:47], v26, s[40:43], s62 offen offset:0 sc1
    v_mfma_f32_16x16x32_bf16 a[212:215], v[52:55], a[120:123], a[212:215]
    v_cvt_pk_bf16_f32 v22, v18, v19
    v_accvgpr_read_b32 v18, a150
    v_mfma_f32_16x16x32_bf16 a[220:223], v[52:55], a[124:127], a[220:223]
    v_accvgpr_read_b32 v19, a151
    v_cvt_pk_bf16_f32 v23, v18, v19
    v_mfma_f32_16x16x32_bf16 a[224:227], a[112:115], v[56:59], a[224:227]
    s_add_u32 s63, s57, 32768
    v_mfma_f32_16x16x32_bf16 a[228:231], a[116:119], v[56:59], a[228:231]
    buffer_store_dwordx4 v[20:23], v2, s[48:51], s63 offen sc1
    v_mfma_f32_16x16x32_bf16 a[240:243], v[56:59], a[120:123], a[240:243]
    v_mfma_f32_16x16x32_bf16 a[248:251], v[56:59], a[124:127], a[248:251]
    s_waitcnt lgkmcnt(0)
    v_mfma_f32_16x16x32_bf16 a[232:235], a[112:115], v[60:63], a[232:235]
    v_mfma_f32_16x16x32_bf16 a[236:239], a[116:119], v[60:63], a[236:239]
    buffer_load_dwordx4 a[48:51], v2, s[40:43], s61 offen offset:1024 sc1
    v_mfma_f32_16x16x32_bf16 a[244:247], v[60:63], a[120:123], a[244:247]
    v_mfma_f32_16x16x32_bf16 a[252:255], v[60:63], a[124:127], a[252:255]
    v_xor_b32 v8, 0, v12
    v_xor_b32 v9, 32, v12
    v_xor_b32 v10, 64, v12
    v_xor_b32 v11, 96, v12
    v_xor_b32 v13, 160, v12
    v_xor_b32 v14, 192, v12
    v_xor_b32 v15, 224, v12
    v_xor_b32 v12, 128, v12
    ds_read_b64_tr_b16 v[32:33], v8 offset:16384
    ds_read_b64_tr_b16 v[34:35], v8 offset:17408
    ds_read_b64_tr_b16 v[36:37], v9 offset:16384
    ds_read_b64_tr_b16 v[38:39], v9 offset:17408
    ds_read_b64_tr_b16 v[40:41], v10 offset:16384
    ds_read_b64_tr_b16 v[42:43], v10 offset:17408
    ds_read_b64_tr_b16 v[44:45], v11 offset:16384
    ds_read_b64_tr_b16 v[46:47], v11 offset:17408
    ds_read_b64_tr_b16 v[48:49], v12 offset:16384
    ds_read_b64_tr_b16 v[50:51], v12 offset:17408
    s_add_u32 s36, s12, 0x3000000
    s_addc_u32 s37, s13, 0
    s_mov_b32 s38, 0x1000000
    s_mov_b32 s39, 0x20000
    s_waitcnt lgkmcnt(8)
    v_mfma_f32_16x16x32_bf16 v[128:131], v[32:35], v[64:67], 0
    s_nop 0
    ds_read_b64_tr_b16 v[52:53], v13 offset:16384
    ds_read_b64_tr_b16 v[54:55], v13 offset:17408
    v_mfma_f32_16x16x32_bf16 v[192:195], v[32:35], v[68:71], 0
    buffer_load_dwordx4 a[52:55], v26, s[40:43], s61 offen offset:1024 sc1
    v_mfma_f32_16x16x32_bf16 v[160:163], v[32:35], v[72:75], 0
    v_mfma_f32_16x16x32_bf16 v[224:227], v[32:35], v[76:79], 0
    s_waitcnt lgkmcnt(8)
    v_mfma_f32_16x16x32_bf16 v[132:135], v[36:39], v[64:67], 0
    s_nop 0
    ds_read_b64_tr_b16 v[56:57], v14 offset:16384
    ds_read_b64_tr_b16 v[58:59], v14 offset:17408
    v_mfma_f32_16x16x32_bf16 v[196:199], v[36:39], v[68:71], 0
    buffer_load_dwordx4 a[56:59], v2, s[40:43], s62 offen offset:1024 sc1
    v_mfma_f32_16x16x32_bf16 v[164:167], v[36:39], v[72:75], 0
    v_mfma_f32_16x16x32_bf16 v[228:231], v[36:39], v[76:79], 0
    s_waitcnt lgkmcnt(8)
    v_mfma_f32_16x16x32_bf16 v[136:139], v[40:43], v[64:67], 0
    s_nop 0
    ds_read_b64_tr_b16 v[60:61], v15 offset:16384
    ds_read_b64_tr_b16 v[62:63], v15 offset:17408
    v_mfma_f32_16x16x32_bf16 v[200:203], v[40:43], v[68:71], 0
    buffer_load_dwordx4 a[60:63], v26, s[40:43], s62 offen offset:1024 sc1
    v_mfma_f32_16x16x32_bf16 v[168:171], v[40:43], v[72:75], 0
    s_xor_b32 s61, s24, 8192
    s_xor_b32 s62, s25, 8192
    v_mfma_f32_16x16x32_bf16 v[232:235], v[40:43], v[76:79], 0
    s_waitcnt lgkmcnt(6)
    v_mfma_f32_16x16x32_bf16 v[140:143], v[44:47], v[64:67], 0
    s_nop 0
    ds_read_b64_tr_b16 v[32:33], v8 offset:24576
    ds_read_b64_tr_b16 v[34:35], v8 offset:25600
    v_mfma_f32_16x16x32_bf16 v[204:207], v[44:47], v[68:71], 0
    buffer_load_dwordx4 a[64:67], v2, s[40:43], s61 offen offset:0 sc1
    v_mfma_f32_16x16x32_bf16 v[172:175], v[44:47], v[72:75], 0
    v_mfma_f32_16x16x32_bf16 v[236:239], v[44:47], v[76:79], 0
    v_mfma_f32_16x16x32_bf16 v[144:147], v[48:51], v[64:67], 0
    s_nop 0
    ds_read_b64_tr_b16 v[36:37], v9 offset:24576
    ds_read_b64_tr_b16 v[38:39], v9 offset:25600
    v_mfma_f32_16x16x32_bf16 v[208:211], v[48:51], v[68:71], 0
    buffer_load_dwordx4 a[68:71], v26, s[40:43], s61 offen offset:0 sc1
    v_mfma_f32_16x16x32_bf16 v[176:179], v[48:51], v[72:75], 0
    v_mfma_f32_16x16x32_bf16 v[240:243], v[48:51], v[76:79], 0
    s_waitcnt lgkmcnt(6)
    v_mfma_f32_16x16x32_bf16 v[148:151], v[52:55], v[64:67], 0
    s_nop 0
    ds_read_b64_tr_b16 v[40:41], v10 offset:24576
    ds_read_b64_tr_b16 v[42:43], v10 offset:25600
    v_mfma_f32_16x16x32_bf16 v[212:215], v[52:55], v[68:71], 0
    buffer_load_dwordx4 a[72:75], v2, s[40:43], s62 offen offset:0 sc1
    v_mfma_f32_16x16x32_bf16 v[180:183], v[52:55], v[72:75], 0
    v_mfma_f32_16x16x32_bf16 v[244:247], v[52:55], v[76:79], 0
    v_mfma_f32_16x16x32_bf16 v[152:155], v[56:59], v[64:67], 0
    s_nop 0
    ds_read_b64_tr_b16 v[44:45], v11 offset:24576
    ds_read_b64_tr_b16 v[46:47], v11 offset:25600
    v_mfma_f32_16x16x32_bf16 v[216:219], v[56:59], v[68:71], 0
    buffer_load_dwordx4 a[76:79], v26, s[40:43], s62 offen offset:0 sc1
    v_mfma_f32_16x16x32_bf16 v[184:187], v[56:59], v[72:75], 0
    v_accvgpr_read_b32 v18, a152
    v_accvgpr_read_b32 v19, a153
    v_mfma_f32_16x16x32_bf16 v[248:251], v[56:59], v[76:79], 0
    s_waitcnt lgkmcnt(6)
    v_cvt_pk_bf16_f32 v20, v18, v19
    v_accvgpr_read_b32 v18, a154
    v_mfma_f32_16x16x32_bf16 v[156:159], v[60:63], v[64:67], 0
    s_nop 0
    ds_read_b64_tr_b16 v[48:49], v12 offset:24576
    ds_read_b64_tr_b16 v[50:51], v12 offset:25600
    v_mfma_f32_16x16x32_bf16 v[220:223], v[60:63], v[68:71], 0
    buffer_load_dwordx4 a[80:83], v2, s[40:43], s61 offen offset:1024 sc1
    v_mfma_f32_16x16x32_bf16 v[188:191], v[60:63], v[72:75], 0
    v_accvgpr_read_b32 v19, a155
    v_cvt_pk_bf16_f32 v21, v18, v19
    v_mfma_f32_16x16x32_bf16 v[252:255], v[60:63], v[76:79], 0
    s_waitcnt vmcnt(63)
    v_accvgpr_read_b32 v18, a156
    v_accvgpr_read_b32 v19, a157
    v_mfma_f32_16x16x32_bf16 v[128:131], v[32:35], v[80:83], v[128:131]
    s_nop 0
    ds_read_b64_tr_b16 v[52:53], v13 offset:24576
    ds_read_b64_tr_b16 v[54:55], v13 offset:25600
    v_mfma_f32_16x16x32_bf16 v[192:195], v[32:35], v[84:87], v[192:195]
    s_waitcnt vmcnt(61)
    buffer_load_dwordx4 a[84:87], v26, s[40:43], s61 offen offset:1024 sc1
    v_mfma_f32_16x16x32_bf16 v[160:163], v[32:35], v[88:91], v[160:163]
    s_waitcnt vmcnt(60)
    v_cvt_pk_bf16_f32 v22, v18, v19
    v_accvgpr_read_b32 v18, a158
    v_mfma_f32_16x16x32_bf16 v[224:227], v[32:35], v[92:95], v[224:227]
    s_waitcnt lgkmcnt(6)
    v_accvgpr_read_b32 v19, a159
    v_cvt_pk_bf16_f32 v23, v18, v19
    v_mfma_f32_16x16x32_bf16 v[132:135], v[36:39], v[80:83], v[132:135]
    s_nop 0
    ds_read_b64_tr_b16 v[56:57], v14 offset:24576
    ds_read_b64_tr_b16 v[58:59], v14 offset:25600
    v_mfma_f32_16x16x32_bf16 v[196:199], v[36:39], v[84:87], v[196:199]
    s_add_u32 s63, s57, 33792
    buffer_store_dwordx4 v[20:23], v2, s[48:51], s63 offen sc1
    v_mfma_f32_16x16x32_bf16 v[164:167], v[36:39], v[88:91], v[164:167]
    v_mfma_f32_16x16x32_bf16 v[228:231], v[36:39], v[92:95], v[228:231]
    v_mfma_f32_16x16x32_bf16 v[136:139], v[40:43], v[80:83], v[136:139]
    s_nop 0
    ds_read_b64_tr_b16 v[60:61], v15 offset:24576
    ds_read_b64_tr_b16 v[62:63], v15 offset:25600
    v_mfma_f32_16x16x32_bf16 v[200:203], v[40:43], v[84:87], v[200:203]
    buffer_load_dwordx4 a[88:91], v2, s[40:43], s62 offen offset:1024 sc1
    v_mfma_f32_16x16x32_bf16 v[168:171], v[40:43], v[88:91], v[168:171]
    v_mfma_f32_16x16x32_bf16 v[232:235], v[40:43], v[92:95], v[232:235]
    v_accvgpr_read_b32 v18, a160
    v_accvgpr_read_b32 v19, a161
    v_cvt_pk_bf16_f32 v20, v18, v19
    v_accvgpr_read_b32 v18, a162
    v_accvgpr_read_b32 v19, a163
    v_cvt_pk_bf16_f32 v21, v18, v19
    v_accvgpr_read_b32 v18, a164
    v_accvgpr_read_b32 v19, a165
    v_cvt_pk_bf16_f32 v22, v18, v19
    v_accvgpr_read_b32 v18, a166
    v_accvgpr_read_b32 v19, a167
    v_cvt_pk_bf16_f32 v23, v18, v19
    s_add_u32 s63, s56, 40960
    buffer_store_dwordx4 v[20:23], v2, s[44:47], s63 offen sc1
    s_barrier
    s_waitcnt lgkmcnt(4)
    v_mfma_f32_16x16x32_bf16 v[140:143], v[44:47], v[80:83], v[140:143]
    v_add_u32 v8, 0x10000, v8
    v_add_u32 v9, 0x10000, v9
    v_add_u32 v10, 0x10000, v10
    v_add_u32 v11, 0x10000, v11
    v_add_u32 v12, 0x10000, v12
    v_add_u32 v13, 0x10000, v13
    v_add_u32 v14, 0x10000, v14
    v_add_u32 v15, 0x10000, v15
    ds_read_b64_tr_b16 v[32:33], v8 offset:0
    ds_read_b64_tr_b16 v[34:35], v8 offset:1024
    v_mfma_f32_16x16x32_bf16 v[204:207], v[44:47], v[84:87], v[204:207]
    buffer_load_dwordx4 a[92:95], v26, s[40:43], s62 offen offset:1024 sc1
    v_mfma_f32_16x16x32_bf16 v[172:175], v[44:47], v[88:91], v[172:175]
    s_xor_b32 s61, s24, 10240
    s_xor_b32 s62, s25, 10240
    v_mfma_f32_16x16x32_bf16 v[236:239], v[44:47], v[92:95], v[236:239]
    v_mfma_f32_16x16x32_bf16 v[144:147], v[48:51], v[80:83], v[144:147]
    s_nop 0
    ds_read_b64_tr_b16 v[36:37], v9 offset:0
    ds_read_b64_tr_b16 v[38:39], v9 offset:1024
    v_mfma_f32_16x16x32_bf16 v[208:211], v[48:51], v[84:87], v[208:211]
    buffer_load_dwordx4 a[96:99], v2, s[40:43], s61 offen offset:0 sc1
    v_mfma_f32_16x16x32_bf16 v[176:179], v[48:51], v[88:91], v[176:179]
    v_mfma_f32_16x16x32_bf16 v[240:243], v[48:51], v[92:95], v[240:243]
    v_mfma_f32_16x16x32_bf16 v[148:151], v[52:55], v[80:83], v[148:151]
    s_nop 0
    ds_read_b64_tr_b16 v[40:41], v10 offset:0
    ds_read_b64_tr_b16 v[42:43], v10 offset:1024
    v_mfma_f32_16x16x32_bf16 v[212:215], v[52:55], v[84:87], v[212:215]
    buffer_load_dwordx4 a[100:103], v26, s[40:43], s61 offen offset:0 sc1
    v_mfma_f32_16x16x32_bf16 v[180:183], v[52:55], v[88:91], v[180:183]
    v_mfma_f32_16x16x32_bf16 v[244:247], v[52:55], v[92:95], v[244:247]
    s_waitcnt lgkmcnt(6)
    v_mfma_f32_16x16x32_bf16 v[152:155], v[56:59], v[80:83], v[152:155]
    s_nop 0
    ds_read_b64_tr_b16 v[44:45], v11 offset:0
    ds_read_b64_tr_b16 v[46:47], v11 offset:1024
    v_mfma_f32_16x16x32_bf16 v[216:219], v[56:59], v[84:87], v[216:219]
    buffer_load_dwordx4 a[104:107], v2, s[40:43], s62 offen offset:0 sc1
    v_mfma_f32_16x16x32_bf16 v[184:187], v[56:59], v[88:91], v[184:187]
    v_mfma_f32_16x16x32_bf16 v[248:251], v[56:59], v[92:95], v[248:251]
    v_mfma_f32_16x16x32_bf16 v[156:159], v[60:63], v[80:83], v[156:159]
    s_nop 0
    ds_read_b64_tr_b16 v[48:49], v12 offset:0
    ds_read_b64_tr_b16 v[50:51], v12 offset:1024
    v_mfma_f32_16x16x32_bf16 v[220:223], v[60:63], v[84:87], v[220:223]
    buffer_load_dwordx4 a[108:111], v26, s[40:43], s62 offen offset:0 sc1
    v_mfma_f32_16x16x32_bf16 v[188:191], v[60:63], v[88:91], v[188:191]
    v_mfma_f32_16x16x32_bf16 v[252:255], v[60:63], v[92:95], v[252:255]
    s_waitcnt vmcnt(63) lgkmcnt(6)
    v_mfma_f32_16x16x32_bf16 v[128:131], v[32:35], v[96:99], v[128:131]
    s_waitcnt vmcnt(60)
    ds_read_b64_tr_b16 v[52:53], v13 offset:0
    ds_read_b64_tr_b16 v[54:55], v13 offset:1024
    v_mfma_f32_16x16x32_bf16 v[192:195], v[32:35], v[100:103], v[192:195]
    s_waitcnt vmcnt(58)
    buffer_load_dwordx4 a[112:115], v2, s[40:43], s61 offen offset:1024 sc1
    v_mfma_f32_16x16x32_bf16 v[160:163], v[32:35], v[104:107], v[160:163]
    s_waitcnt vmcnt(55)
    v_accvgpr_read_b32 v18, a168
    v_accvgpr_read_b32 v19, a169
    v_mfma_f32_16x16x32_bf16 v[224:227], v[32:35], v[108:111], v[224:227]
    v_cvt_pk_bf16_f32 v20, v18, v19
    v_accvgpr_read_b32 v18, a170
    v_mfma_f32_16x16x32_bf16 v[132:135], v[36:39], v[96:99], v[132:135]
    s_nop 0
    ds_read_b64_tr_b16 v[56:57], v14 offset:0
    ds_read_b64_tr_b16 v[58:59], v14 offset:1024
    v_mfma_f32_16x16x32_bf16 v[196:199], v[36:39], v[100:103], v[196:199]
    buffer_load_dwordx4 a[116:119], v26, s[40:43], s61 offen offset:1024 sc1
    v_mfma_f32_16x16x32_bf16 v[164:167], v[36:39], v[104:107], v[164:167]
    v_accvgpr_read_b32 v19, a171
    v_cvt_pk_bf16_f32 v21, v18, v19
    v_mfma_f32_16x16x32_bf16 v[228:231], v[36:39], v[108:111], v[228:231]
    s_waitcnt lgkmcnt(6)
    v_accvgpr_read_b32 v18, a172
    v_accvgpr_read_b32 v19, a173
    v_mfma_f32_16x16x32_bf16 v[136:139], v[40:43], v[96:99], v[136:139]
    s_nop 0
    ds_read_b64_tr_b16 v[60:61], v15 offset:0
    ds_read_b64_tr_b16 v[62:63], v15 offset:1024
    v_mfma_f32_16x16x32_bf16 v[200:203], v[40:43], v[100:103], v[200:203]
    buffer_load_dwordx4 a[120:123], v2, s[40:43], s62 offen offset:1024 sc1
    v_mfma_f32_16x16x32_bf16 v[168:171], v[40:43], v[104:107], v[168:171]
    v_cvt_pk_bf16_f32 v22, v18, v19
    v_accvgpr_read_b32 v18, a174
    v_mfma_f32_16x16x32_bf16 v[232:235], v[40:43], v[108:111], v[232:235]
    v_accvgpr_read_b32 v19, a175
    v_cvt_pk_bf16_f32 v23, v18, v19
    v_mfma_f32_16x16x32_bf16 v[140:143], v[44:47], v[96:99], v[140:143]
    s_nop 0
    ds_read_b64_tr_b16 v[32:33], v8 offset:8192
    ds_read_b64_tr_b16 v[34:35], v8 offset:9216
    v_mfma_f32_16x16x32_bf16 v[204:207], v[44:47], v[100:103], v[204:207]
    s_add_u32 s63, s56, 45056
    buffer_store_dwordx4 v[20:23], v2, s[44:47], s63 offen sc1
    v_mfma_f32_16x16x32_bf16 v[172:175], v[44:47], v[104:107], v[172:175]
    v_mfma_f32_16x16x32_bf16 v[236:239], v[44:47], v[108:111], v[236:239]
    s_waitcnt lgkmcnt(6)
    v_mfma_f32_16x16x32_bf16 v[144:147], v[48:51], v[96:99], v[144:147]
    s_nop 0
    ds_read_b64_tr_b16 v[36:37], v9 offset:8192
    ds_read_b64_tr_b16 v[38:39], v9 offset:9216
    v_mfma_f32_16x16x32_bf16 v[208:211], v[48:51], v[100:103], v[208:211]
    buffer_load_dwordx4 a[124:127], v26, s[40:43], s62 offen offset:1024 sc1
    v_mfma_f32_16x16x32_bf16 v[176:179], v[48:51], v[104:107], v[176:179]
    s_lshl_b32 s35, s14, 7
    s_add_u32 s35, s35, 67584
    v_mfma_f32_16x16x32_bf16 v[240:243], v[48:51], v[108:111], v[240:243]
    v_mfma_f32_16x16x32_bf16 v[148:151], v[52:55], v[96:99], v[148:151]
    s_nop 0
    ds_read_b64_tr_b16 v[40:41], v10 offset:8192
    ds_read_b64_tr_b16 v[42:43], v10 offset:9216
    v_mfma_f32_16x16x32_bf16 v[212:215], v[52:55], v[100:103], v[212:215]
    v_accvgpr_read_b32 v18, a176
    v_accvgpr_read_b32 v19, a177
    v_mfma_f32_16x16x32_bf16 v[180:183], v[52:55], v[104:107], v[180:183]
    v_cvt_pk_bf16_f32 v20, v18, v19
    v_accvgpr_read_b32 v18, a178
    v_mfma_f32_16x16x32_bf16 v[244:247], v[52:55], v[108:111], v[244:247]
    s_waitcnt lgkmcnt(6)
    v_accvgpr_read_b32 v19, a179
    v_cvt_pk_bf16_f32 v21, v18, v19
    v_mfma_f32_16x16x32_bf16 v[152:155], v[56:59], v[96:99], v[152:155]
    s_nop 0
    ds_read_b64_tr_b16 v[44:45], v11 offset:8192
    ds_read_b64_tr_b16 v[46:47], v11 offset:9216
    v_mfma_f32_16x16x32_bf16 v[216:219], v[56:59], v[100:103], v[216:219]
    v_accvgpr_read_b32 v18, a180
    v_accvgpr_read_b32 v19, a181
    v_mfma_f32_16x16x32_bf16 v[184:187], v[56:59], v[104:107], v[184:187]
    v_cvt_pk_bf16_f32 v22, v18, v19
    v_accvgpr_read_b32 v18, a182
    v_mfma_f32_16x16x32_bf16 v[248:251], v[56:59], v[108:111], v[248:251]
    v_accvgpr_read_b32 v19, a183
    v_cvt_pk_bf16_f32 v23, v18, v19
    v_mfma_f32_16x16x32_bf16 v[156:159], v[60:63], v[96:99], v[156:159]
    s_nop 0
    ds_read_b64_tr_b16 v[48:49], v12 offset:8192
    ds_read_b64_tr_b16 v[50:51], v12 offset:9216
    v_mfma_f32_16x16x32_bf16 v[220:223], v[60:63], v[100:103], v[220:223]
    s_add_u32 s63, s57, 40960
    buffer_store_dwordx4 v[20:23], v2, s[48:51], s63 offen sc1
    v_mfma_f32_16x16x32_bf16 v[188:191], v[60:63], v[104:107], v[188:191]
    v_mfma_f32_16x16x32_bf16 v[252:255], v[60:63], v[108:111], v[252:255]
    s_waitcnt vmcnt(56) lgkmcnt(6)
    v_mfma_f32_16x16x32_bf16 v[128:131], v[32:35], v[112:115], v[128:131]
    s_waitcnt vmcnt(54)
    ds_read_b64_tr_b16 v[52:53], v13 offset:8192
    ds_read_b64_tr_b16 v[54:55], v13 offset:9216
    v_mfma_f32_16x16x32_bf16 v[192:195], v[32:35], v[116:119], v[192:195]
    s_waitcnt vmcnt(51)
    v_mfma_f32_16x16x32_bf16 v[160:163], v[32:35], v[120:123], v[160:163]
    s_waitcnt vmcnt(46)
    v_mfma_f32_16x16x32_bf16 v[224:227], v[32:35], v[124:127], v[224:227]
    v_mfma_f32_16x16x32_bf16 v[132:135], v[36:39], v[112:115], v[132:135]
    s_nop 0
    ds_read_b64_tr_b16 v[56:57], v14 offset:8192
    ds_read_b64_tr_b16 v[58:59], v14 offset:9216
    v_mfma_f32_16x16x32_bf16 v[196:199], v[36:39], v[116:119], v[196:199]
    v_mfma_f32_16x16x32_bf16 v[164:167], v[36:39], v[120:123], v[164:167]
    v_mfma_f32_16x16x32_bf16 v[228:231], v[36:39], v[124:127], v[228:231]
    s_waitcnt lgkmcnt(6)
    v_mfma_f32_16x16x32_bf16 v[136:139], v[40:43], v[112:115], v[136:139]
    s_nop 0
    ds_read_b64_tr_b16 v[60:61], v15 offset:8192
    ds_read_b64_tr_b16 v[62:63], v15 offset:9216
    v_mfma_f32_16x16x32_bf16 v[200:203], v[40:43], v[116:119], v[200:203]
    v_accvgpr_read_b32 v18, a184
    v_accvgpr_read_b32 v19, a185
    v_mfma_f32_16x16x32_bf16 v[168:171], v[40:43], v[120:123], v[168:171]
    v_cvt_pk_bf16_f32 v20, v18, v19
    v_accvgpr_read_b32 v18, a186
    v_mfma_f32_16x16x32_bf16 v[232:235], v[40:43], v[124:127], v[232:235]
    v_accvgpr_read_b32 v19, a187
    v_cvt_pk_bf16_f32 v21, v18, v19
    v_accvgpr_read_b32 v18, a188
    v_accvgpr_read_b32 v19, a189
    v_cvt_pk_bf16_f32 v22, v18, v19
    v_accvgpr_read_b32 v18, a190
    v_accvgpr_read_b32 v19, a191
    v_cvt_pk_bf16_f32 v23, v18, v19
    s_add_u32 s63, s57, 41984
    buffer_store_dwordx4 v[20:23], v2, s[48:51], s63 offen sc1
    s_barrier
    v_mfma_f32_16x16x32_bf16 v[140:143], v[44:47], v[112:115], v[140:143]
    v_add_u32 v8, 0xffff0000, v8
    v_add_u32 v9, 0xffff0000, v9
    v_add_u32 v10, 0xffff0000, v10
    v_add_u32 v11, 0xffff0000, v11
    v_add_u32 v12, 0xffff0000, v12
    v_add_u32 v13, 0xffff0000, v13
    v_add_u32 v14, 0xffff0000, v14
    v_add_u32 v15, 0xffff0000, v15
    ds_read_b64_tr_b16 v[32:33], v8 offset:32768
    ds_read_b64_tr_b16 v[34:35], v8 offset:33792
    v_mfma_f32_16x16x32_bf16 v[204:207], v[44:47], v[116:119], v[204:207]
    v_mfma_f32_16x16x32_bf16 v[172:175], v[44:47], v[120:123], v[172:175]
    v_mfma_f32_16x16x32_bf16 v[236:239], v[44:47], v[124:127], v[236:239]
    s_waitcnt lgkmcnt(4)
    v_mfma_f32_16x16x32_bf16 v[144:147], v[48:51], v[112:115], v[144:147]
    s_nop 0
    ds_read_b64_tr_b16 v[36:37], v9 offset:32768
    ds_read_b64_tr_b16 v[38:39], v9 offset:33792
    v_mfma_f32_16x16x32_bf16 v[208:211], v[48:51], v[116:119], v[208:211]
    v_mfma_f32_16x16x32_bf16 v[176:179], v[48:51], v[120:123], v[176:179]
    v_mfma_f32_16x16x32_bf16 v[240:243], v[48:51], v[124:127], v[240:243]
    v_mfma_f32_16x16x32_bf16 v[148:151], v[52:55], v[112:115], v[148:151]
    s_nop 0
    ds_read_b64_tr_b16 v[40:41], v10 offset:32768
    ds_read_b64_tr_b16 v[42:43], v10 offset:33792
    v_mfma_f32_16x16x32_bf16 v[212:215], v[52:55], v[116:119], v[212:215]
    v_mfma_f32_16x16x32_bf16 v[180:183], v[52:55], v[120:123], v[180:183]
    v_mfma_f32_16x16x32_bf16 v[244:247], v[52:55], v[124:127], v[244:247]
    v_mfma_f32_16x16x32_bf16 v[152:155], v[56:59], v[112:115], v[152:155]
    s_nop 0
    ds_read_b64_tr_b16 v[44:45], v11 offset:32768
    ds_read_b64_tr_b16 v[46:47], v11 offset:33792
    v_mfma_f32_16x16x32_bf16 v[216:219], v[56:59], v[116:119], v[216:219]
    v_mfma_f32_16x16x32_bf16 v[184:187], v[56:59], v[120:123], v[184:187]
    v_mfma_f32_16x16x32_bf16 v[248:251], v[56:59], v[124:127], v[248:251]
    s_waitcnt lgkmcnt(6)
    v_mfma_f32_16x16x32_bf16 v[156:159], v[60:63], v[112:115], v[156:159]
    s_nop 0
    ds_read_b64_tr_b16 v[48:49], v12 offset:32768
    ds_read_b64_tr_b16 v[50:51], v12 offset:33792
    v_mfma_f32_16x16x32_bf16 v[220:223], v[60:63], v[116:119], v[220:223]
    v_accvgpr_read_b32 v18, a192
    v_accvgpr_read_b32 v19, a193
    v_mfma_f32_16x16x32_bf16 v[188:191], v[60:63], v[120:123], v[188:191]
    v_cvt_pk_bf16_f32 v20, v18, v19
    v_accvgpr_read_b32 v18, a194
    v_mfma_f32_16x16x32_bf16 v[252:255], v[60:63], v[124:127], v[252:255]
    s_waitcnt vmcnt(39)
    v_accvgpr_read_b32 v19, a195
    v_cvt_pk_bf16_f32 v21, v18, v19
    v_mfma_f32_16x16x32_bf16 v[128:131], v[32:35], a[0:3], v[128:131]
    s_waitcnt vmcnt(38)
    ds_read_b64_tr_b16 v[52:53], v13 offset:32768
    ds_read_b64_tr_b16 v[54:55], v13 offset:33792
    v_mfma_f32_16x16x32_bf16 v[192:195], v[32:35], a[4:7], v[192:195]
    s_waitcnt vmcnt(37)
    v_accvgpr_read_b32 v18, a196
    v_accvgpr_read_b32 v19, a197
    v_mfma_f32_16x16x32_bf16 v[160:163], v[32:35], a[8:11], v[160:163]
    s_waitcnt vmcnt(36)
    v_cvt_pk_bf16_f32 v22, v18, v19
    v_accvgpr_read_b32 v18, a198
    v_mfma_f32_16x16x32_bf16 v[224:227], v[32:35], a[12:15], v[224:227]
    s_waitcnt lgkmcnt(6)
    v_accvgpr_read_b32 v19, a199
    v_cvt_pk_bf16_f32 v23, v18, v19
    v_mfma_f32_16x16x32_bf16 v[132:135], v[36:39], a[0:3], v[132:135]
    s_nop 0
    ds_read_b64_tr_b16 v[56:57], v14 offset:32768
    ds_read_b64_tr_b16 v[58:59], v14 offset:33792
    v_mfma_f32_16x16x32_bf16 v[196:199], v[36:39], a[4:7], v[196:199]
    s_add_u32 s63, s56, 49152
    buffer_store_dwordx4 v[20:23], v2, s[44:47], s63 offen sc1
    v_mfma_f32_16x16x32_bf16 v[164:167], v[36:39], a[8:11], v[164:167]
    v_lshrrev_b32 v29, 1, v0
    v_and_b32 v30, 1, v0
    v_mfma_f32_16x16x32_bf16 v[228:231], v[36:39], a[12:15], v[228:231]
    v_mul_u32_u24 v28, 6144, v29
    v_lshl_add_u32 v28, v30, 4, v28
    v_mfma_f32_16x16x32_bf16 v[136:139], v[40:43], a[0:3], v[136:139]
    s_nop 0
    ds_read_b64_tr_b16 v[60:61], v15 offset:32768
    ds_read_b64_tr_b16 v[62:63], v15 offset:33792
    v_mfma_f32_16x16x32_bf16 v[200:203], v[40:43], a[4:7], v[200:203]
    s_lshl_b32 s23, s16, 6
    v_lshlrev_b32 v29, 1, v29
    v_mfma_f32_16x16x32_bf16 v[168:171], v[40:43], a[8:11], v[168:171]
    s_add_u32 s21, s21, s23
    s_sub_u32 s21, s21, 64
    s_lshl_b32 s23, s21, 5
    v_mfma_f32_16x16x32_bf16 v[232:235], v[40:43], a[12:15], v[232:235]
    s_cmp_ge_u32 s16, 2
    s_cselect_b32 s23, s23, 0x40000000
    s_waitcnt lgkmcnt(6)
    buffer_load_ushort v64, v29, s[76:79], 0 offen offset:0
    v_mfma_f32_16x16x32_bf16 v[140:143], v[44:47], a[0:3], v[140:143]
    s_nop 0
    ds_read_b64_tr_b16 v[32:33], v8 offset:40960
    ds_read_b64_tr_b16 v[34:35], v8 offset:41984
    v_mfma_f32_16x16x32_bf16 v[204:207], v[44:47], a[4:7], v[204:207]
    buffer_load_ushort v65, v29, s[76:79], 0 offen offset:256
    v_mfma_f32_16x16x32_bf16 v[172:175], v[44:47], a[8:11], v[172:175]
    v_mfma_f32_16x16x32_bf16 v[236:239], v[44:47], a[12:15], v[236:239]
    buffer_load_ushort v66, v29, s[76:79], 0 offen offset:512
    v_mfma_f32_16x16x32_bf16 v[144:147], v[48:51], a[0:3], v[144:147]
    s_nop 0
    ds_read_b64_tr_b16 v[36:37], v9 offset:40960
    ds_read_b64_tr_b16 v[38:39], v9 offset:41984
    v_mfma_f32_16x16x32_bf16 v[208:211], v[48:51], a[4:7], v[208:211]
    buffer_load_ushort v67, v29, s[76:79], 0 offen offset:768
    v_mfma_f32_16x16x32_bf16 v[176:179], v[48:51], a[8:11], v[176:179]
    v_accvgpr_read_b32 v18, a200
    v_accvgpr_read_b32 v19, a201
    v_mfma_f32_16x16x32_bf16 v[240:243], v[48:51], a[12:15], v[240:243]
    s_waitcnt lgkmcnt(6)
    buffer_load_dwordx4 v[72:75], v28, s[80:83], s23 offen
    v_mfma_f32_16x16x32_bf16 v[148:151], v[52:55], a[0:3], v[148:151]
    s_nop 0
    ds_read_b64_tr_b16 v[40:41], v10 offset:40960
    ds_read_b64_tr_b16 v[42:43], v10 offset:41984
    v_mfma_f32_16x16x32_bf16 v[212:215], v[52:55], a[4:7], v[212:215]
    s_add_u32 s23, s23, 786432
    v_cvt_pk_bf16_f32 v20, v18, v19
    v_accvgpr_read_b32 v18, a202
    v_mfma_f32_16x16x32_bf16 v[180:183], v[52:55], a[8:11], v[180:183]
    v_accvgpr_read_b32 v19, a203
    v_cvt_pk_bf16_f32 v21, v18, v19
    v_mfma_f32_16x16x32_bf16 v[244:247], v[52:55], a[12:15], v[244:247]
    v_accvgpr_read_b32 v18, a204
    v_accvgpr_read_b32 v19, a205
    v_mfma_f32_16x16x32_bf16 v[152:155], v[56:59], a[0:3], v[152:155]
    s_nop 0
    ds_read_b64_tr_b16 v[44:45], v11 offset:40960
    ds_read_b64_tr_b16 v[46:47], v11 offset:41984
    v_mfma_f32_16x16x32_bf16 v[216:219], v[56:59], a[4:7], v[216:219]
    v_cvt_pk_bf16_f32 v22, v18, v19
    v_accvgpr_read_b32 v18, a206
    v_mfma_f32_16x16x32_bf16 v[184:187], v[56:59], a[8:11], v[184:187]
    v_accvgpr_read_b32 v19, a207
    v_cvt_pk_bf16_f32 v23, v18, v19
    v_mfma_f32_16x16x32_bf16 v[248:251], v[56:59], a[12:15], v[248:251]
    s_add_u32 s63, s56, 53248
    s_waitcnt lgkmcnt(6)
    v_mfma_f32_16x16x32_bf16 v[156:159], v[60:63], a[0:3], v[156:159]
    s_nop 0
    ds_read_b64_tr_b16 v[48:49], v12 offset:40960
    ds_read_b64_tr_b16 v[50:51], v12 offset:41984
    v_mfma_f32_16x16x32_bf16 v[220:223], v[60:63], a[4:7], v[220:223]
    buffer_store_dwordx4 v[20:23], v2, s[44:47], s63 offen sc1
    v_mfma_f32_16x16x32_bf16 v[188:191], v[60:63], a[8:11], v[188:191]
    v_mfma_f32_16x16x32_bf16 v[252:255], v[60:63], a[12:15], v[252:255]
    s_waitcnt vmcnt(42)
    v_mfma_f32_16x16x32_bf16 v[128:131], v[32:35], a[16:19], v[128:131]
    s_waitcnt vmcnt(40)
    ds_read_b64_tr_b16 v[52:53], v13 offset:40960
    ds_read_b64_tr_b16 v[54:55], v13 offset:41984
    v_mfma_f32_16x16x32_bf16 v[192:195], v[32:35], a[20:23], v[192:195]
    s_waitcnt vmcnt(39)
    buffer_load_dwordx4 v[76:79], v28, s[80:83], s23 offen
    v_mfma_f32_16x16x32_bf16 v[160:163], v[32:35], a[24:27], v[160:163]
    s_add_u32 s23, s23, 786432
    s_waitcnt vmcnt(39)
    v_mfma_f32_16x16x32_bf16 v[224:227], v[32:35], a[28:31], v[224:227]
    s_waitcnt lgkmcnt(6)
    v_mfma_f32_16x16x32_bf16 v[132:135], v[36:39], a[16:19], v[132:135]
    s_nop 0
    ds_read_b64_tr_b16 v[56:57], v14 offset:40960
    ds_read_b64_tr_b16 v[58:59], v14 offset:41984
    v_mfma_f32_16x16x32_bf16 v[196:199], v[36:39], a[20:23], v[196:199]
    v_accvgpr_read_b32 v18, a208
    v_accvgpr_read_b32 v19, a209
    v_mfma_f32_16x16x32_bf16 v[164:167], v[36:39], a[24:27], v[164:167]
    v_cvt_pk_bf16_f32 v20, v18, v19
    v_accvgpr_read_b32 v18, a210
    v_mfma_f32_16x16x32_bf16 v[228:231], v[36:39], a[28:31], v[228:231]
    v_accvgpr_read_b32 v19, a211
    v_cvt_pk_bf16_f32 v21, v18, v19
    v_mfma_f32_16x16x32_bf16 v[136:139], v[40:43], a[16:19], v[136:139]
    s_nop 0
    ds_read_b64_tr_b16 v[60:61], v15 offset:40960
    ds_read_b64_tr_b16 v[62:63], v15 offset:41984
    v_mfma_f32_16x16x32_bf16 v[200:203], v[40:43], a[20:23], v[200:203]
    v_accvgpr_read_b32 v18, a212
    v_accvgpr_read_b32 v19, a213
    v_mfma_f32_16x16x32_bf16 v[168:171], v[40:43], a[24:27], v[168:171]
    v_cvt_pk_bf16_f32 v22, v18, v19
    v_accvgpr_read_b32 v18, a214
    v_mfma_f32_16x16x32_bf16 v[232:235], v[40:43], a[28:31], v[232:235]
    buffer_load_dwordx4 v[80:83], v28, s[80:83], s23 offen
    v_accvgpr_read_b32 v19, a215
    v_cvt_pk_bf16_f32 v23, v18, v19
    s_add_u32 s63, s57, 49152
    buffer_store_dwordx4 v[20:23], v2, s[48:51], s63 offen sc1
    s_barrier
    s_waitcnt lgkmcnt(4)
    v_mfma_f32_16x16x32_bf16 v[140:143], v[44:47], a[16:19], v[140:143]
    v_add_u32 v8, 0x10000, v8
    v_add_u32 v9, 0x10000, v9
    v_add_u32 v10, 0x10000, v10
    v_add_u32 v11, 0x10000, v11
    v_add_u32 v12, 0x10000, v12
    v_add_u32 v13, 0x10000, v13
    v_add_u32 v14, 0x10000, v14
    v_add_u32 v15, 0x10000, v15
    ds_read_b64_tr_b16 v[32:33], v8 offset:16384
    ds_read_b64_tr_b16 v[34:35], v8 offset:17408
    v_mfma_f32_16x16x32_bf16 v[204:207], v[44:47], a[20:23], v[204:207]
    s_add_u32 s23, s23, 786432
    v_mfma_f32_16x16x32_bf16 v[172:175], v[44:47], a[24:27], v[172:175]
    v_mfma_f32_16x16x32_bf16 v[236:239], v[44:47], a[28:31], v[236:239]
    v_mfma_f32_16x16x32_bf16 v[144:147], v[48:51], a[16:19], v[144:147]
    s_nop 0
    ds_read_b64_tr_b16 v[36:37], v9 offset:16384
    ds_read_b64_tr_b16 v[38:39], v9 offset:17408
    v_mfma_f32_16x16x32_bf16 v[208:211], v[48:51], a[20:23], v[208:211]
    v_mfma_f32_16x16x32_bf16 v[176:179], v[48:51], a[24:27], v[176:179]
    v_mfma_f32_16x16x32_bf16 v[240:243], v[48:51], a[28:31], v[240:243]
    v_mfma_f32_16x16x32_bf16 v[148:151], v[52:55], a[16:19], v[148:151]
    s_nop 0
    ds_read_b64_tr_b16 v[40:41], v10 offset:16384
    ds_read_b64_tr_b16 v[42:43], v10 offset:17408
    v_mfma_f32_16x16x32_bf16 v[212:215], v[52:55], a[20:23], v[212:215]
    buffer_load_dwordx4 v[84:87], v28, s[80:83], s23 offen
    v_mfma_f32_16x16x32_bf16 v[180:183], v[52:55], a[24:27], v[180:183]
    v_mfma_f32_16x16x32_bf16 v[244:247], v[52:55], a[28:31], v[244:247]
    s_waitcnt lgkmcnt(6)
    v_mfma_f32_16x16x32_bf16 v[152:155], v[56:59], a[16:19], v[152:155]
    s_nop 0
    ds_read_b64_tr_b16 v[44:45], v11 offset:16384
    ds_read_b64_tr_b16 v[46:47], v11 offset:17408
    v_mfma_f32_16x16x32_bf16 v[216:219], v[56:59], a[20:23], v[216:219]
    v_accvgpr_read_b32 v18, a216
    v_accvgpr_read_b32 v19, a217
    v_mfma_f32_16x16x32_bf16 v[184:187], v[56:59], a[24:27], v[184:187]
    v_cvt_pk_bf16_f32 v20, v18, v19
    v_accvgpr_read_b32 v18, a218
    v_mfma_f32_16x16x32_bf16 v[248:251], v[56:59], a[28:31], v[248:251]
    v_accvgpr_read_b32 v19, a219
    v_cvt_pk_bf16_f32 v21, v18, v19
    v_mfma_f32_16x16x32_bf16 v[156:159], v[60:63], a[16:19], v[156:159]
    s_nop 0
    ds_read_b64_tr_b16 v[48:49], v12 offset:16384
    ds_read_b64_tr_b16 v[50:51], v12 offset:17408
    v_mfma_f32_16x16x32_bf16 v[220:223], v[60:63], a[20:23], v[220:223]
    v_accvgpr_read_b32 v18, a220
    v_accvgpr_read_b32 v19, a221
    v_mfma_f32_16x16x32_bf16 v[188:191], v[60:63], a[24:27], v[188:191]
    v_cvt_pk_bf16_f32 v22, v18, v19
    v_accvgpr_read_b32 v18, a222
    v_mfma_f32_16x16x32_bf16 v[252:255], v[60:63], a[28:31], v[252:255]
    s_waitcnt vmcnt(41) lgkmcnt(6)
    v_accvgpr_read_b32 v19, a223
    v_cvt_pk_bf16_f32 v23, v18, v19
    v_mfma_f32_16x16x32_bf16 v[128:131], v[32:35], a[32:35], v[128:131]
    s_waitcnt vmcnt(39)
    ds_read_b64_tr_b16 v[52:53], v13 offset:16384
    ds_read_b64_tr_b16 v[54:55], v13 offset:17408
    v_mfma_f32_16x16x32_bf16 v[192:195], v[32:35], a[36:39], v[192:195]
    s_add_u32 s63, s57, 50176
    s_waitcnt vmcnt(38)
    buffer_store_dwordx4 v[20:23], v2, s[48:51], s63 offen sc1
    v_mfma_f32_16x16x32_bf16 v[160:163], v[32:35], a[40:43], v[160:163]
    s_xor_b32 s61, s24, 12288
    s_xor_b32 s62, s25, 12288
    s_waitcnt vmcnt(10)
    v_lshlrev_b32 v64, 16, v64
    v_mfma_f32_16x16x32_bf16 v[224:227], v[32:35], a[44:47], v[224:227]
    s_waitcnt vmcnt(9)
    v_mul_f32 v68, 0xbfb8aa3b, v64
    v_lshlrev_b32 v65, 16, v65
    v_mfma_f32_16x16x32_bf16 v[132:135], v[36:39], a[32:35], v[132:135]
    s_nop 0
    ds_read_b64_tr_b16 v[56:57], v14 offset:16384
    ds_read_b64_tr_b16 v[58:59], v14 offset:17408
    v_mfma_f32_16x16x32_bf16 v[196:199], v[36:39], a[36:39], v[196:199]
    buffer_load_dwordx4 a[0:3], v2, s[40:43], s61 offen offset:0 sc1
    v_mfma_f32_16x16x32_bf16 v[164:167], v[36:39], a[40:43], v[164:167]
    s_waitcnt vmcnt(9)
    v_mul_f32 v69, 0xbfb8aa3b, v65
    v_lshlrev_b32 v66, 16, v66
    v_mfma_f32_16x16x32_bf16 v[228:231], v[36:39], a[44:47], v[228:231]
    s_waitcnt vmcnt(8)
    s_waitcnt lgkmcnt(6)
    v_mul_f32 v70, 0xbfb8aa3b, v66
    v_lshlrev_b32 v67, 16, v67
    v_mfma_f32_16x16x32_bf16 v[136:139], v[40:43], a[32:35], v[136:139]
    s_nop 0
    ds_read_b64_tr_b16 v[60:61], v15 offset:16384
    ds_read_b64_tr_b16 v[62:63], v15 offset:17408
    v_mfma_f32_16x16x32_bf16 v[200:203], v[40:43], a[36:39], v[200:203]
    buffer_load_dwordx4 a[4:7], v26, s[40:43], s61 offen offset:0 sc1
    v_mfma_f32_16x16x32_bf16 v[168:171], v[40:43], a[40:43], v[168:171]
    v_mul_f32 v71, 0xbfb8aa3b, v67
    v_exp_f32 v68, v68
    v_mfma_f32_16x16x32_bf16 v[232:235], v[40:43], a[44:47], v[232:235]
    v_exp_f32 v69, v69
    v_mfma_f32_16x16x32_bf16 v[140:143], v[44:47], a[32:35], v[140:143]
    s_nop 0
    ds_read_b64_tr_b16 v[32:33], v8 offset:24576
    ds_read_b64_tr_b16 v[34:35], v8 offset:25600
    v_mfma_f32_16x16x32_bf16 v[204:207], v[44:47], a[36:39], v[204:207]
    buffer_load_dwordx4 a[8:11], v2, s[40:43], s62 offen offset:0 sc1
    v_mfma_f32_16x16x32_bf16 v[172:175], v[44:47], a[40:43], v[172:175]
    v_exp_f32 v70, v70
    v_mfma_f32_16x16x32_bf16 v[236:239], v[44:47], a[44:47], v[236:239]
    s_waitcnt lgkmcnt(6)
    v_exp_f32 v71, v71
    v_mfma_f32_16x16x32_bf16 v[144:147], v[48:51], a[32:35], v[144:147]
    s_nop 0
    ds_read_b64_tr_b16 v[36:37], v9 offset:24576
    ds_read_b64_tr_b16 v[38:39], v9 offset:25600
    v_mfma_f32_16x16x32_bf16 v[208:211], v[48:51], a[36:39], v[208:211]
    buffer_load_dwordx4 a[12:15], v26, s[40:43], s62 offen offset:0 sc1
    v_mfma_f32_16x16x32_bf16 v[176:179], v[48:51], a[40:43], v[176:179]
    v_add_f32 v68, 1.0, v68
    v_add_f32 v69, 1.0, v69
    v_mfma_f32_16x16x32_bf16 v[240:243], v[48:51], a[44:47], v[240:243]
    v_add_f32 v70, 1.0, v70
    v_add_f32 v71, 1.0, v71
    v_mfma_f32_16x16x32_bf16 v[148:151], v[52:55], a[32:35], v[148:151]
    s_nop 0
    ds_read_b64_tr_b16 v[40:41], v10 offset:24576
    ds_read_b64_tr_b16 v[42:43], v10 offset:25600
    v_mfma_f32_16x16x32_bf16 v[212:215], v[52:55], a[36:39], v[212:215]
    buffer_load_dwordx4 a[16:19], v2, s[40:43], s61 offen offset:1024 sc1
    v_mfma_f32_16x16x32_bf16 v[180:183], v[52:55], a[40:43], v[180:183]
    v_rcp_f32 v68, v68
    v_mfma_f32_16x16x32_bf16 v[244:247], v[52:55], a[44:47], v[244:247]
    s_waitcnt lgkmcnt(6)
    v_rcp_f32 v69, v69
    v_mfma_f32_16x16x32_bf16 v[152:155], v[56:59], a[32:35], v[152:155]
    s_nop 0
    ds_read_b64_tr_b16 v[44:45], v11 offset:24576
    ds_read_b64_tr_b16 v[46:47], v11 offset:25600
    v_mfma_f32_16x16x32_bf16 v[216:219], v[56:59], a[36:39], v[216:219]
    buffer_load_dwordx4 a[20:23], v26, s[40:43], s61 offen offset:1024 sc1
    v_mfma_f32_16x16x32_bf16 v[184:187], v[56:59], a[40:43], v[184:187]
    v_rcp_f32 v70, v70
    v_mfma_f32_16x16x32_bf16 v[248:251], v[56:59], a[44:47], v[248:251]
    v_rcp_f32 v71, v71
    v_mfma_f32_16x16x32_bf16 v[156:159], v[60:63], a[32:35], v[156:159]
    s_nop 0
    ds_read_b64_tr_b16 v[48:49], v12 offset:24576
    ds_read_b64_tr_b16 v[50:51], v12 offset:25600
    v_mfma_f32_16x16x32_bf16 v[220:223], v[60:63], a[36:39], v[220:223]
    buffer_load_dwordx4 a[24:27], v2, s[40:43], s62 offen offset:1024 sc1
    v_mfma_f32_16x16x32_bf16 v[188:191], v[60:63], a[40:43], v[188:191]
    v_mul_f32 v64, v64, v68
    v_mul_f32 v65, v65, v69
    v_mfma_f32_16x16x32_bf16 v[252:255], v[60:63], a[44:47], v[252:255]
    s_waitcnt lgkmcnt(6)
    v_mul_f32 v66, v66, v70
    v_mul_f32 v67, v67, v71
    v_mfma_f32_16x16x32_bf16 v[128:131], v[32:35], a[48:51], v[128:131]
    s_nop 0
    ds_read_b64_tr_b16 v[52:53], v13 offset:24576
    ds_read_b64_tr_b16 v[54:55], v13 offset:25600
    v_mfma_f32_16x16x32_bf16 v[192:195], v[32:35], a[52:55], v[192:195]
    buffer_load_dwordx4 a[28:31], v26, s[40:43], s62 offen offset:1024 sc1
    v_mfma_f32_16x16x32_bf16 v[160:163], v[32:35], a[56:59], v[160:163]
    v_accvgpr_read_b32 v18, a224
    v_accvgpr_read_b32 v19, a225
    v_mfma_f32_16x16x32_bf16 v[224:227], v[32:35], a[60:63], v[224:227]
    v_cvt_pk_bf16_f32 v20, v18, v19
    v_accvgpr_read_b32 v18, a226
    v_mfma_f32_16x16x32_bf16 v[132:135], v[36:39], a[48:51], v[132:135]
    s_nop 0
    ds_read_b64_tr_b16 v[56:57], v14 offset:24576
    ds_read_b64_tr_b16 v[58:59], v14 offset:25600
    v_mfma_f32_16x16x32_bf16 v[196:199], v[36:39], a[52:55], v[196:199]
    v_accvgpr_read_b32 v19, a227
    v_cvt_pk_bf16_f32 v21, v18, v19
    v_mfma_f32_16x16x32_bf16 v[164:167], v[36:39], a[56:59], v[164:167]
    v_accvgpr_read_b32 v18, a228
    v_accvgpr_read_b32 v19, a229
    v_mfma_f32_16x16x32_bf16 v[228:231], v[36:39], a[60:63], v[228:231]
    s_waitcnt lgkmcnt(6)
    v_cvt_pk_bf16_f32 v22, v18, v19
    v_accvgpr_read_b32 v18, a230
    v_mfma_f32_16x16x32_bf16 v[136:139], v[40:43], a[48:51], v[136:139]
    s_nop 0
    ds_read_b64_tr_b16 v[60:61], v15 offset:24576
    ds_read_b64_tr_b16 v[62:63], v15 offset:25600
    v_mfma_f32_16x16x32_bf16 v[200:203], v[40:43], a[52:55], v[200:203]
    v_accvgpr_read_b32 v19, a231
    v_cvt_pk_bf16_f32 v23, v18, v19
    v_mfma_f32_16x16x32_bf16 v[168:171], v[40:43], a[56:59], v[168:171]
    s_add_u32 s63, s56, 57344
    buffer_store_dwordx4 v[20:23], v2, s[44:47], s63 offen sc1
    v_mfma_f32_16x16x32_bf16 v[232:235], v[40:43], a[60:63], v[232:235]
    v_accvgpr_read_b32 v18, a232
    v_accvgpr_read_b32 v19, a233
    v_cvt_pk_bf16_f32 v20, v18, v19
    v_accvgpr_read_b32 v18, a234
    v_accvgpr_read_b32 v19, a235
    v_cvt_pk_bf16_f32 v21, v18, v19
    v_accvgpr_read_b32 v18, a236
    v_accvgpr_read_b32 v19, a237
    v_cvt_pk_bf16_f32 v22, v18, v19
    v_accvgpr_read_b32 v18, a238
    v_accvgpr_read_b32 v19, a239
    v_cvt_pk_bf16_f32 v23, v18, v19
    s_add_u32 s63, s56, 61440
    buffer_store_dwordx4 v[20:23], v2, s[44:47], s63 offen sc1
    s_barrier
    v_mfma_f32_16x16x32_bf16 v[140:143], v[44:47], a[48:51], v[140:143]
    v_add_u32 v8, 0xffff0000, v8
    v_add_u32 v9, 0xffff0000, v9
    v_add_u32 v10, 0xffff0000, v10
    v_add_u32 v11, 0xffff0000, v11
    v_add_u32 v12, 0xffff0000, v12
    v_add_u32 v13, 0xffff0000, v13
    v_add_u32 v14, 0xffff0000, v14
    v_add_u32 v15, 0xffff0000, v15
    ds_read_b64_tr_b16 v[32:33], v8 offset:49152
    ds_read_b64_tr_b16 v[34:35], v8 offset:50176
    v_mfma_f32_16x16x32_bf16 v[204:207], v[44:47], a[52:55], v[204:207]
    v_cvt_pk_bf16_f32 v64, v64, v64
    v_cvt_pk_bf16_f32 v65, v65, v65
    v_mfma_f32_16x16x32_bf16 v[172:175], v[44:47], a[56:59], v[172:175]
    v_cvt_pk_bf16_f32 v66, v66, v66
    v_cvt_pk_bf16_f32 v67, v67, v67
    v_mfma_f32_16x16x32_bf16 v[236:239], v[44:47], a[60:63], v[236:239]
    s_waitcnt lgkmcnt(2)
    v_lshlrev_b32 v64, 16, v64
    v_lshlrev_b32 v65, 16, v65
    v_mfma_f32_16x16x32_bf16 v[144:147], v[48:51], a[48:51], v[144:147]
    s_nop 0
    ds_read_b64_tr_b16 v[36:37], v9 offset:49152
    ds_read_b64_tr_b16 v[38:39], v9 offset:50176
    v_mfma_f32_16x16x32_bf16 v[208:211], v[48:51], a[52:55], v[208:211]
    v_lshlrev_b32 v66, 16, v66
    v_lshlrev_b32 v67, 16, v67
    v_mfma_f32_16x16x32_bf16 v[176:179], v[48:51], a[56:59], v[176:179]
    s_waitcnt vmcnt(16)
    v_lshlrev_b32 v28, 16, v72
    v_and_b32 v29, 0xffff0000, v72
    v_mfma_f32_16x16x32_bf16 v[240:243], v[48:51], a[60:63], v[240:243]
    v_mul_f32 v88, v28, v64
    v_mul_f32 v89, v29, v64
    v_mfma_f32_16x16x32_bf16 v[148:151], v[52:55], a[48:51], v[148:151]
    s_nop 0
    ds_read_b64_tr_b16 v[40:41], v10 offset:49152
    ds_read_b64_tr_b16 v[42:43], v10 offset:50176
    v_mfma_f32_16x16x32_bf16 v[212:215], v[52:55], a[52:55], v[212:215]
    v_accvgpr_read_b32 v18, a240
    v_accvgpr_read_b32 v19, a241
    v_mfma_f32_16x16x32_bf16 v[180:183], v[52:55], a[56:59], v[180:183]
    v_cvt_pk_bf16_f32 v20, v18, v19
    v_accvgpr_read_b32 v18, a242
    v_mfma_f32_16x16x32_bf16 v[244:247], v[52:55], a[60:63], v[244:247]
    v_accvgpr_read_b32 v19, a243
    v_cvt_pk_bf16_f32 v21, v18, v19
    v_mfma_f32_16x16x32_bf16 v[152:155], v[56:59], a[48:51], v[152:155]
    s_nop 0
    ds_read_b64_tr_b16 v[44:45], v11 offset:49152
    ds_read_b64_tr_b16 v[46:47], v11 offset:50176
    v_mfma_f32_16x16x32_bf16 v[216:219], v[56:59], a[52:55], v[216:219]
    v_accvgpr_read_b32 v18, a244
    v_accvgpr_read_b32 v19, a245
    v_mfma_f32_16x16x32_bf16 v[184:187], v[56:59], a[56:59], v[184:187]
    v_cvt_pk_bf16_f32 v22, v18, v19
    v_accvgpr_read_b32 v18, a246
    v_mfma_f32_16x16x32_bf16 v[248:251], v[56:59], a[60:63], v[248:251]
    v_accvgpr_read_b32 v19, a247
    v_cvt_pk_bf16_f32 v23, v18, v19
    v_mfma_f32_16x16x32_bf16 v[156:159], v[60:63], a[48:51], v[156:159]
    s_nop 0
    ds_read_b64_tr_b16 v[48:49], v12 offset:49152
    ds_read_b64_tr_b16 v[50:51], v12 offset:50176
    v_mfma_f32_16x16x32_bf16 v[220:223], v[60:63], a[52:55], v[220:223]
    s_add_u32 s63, s57, 57344
    buffer_store_dwordx4 v[20:23], v2, s[48:51], s63 offen sc1
    v_mfma_f32_16x16x32_bf16 v[188:191], v[60:63], a[56:59], v[188:191]
    v_lshlrev_b32 v28, 16, v73
    v_and_b32 v29, 0xffff0000, v73
    v_mfma_f32_16x16x32_bf16 v[252:255], v[60:63], a[60:63], v[252:255]
    s_waitcnt lgkmcnt(6)
    v_mul_f32 v90, v28, v64
    v_mul_f32 v91, v29, v64
    v_mfma_f32_16x16x32_bf16 v[128:131], v[32:35], a[64:67], v[128:131]
    s_nop 0
    ds_read_b64_tr_b16 v[52:53], v13 offset:49152
    ds_read_b64_tr_b16 v[54:55], v13 offset:50176
    v_mfma_f32_16x16x32_bf16 v[192:195], v[32:35], a[68:71], v[192:195]
    s_xor_b32 s61, s24, 14336
    s_xor_b32 s62, s25, 14336
    v_lshlrev_b32 v28, 16, v74
    v_mfma_f32_16x16x32_bf16 v[160:163], v[32:35], a[72:75], v[160:163]
    buffer_load_dwordx4 a[32:35], v2, s[40:43], s61 offen offset:0 sc1
    v_mfma_f32_16x16x32_bf16 v[224:227], v[32:35], a[76:79], v[224:227]
    v_and_b32 v29, 0xffff0000, v74
    v_mul_f32 v92, v28, v64
    v_mfma_f32_16x16x32_bf16 v[132:135], v[36:39], a[64:67], v[132:135]
    s_nop 0
    ds_read_b64_tr_b16 v[56:57], v14 offset:49152
    ds_read_b64_tr_b16 v[58:59], v14 offset:50176
    v_mfma_f32_16x16x32_bf16 v[196:199], v[36:39], a[68:71], v[196:199]
    v_mul_f32 v93, v29, v64
    v_lshlrev_b32 v28, 16, v75
    v_mfma_f32_16x16x32_bf16 v[164:167], v[36:39], a[72:75], v[164:167]
    buffer_load_dwordx4 a[36:39], v26, s[40:43], s61 offen offset:0 sc1
    v_mfma_f32_16x16x32_bf16 v[228:231], v[36:39], a[76:79], v[228:231]
    s_waitcnt lgkmcnt(6)
    v_and_b32 v29, 0xffff0000, v75
    v_mul_f32 v94, v28, v64
    v_mfma_f32_16x16x32_bf16 v[136:139], v[40:43], a[64:67], v[136:139]
    s_nop 0
    ds_read_b64_tr_b16 v[60:61], v15 offset:49152
    ds_read_b64_tr_b16 v[62:63], v15 offset:50176
    v_mfma_f32_16x16x32_bf16 v[200:203], v[40:43], a[68:71], v[200:203]
    s_waitcnt vmcnt(17)
    v_mul_f32 v95, v29, v64
    v_lshlrev_b32 v28, 16, v76
    v_mfma_f32_16x16x32_bf16 v[168:171], v[40:43], a[72:75], v[168:171]
    buffer_load_dwordx4 a[40:43], v2, s[40:43], s62 offen offset:0 sc1
    v_mfma_f32_16x16x32_bf16 v[232:235], v[40:43], a[76:79], v[232:235]
    v_and_b32 v29, 0xffff0000, v76
    v_fmac_f32 v88, v28, v65
    v_mfma_f32_16x16x32_bf16 v[140:143], v[44:47], a[64:67], v[140:143]
    s_nop 0
    ds_read_b64_tr_b16 v[32:33], v8 offset:57344
    ds_read_b64_tr_b16 v[34:35], v8 offset:58368
    v_mfma_f32_16x16x32_bf16 v[204:207], v[44:47], a[68:71], v[204:207]
    v_fmac_f32 v89, v29, v65
    v_lshlrev_b32 v28, 16, v77
    v_mfma_f32_16x16x32_bf16 v[172:175], v[44:47], a[72:75], v[172:175]
    buffer_load_dwordx4 a[44:47], v26, s[40:43], s62 offen offset:0 sc1
    v_mfma_f32_16x16x32_bf16 v[236:239], v[44:47], a[76:79], v[236:239]
    s_waitcnt lgkmcnt(6)
    v_and_b32 v29, 0xffff0000, v77
    v_fmac_f32 v90, v28, v65
    v_mfma_f32_16x16x32_bf16 v[144:147], v[48:51], a[64:67], v[144:147]
    s_nop 0
    ds_read_b64_tr_b16 v[36:37], v9 offset:57344
    ds_read_b64_tr_b16 v[38:39], v9 offset:58368
    v_mfma_f32_16x16x32_bf16 v[208:211], v[48:51], a[68:71], v[208:211]
    v_fmac_f32 v91, v29, v65
    v_lshlrev_b32 v28, 16, v78
    v_mfma_f32_16x16x32_bf16 v[176:179], v[48:51], a[72:75], v[176:179]
    buffer_load_dwordx4 a[48:51], v2, s[40:43], s61 offen offset:1024 sc1
    v_mfma_f32_16x16x32_bf16 v[240:243], v[48:51], a[76:79], v[240:243]
    v_and_b32 v29, 0xffff0000, v78
    v_fmac_f32 v92, v28, v65
    v_mfma_f32_16x16x32_bf16 v[148:151], v[52:55], a[64:67], v[148:151]
    s_nop 0
    ds_read_b64_tr_b16 v[40:41], v10 offset:57344
    ds_read_b64_tr_b16 v[42:43], v10 offset:58368
    v_mfma_f32_16x16x32_bf16 v[212:215], v[52:55], a[68:71], v[212:215]
    v_fmac_f32 v93, v29, v65
    v_lshlrev_b32 v28, 16, v79
    v_mfma_f32_16x16x32_bf16 v[180:183], v[52:55], a[72:75], v[180:183]
    buffer_load_dwordx4 a[52:55], v26, s[40:43], s61 offen offset:1024 sc1
    v_mfma_f32_16x16x32_bf16 v[244:247], v[52:55], a[76:79], v[244:247]
    s_waitcnt lgkmcnt(6)
    v_and_b32 v29, 0xffff0000, v79
    v_fmac_f32 v94, v28, v65
    v_mfma_f32_16x16x32_bf16 v[152:155], v[56:59], a[64:67], v[152:155]
    s_nop 0
    ds_read_b64_tr_b16 v[44:45], v11 offset:57344
    ds_read_b64_tr_b16 v[46:47], v11 offset:58368
    v_mfma_f32_16x16x32_bf16 v[216:219], v[56:59], a[68:71], v[216:219]
    s_waitcnt vmcnt(20)
    v_fmac_f32 v95, v29, v65
    v_lshlrev_b32 v28, 16, v80
    v_mfma_f32_16x16x32_bf16 v[184:187], v[56:59], a[72:75], v[184:187]
    buffer_load_dwordx4 a[56:59], v2, s[40:43], s62 offen offset:1024 sc1
    v_mfma_f32_16x16x32_bf16 v[248:251], v[56:59], a[76:79], v[248:251]
    v_and_b32 v29, 0xffff0000, v80
    v_fmac_f32 v88, v28, v66
    v_mfma_f32_16x16x32_bf16 v[156:159], v[60:63], a[64:67], v[156:159]
    s_nop 0
    ds_read_b64_tr_b16 v[48:49], v12 offset:57344
    ds_read_b64_tr_b16 v[50:51], v12 offset:58368
    v_mfma_f32_16x16x32_bf16 v[220:223], v[60:63], a[68:71], v[220:223]
    v_fmac_f32 v89, v29, v66
    v_lshlrev_b32 v28, 16, v81
    v_mfma_f32_16x16x32_bf16 v[188:191], v[60:63], a[72:75], v[188:191]
    buffer_load_dwordx4 a[60:63], v26, s[40:43], s62 offen offset:1024 sc1
    v_mfma_f32_16x16x32_bf16 v[252:255], v[60:63], a[76:79], v[252:255]
    s_waitcnt lgkmcnt(6)
    v_accvgpr_read_b32 v18, a248
    v_accvgpr_read_b32 v19, a249
    v_mfma_f32_16x16x32_bf16 v[128:131], v[32:35], a[80:83], v[128:131]
    s_nop 0
    ds_read_b64_tr_b16 v[52:53], v13 offset:57344
    ds_read_b64_tr_b16 v[54:55], v13 offset:58368
    v_mfma_f32_16x16x32_bf16 v[192:195], v[32:35], a[84:87], v[192:195]
    v_cvt_pk_bf16_f32 v20, v18, v19
    v_accvgpr_read_b32 v18, a250
    v_mfma_f32_16x16x32_bf16 v[160:163], v[32:35], a[88:91], v[160:163]
    v_accvgpr_read_b32 v19, a251
    v_cvt_pk_bf16_f32 v21, v18, v19
    v_mfma_f32_16x16x32_bf16 v[224:227], v[32:35], a[92:95], v[224:227]
    v_accvgpr_read_b32 v18, a252
    v_accvgpr_read_b32 v19, a253
    v_mfma_f32_16x16x32_bf16 v[132:135], v[36:39], a[80:83], v[132:135]
    s_nop 0
    ds_read_b64_tr_b16 v[56:57], v14 offset:57344
    ds_read_b64_tr_b16 v[58:59], v14 offset:58368
    v_mfma_f32_16x16x32_bf16 v[196:199], v[36:39], a[84:87], v[196:199]
    v_cvt_pk_bf16_f32 v22, v18, v19
    v_accvgpr_read_b32 v18, a254
    v_mfma_f32_16x16x32_bf16 v[164:167], v[36:39], a[88:91], v[164:167]
    v_accvgpr_read_b32 v19, a255
    v_cvt_pk_bf16_f32 v23, v18, v19
    v_mfma_f32_16x16x32_bf16 v[228:231], v[36:39], a[92:95], v[228:231]
    s_add_u32 s63, s57, 58368
    s_waitcnt lgkmcnt(6)
    buffer_store_dwordx4 v[20:23], v2, s[48:51], s63 offen sc1
    v_mfma_f32_16x16x32_bf16 v[136:139], v[40:43], a[80:83], v[136:139]
    s_nop 0
    ds_read_b64_tr_b16 v[60:61], v15 offset:57344
    ds_read_b64_tr_b16 v[62:63], v15 offset:58368
    v_mfma_f32_16x16x32_bf16 v[200:203], v[40:43], a[84:87], v[200:203]
    v_and_b32 v29, 0xffff0000, v81
    v_fmac_f32 v90, v28, v66
    v_mfma_f32_16x16x32_bf16 v[168:171], v[40:43], a[88:91], v[168:171]
    v_fmac_f32 v91, v29, v66
    v_lshlrev_b32 v28, 16, v82
    v_mfma_f32_16x16x32_bf16 v[232:235], v[40:43], a[92:95], v[232:235]
    v_and_b32 v29, 0xffff0000, v82
    v_fmac_f32 v92, v28, v66
    v_fmac_f32 v93, v29, v66
    v_lshlrev_b32 v28, 16, v83
    v_and_b32 v29, 0xffff0000, v83
    v_fmac_f32 v94, v28, v66
    v_fmac_f32 v95, v29, v66
    s_waitcnt vmcnt(21)
    v_lshlrev_b32 v28, 16, v84
    v_and_b32 v29, 0xffff0000, v84
    v_fmac_f32 v88, v28, v67
    v_fmac_f32 v89, v29, v67
    v_lshlrev_b32 v28, 16, v85
    v_and_b32 v29, 0xffff0000, v85
    v_fmac_f32 v90, v28, v67
    v_fmac_f32 v91, v29, v67
    v_lshlrev_b32 v28, 16, v86
    v_and_b32 v29, 0xffff0000, v86
    v_fmac_f32 v92, v28, v67
    v_fmac_f32 v93, v29, v67
    v_lshlrev_b32 v28, 16, v87
    v_and_b32 v29, 0xffff0000, v87
    v_fmac_f32 v94, v28, v67
    v_fmac_f32 v95, v29, v67
    v_add_f32_dpp v88, v88, v88 quad_perm:[2,3,0,1] row_mask:0xf bank_mask:0xf
    v_add_f32_dpp v89, v89, v89 quad_perm:[2,3,0,1] row_mask:0xf bank_mask:0xf
    v_add_f32_dpp v90, v90, v90 quad_perm:[2,3,0,1] row_mask:0xf bank_mask:0xf
    v_add_f32_dpp v91, v91, v91 quad_perm:[2,3,0,1] row_mask:0xf bank_mask:0xf
    v_add_f32_dpp v92, v92, v92 quad_perm:[2,3,0,1] row_mask:0xf bank_mask:0xf
    v_add_f32_dpp v93, v93, v93 quad_perm:[2,3,0,1] row_mask:0xf bank_mask:0xf
    v_add_f32_dpp v94, v94, v94 quad_perm:[2,3,0,1] row_mask:0xf bank_mask:0xf
    v_add_f32_dpp v95, v95, v95 quad_perm:[2,3,0,1] row_mask:0xf bank_mask:0xf
    v_add_f32_dpp v88, v88, v88 row_ror:4 row_mask:0xf bank_mask:0xf
    v_add_f32_dpp v89, v89, v89 row_ror:4 row_mask:0xf bank_mask:0xf
    v_add_f32_dpp v90, v90, v90 row_ror:4 row_mask:0xf bank_mask:0xf
    v_add_f32_dpp v91, v91, v91 row_ror:4 row_mask:0xf bank_mask:0xf
    v_add_f32_dpp v92, v92, v92 row_ror:4 row_mask:0xf bank_mask:0xf
    v_add_f32_dpp v93, v93, v93 row_ror:4 row_mask:0xf bank_mask:0xf
    v_add_f32_dpp v94, v94, v94 row_ror:4 row_mask:0xf bank_mask:0xf
    v_add_f32_dpp v95, v95, v95 row_ror:4 row_mask:0xf bank_mask:0xf
    v_add_f32_dpp v88, v88, v88 row_ror:8 row_mask:0xf bank_mask:0xf
    v_add_f32_dpp v89, v89, v89 row_ror:8 row_mask:0xf bank_mask:0xf
    v_add_f32_dpp v90, v90, v90 row_ror:8 row_mask:0xf bank_mask:0xf
    v_add_f32_dpp v91, v91, v91 row_ror:8 row_mask:0xf bank_mask:0xf
    v_add_f32_dpp v92, v92, v92 row_ror:8 row_mask:0xf bank_mask:0xf
    v_add_f32_dpp v93, v93, v93 row_ror:8 row_mask:0xf bank_mask:0xf
    v_add_f32_dpp v94, v94, v94 row_ror:8 row_mask:0xf bank_mask:0xf
    v_add_f32_dpp v95, v95, v95 row_ror:8 row_mask:0xf bank_mask:0xf
    v_lshrrev_b32 v28, 4, v0
    v_lshlrev_b32 v28, 6, v28
    v_and_b32 v29, 1, v0
    v_lshl_add_u32 v28, v29, 5, v28
    v_add_u32 v28, 0x24000, v28
    ds_write_b128 v28, v[88:91]
    ds_write_b128 v28, v[92:95] offset:16
    s_waitcnt lgkmcnt(0)
    s_barrier
    v_mfma_f32_16x16x32_bf16 v[140:143], v[44:47], a[80:83], v[140:143]
    v_add_u32 v8, 0x10000, v8
    v_add_u32 v9, 0x10000, v9
    v_add_u32 v10, 0x10000, v10
    v_add_u32 v11, 0x10000, v11
    v_add_u32 v12, 0x10000, v12
    v_add_u32 v13, 0x10000, v13
    v_add_u32 v14, 0x10000, v14
    v_add_u32 v15, 0x10000, v15
    ds_read_b64_tr_b16 v[32:33], v8 offset:32768
    ds_read_b64_tr_b16 v[34:35], v8 offset:33792
    v_mfma_f32_16x16x32_bf16 v[204:207], v[44:47], a[84:87], v[204:207]
    v_and_b32 v28, 15, v0
    v_lshlrev_b32 v28, 2, v28
    v_mfma_f32_16x16x32_bf16 v[172:175], v[44:47], a[88:91], v[172:175]
    v_add_u32 v29, 0x24000, v28
    ds_read_b32 v72, v29 offset:0
    v_mfma_f32_16x16x32_bf16 v[236:239], v[44:47], a[92:95], v[236:239]
    s_nop 0
    ds_read_b32 v73, v29 offset:64
    ds_read_b32 v74, v29 offset:128
    v_mfma_f32_16x16x32_bf16 v[144:147], v[48:51], a[80:83], v[144:147]
    s_nop 0
    ds_read_b64_tr_b16 v[36:37], v9 offset:32768
    ds_read_b64_tr_b16 v[38:39], v9 offset:33792
    v_mfma_f32_16x16x32_bf16 v[208:211], v[48:51], a[84:87], v[208:211]
    s_nop 0
    ds_read_b32 v75, v29 offset:192
    ds_read_b32 v76, v29 offset:256
    v_mfma_f32_16x16x32_bf16 v[176:179], v[48:51], a[88:91], v[176:179]
    s_nop 0
    ds_read_b32 v77, v29 offset:320
    ds_read_b32 v78, v29 offset:384
    v_mfma_f32_16x16x32_bf16 v[240:243], v[48:51], a[92:95], v[240:243]
    s_nop 0
    ds_read_b32 v79, v29 offset:448
    ds_read_b32 v80, v29 offset:512
    v_mfma_f32_16x16x32_bf16 v[148:151], v[52:55], a[80:83], v[148:151]
    s_nop 0
    ds_read_b64_tr_b16 v[40:41], v10 offset:32768
    ds_read_b64_tr_b16 v[42:43], v10 offset:33792
    v_mfma_f32_16x16x32_bf16 v[212:215], v[52:55], a[84:87], v[212:215]
    s_nop 0
    ds_read_b32 v81, v29 offset:576
    ds_read_b32 v82, v29 offset:640
    v_mfma_f32_16x16x32_bf16 v[180:183], v[52:55], a[88:91], v[180:183]
    s_nop 0
    ds_read_b32 v83, v29 offset:704
    ds_read_b32 v84, v29 offset:768
    v_mfma_f32_16x16x32_bf16 v[244:247], v[52:55], a[92:95], v[244:247]
    s_nop 0
    ds_read_b32 v85, v29 offset:832
    ds_read_b32 v86, v29 offset:896
    v_mfma_f32_16x16x32_bf16 v[152:155], v[56:59], a[80:83], v[152:155]
    s_nop 0
    ds_read_b64_tr_b16 v[44:45], v11 offset:32768
    ds_read_b64_tr_b16 v[46:47], v11 offset:33792
    v_mfma_f32_16x16x32_bf16 v[216:219], v[56:59], a[84:87], v[216:219]
    s_waitcnt vmcnt(0)
    v_mov_b32 v27, 1
    s_mov_b64 exec, 1
    buffer_atomic_add v27, off, s[84:87], s35 sc1
    s_mov_b64 exec, -1
    s_nop 0
    v_mfma_f32_16x16x32_bf16 v[184:187], v[56:59], a[88:91], v[184:187]
    s_lshl_b32 s22, s21, 6
    ds_read_b32 v87, v29 offset:960
    v_mfma_f32_16x16x32_bf16 v[248:251], v[56:59], a[92:95], v[248:251]
    s_lshr_b32 s23, s21, 5
    s_cmp_eq_u32 s23, 4
    s_cselect_b32 s23, 1.0, 0
    s_cmp_ge_u32 s16, 2
    s_cselect_b32 s22, s22, 0x40000000
    v_mfma_f32_16x16x32_bf16 v[156:159], v[60:63], a[80:83], v[156:159]
    s_nop 0
    ds_read_b64_tr_b16 v[48:49], v12 offset:32768
    ds_read_b64_tr_b16 v[50:51], v12 offset:33792
    v_mfma_f32_16x16x32_bf16 v[220:223], v[60:63], a[84:87], v[220:223]
    s_cmp_eq_u32 s3, 0
    s_cselect_b32 s22, s22, 0x40000000
    s_waitcnt lgkmcnt(13)
    s_waitcnt lgkmcnt(10)
    v_add_f32 v72, v72, v80
    v_add_f32 v73, v73, v81
    v_mfma_f32_16x16x32_bf16 v[188:191], v[60:63], a[88:91], v[188:191]
    s_waitcnt lgkmcnt(9)
    s_waitcnt lgkmcnt(8)
    v_add_f32 v74, v74, v82
    v_add_f32 v75, v75, v83
    v_mfma_f32_16x16x32_bf16 v[252:255], v[60:63], a[92:95], v[252:255]
    s_waitcnt lgkmcnt(7)
    s_waitcnt lgkmcnt(6)
    v_add_f32 v76, v76, v84
    v_add_f32 v77, v77, v85
    v_mfma_f32_16x16x32_bf16 v[128:131], v[32:35], a[96:99], v[128:131]
    s_nop 0
    ds_read_b64_tr_b16 v[52:53], v13 offset:32768
    ds_read_b64_tr_b16 v[54:55], v13 offset:33792
    v_mfma_f32_16x16x32_bf16 v[192:195], v[32:35], a[100:103], v[192:195]
    s_getpc_b64 s[56:57]
main_pc11:
    s_lshr_b32 s63, s2, 3
    v_mfma_f32_16x16x32_bf16 v[160:163], v[32:35], a[104:107], v[160:163]
    s_lshl_b32 s63, s63, 2
    s_add_u32 s63, s63, s3
    s_lshl_b32 s63, s63, 7
    v_mfma_f32_16x16x32_bf16 v[224:227], v[32:35], a[108:111], v[224:227]
    s_add_u32 s63, s63, main_tail2-main_pc11-16384
    s_add_u32 s56, s56, s63
    s_addc_u32 s57, s57, 0
    v_mov_b32 v18, s56
    v_mfma_f32_16x16x32_bf16 v[132:135], v[36:39], a[96:99], v[132:135]
    s_nop 0
    ds_read_b64_tr_b16 v[56:57], v14 offset:32768
    ds_read_b64_tr_b16 v[58:59], v14 offset:33792
    v_mfma_f32_16x16x32_bf16 v[196:199], v[36:39], a[100:103], v[196:199]
    v_mov_b32 v19, s57
    global_load_dword v3, v[18:19], off
    v_mfma_f32_16x16x32_bf16 v[164:167], v[36:39], a[104:107], v[164:167]
    s_waitcnt lgkmcnt(6)
    v_add_f32 v78, v78, v86
    v_add_f32 v79, v79, v87
    v_mfma_f32_16x16x32_bf16 v[228:231], v[36:39], a[108:111], v[228:231]
    v_add_f32 v72, v72, v76
    v_add_f32 v73, v73, v77
    v_mfma_f32_16x16x32_bf16 v[136:139], v[40:43], a[96:99], v[136:139]
    s_nop 0
    ds_read_b64_tr_b16 v[60:61], v15 offset:32768
    ds_read_b64_tr_b16 v[62:63], v15 offset:33792
    v_mfma_f32_16x16x32_bf16 v[200:203], v[40:43], a[100:103], v[200:203]
    v_add_f32 v74, v74, v78
    v_add_f32 v75, v75, v79
    v_mfma_f32_16x16x32_bf16 v[168:171], v[40:43], a[104:107], v[168:171]
    v_add_f32 v72, v72, v74
    v_add_f32 v73, v73, v75
    v_mfma_f32_16x16x32_bf16 v[232:235], v[40:43], a[108:111], v[232:235]
    v_add_f32 v72, v72, v73
    v_cvt_pk_bf16_f32 v72, v72, v72
    v_mfma_f32_16x16x32_bf16 v[140:143], v[44:47], a[96:99], v[140:143]
    s_nop 0
    ds_read_b64_tr_b16 v[32:33], v8 offset:40960
    ds_read_b64_tr_b16 v[34:35], v8 offset:41984
    v_mfma_f32_16x16x32_bf16 v[204:207], v[44:47], a[100:103], v[204:207]
    v_lshlrev_b32 v72, 16, v72
    v_add_f32 v72, s23, v72
    v_mfma_f32_16x16x32_bf16 v[172:175], v[44:47], a[104:107], v[172:175]
    v_cvt_pk_bf16_f32 v72, v72, v72
    v_lshlrev_b32 v72, 16, v72
    v_mfma_f32_16x16x32_bf16 v[236:239], v[44:47], a[108:111], v[236:239]
    s_waitcnt lgkmcnt(6)
    buffer_store_dword v72, v28, s[84:87], s22 offen sc1
    v_mfma_f32_16x16x32_bf16 v[144:147], v[48:51], a[96:99], v[144:147]
    s_nop 0
    ds_read_b64_tr_b16 v[36:37], v9 offset:40960
    ds_read_b64_tr_b16 v[38:39], v9 offset:41984
    v_mfma_f32_16x16x32_bf16 v[208:211], v[48:51], a[100:103], v[208:211]
    v_mfma_f32_16x16x32_bf16 v[176:179], v[48:51], a[104:107], v[176:179]
    v_mfma_f32_16x16x32_bf16 v[240:243], v[48:51], a[108:111], v[240:243]
    v_mfma_f32_16x16x32_bf16 v[148:151], v[52:55], a[96:99], v[148:151]
    s_nop 0
    ds_read_b64_tr_b16 v[40:41], v10 offset:40960
    ds_read_b64_tr_b16 v[42:43], v10 offset:41984
    v_mfma_f32_16x16x32_bf16 v[212:215], v[52:55], a[100:103], v[212:215]
    v_mfma_f32_16x16x32_bf16 v[180:183], v[52:55], a[104:107], v[180:183]
    v_mfma_f32_16x16x32_bf16 v[244:247], v[52:55], a[108:111], v[244:247]
    s_waitcnt lgkmcnt(6)
    v_mfma_f32_16x16x32_bf16 v[152:155], v[56:59], a[96:99], v[152:155]
    s_nop 0
    ds_read_b64_tr_b16 v[44:45], v11 offset:40960
    ds_read_b64_tr_b16 v[46:47], v11 offset:41984
    v_mfma_f32_16x16x32_bf16 v[216:219], v[56:59], a[100:103], v[216:219]
    v_mfma_f32_16x16x32_bf16 v[184:187], v[56:59], a[104:107], v[184:187]
    v_mfma_f32_16x16x32_bf16 v[248:251], v[56:59], a[108:111], v[248:251]
    v_mfma_f32_16x16x32_bf16 v[156:159], v[60:63], a[96:99], v[156:159]
    s_nop 0
    ds_read_b64_tr_b16 v[48:49], v12 offset:40960
    ds_read_b64_tr_b16 v[50:51], v12 offset:41984
    v_mfma_f32_16x16x32_bf16 v[220:223], v[60:63], a[100:103], v[220:223]
    v_mfma_f32_16x16x32_bf16 v[188:191], v[60:63], a[104:107], v[188:191]
    v_mfma_f32_16x16x32_bf16 v[252:255], v[60:63], a[108:111], v[252:255]
    s_waitcnt lgkmcnt(6)
    v_mfma_f32_16x16x32_bf16 v[128:131], v[32:35], a[112:115], v[128:131]
    s_nop 0
    ds_read_b64_tr_b16 v[52:53], v13 offset:40960
    ds_read_b64_tr_b16 v[54:55], v13 offset:41984
    v_mfma_f32_16x16x32_bf16 v[192:195], v[32:35], a[116:119], v[192:195]
    v_mfma_f32_16x16x32_bf16 v[160:163], v[32:35], a[120:123], v[160:163]
    v_mfma_f32_16x16x32_bf16 v[224:227], v[32:35], a[124:127], v[224:227]
    v_mfma_f32_16x16x32_bf16 v[132:135], v[36:39], a[112:115], v[132:135]
    s_nop 0
    ds_read_b64_tr_b16 v[56:57], v14 offset:40960
    ds_read_b64_tr_b16 v[58:59], v14 offset:41984
    v_mfma_f32_16x16x32_bf16 v[196:199], v[36:39], a[116:119], v[196:199]
    v_mfma_f32_16x16x32_bf16 v[164:167], v[36:39], a[120:123], v[164:167]
    v_mfma_f32_16x16x32_bf16 v[228:231], v[36:39], a[124:127], v[228:231]
    s_waitcnt lgkmcnt(6)
    v_mfma_f32_16x16x32_bf16 v[136:139], v[40:43], a[112:115], v[136:139]
    s_nop 0
    ds_read_b64_tr_b16 v[60:61], v15 offset:40960
    ds_read_b64_tr_b16 v[62:63], v15 offset:41984
    v_mfma_f32_16x16x32_bf16 v[200:203], v[40:43], a[116:119], v[200:203]
    v_mfma_f32_16x16x32_bf16 v[168:171], v[40:43], a[120:123], v[168:171]
    v_mfma_f32_16x16x32_bf16 v[232:235], v[40:43], a[124:127], v[232:235]
    s_barrier
    v_mfma_f32_16x16x32_bf16 v[140:143], v[44:47], a[112:115], v[140:143]
    s_nop 0
    ds_read_b64_tr_b16 v[32:33], v8 offset:49152
    ds_read_b64_tr_b16 v[34:35], v8 offset:50176
    v_mfma_f32_16x16x32_bf16 v[204:207], v[44:47], a[116:119], v[204:207]
    v_mov_b32 v64, 0
    v_mov_b32 v65, 0
    v_mfma_f32_16x16x32_bf16 v[172:175], v[44:47], a[120:123], v[172:175]
    v_mov_b32 v66, 0
    v_mov_b32 v67, 0
    v_mfma_f32_16x16x32_bf16 v[236:239], v[44:47], a[124:127], v[236:239]
    s_waitcnt lgkmcnt(6)
    v_mov_b32 v68, 0
    v_mov_b32 v69, 0
    v_mfma_f32_16x16x32_bf16 v[144:147], v[48:51], a[112:115], v[144:147]
    s_nop 0
    ds_read_b64_tr_b16 v[36:37], v9 offset:49152
    ds_read_b64_tr_b16 v[38:39], v9 offset:50176
    v_mfma_f32_16x16x32_bf16 v[208:211], v[48:51], a[116:119], v[208:211]
    v_mov_b32 v70, 0
    v_mov_b32 v71, 0
    v_mfma_f32_16x16x32_bf16 v[176:179], v[48:51], a[120:123], v[176:179]
    v_mov_b32 v72, 0
    v_mov_b32 v73, 0
    v_mfma_f32_16x16x32_bf16 v[240:243], v[48:51], a[124:127], v[240:243]
    v_mov_b32 v74, 0
    v_mov_b32 v75, 0
    v_mfma_f32_16x16x32_bf16 v[148:151], v[52:55], a[112:115], v[148:151]
    s_nop 0
    ds_read_b64_tr_b16 v[40:41], v10 offset:49152
    ds_read_b64_tr_b16 v[42:43], v10 offset:50176
    v_mfma_f32_16x16x32_bf16 v[212:215], v[52:55], a[116:119], v[212:215]
    v_mov_b32 v76, 0
    v_mov_b32 v77, 0
    v_mfma_f32_16x16x32_bf16 v[180:183], v[52:55], a[120:123], v[180:183]
    v_mov_b32 v78, 0
    v_mov_b32 v79, 0
    v_mfma_f32_16x16x32_bf16 v[244:247], v[52:55], a[124:127], v[244:247]
    s_waitcnt lgkmcnt(6)
    v_mov_b32 v80, 0
    v_mov_b32 v81, 0
    v_mfma_f32_16x16x32_bf16 v[152:155], v[56:59], a[112:115], v[152:155]
    s_nop 0
    ds_read_b64_tr_b16 v[44:45], v11 offset:49152
    ds_read_b64_tr_b16 v[46:47], v11 offset:50176
    v_mfma_f32_16x16x32_bf16 v[216:219], v[56:59], a[116:119], v[216:219]
    v_mov_b32 v82, 0
    v_mov_b32 v83, 0
    v_mfma_f32_16x16x32_bf16 v[184:187], v[56:59], a[120:123], v[184:187]
    v_mov_b32 v84, 0
    v_mov_b32 v85, 0
    v_mfma_f32_16x16x32_bf16 v[248:251], v[56:59], a[124:127], v[248:251]
    v_mov_b32 v86, 0
    v_mov_b32 v87, 0
    v_mfma_f32_16x16x32_bf16 v[156:159], v[60:63], a[112:115], v[156:159]
    s_nop 0
    ds_read_b64_tr_b16 v[48:49], v12 offset:49152
    ds_read_b64_tr_b16 v[50:51], v12 offset:50176
    v_mfma_f32_16x16x32_bf16 v[220:223], v[60:63], a[116:119], v[220:223]
    v_mov_b32 v88, 0
    v_mov_b32 v89, 0
    v_mfma_f32_16x16x32_bf16 v[188:191], v[60:63], a[120:123], v[188:191]
    v_mov_b32 v90, 0
    v_mov_b32 v91, 0
    v_mfma_f32_16x16x32_bf16 v[252:255], v[60:63], a[124:127], v[252:255]
    s_waitcnt lgkmcnt(6)
    v_mov_b32 v92, 0
    v_mov_b32 v93, 0
    v_mfma_f32_16x16x32_bf16 v[128:131], v[32:35], a[0:3], v[128:131]
    s_nop 0
    ds_read_b64_tr_b16 v[52:53], v13 offset:49152
    ds_read_b64_tr_b16 v[54:55], v13 offset:50176
    v_mfma_f32_16x16x32_bf16 v[192:195], v[32:35], a[4:7], v[192:195]
    v_mov_b32 v94, 0
    v_mov_b32 v95, 0
    v_mfma_f32_16x16x32_bf16 v[160:163], v[32:35], a[8:11], v[160:163]
    v_mov_b32 v96, 0
    v_mov_b32 v97, 0
    v_mfma_f32_16x16x32_bf16 v[224:227], v[32:35], a[12:15], v[224:227]
    v_mov_b32 v98, 0
    v_mov_b32 v99, 0
    v_mfma_f32_16x16x32_bf16 v[132:135], v[36:39], a[0:3], v[132:135]
    s_nop 0
    ds_read_b64_tr_b16 v[56:57], v14 offset:49152
    ds_read_b64_tr_b16 v[58:59], v14 offset:50176
    v_mfma_f32_16x16x32_bf16 v[196:199], v[36:39], a[4:7], v[196:199]
    v_mov_b32 v100, 0
    v_mov_b32 v101, 0
    v_mfma_f32_16x16x32_bf16 v[164:167], v[36:39], a[8:11], v[164:167]
    v_mov_b32 v102, 0
    v_mov_b32 v103, 0
    v_mfma_f32_16x16x32_bf16 v[228:231], v[36:39], a[12:15], v[228:231]
    s_waitcnt lgkmcnt(6)
    v_mov_b32 v104, 0
    v_mov_b32 v105, 0
    v_mfma_f32_16x16x32_bf16 v[136:139], v[40:43], a[0:3], v[136:139]
    s_nop 0
    ds_read_b64_tr_b16 v[60:61], v15 offset:49152
    ds_read_b64_tr_b16 v[62:63], v15 offset:50176
    v_mfma_f32_16x16x32_bf16 v[200:203], v[40:43], a[4:7], v[200:203]
    v_mov_b32 v106, 0
    v_mov_b32 v107, 0
    v_mfma_f32_16x16x32_bf16 v[168:171], v[40:43], a[8:11], v[168:171]
    v_mov_b32 v108, 0
    v_mov_b32 v109, 0
    v_mfma_f32_16x16x32_bf16 v[232:235], v[40:43], a[12:15], v[232:235]
    v_mov_b32 v110, 0
    v_mov_b32 v111, 0
    v_mfma_f32_16x16x32_bf16 v[140:143], v[44:47], a[0:3], v[140:143]
    s_nop 0
    ds_read_b64_tr_b16 v[32:33], v8 offset:57344
    ds_read_b64_tr_b16 v[34:35], v8 offset:58368
    v_mfma_f32_16x16x32_bf16 v[204:207], v[44:47], a[4:7], v[204:207]
    v_mov_b32 v112, 0
    v_mov_b32 v113, 0
    v_mfma_f32_16x16x32_bf16 v[172:175], v[44:47], a[8:11], v[172:175]
    v_mov_b32 v114, 0
    v_mov_b32 v115, 0
    v_mfma_f32_16x16x32_bf16 v[236:239], v[44:47], a[12:15], v[236:239]
    s_waitcnt lgkmcnt(6)
    v_mov_b32 v116, 0
    v_mov_b32 v117, 0
    v_mfma_f32_16x16x32_bf16 v[144:147], v[48:51], a[0:3], v[144:147]
    s_nop 0
    ds_read_b64_tr_b16 v[36:37], v9 offset:57344
    ds_read_b64_tr_b16 v[38:39], v9 offset:58368
    v_mfma_f32_16x16x32_bf16 v[208:211], v[48:51], a[4:7], v[208:211]
    v_mov_b32 v118, 0
    v_mov_b32 v119, 0
    v_mfma_f32_16x16x32_bf16 v[176:179], v[48:51], a[8:11], v[176:179]
    v_mov_b32 v120, 0
    v_mov_b32 v121, 0
    v_mfma_f32_16x16x32_bf16 v[240:243], v[48:51], a[12:15], v[240:243]
    v_mov_b32 v122, 0
    v_mov_b32 v123, 0
    v_mfma_f32_16x16x32_bf16 v[148:151], v[52:55], a[0:3], v[148:151]
    s_nop 0
    ds_read_b64_tr_b16 v[40:41], v10 offset:57344
    ds_read_b64_tr_b16 v[42:43], v10 offset:58368
    v_mfma_f32_16x16x32_bf16 v[212:215], v[52:55], a[4:7], v[212:215]
    v_mov_b32 v124, 0
    v_mov_b32 v125, 0
    v_mfma_f32_16x16x32_bf16 v[180:183], v[52:55], a[8:11], v[180:183]
    v_mov_b32 v126, 0
    v_mov_b32 v127, 0
    v_mfma_f32_16x16x32_bf16 v[244:247], v[52:55], a[12:15], v[244:247]
    s_waitcnt lgkmcnt(6)
    v_mov_b32 v21, 0xff800000
    v_mov_b32 v25, 0x3f803f80
    v_mfma_f32_16x16x32_bf16 v[152:155], v[56:59], a[0:3], v[152:155]
    s_nop 0
    ds_read_b64_tr_b16 v[44:45], v11 offset:57344
    ds_read_b64_tr_b16 v[46:47], v11 offset:58368
    v_mfma_f32_16x16x32_bf16 v[216:219], v[56:59], a[4:7], v[216:219]
    v_accvgpr_write_b32 a192, v25
    v_accvgpr_write_b32 a193, v25
    v_mfma_f32_16x16x32_bf16 v[184:187], v[56:59], a[8:11], v[184:187]
    v_accvgpr_write_b32 a194, v25
    v_accvgpr_write_b32 a195, v25
    v_mfma_f32_16x16x32_bf16 v[248:251], v[56:59], a[12:15], v[248:251]
    v_mov_b32 v22, 0
    v_mov_b32 v23, 0
    v_mfma_f32_16x16x32_bf16 v[156:159], v[60:63], a[0:3], v[156:159]
    s_nop 0
    ds_read_b64_tr_b16 v[48:49], v12 offset:57344
    ds_read_b64_tr_b16 v[50:51], v12 offset:58368
    v_mfma_f32_16x16x32_bf16 v[220:223], v[60:63], a[4:7], v[220:223]
    v_mov_b32 v16, v2
    v_add_u32 v17, 0x18000, v2
    v_mfma_f32_16x16x32_bf16 v[188:191], v[60:63], a[8:11], v[188:191]
    s_lshl_b32 s20, s3, 18
    s_sub_u32 s20, 0xe0000, s20
    v_add_u32 v20, s20, v2
    v_mfma_f32_16x16x32_bf16 v[252:255], v[60:63], a[12:15], v[252:255]
    s_waitcnt lgkmcnt(6)
    v_and_b32 v18, 15, v1
    v_and_b32 v19, 4, v18
    v_mfma_f32_16x16x32_bf16 v[128:131], v[32:35], a[16:19], v[128:131]
    s_nop 0
    ds_read_b64_tr_b16 v[52:53], v13 offset:57344
    ds_read_b64_tr_b16 v[54:55], v13 offset:58368
    v_mfma_f32_16x16x32_bf16 v[192:195], v[32:35], a[20:23], v[192:195]
    buffer_load_dword v30, off, s[84:87], s35 sc1
    v_mfma_f32_16x16x32_bf16 v[160:163], v[32:35], a[24:27], v[160:163]
    v_lshlrev_b32 v19, 1, v19
    v_and_b32 v24, 8, v18
    v_mfma_f32_16x16x32_bf16 v[224:227], v[32:35], a[28:31], v[224:227]
    v_lshrrev_b32 v24, 1, v24
    v_or_b32 v19, v19, v24
    v_mfma_f32_16x16x32_bf16 v[132:135], v[36:39], a[16:19], v[132:135]
    s_nop 0
    ds_read_b64_tr_b16 v[56:57], v14 offset:57344
    ds_read_b64_tr_b16 v[58:59], v14 offset:58368
    v_mfma_f32_16x16x32_bf16 v[196:199], v[36:39], a[20:23], v[196:199]
    v_and_b32 v24, 0xfffffff3, v18
    v_or_b32 v24, v24, v19
    v_mfma_f32_16x16x32_bf16 v[164:167], v[36:39], a[24:27], v[164:167]
    v_lshrrev_b32 v18, 4, v1
    v_lshlrev_b32 v18, 3, v18
    v_mfma_f32_16x16x32_bf16 v[228:231], v[36:39], a[28:31], v[228:231]
    s_and_b32 s20, s3, 1
    s_waitcnt lgkmcnt(6)
    v_sub_u32 v24, v24, v18
    v_mfma_f32_16x16x32_bf16 v[136:139], v[40:43], a[16:19], v[136:139]
    s_nop 0
    ds_read_b64_tr_b16 v[60:61], v15 offset:57344
    ds_read_b64_tr_b16 v[62:63], v15 offset:58368
    v_mfma_f32_16x16x32_bf16 v[200:203], v[40:43], a[20:23], v[200:203]
    s_lshl_b32 s20, s20, 4
    v_add_u32 v25, s20, v24
    s_xor_b32 s20, s20, 16
    v_mfma_f32_16x16x32_bf16 v[168:171], v[40:43], a[24:27], v[168:171]
    s_lshr_b32 s15, s3, 1
    v_add_u32 v24, s20, v24
    v_mfma_f32_16x16x32_bf16 v[232:235], v[40:43], a[28:31], v[232:235]
    v_cmp_le_i32 s[64:65], 0, v25
    v_cmp_le_i32 s[66:67], 1, v25
    s_barrier
    v_mfma_f32_16x16x32_bf16 v[140:143], v[44:47], a[16:19], v[140:143]
    v_add_u32 v8, 0x10000, v8
    v_add_u32 v9, 0x10000, v9
    v_add_u32 v10, 0x10000, v10
    v_add_u32 v11, 0x10000, v11
    v_add_u32 v12, 0x10000, v12
    v_add_u32 v13, 0x10000, v13
    v_add_u32 v14, 0x10000, v14
    v_add_u32 v15, 0x10000, v15
    ds_read_b64_tr_b16 v[32:33], v8 offset:0
    ds_read_b64_tr_b16 v[34:35], v8 offset:1024
    v_mfma_f32_16x16x32_bf16 v[204:207], v[44:47], a[20:23], v[204:207]
    s_and_b32 s22, s2, 3
    s_lshl_b32 s22, s22, 7
    s_add_u32 s22, s22, 92160
    v_mfma_f32_16x16x32_bf16 v[172:175], v[44:47], a[24:27], v[172:175]
    v_mov_b32 v29, 1
    s_waitcnt vmcnt(1)
    s_cmp_lg_u32 s3, 0
    s_cbranch_scc1 main_skip13
    s_mov_b64 exec, 1
    buffer_atomic_add v29, off, s[84:87], s22 sc1
    s_mov_b64 exec, -1
main_skip13:
    s_nop 0
    v_mfma_f32_16x16x32_bf16 v[236:239], v[44:47], a[28:31], v[236:239]
    s_waitcnt lgkmcnt(4)
    v_cmp_le_i32 s[68:69], 2, v25
    v_cmp_le_i32 s[70:71], 3, v25
    v_mfma_f32_16x16x32_bf16 v[144:147], v[48:51], a[16:19], v[144:147]
    s_nop 0
    ds_read_b64_tr_b16 v[36:37], v9 offset:0
    ds_read_b64_tr_b16 v[38:39], v9 offset:1024
    v_mfma_f32_16x16x32_bf16 v[208:211], v[48:51], a[20:23], v[208:211]
    v_cmp_le_i32 s[72:73], 4, v25
    v_cmp_le_i32 s[74:75], 5, v25
    v_mfma_f32_16x16x32_bf16 v[176:179], v[48:51], a[24:27], v[176:179]
    v_cmp_le_i32 s[76:77], 6, v25
    v_cmp_le_i32 s[78:79], 7, v25
    v_mfma_f32_16x16x32_bf16 v[240:243], v[48:51], a[28:31], v[240:243]
    v_cmp_le_i32 s[80:81], 0, v24
    v_cmp_le_i32 s[82:83], 1, v24
    v_mfma_f32_16x16x32_bf16 v[148:151], v[52:55], a[16:19], v[148:151]
    s_nop 0
    ds_read_b64_tr_b16 v[40:41], v10 offset:0
    ds_read_b64_tr_b16 v[42:43], v10 offset:1024
    v_mfma_f32_16x16x32_bf16 v[212:215], v[52:55], a[20:23], v[212:215]
    v_cmp_le_i32 s[88:89], 4, v24
    v_cmp_le_i32 s[90:91], 5, v24
    v_mfma_f32_16x16x32_bf16 v[180:183], v[52:55], a[24:27], v[180:183]
    v_cmp_le_i32 s[92:93], 6, v24
    v_cmp_le_i32 s[94:95], 7, v24
    v_mfma_f32_16x16x32_bf16 v[244:247], v[52:55], a[28:31], v[244:247]
    s_bfe_u32 s20, s2, 0x20001
    s_bfe_u32 s21, s2, 0x20003
    s_lshr_b32 s25, s2, 5
    v_mfma_f32_16x16x32_bf16 v[152:155], v[56:59], a[16:19], v[152:155]
    s_nop 0
    ds_read_b64_tr_b16 v[44:45], v11 offset:0
    ds_read_b64_tr_b16 v[46:47], v11 offset:1024
    v_mfma_f32_16x16x32_bf16 v[216:219], v[56:59], a[20:23], v[216:219]
    s_and_b32 s24, s2, 1
    s_lshl_b32 s24, s24, 3
    s_add_u32 s24, s24, s25
    v_mfma_f32_16x16x32_bf16 v[184:187], v[56:59], a[24:27], v[184:187]
    s_add_u32 s25, s25, s21
    s_and_b32 s25, s25, 3
    s_lshl_b32 s25, s25, 1
    v_mfma_f32_16x16x32_bf16 v[248:251], v[56:59], a[28:31], v[248:251]
    s_lshr_b32 s56, s24, 1
    s_lshl_b32 s56, s56, 2
    s_add_u32 s56, s56, s20
    s_waitcnt lgkmcnt(4)
    v_mfma_f32_16x16x32_bf16 v[156:159], v[60:63], a[16:19], v[156:159]
    s_nop 0
    ds_read_b64_tr_b16 v[48:49], v12 offset:0
    ds_read_b64_tr_b16 v[50:51], v12 offset:1024
    v_mfma_f32_16x16x32_bf16 v[220:223], v[60:63], a[20:23], v[220:223]
    s_lshl_b32 s56, s56, 7
    s_add_u32 s56, s56, 83968
    s_lshl_b32 s52, s3, 14
    v_mfma_f32_16x16x32_bf16 v[188:191], v[60:63], a[24:27], v[188:191]
    s_lshl_b32 s53, s21, 8
    s_add_u32 s52, s52, s53
    s_lshl_b32 s53, s20, 20
    v_mfma_f32_16x16x32_bf16 v[252:255], v[60:63], a[28:31], v[252:255]
    s_add_u32 s52, s52, s53
    v_lshrrev_b32 v19, 4, v1
    v_and_b32 v18, 15, v1
    v_mfma_f32_16x16x32_bf16 v[128:131], v[32:35], a[32:35], v[128:131]
    s_nop 0
    ds_read_b64_tr_b16 v[52:53], v13 offset:0
    ds_read_b64_tr_b16 v[54:55], v13 offset:1024
    v_mfma_f32_16x16x32_bf16 v[192:195], v[32:35], a[36:39], v[192:195]
    v_lshlrev_b32 v4, 1, v19
    v_xor_b32 v18, v18, v4
    v_mfma_f32_16x16x32_bf16 v[160:163], v[32:35], a[40:43], v[160:163]
    v_mul_u32_u24 v4, 1024, v19
    v_add_u32 v4, s52, v4
    v_mfma_f32_16x16x32_bf16 v[224:227], v[32:35], a[44:47], v[224:227]
    v_xor_b32 v19, 8, v18
    v_lshl_add_u32 v5, v19, 4, v4
    v_mfma_f32_16x16x32_bf16 v[132:135], v[36:39], a[32:35], v[132:135]
    s_nop 0
    ds_read_b64_tr_b16 v[56:57], v14 offset:0
    ds_read_b64_tr_b16 v[58:59], v14 offset:1024
    v_mfma_f32_16x16x32_bf16 v[196:199], v[36:39], a[36:39], v[196:199]
    v_lshl_add_u32 v4, v18, 4, v4
    v_add_u32 v6, 6144, v4
    v_mfma_f32_16x16x32_bf16 v[164:167], v[36:39], a[40:43], v[164:167]
    v_add_u32 v7, 9216, v5
    v_add_u32 v5, 3072, v5
    v_mfma_f32_16x16x32_bf16 v[228:231], v[36:39], a[44:47], v[228:231]
    s_lshl_b32 s52, s25, 17
    s_lshl_b32 s53, s24, 2
    s_add_u32 s53, s53, s3
    s_waitcnt lgkmcnt(4)
    v_mfma_f32_16x16x32_bf16 v[136:139], v[40:43], a[32:35], v[136:139]
    s_nop 0
    ds_read_b64_tr_b16 v[60:61], v15 offset:0
    ds_read_b64_tr_b16 v[62:63], v15 offset:1024
    v_mfma_f32_16x16x32_bf16 v[200:203], v[40:43], a[36:39], v[200:203]
    s_lshl_b32 s53, s53, 17
    s_waitcnt vmcnt(0)
    v_cmp_gt_u32 vcc, 32, v30
    s_nop 0
    v_mfma_f32_16x16x32_bf16 v[168:171], v[40:43], a[40:43], v[168:171]
    s_nop 0
    s_nop 0
    s_cbranch_vccnz main_spin14
main_back15:
    s_add_u32 m0, s55, 0
    v_mfma_f32_16x16x32_bf16 v[232:235], v[40:43], a[44:47], v[232:235]
    s_add_u32 s60, s58, 0
    buffer_load_dwordx4 v2, s[44:47], s60 offen offset:0 sc1 lds
    v_mfma_f32_16x16x32_bf16 v[140:143], v[44:47], a[32:35], v[140:143]
    s_nop 0
    ds_read_b64_tr_b16 v[32:33], v8 offset:8192
    ds_read_b64_tr_b16 v[34:35], v8 offset:9216
    v_mfma_f32_16x16x32_bf16 v[204:207], v[44:47], a[36:39], v[204:207]
    s_lshl_b32 s20, s20, 15
    s_add_u32 s53, s53, s20
    s_lshl_b32 s25, s25, 12
    v_mfma_f32_16x16x32_bf16 v[172:175], v[44:47], a[40:43], v[172:175]
    s_add_u32 s53, s53, s25
    s_mov_b32 s40, s12
    s_mov_b32 s41, s13
    v_mfma_f32_16x16x32_bf16 v[236:239], v[44:47], a[44:47], v[236:239]
    s_mov_b32 s42, 0x20000
    buffer_load_dwordx4 v2, s[44:47], s60 offen offset:1024 sc1 lds
    v_mfma_f32_16x16x32_bf16 v[144:147], v[48:51], a[32:35], v[144:147]
    s_nop 0
    ds_read_b64_tr_b16 v[36:37], v9 offset:8192
    ds_read_b64_tr_b16 v[38:39], v9 offset:9216
    v_mfma_f32_16x16x32_bf16 v[208:211], v[48:51], a[36:39], v[208:211]
    s_mov_b32 s43, 0x20000
    s_lshr_b32 s54, s14, 3
    s_lshr_b32 s20, s17, 3
    v_mfma_f32_16x16x32_bf16 v[176:179], v[48:51], a[40:43], v[176:179]
    s_lshl_b32 s20, s20, 2
    s_add_u32 s54, s54, s20
    s_lshl_b32 s54, s54, 7
    v_mfma_f32_16x16x32_bf16 v[240:243], v[48:51], a[44:47], v[240:243]
    s_add_u32 s54, s54, 83968
    s_waitcnt lgkmcnt(4)
    buffer_load_dwordx4 v2, s[44:47], s60 offen offset:2048 sc1 lds
    v_mfma_f32_16x16x32_bf16 v[148:151], v[52:55], a[32:35], v[148:151]
    s_nop 0
    ds_read_b64_tr_b16 v[40:41], v10 offset:8192
    ds_read_b64_tr_b16 v[42:43], v10 offset:9216
    v_mfma_f32_16x16x32_bf16 v[212:215], v[52:55], a[36:39], v[212:215]
    s_mov_b32 s6, 0x400000
    s_mov_b32 s7, 0x20000
    s_mov_b32 s10, 1409024
    v_mfma_f32_16x16x32_bf16 v[180:183], v[52:55], a[40:43], v[180:183]
    s_mov_b32 s11, 0x20000
    s_mov_b32 s30, 1409024
    s_mov_b32 s31, 0x20000
    v_mfma_f32_16x16x32_bf16 v[244:247], v[52:55], a[44:47], v[244:247]
    s_lshl_b32 s57, s2, 2
    buffer_load_dwordx4 v2, s[44:47], s60 offen offset:3072 sc1 lds
    v_mfma_f32_16x16x32_bf16 v[152:155], v[56:59], a[32:35], v[152:155]
    s_nop 0
    ds_read_b64_tr_b16 v[44:45], v11 offset:8192
    ds_read_b64_tr_b16 v[46:47], v11 offset:9216
    v_mfma_f32_16x16x32_bf16 v[216:219], v[56:59], a[36:39], v[216:219]
    s_add_u32 m0, s55, 16384
    s_add_u32 s60, s58, 16384
    s_add_u32 s57, s57, s3
    v_mfma_f32_16x16x32_bf16 v[184:187], v[56:59], a[40:43], v[184:187]
    s_mul_i32 s26, s57, 1376
    s_lshl_b32 s57, s57, 12
    s_getpc_b64 s[100:101]
main_pc12:
    s_lshr_b32 s27, s2, 3
    v_mfma_f32_16x16x32_bf16 v[248:251], v[56:59], a[44:47], v[248:251]
    s_lshl_b32 s27, s27, 2
    buffer_load_dwordx4 v2, s[44:47], s60 offen offset:0 sc1 lds
    v_mfma_f32_16x16x32_bf16 v[156:159], v[60:63], a[32:35], v[156:159]
    s_nop 0
    ds_read_b64_tr_b16 v[48:49], v12 offset:8192
    ds_read_b64_tr_b16 v[50:51], v12 offset:9216
    v_mfma_f32_16x16x32_bf16 v[220:223], v[60:63], a[36:39], v[220:223]
    s_add_u32 s27, s27, s3
    s_lshl_b32 s27, s27, 7
    s_add_u32 s27, s27, main_tail2-main_pc12-6144
    v_mfma_f32_16x16x32_bf16 v[188:191], v[60:63], a[40:43], v[188:191]
    v_mfma_f32_16x16x32_bf16 v[252:255], v[60:63], a[44:47], v[252:255]
    s_waitcnt lgkmcnt(4)
    buffer_load_dwordx4 v2, s[44:47], s60 offen offset:1024 sc1 lds
    v_mfma_f32_16x16x32_bf16 v[128:131], v[32:35], a[48:51], v[128:131]
    s_nop 0
    ds_read_b64_tr_b16 v[52:53], v13 offset:8192
    ds_read_b64_tr_b16 v[54:55], v13 offset:9216
    v_mfma_f32_16x16x32_bf16 v[192:195], v[32:35], a[52:55], v[192:195]
    v_mfma_f32_16x16x32_bf16 v[160:163], v[32:35], a[56:59], v[160:163]
    v_mfma_f32_16x16x32_bf16 v[224:227], v[32:35], a[60:63], v[224:227]
    buffer_load_dwordx4 v2, s[44:47], s60 offen offset:2048 sc1 lds
    v_mfma_f32_16x16x32_bf16 v[132:135], v[36:39], a[48:51], v[132:135]
    s_nop 0
    ds_read_b64_tr_b16 v[56:57], v14 offset:8192
    ds_read_b64_tr_b16 v[58:59], v14 offset:9216
    v_mfma_f32_16x16x32_bf16 v[196:199], v[36:39], a[52:55], v[196:199]
    v_mfma_f32_16x16x32_bf16 v[164:167], v[36:39], a[56:59], v[164:167]
    v_mfma_f32_16x16x32_bf16 v[228:231], v[36:39], a[60:63], v[228:231]
    buffer_load_dwordx4 v2, s[44:47], s60 offen offset:3072 sc1 lds
    v_mfma_f32_16x16x32_bf16 v[136:139], v[40:43], a[48:51], v[136:139]
    s_nop 0
    ds_read_b64_tr_b16 v[60:61], v15 offset:8192
    ds_read_b64_tr_b16 v[62:63], v15 offset:9216
    v_mfma_f32_16x16x32_bf16 v[200:203], v[40:43], a[52:55], v[200:203]
    s_add_u32 m0, s55, 65536
    s_add_u32 s60, s58, 0
    v_mfma_f32_16x16x32_bf16 v[168:171], v[40:43], a[56:59], v[168:171]
    v_mfma_f32_16x16x32_bf16 v[232:235], v[40:43], a[60:63], v[232:235]
    s_waitcnt lgkmcnt(6)
    buffer_load_dwordx4 v2, s[48:51], s60 offen offset:0 sc1 lds
    v_mfma_f32_16x16x32_bf16 v[140:143], v[44:47], a[48:51], v[140:143]
    v_mfma_f32_16x16x32_bf16 v[204:207], v[44:47], a[52:55], v[204:207]
    v_mfma_f32_16x16x32_bf16 v[172:175], v[44:47], a[56:59], v[172:175]
    v_mfma_f32_16x16x32_bf16 v[236:239], v[44:47], a[60:63], v[236:239]
    buffer_load_dwordx4 v2, s[48:51], s60 offen offset:1024 sc1 lds
    v_mfma_f32_16x16x32_bf16 v[144:147], v[48:51], a[48:51], v[144:147]
    v_mfma_f32_16x16x32_bf16 v[208:211], v[48:51], a[52:55], v[208:211]
    v_mfma_f32_16x16x32_bf16 v[176:179], v[48:51], a[56:59], v[176:179]
    v_mfma_f32_16x16x32_bf16 v[240:243], v[48:51], a[60:63], v[240:243]
    s_waitcnt lgkmcnt(2)
    buffer_load_dwordx4 v2, s[48:51], s60 offen offset:2048 sc1 lds
    v_mfma_f32_16x16x32_bf16 v[148:151], v[52:55], a[48:51], v[148:151]
    v_mfma_f32_16x16x32_bf16 v[212:215], v[52:55], a[52:55], v[212:215]
    v_mfma_f32_16x16x32_bf16 v[180:183], v[52:55], a[56:59], v[180:183]
    v_mfma_f32_16x16x32_bf16 v[244:247], v[52:55], a[60:63], v[244:247]
    buffer_load_dwordx4 v2, s[48:51], s60 offen offset:3072 sc1 lds
    v_mfma_f32_16x16x32_bf16 v[152:155], v[56:59], a[48:51], v[152:155]
    v_mfma_f32_16x16x32_bf16 v[216:219], v[56:59], a[52:55], v[216:219]
    s_add_u32 m0, s55, 32768
    s_add_u32 s60, s58, 32768
    s_cmp_eq_u32 s19, 2
    s_cselect_b32 s60, s58, s60
    v_mfma_f32_16x16x32_bf16 v[184:187], v[56:59], a[56:59], v[184:187]
    v_mfma_f32_16x16x32_bf16 v[248:251], v[56:59], a[60:63], v[248:251]
    s_waitcnt lgkmcnt(0)
    buffer_load_dwordx4 v2, s[44:47], s60 offen offset:0 sc1 lds
    v_mfma_f32_16x16x32_bf16 v[156:159], v[60:63], a[48:51], v[156:159]
    v_mfma_f32_16x16x32_bf16 v[220:223], v[60:63], a[52:55], v[220:223]
    v_mfma_f32_16x16x32_bf16 v[188:191], v[60:63], a[56:59], v[188:191]
    v_mfma_f32_16x16x32_bf16 v[252:255], v[60:63], a[60:63], v[252:255]
    buffer_load_dwordx4 v2, s[44:47], s60 offen offset:1024 sc1 lds
    buffer_load_dwordx4 v2, s[44:47], s60 offen offset:2048 sc1 lds
    buffer_load_dwordx4 v2, s[44:47], s60 offen offset:3072 sc1 lds
    s_add_u32 m0, s55, 81920
    s_add_u32 s60, s58, 16384
    buffer_load_dwordx4 v2, s[48:51], s60 offen offset:0 sc1 lds
    buffer_load_dwordx4 v2, s[48:51], s60 offen offset:1024 sc1 lds
    buffer_load_dwordx4 v2, s[48:51], s60 offen offset:2048 sc1 lds
    buffer_load_dwordx4 v2, s[48:51], s60 offen offset:3072 sc1 lds
    s_load_dwordx2 s[4:5], s[0:1], 40
    s_load_dwordx2 s[8:9], s[0:1], 56
    s_load_dwordx2 s[28:29], s[0:1], 72
    s_waitcnt vmcnt(16)
    s_barrier
    ds_read_b128 a[64:67], v16 offset:0
    ds_read_b128 a[68:71], v16 offset:1024
    ds_read_b128 a[72:75], v16 offset:2048
    ds_read_b128 a[76:79], v16 offset:3072
    ds_read_b128 a[80:83], v16 offset:4096
    ds_read_b128 a[84:87], v16 offset:5120
    ds_read_b128 a[88:91], v16 offset:6144
    ds_read_b128 a[92:95], v16 offset:7168
    ds_read_b128 a[96:99], v16 offset:8192
    ds_read_b128 a[100:103], v16 offset:9216
    v_cvt_pk_bf16_f32 v128, v128, v129
    v_cvt_pk_bf16_f32 v129, v130, v131
    v_cvt_pk_bf16_f32 v130, v132, v133
    v_cvt_pk_bf16_f32 v131, v134, v135
    v_cvt_pk_bf16_f32 v132, v136, v137
    v_cvt_pk_bf16_f32 v133, v138, v139
    v_cvt_pk_bf16_f32 v134, v140, v141
    v_cvt_pk_bf16_f32 v135, v142, v143
    v_cvt_pk_bf16_f32 v136, v144, v145
    v_cvt_pk_bf16_f32 v137, v146, v147
    v_cvt_pk_bf16_f32 v138, v148, v149
    v_cvt_pk_bf16_f32 v139, v150, v151
    v_cvt_pk_bf16_f32 v140, v152, v153
    v_cvt_pk_bf16_f32 v141, v154, v155
    v_cvt_pk_bf16_f32 v142, v156, v157
    v_cvt_pk_bf16_f32 v143, v158, v159
    v_accvgpr_write_b32 a0, v128
    v_accvgpr_write_b32 a1, v129
    v_accvgpr_write_b32 a2, v130
    v_accvgpr_write_b32 a3, v131
    v_accvgpr_write_b32 a4, v132
    v_accvgpr_write_b32 a5, v133
    v_accvgpr_write_b32 a6, v134
    v_accvgpr_write_b32 a7, v135
    v_accvgpr_write_b32 a8, v136
    v_accvgpr_write_b32 a9, v137
    v_accvgpr_write_b32 a10, v138
    v_accvgpr_write_b32 a11, v139
    v_accvgpr_write_b32 a12, v140
    v_accvgpr_write_b32 a13, v141
    v_accvgpr_write_b32 a14, v142
    v_accvgpr_write_b32 a15, v143
    v_cvt_pk_bf16_f32 v192, v192, v193
    v_cvt_pk_bf16_f32 v193, v194, v195
    v_cvt_pk_bf16_f32 v194, v196, v197
    v_cvt_pk_bf16_f32 v195, v198, v199
    v_cvt_pk_bf16_f32 v196, v200, v201
    v_cvt_pk_bf16_f32 v197, v202, v203
    v_cvt_pk_bf16_f32 v198, v204, v205
    v_cvt_pk_bf16_f32 v199, v206, v207
    v_cvt_pk_bf16_f32 v200, v208, v209
    v_cvt_pk_bf16_f32 v201, v210, v211
    v_cvt_pk_bf16_f32 v202, v212, v213
    v_cvt_pk_bf16_f32 v203, v214, v215
    v_cvt_pk_bf16_f32 v204, v216, v217
    v_cvt_pk_bf16_f32 v205, v218, v219
    v_cvt_pk_bf16_f32 v206, v220, v221
    v_cvt_pk_bf16_f32 v207, v222, v223
    v_accvgpr_write_b32 a16, v192
    v_accvgpr_write_b32 a17, v193
    v_accvgpr_write_b32 a18, v194
    v_accvgpr_write_b32 a19, v195
    v_accvgpr_write_b32 a20, v196
    v_accvgpr_write_b32 a21, v197
    v_accvgpr_write_b32 a22, v198
    v_accvgpr_write_b32 a23, v199
    v_accvgpr_write_b32 a24, v200
    v_accvgpr_write_b32 a25, v201
    v_accvgpr_write_b32 a26, v202
    v_accvgpr_write_b32 a27, v203
    v_accvgpr_write_b32 a28, v204
    v_accvgpr_write_b32 a29, v205
    v_accvgpr_write_b32 a30, v206
    v_accvgpr_write_b32 a31, v207
    v_cmp_le_i32 s[84:85], 2, v24
    v_cmp_le_i32 s[86:87], 3, v24
    v_mov_b64 v[192:193], 0
    v_mov_b64 v[194:195], 0
    v_mov_b64 v[196:197], 0
    v_mov_b64 v[198:199], 0
    v_mov_b64 v[200:201], 0
    v_mov_b64 v[202:203], 0
    v_mov_b64 v[204:205], 0
    v_mov_b64 v[206:207], 0
    v_mov_b64 v[208:209], 0
    v_mov_b64 v[210:211], 0
    v_mov_b64 v[212:213], 0
    v_mov_b64 v[214:215], 0
    v_mov_b64 v[216:217], 0
    v_mov_b64 v[218:219], 0
    v_mov_b64 v[220:221], 0
    v_mov_b64 v[222:223], 0
    v_mov_b64 v[48:49], 0
    v_mov_b64 v[50:51], 0
    v_mov_b64 v[52:53], 0
    v_mov_b64 v[54:55], 0
    s_mov_b32 s33, 0x4e800000
    s_mov_b32 s32, 0
    s_add_u32 s21, s55, 0x8000
    s_add_u32 s22, s55, 0xc000
    s_add_u32 s23, s58, 0x8000
    s_cmp_eq_u32 s19, 2
    s_cselect_b32 s23, s58, s23
    s_lshl_b32 s25, s19, 14
    s_add_u32 s25, s25, s58
    s_sub_u32 s35, s19, 3
    s_mov_b32 s34, s58
    s_add_u32 s61, s58, 0x4000
    s_cmp_eq_u32 s19, 2
    s_cselect_b32 s25, -1, s25
    s_cselect_b32 s35, 0, s35
    s_cselect_b32 s34, s61, s34
    s_waitcnt lgkmcnt(0)
    s_mov_b32 s20, -1
    s_cmp_eq_u32 s19, 2
    s_cbranch_scc1 main_mask29
main_f030:
    v_mfma_f32_16x16x32_bf16 v[128:131], a[64:67], a[0:3], v[192:195]
    s_mov_b32 m0, s22
    v_cvt_pk_bf16_f32 v160, v160, v161
    v_cvt_pk_bf16_f32 v161, v162, v163
    v_mfma_f32_16x16x32_bf16 v[136:139], a[64:67], a[16:19], v[200:203]
    s_add_u32 s24, s23, 0x4000
    v_cvt_pk_bf16_f32 v162, v164, v165
    v_cvt_pk_bf16_f32 v163, v166, v167
    v_mfma_f32_16x16x32_bf16 v[128:131], a[68:71], a[4:7], v[128:131]
    ds_read_b128 a[104:107], v16 offset:10240
    v_cvt_pk_bf16_f32 v164, v168, v169
    v_mfma_f32_16x16x32_bf16 v[136:139], a[68:71], a[20:23], v[136:139]
    s_cmp_eq_u32 s24, s25
    s_cselect_b32 s24, s58, s24
    ds_read_b128 a[108:111], v16 offset:11264
    v_cvt_pk_bf16_f32 v165, v170, v171
    v_mfma_f32_16x16x32_bf16 v[128:131], a[72:75], a[8:11], v[128:131]
    buffer_load_dwordx4 v2, s[44:47], s24 offen offset:0 sc1 lds
    v_mfma_f32_16x16x32_bf16 v[136:139], a[72:75], a[24:27], v[136:139]
    v_cvt_pk_bf16_f32 v166, v172, v173
    v_cvt_pk_bf16_f32 v167, v174, v175
    v_mfma_f32_16x16x32_bf16 v[128:131], a[76:79], a[12:15], v[128:131]
    v_cvt_pk_bf16_f32 v168, v176, v177
    v_cvt_pk_bf16_f32 v169, v178, v179
    v_mfma_f32_16x16x32_bf16 v[136:139], a[76:79], a[28:31], v[136:139]
    ds_read_b128 a[112:115], v16 offset:12288
    v_cvt_pk_bf16_f32 v170, v180, v181
    v_mfma_f32_16x16x32_bf16 v[132:135], a[80:83], a[0:3], v[196:199]
    v_cvt_pk_bf16_f32 v171, v182, v183
    v_cvt_pk_bf16_f32 v172, v184, v185
    v_mfma_f32_16x16x32_bf16 v[140:143], a[80:83], a[16:19], v[204:207]
    v_cvt_pk_bf16_f32 v173, v186, v187
    v_cvt_pk_bf16_f32 v174, v188, v189
    v_mfma_f32_16x16x32_bf16 v[132:135], a[84:87], a[4:7], v[132:135]
    ds_read_b128 a[116:119], v16 offset:13312
    v_cvt_pk_bf16_f32 v175, v190, v191
    v_mfma_f32_16x16x32_bf16 v[140:143], a[84:87], a[20:23], v[140:143]
    buffer_load_dwordx4 v2, s[44:47], s24 offen offset:1024 sc1 lds
    v_mfma_f32_16x16x32_bf16 v[132:135], a[88:91], a[8:11], v[132:135]
    v_accvgpr_write_b32 a32, v160
    v_accvgpr_write_b32 a33, v161
    v_mfma_f32_16x16x32_bf16 v[140:143], a[88:91], a[24:27], v[140:143]
    ds_read_b128 a[120:123], v16 offset:14336
    v_accvgpr_write_b32 a34, v162
    v_mfma_f32_16x16x32_bf16 v[132:135], a[92:95], a[12:15], v[132:135]
    v_accvgpr_write_b32 a35, v163
    v_accvgpr_write_b32 a36, v164
    v_mfma_f32_16x16x32_bf16 v[140:143], a[92:95], a[28:31], v[140:143]
    v_accvgpr_write_b32 a37, v165
    v_accvgpr_write_b32 a38, v166
    v_mfma_f32_16x16x32_bf16 v[144:147], a[96:99], a[0:3], v[208:211]
    ds_read_b128 a[124:127], v16 offset:15360
    v_accvgpr_write_b32 a39, v167
    v_mfma_f32_16x16x32_bf16 v[152:155], a[96:99], a[16:19], v[216:219]
    buffer_load_dwordx4 v2, s[44:47], s24 offen offset:2048 sc1 lds
    v_mfma_f32_16x16x32_bf16 v[144:147], a[100:103], a[4:7], v[144:147]
    v_accvgpr_write_b32 a40, v168
    v_accvgpr_write_b32 a41, v169
    v_mfma_f32_16x16x32_bf16 v[152:155], a[100:103], a[20:23], v[152:155]
    s_waitcnt lgkmcnt(3)
    v_accvgpr_write_b32 a42, v170
    v_accvgpr_write_b32 a43, v171
    v_mfma_f32_16x16x32_bf16 v[144:147], a[104:107], a[8:11], v[144:147]
    v_accvgpr_write_b32 a44, v172
    v_accvgpr_write_b32 a45, v173
    v_mfma_f32_16x16x32_bf16 v[152:155], a[104:107], a[24:27], v[152:155]
    buffer_load_dwordx4 v2, s[44:47], s24 offen offset:3072 sc1 lds
    v_mfma_f32_16x16x32_bf16 v[144:147], a[108:111], a[12:15], v[144:147]
    v_accvgpr_write_b32 a46, v174
    v_accvgpr_write_b32 a47, v175
    v_mfma_f32_16x16x32_bf16 v[152:155], a[108:111], a[28:31], v[152:155]
    s_add_u32 m0, s21, 0x10000
    v_cvt_pk_bf16_f32 v224, v224, v225
    v_cvt_pk_bf16_f32 v225, v226, v227
    v_mfma_f32_16x16x32_bf16 v[148:151], a[112:115], a[0:3], v[212:215]
    v_cvt_pk_bf16_f32 v226, v228, v229
    v_cvt_pk_bf16_f32 v227, v230, v231
    v_mfma_f32_16x16x32_bf16 v[156:159], a[112:115], a[16:19], v[220:223]
    s_waitcnt lgkmcnt(0)
    v_cvt_pk_bf16_f32 v228, v232, v233
    v_cvt_pk_bf16_f32 v229, v234, v235
    v_mfma_f32_16x16x32_bf16 v[148:151], a[116:119], a[4:7], v[148:151]
    v_cvt_pk_bf16_f32 v230, v236, v237
    v_cvt_pk_bf16_f32 v231, v238, v239
    v_mfma_f32_16x16x32_bf16 v[156:159], a[116:119], a[20:23], v[156:159]
    v_cvt_pk_bf16_f32 v232, v240, v241
    v_cvt_pk_bf16_f32 v233, v242, v243
    v_mfma_f32_16x16x32_bf16 v[148:151], a[120:123], a[8:11], v[148:151]
    v_cvt_pk_bf16_f32 v234, v244, v245
    v_cvt_pk_bf16_f32 v235, v246, v247
    v_mfma_f32_16x16x32_bf16 v[156:159], a[120:123], a[24:27], v[156:159]
    v_cvt_pk_bf16_f32 v236, v248, v249
    v_cvt_pk_bf16_f32 v237, v250, v251
    v_mfma_f32_16x16x32_bf16 v[148:151], a[124:127], a[12:15], v[148:151]
    v_cvt_pk_bf16_f32 v238, v252, v253
    v_cvt_pk_bf16_f32 v239, v254, v255
    v_mfma_f32_16x16x32_bf16 v[156:159], a[124:127], a[28:31], v[156:159]
    v_accvgpr_write_b32 a48, v224
    v_accvgpr_write_b32 a49, v225
    v_accvgpr_write_b32 a50, v226
    v_accvgpr_write_b32 a51, v227
    v_accvgpr_write_b32 a52, v228
    v_accvgpr_write_b32 a53, v229
    v_accvgpr_write_b32 a54, v230
    v_accvgpr_write_b32 a55, v231
    v_accvgpr_write_b32 a56, v232
    v_accvgpr_write_b32 a57, v233
    v_accvgpr_write_b32 a58, v234
    v_accvgpr_write_b32 a59, v235
    v_accvgpr_write_b32 a60, v236
    v_accvgpr_write_b32 a61, v237
    v_accvgpr_write_b32 a62, v238
    v_accvgpr_write_b32 a63, v239
    v_mul_u32_u24 v8, 24, v1
    v_lshlrev_b32 v15, 6, v1
    v_and_b32 v10, 3, v1
    v_lshlrev_b32 v10, 14, v10
    v_add_u32 v10, s27, v10
    v_min_u32 v10, main_done1-main_pc12, v10
    v_mov_b32 v11, s101
    v_add_co_u32 v10, vcc, s100, v10
    s_nop 1
    v_addc_co_u32 v11, vcc, 0, v11, vcc
    v_bfe_u32 v18, v1, 2, 2
    v_lshrrev_b32 v19, 4, v1
    v_lshl_add_u32 v12, v19, 2, v18
    v_lshlrev_b32 v12, 8, v12
    v_and_b32 v19, 1, v19
    v_lshl_add_u32 v18, v19, 2, v18
    v_lshl_add_u32 v12, v18, 5, v12
    v_and_b32 v18, 3, v1
    v_lshl_add_u32 v12, v18, 3, v12
    s_lshl_b32 s59, s3, 6
    v_xor_b32 v12, s59, v12
    v_xor_b32 v13, 32, v12
    v_mov_b32 v14, v2
    v_add_u32 v29, 0x10000, v12
    v_add_u32 v30, 0x10000, v13
    v_max3_f32 v24, v128, v129, v130
    v_max3_f32 v25, v136, v137, v138
    v_max3_f32 v24, v24, v131, v132
    v_max3_f32 v25, v25, v139, v140
    v_max3_f32 v24, v24, v133, v134
    v_max3_f32 v25, v25, v141, v142
    v_max3_f32 v24, v24, v135, v144
    v_max3_f32 v25, v25, v143, v152
    v_max3_f32 v24, v24, v145, v146
    v_max3_f32 v25, v25, v153, v154
    v_max3_f32 v24, v24, v147, v148
    v_max3_f32 v25, v25, v155, v156
    v_max3_f32 v24, v24, v149, v150
    v_max3_f32 v25, v25, v157, v158
    v_max_f32 v24, v24, v151
    v_max_f32 v25, v25, v159
    v_mov_b64 v[26:27], v[24:25]
    s_nop 1
    v_permlane16_swap_b32 v24, v26
    v_permlane16_swap_b32 v25, v27
    v_max_f32 v24, v24, v26
    v_max_f32 v25, v25, v27
    v_mov_b64 v[26:27], v[24:25]
    s_nop 1
    v_permlane32_swap_b32 v24, v26
    v_permlane32_swap_b32 v25, v27
    v_max_f32 v24, v24, v26
    v_max_f32 v25, v25, v27
    v_pk_add_f32 v[128:129], v[128:129], v[24:25] op_sel:[0,0] op_sel_hi:[1,0] neg_lo:[0,1] neg_hi:[0,1]
    v_pk_add_f32 v[130:131], v[130:131], v[24:25] op_sel:[0,0] op_sel_hi:[1,0] neg_lo:[0,1] neg_hi:[0,1]
    v_pk_add_f32 v[132:133], v[132:133], v[24:25] op_sel:[0,0] op_sel_hi:[1,0] neg_lo:[0,1] neg_hi:[0,1]
    v_pk_add_f32 v[134:135], v[134:135], v[24:25] op_sel:[0,0] op_sel_hi:[1,0] neg_lo:[0,1] neg_hi:[0,1]
    v_pk_add_f32 v[136:137], v[136:137], v[24:25] op_sel:[0,1] op_sel_hi:[1,1] neg_lo:[0,1] neg_hi:[0,1]
    v_pk_add_f32 v[138:139], v[138:139], v[24:25] op_sel:[0,1] op_sel_hi:[1,1] neg_lo:[0,1] neg_hi:[0,1]
    v_pk_add_f32 v[140:141], v[140:141], v[24:25] op_sel:[0,1] op_sel_hi:[1,1] neg_lo:[0,1] neg_hi:[0,1]
    v_pk_add_f32 v[142:143], v[142:143], v[24:25] op_sel:[0,1] op_sel_hi:[1,1] neg_lo:[0,1] neg_hi:[0,1]
    v_pk_add_f32 v[144:145], v[144:145], v[24:25] op_sel:[0,0] op_sel_hi:[1,0] neg_lo:[0,1] neg_hi:[0,1]
    v_pk_add_f32 v[146:147], v[146:147], v[24:25] op_sel:[0,0] op_sel_hi:[1,0] neg_lo:[0,1] neg_hi:[0,1]
    v_pk_add_f32 v[148:149], v[148:149], v[24:25] op_sel:[0,0] op_sel_hi:[1,0] neg_lo:[0,1] neg_hi:[0,1]
    v_pk_add_f32 v[150:151], v[150:151], v[24:25] op_sel:[0,0] op_sel_hi:[1,0] neg_lo:[0,1] neg_hi:[0,1]
    v_pk_add_f32 v[152:153], v[152:153], v[24:25] op_sel:[0,1] op_sel_hi:[1,1] neg_lo:[0,1] neg_hi:[0,1]
    v_pk_add_f32 v[154:155], v[154:155], v[24:25] op_sel:[0,1] op_sel_hi:[1,1] neg_lo:[0,1] neg_hi:[0,1]
    v_pk_add_f32 v[156:157], v[156:157], v[24:25] op_sel:[0,1] op_sel_hi:[1,1] neg_lo:[0,1] neg_hi:[0,1]
    v_pk_add_f32 v[158:159], v[158:159], v[24:25] op_sel:[0,1] op_sel_hi:[1,1] neg_lo:[0,1] neg_hi:[0,1]
    v_pk_add_f32 v[192:193], v[192:193], v[24:25] op_sel:[0,0] op_sel_hi:[1,0] neg_lo:[0,1] neg_hi:[0,1]
    v_pk_add_f32 v[194:195], v[194:195], v[24:25] op_sel:[0,0] op_sel_hi:[1,0] neg_lo:[0,1] neg_hi:[0,1]
    v_pk_add_f32 v[196:197], v[196:197], v[24:25] op_sel:[0,0] op_sel_hi:[1,0] neg_lo:[0,1] neg_hi:[0,1]
    v_pk_add_f32 v[198:199], v[198:199], v[24:25] op_sel:[0,0] op_sel_hi:[1,0] neg_lo:[0,1] neg_hi:[0,1]
    v_pk_add_f32 v[200:201], v[200:201], v[24:25] op_sel:[0,1] op_sel_hi:[1,1] neg_lo:[0,1] neg_hi:[0,1]
    v_pk_add_f32 v[202:203], v[202:203], v[24:25] op_sel:[0,1] op_sel_hi:[1,1] neg_lo:[0,1] neg_hi:[0,1]
    v_pk_add_f32 v[204:205], v[204:205], v[24:25] op_sel:[0,1] op_sel_hi:[1,1] neg_lo:[0,1] neg_hi:[0,1]
    v_pk_add_f32 v[206:207], v[206:207], v[24:25] op_sel:[0,1] op_sel_hi:[1,1] neg_lo:[0,1] neg_hi:[0,1]
    v_pk_add_f32 v[208:209], v[208:209], v[24:25] op_sel:[0,0] op_sel_hi:[1,0] neg_lo:[0,1] neg_hi:[0,1]
    v_pk_add_f32 v[210:211], v[210:211], v[24:25] op_sel:[0,0] op_sel_hi:[1,0] neg_lo:[0,1] neg_hi:[0,1]
    v_pk_add_f32 v[212:213], v[212:213], v[24:25] op_sel:[0,0] op_sel_hi:[1,0] neg_lo:[0,1] neg_hi:[0,1]
    v_pk_add_f32 v[214:215], v[214:215], v[24:25] op_sel:[0,0] op_sel_hi:[1,0] neg_lo:[0,1] neg_hi:[0,1]
    v_pk_add_f32 v[216:217], v[216:217], v[24:25] op_sel:[0,1] op_sel_hi:[1,1] neg_lo:[0,1] neg_hi:[0,1]
    v_pk_add_f32 v[218:219], v[218:219], v[24:25] op_sel:[0,1] op_sel_hi:[1,1] neg_lo:[0,1] neg_hi:[0,1]
    v_pk_add_f32 v[220:221], v[220:221], v[24:25] op_sel:[0,1] op_sel_hi:[1,1] neg_lo:[0,1] neg_hi:[0,1]
    v_pk_add_f32 v[222:223], v[222:223], v[24:25] op_sel:[0,1] op_sel_hi:[1,1] neg_lo:[0,1] neg_hi:[0,1]
    v_pk_add_f32 v[22:23], v[22:23], v[24:25] neg_lo:[0,1] neg_hi:[0,1]
    s_xor_b32 s21, s21, 0x8000
    v_exp_f32 v32, v128
    v_exp_f32 v33, v129
    s_nop 0
    v_cvt_pk_bf16_f32 v224, v32, v33
    v_exp_f32 v34, v130
    v_exp_f32 v35, v131
    s_nop 0
    v_cvt_pk_bf16_f32 v225, v34, v35
    v_xor_b32 v17, 0x8000, v17
    s_waitcnt vmcnt(12)
    v_exp_f32 v36, v132
    s_barrier
    v_exp_f32 v37, v133
    ds_read_b128 a[64:67], v16 offset:16384
    v_cvt_pk_bf16_f32 v226, v36, v37
    buffer_load_dwordx4 v2, s[48:51], s23 offen offset:0 sc1 lds
    v_exp_f32 v38, v134
    v_exp_f32 v39, v135
    ds_read_b128 a[68:71], v16 offset:17408
    v_cvt_pk_bf16_f32 v227, v38, v39
    ds_read_b128 a[72:75], v16 offset:18432
    ds_read_b128 a[76:79], v16 offset:19456
    v_exp_f32 v32, v136
    v_exp_f32 v33, v137
    ds_read_b128 a[80:83], v16 offset:20480
    v_cvt_pk_bf16_f32 v228, v32, v33
    buffer_load_dwordx4 v2, s[48:51], s23 offen offset:1024 sc1 lds
    s_cmp_eq_u32 s24, s34
    v_exp_f32 v34, v138
    v_exp_f32 v35, v139
    ds_read_b128 a[84:87], v16 offset:21504
    v_cvt_pk_bf16_f32 v229, v34, v35
    buffer_load_dwordx4 v2, s[48:51], s23 offen offset:2048 sc1 lds
    ds_read_b128 a[88:91], v16 offset:22528
    ds_read_b128 a[92:95], v16 offset:23552
    v_exp_f32 v36, v140
    v_exp_f32 v37, v141
    ds_read_b128 a[96:99], v16 offset:24576
    v_cvt_pk_bf16_f32 v230, v36, v37
    buffer_load_dwordx4 v2, s[48:51], s23 offen offset:3072 sc1 lds
    v_exp_f32 v38, v142
    v_exp_f32 v39, v143
    ds_read_b128 a[100:103], v16 offset:25600
    v_cvt_pk_bf16_f32 v231, v38, v39
    s_waitcnt lgkmcnt(0)
    s_cbranch_scc1 main_esp18
main_eb16:
    v_mfma_f32_16x16x32_bf16 v[160:163], a[64:67], a[0:3], v[192:195]
    s_mov_b32 m0, s21
    v_exp_f32 v32, v144
    v_mfma_f32_16x16x32_bf16 v[168:171], a[64:67], a[16:19], v[200:203]
    s_add_u32 s23, s24, 0x4000
    v_exp_f32 v33, v145
    v_mfma_f32_16x16x32_bf16 v[160:163], a[68:71], a[4:7], v[160:163]
    ds_read_b128 a[104:107], v16 offset:26624
    v_cvt_pk_bf16_f32 v232, v32, v33
    v_mfma_f32_16x16x32_bf16 v[168:171], a[68:71], a[20:23], v[168:171]
    s_cmp_eq_u32 s23, s25
    v_exp_f32 v34, v146
    v_mfma_f32_16x16x32_bf16 v[40:43], a[192:195], v[224:227], v[48:51]
    s_cselect_b32 s23, s58, s23
    v_exp_f32 v35, v147
    v_mfma_f32_16x16x32_bf16 v[44:47], a[192:195], v[228:231], v[52:55]
    ds_read_b128 a[108:111], v16 offset:27648
    v_cvt_pk_bf16_f32 v233, v34, v35
    v_mfma_f32_16x16x32_bf16 v[160:163], a[72:75], a[8:11], v[160:163]
    buffer_load_dwordx4 v2, s[44:47], s23 offen offset:0 sc1 lds
    v_mfma_f32_16x16x32_bf16 v[168:171], a[72:75], a[24:27], v[168:171]
    v_exp_f32 v36, v148
    v_mfma_f32_16x16x32_bf16 v[160:163], a[76:79], a[12:15], v[160:163]
    s_waitcnt lgkmcnt(2)
    v_exp_f32 v37, v149
    v_mfma_f32_16x16x32_bf16 v[168:171], a[76:79], a[28:31], v[168:171]
    ds_read_b128 a[112:115], v16 offset:28672
    v_cvt_pk_bf16_f32 v234, v36, v37
    v_mfma_f32_16x16x32_bf16 v[164:167], a[80:83], a[0:3], v[196:199]
    v_exp_f32 v38, v150
    v_mfma_f32_16x16x32_bf16 v[172:175], a[80:83], a[16:19], v[204:207]
    v_exp_f32 v39, v151
    v_mfma_f32_16x16x32_bf16 v[164:167], a[84:87], a[4:7], v[164:167]
    ds_read_b128 a[116:119], v16 offset:29696
    v_cvt_pk_bf16_f32 v235, v38, v39
    v_mfma_f32_16x16x32_bf16 v[172:175], a[84:87], a[20:23], v[172:175]
    buffer_load_dwordx4 v2, s[44:47], s23 offen offset:1024 sc1 lds
    v_mfma_f32_16x16x32_bf16 v[164:167], a[88:91], a[8:11], v[164:167]
    v_exp_f32 v32, v152
    v_mfma_f32_16x16x32_bf16 v[172:175], a[88:91], a[24:27], v[172:175]
    v_exp_f32 v33, v153
    v_mfma_f32_16x16x32_bf16 v[40:43], a[192:195], v[232:235], v[40:43]
    ds_read_b128 a[120:123], v16 offset:30720
    v_cvt_pk_bf16_f32 v236, v32, v33
    v_mfma_f32_16x16x32_bf16 v[164:167], a[92:95], a[12:15], v[164:167]
    v_exp_f32 v34, v154
    v_mfma_f32_16x16x32_bf16 v[172:175], a[92:95], a[28:31], v[172:175]
    v_exp_f32 v35, v155
    v_mfma_f32_16x16x32_bf16 v[176:179], a[96:99], a[0:3], v[208:211]
    ds_read_b128 a[124:127], v16 offset:31744
    v_cvt_pk_bf16_f32 v237, v34, v35
    v_mfma_f32_16x16x32_bf16 v[184:187], a[96:99], a[16:19], v[216:219]
    buffer_load_dwordx4 v2, s[44:47], s23 offen offset:2048 sc1 lds
    v_mfma_f32_16x16x32_bf16 v[176:179], a[100:103], a[4:7], v[176:179]
    s_waitcnt lgkmcnt(4)
    v_exp_f32 v36, v156
    v_mfma_f32_16x16x32_bf16 v[184:187], a[100:103], a[20:23], v[184:187]
    v_exp_f32 v37, v157
    v_mfma_f32_16x16x32_bf16 v[176:179], a[104:107], a[8:11], v[176:179]
    ds_read_b128 a[128:131], v17 offset:0
    v_cvt_pk_bf16_f32 v238, v36, v37
    v_mfma_f32_16x16x32_bf16 v[184:187], a[104:107], a[24:27], v[184:187]
    buffer_load_dwordx4 v2, s[44:47], s23 offen offset:3072 sc1 lds
    v_mfma_f32_16x16x32_bf16 v[176:179], a[108:111], a[12:15], v[176:179]
    s_waitcnt lgkmcnt(1)
    v_exp_f32 v38, v158
    v_mfma_f32_16x16x32_bf16 v[184:187], a[108:111], a[28:31], v[184:187]
    s_add_u32 m0, s22, 0x10000
    v_exp_f32 v39, v159
    v_mfma_f32_16x16x32_bf16 v[180:183], a[112:115], a[0:3], v[212:215]
    ds_read_b128 a[132:135], v17 offset:1024
    v_cvt_pk_bf16_f32 v239, v38, v39
    v_mfma_f32_16x16x32_bf16 v[188:191], a[112:115], a[16:19], v[220:223]
    s_nop 0
    ds_read_b128 a[136:139], v17 offset:2048
    ds_read_b128 a[140:143], v17 offset:3072
    v_mfma_f32_16x16x32_bf16 v[44:47], a[192:195], v[236:239], v[44:47]
    s_nop 0
    ds_read_b128 a[144:147], v17 offset:4096
    ds_read_b128 a[148:151], v17 offset:5120
    v_mfma_f32_16x16x32_bf16 v[180:183], a[116:119], a[4:7], v[180:183]
    s_nop 0
    ds_read_b128 a[152:155], v17 offset:6144
    ds_read_b128 a[156:159], v17 offset:7168
    v_mfma_f32_16x16x32_bf16 v[188:191], a[116:119], a[20:23], v[188:191]
    s_nop 0
    ds_read_b128 a[160:163], v17 offset:8192
    ds_read_b128 a[164:167], v17 offset:9216
    v_mfma_f32_16x16x32_bf16 v[180:183], a[120:123], a[8:11], v[180:183]
    ds_read_b128 a[168:171], v17 offset:10240
    v_max_f32 v24, v40, v44
    v_mfma_f32_16x16x32_bf16 v[188:191], a[120:123], a[24:27], v[188:191]
    ds_read_b128 a[172:175], v17 offset:11264
    v_cmp_lt_f32 vcc, s33, v24
    v_mfma_f32_16x16x32_bf16 v[180:183], a[124:127], a[12:15], v[180:183]
    s_nop 0
    ds_read_b128 a[176:179], v17 offset:12288
    ds_read_b128 a[180:183], v17 offset:13312
    v_mfma_f32_16x16x32_bf16 v[188:191], a[124:127], a[28:31], v[188:191]
    s_waitcnt lgkmcnt(12)
    s_cbranch_vccnz main_erare20
main_econt22:
    v_mfma_f32_16x16x32_bf16 v[64:67], a[128:131], v[224:227], v[64:67]
    s_xor_b32 s22, s22, 0x8000
    v_exp_f32 v32, v160
    v_mfma_f32_16x16x32_bf16 v[72:75], a[128:131], v[228:231], v[72:75]
    v_exp_f32 v33, v161
    v_mfma_f32_16x16x32_bf16 v[68:71], a[132:135], v[224:227], v[68:71]
    ds_read_b128 a[184:187], v17 offset:14336
    v_cvt_pk_bf16_f32 v240, v32, v33
    v_mfma_f32_16x16x32_bf16 v[76:79], a[132:135], v[228:231], v[76:79]
    s_waitcnt lgkmcnt(11)
    v_exp_f32 v34, v162
    v_mfma_f32_16x16x32_bf16 v[80:83], a[136:139], v[224:227], v[80:83]
    v_exp_f32 v35, v163
    v_mfma_f32_16x16x32_bf16 v[88:91], a[136:139], v[228:231], v[88:91]
    ds_read_b128 a[188:191], v17 offset:15360
    v_cvt_pk_bf16_f32 v241, v34, v35
    v_mfma_f32_16x16x32_bf16 v[84:87], a[140:143], v[224:227], v[84:87]
    v_xor_b32 v16, 0x8000, v16
    v_mfma_f32_16x16x32_bf16 v[92:95], a[140:143], v[228:231], v[92:95]
    s_waitcnt vmcnt(12) lgkmcnt(8)
    v_exp_f32 v36, v164
    v_mfma_f32_16x16x32_bf16 v[96:99], a[144:147], v[224:227], v[96:99]
    s_barrier
    v_exp_f32 v37, v165
    v_mfma_f32_16x16x32_bf16 v[104:107], a[144:147], v[228:231], v[104:107]
    ds_read_b128 a[64:67], v16 offset:0
    v_cvt_pk_bf16_f32 v242, v36, v37
    v_mfma_f32_16x16x32_bf16 v[100:103], a[148:151], v[224:227], v[100:103]
    buffer_load_dwordx4 v2, s[48:51], s24 offen offset:0 sc1 lds
    v_mfma_f32_16x16x32_bf16 v[108:111], a[148:151], v[228:231], v[108:111]
    v_exp_f32 v38, v166
    v_mfma_f32_16x16x32_bf16 v[112:115], a[152:155], v[224:227], v[112:115]
    v_exp_f32 v39, v167
    v_mfma_f32_16x16x32_bf16 v[120:123], a[152:155], v[228:231], v[120:123]
    ds_read_b128 a[68:71], v16 offset:1024
    v_cvt_pk_bf16_f32 v243, v38, v39
    v_mfma_f32_16x16x32_bf16 v[116:119], a[156:159], v[224:227], v[116:119]
    s_nop 0
    ds_read_b128 a[72:75], v16 offset:2048
    ds_read_b128 a[76:79], v16 offset:3072
    v_mfma_f32_16x16x32_bf16 v[124:127], a[156:159], v[228:231], v[124:127]
    s_waitcnt lgkmcnt(5)
    v_exp_f32 v32, v168
    v_mfma_f32_16x16x32_bf16 v[64:67], a[160:163], v[232:235], v[64:67]
    v_exp_f32 v33, v169
    v_mfma_f32_16x16x32_bf16 v[72:75], a[160:163], v[236:239], v[72:75]
    ds_read_b128 a[80:83], v16 offset:4096
    v_cvt_pk_bf16_f32 v244, v32, v33
    v_mfma_f32_16x16x32_bf16 v[68:71], a[164:167], v[232:235], v[68:71]
    buffer_load_dwordx4 v2, s[48:51], s24 offen offset:1024 sc1 lds
    v_mfma_f32_16x16x32_bf16 v[76:79], a[164:167], v[236:239], v[76:79]
    s_cmp_eq_u32 s23, s34
    v_exp_f32 v34, v170
    v_mfma_f32_16x16x32_bf16 v[80:83], a[168:171], v[232:235], v[80:83]
    v_exp_f32 v35, v171
    v_mfma_f32_16x16x32_bf16 v[88:91], a[168:171], v[236:239], v[88:91]
    ds_read_b128 a[84:87], v16 offset:5120
    v_cvt_pk_bf16_f32 v245, v34, v35
    v_mfma_f32_16x16x32_bf16 v[84:87], a[172:175], v[232:235], v[84:87]
    buffer_load_dwordx4 v2, s[48:51], s24 offen offset:2048 sc1 lds
    v_mfma_f32_16x16x32_bf16 v[92:95], a[172:175], v[236:239], v[92:95]
    s_nop 0
    ds_read_b128 a[88:91], v16 offset:6144
    ds_read_b128 a[92:95], v16 offset:7168
    v_mfma_f32_16x16x32_bf16 v[96:99], a[176:179], v[232:235], v[96:99]
    v_exp_f32 v36, v172
    v_mfma_f32_16x16x32_bf16 v[104:107], a[176:179], v[236:239], v[104:107]
    v_exp_f32 v37, v173
    v_mfma_f32_16x16x32_bf16 v[100:103], a[180:183], v[232:235], v[100:103]
    ds_read_b128 a[96:99], v16 offset:8192
    v_cvt_pk_bf16_f32 v246, v36, v37
    v_mfma_f32_16x16x32_bf16 v[108:111], a[180:183], v[236:239], v[108:111]
    buffer_load_dwordx4 v2, s[48:51], s24 offen offset:3072 sc1 lds
    v_mfma_f32_16x16x32_bf16 v[112:115], a[184:187], v[232:235], v[112:115]
    v_exp_f32 v38, v174
    v_mfma_f32_16x16x32_bf16 v[120:123], a[184:187], v[236:239], v[120:123]
    s_waitcnt lgkmcnt(5)
    v_exp_f32 v39, v175
    v_mfma_f32_16x16x32_bf16 v[116:119], a[188:191], v[232:235], v[116:119]
    ds_read_b128 a[100:103], v16 offset:9216
    v_cvt_pk_bf16_f32 v247, v38, v39
    v_mfma_f32_16x16x32_bf16 v[124:127], a[188:191], v[236:239], v[124:127]
    s_cbranch_scc1 main_osp19
main_ob17:
    v_mfma_f32_16x16x32_bf16 v[128:131], a[64:67], a[0:3], v[192:195]
    s_mov_b32 m0, s22
    v_exp_f32 v32, v176
    v_mfma_f32_16x16x32_bf16 v[136:139], a[64:67], a[16:19], v[200:203]
    s_add_u32 s24, s23, 0x4000
    v_exp_f32 v33, v177
    v_mfma_f32_16x16x32_bf16 v[128:131], a[68:71], a[4:7], v[128:131]
    ds_read_b128 a[104:107], v16 offset:10240
    v_cvt_pk_bf16_f32 v248, v32, v33
    v_mfma_f32_16x16x32_bf16 v[136:139], a[68:71], a[20:23], v[136:139]
    s_cmp_eq_u32 s24, s25
    v_exp_f32 v34, v178
    v_mfma_f32_16x16x32_bf16 v[48:51], a[192:195], v[240:243], v[40:43]
    s_cselect_b32 s24, s58, s24
    v_exp_f32 v35, v179
    v_mfma_f32_16x16x32_bf16 v[52:55], a[192:195], v[244:247], v[44:47]
    ds_read_b128 a[108:111], v16 offset:11264
    v_cvt_pk_bf16_f32 v249, v34, v35
    v_mfma_f32_16x16x32_bf16 v[128:131], a[72:75], a[8:11], v[128:131]
    buffer_load_dwordx4 v2, s[44:47], s24 offen offset:0 sc1 lds
    v_mfma_f32_16x16x32_bf16 v[136:139], a[72:75], a[24:27], v[136:139]
    v_exp_f32 v36, v180
    v_mfma_f32_16x16x32_bf16 v[128:131], a[76:79], a[12:15], v[128:131]
    s_waitcnt lgkmcnt(2)
    v_exp_f32 v37, v181
    v_mfma_f32_16x16x32_bf16 v[136:139], a[76:79], a[28:31], v[136:139]
    ds_read_b128 a[112:115], v16 offset:12288
    v_cvt_pk_bf16_f32 v250, v36, v37
    v_mfma_f32_16x16x32_bf16 v[132:135], a[80:83], a[0:3], v[196:199]
    v_exp_f32 v38, v182
    v_mfma_f32_16x16x32_bf16 v[140:143], a[80:83], a[16:19], v[204:207]
    v_exp_f32 v39, v183
    v_mfma_f32_16x16x32_bf16 v[132:135], a[84:87], a[4:7], v[132:135]
    ds_read_b128 a[116:119], v16 offset:13312
    v_cvt_pk_bf16_f32 v251, v38, v39
    v_mfma_f32_16x16x32_bf16 v[140:143], a[84:87], a[20:23], v[140:143]
    buffer_load_dwordx4 v2, s[44:47], s24 offen offset:1024 sc1 lds
    v_mfma_f32_16x16x32_bf16 v[132:135], a[88:91], a[8:11], v[132:135]
    v_exp_f32 v32, v184
    v_mfma_f32_16x16x32_bf16 v[140:143], a[88:91], a[24:27], v[140:143]
    v_exp_f32 v33, v185
    v_mfma_f32_16x16x32_bf16 v[48:51], a[192:195], v[248:251], v[48:51]
    ds_read_b128 a[120:123], v16 offset:14336
    v_cvt_pk_bf16_f32 v252, v32, v33
    v_mfma_f32_16x16x32_bf16 v[132:135], a[92:95], a[12:15], v[132:135]
    v_exp_f32 v34, v186
    v_mfma_f32_16x16x32_bf16 v[140:143], a[92:95], a[28:31], v[140:143]
    v_exp_f32 v35, v187
    v_mfma_f32_16x16x32_bf16 v[144:147], a[96:99], a[0:3], v[208:211]
    ds_read_b128 a[124:127], v16 offset:15360
    v_cvt_pk_bf16_f32 v253, v34, v35
    v_mfma_f32_16x16x32_bf16 v[152:155], a[96:99], a[16:19], v[216:219]
    buffer_load_dwordx4 v2, s[44:47], s24 offen offset:2048 sc1 lds
    v_mfma_f32_16x16x32_bf16 v[144:147], a[100:103], a[4:7], v[144:147]
    s_waitcnt lgkmcnt(4)
    v_exp_f32 v36, v188
    v_mfma_f32_16x16x32_bf16 v[152:155], a[100:103], a[20:23], v[152:155]
    v_exp_f32 v37, v189
    v_mfma_f32_16x16x32_bf16 v[144:147], a[104:107], a[8:11], v[144:147]
    ds_read_b128 a[128:131], v17 offset:16384
    v_cvt_pk_bf16_f32 v254, v36, v37
    v_mfma_f32_16x16x32_bf16 v[152:155], a[104:107], a[24:27], v[152:155]
    buffer_load_dwordx4 v2, s[44:47], s24 offen offset:3072 sc1 lds
    v_mfma_f32_16x16x32_bf16 v[144:147], a[108:111], a[12:15], v[144:147]
    s_waitcnt lgkmcnt(1)
    v_exp_f32 v38, v190
    v_mfma_f32_16x16x32_bf16 v[152:155], a[108:111], a[28:31], v[152:155]
    s_add_u32 m0, s21, 0x10000
    v_exp_f32 v39, v191
    v_mfma_f32_16x16x32_bf16 v[148:151], a[112:115], a[0:3], v[212:215]
    ds_read_b128 a[132:135], v17 offset:17408
    v_cvt_pk_bf16_f32 v255, v38, v39
    v_mfma_f32_16x16x32_bf16 v[156:159], a[112:115], a[16:19], v[220:223]
    s_nop 0
    ds_read_b128 a[136:139], v17 offset:18432
    ds_read_b128 a[140:143], v17 offset:19456
    v_mfma_f32_16x16x32_bf16 v[52:55], a[192:195], v[252:255], v[52:55]
    s_nop 0
    ds_read_b128 a[144:147], v17 offset:20480
    ds_read_b128 a[148:151], v17 offset:21504
    v_mfma_f32_16x16x32_bf16 v[148:151], a[116:119], a[4:7], v[148:151]
    s_nop 0
    ds_read_b128 a[152:155], v17 offset:22528
    ds_read_b128 a[156:159], v17 offset:23552
    v_mfma_f32_16x16x32_bf16 v[156:159], a[116:119], a[20:23], v[156:159]
    s_nop 0
    ds_read_b128 a[160:163], v17 offset:24576
    ds_read_b128 a[164:167], v17 offset:25600
    v_mfma_f32_16x16x32_bf16 v[148:151], a[120:123], a[8:11], v[148:151]
    ds_read_b128 a[168:171], v17 offset:26624
    v_max_f32 v24, v48, v52
    v_mfma_f32_16x16x32_bf16 v[156:159], a[120:123], a[24:27], v[156:159]
    ds_read_b128 a[172:175], v17 offset:27648
    v_cmp_lt_f32 vcc, s33, v24
    v_mfma_f32_16x16x32_bf16 v[148:151], a[124:127], a[12:15], v[148:151]
    s_nop 0
    ds_read_b128 a[176:179], v17 offset:28672
    ds_read_b128 a[180:183], v17 offset:29696
    v_mfma_f32_16x16x32_bf16 v[156:159], a[124:127], a[28:31], v[156:159]
    s_waitcnt lgkmcnt(12)
    s_cbranch_vccnz main_orare21
main_ocont23:
    v_mfma_f32_16x16x32_bf16 v[64:67], a[128:131], v[240:243], v[64:67]
    s_xor_b32 s21, s21, 0x8000
    v_exp_f32 v32, v128
    v_mfma_f32_16x16x32_bf16 v[72:75], a[128:131], v[244:247], v[72:75]
    v_exp_f32 v33, v129
    v_mfma_f32_16x16x32_bf16 v[68:71], a[132:135], v[240:243], v[68:71]
    ds_read_b128 a[184:187], v17 offset:30720
    v_cvt_pk_bf16_f32 v224, v32, v33
    v_mfma_f32_16x16x32_bf16 v[76:79], a[132:135], v[244:247], v[76:79]
    s_waitcnt lgkmcnt(11)
    v_exp_f32 v34, v130
    v_mfma_f32_16x16x32_bf16 v[80:83], a[136:139], v[240:243], v[80:83]
    v_exp_f32 v35, v131
    v_mfma_f32_16x16x32_bf16 v[88:91], a[136:139], v[244:247], v[88:91]
    ds_read_b128 a[188:191], v17 offset:31744
    v_cvt_pk_bf16_f32 v225, v34, v35
    v_mfma_f32_16x16x32_bf16 v[84:87], a[140:143], v[240:243], v[84:87]
    v_xor_b32 v17, 0x8000, v17
    v_mfma_f32_16x16x32_bf16 v[92:95], a[140:143], v[244:247], v[92:95]
    s_waitcnt vmcnt(12) lgkmcnt(8)
    v_exp_f32 v36, v132
    v_mfma_f32_16x16x32_bf16 v[96:99], a[144:147], v[240:243], v[96:99]
    s_barrier
    v_exp_f32 v37, v133
    v_mfma_f32_16x16x32_bf16 v[104:107], a[144:147], v[244:247], v[104:107]
    ds_read_b128 a[64:67], v16 offset:16384
    v_cvt_pk_bf16_f32 v226, v36, v37
    v_mfma_f32_16x16x32_bf16 v[100:103], a[148:151], v[240:243], v[100:103]
    buffer_load_dwordx4 v2, s[48:51], s23 offen offset:0 sc1 lds
    v_mfma_f32_16x16x32_bf16 v[108:111], a[148:151], v[244:247], v[108:111]
    v_exp_f32 v38, v134
    v_mfma_f32_16x16x32_bf16 v[112:115], a[152:155], v[240:243], v[112:115]
    v_exp_f32 v39, v135
    v_mfma_f32_16x16x32_bf16 v[120:123], a[152:155], v[244:247], v[120:123]
    ds_read_b128 a[68:71], v16 offset:17408
    v_cvt_pk_bf16_f32 v227, v38, v39
    v_mfma_f32_16x16x32_bf16 v[116:119], a[156:159], v[240:243], v[116:119]
    s_nop 0
    ds_read_b128 a[72:75], v16 offset:18432
    ds_read_b128 a[76:79], v16 offset:19456
    v_mfma_f32_16x16x32_bf16 v[124:127], a[156:159], v[244:247], v[124:127]
    s_waitcnt lgkmcnt(5)
    v_exp_f32 v32, v136
    v_mfma_f32_16x16x32_bf16 v[64:67], a[160:163], v[248:251], v[64:67]
    v_exp_f32 v33, v137
    v_mfma_f32_16x16x32_bf16 v[72:75], a[160:163], v[252:255], v[72:75]
    ds_read_b128 a[80:83], v16 offset:20480
    v_cvt_pk_bf16_f32 v228, v32, v33
    v_mfma_f32_16x16x32_bf16 v[68:71], a[164:167], v[248:251], v[68:71]
    buffer_load_dwordx4 v2, s[48:51], s23 offen offset:1024 sc1 lds
    v_mfma_f32_16x16x32_bf16 v[76:79], a[164:167], v[252:255], v[76:79]
    s_cmp_eq_u32 s24, s34
    v_exp_f32 v34, v138
    v_mfma_f32_16x16x32_bf16 v[80:83], a[168:171], v[248:251], v[80:83]
    v_exp_f32 v35, v139
    v_mfma_f32_16x16x32_bf16 v[88:91], a[168:171], v[252:255], v[88:91]
    ds_read_b128 a[84:87], v16 offset:21504
    v_cvt_pk_bf16_f32 v229, v34, v35
    v_mfma_f32_16x16x32_bf16 v[84:87], a[172:175], v[248:251], v[84:87]
    buffer_load_dwordx4 v2, s[48:51], s23 offen offset:2048 sc1 lds
    v_mfma_f32_16x16x32_bf16 v[92:95], a[172:175], v[252:255], v[92:95]
    s_nop 0
    ds_read_b128 a[88:91], v16 offset:22528
    ds_read_b128 a[92:95], v16 offset:23552
    v_mfma_f32_16x16x32_bf16 v[96:99], a[176:179], v[248:251], v[96:99]
    v_exp_f32 v36, v140
    v_mfma_f32_16x16x32_bf16 v[104:107], a[176:179], v[252:255], v[104:107]
    v_exp_f32 v37, v141
    v_mfma_f32_16x16x32_bf16 v[100:103], a[180:183], v[248:251], v[100:103]
    ds_read_b128 a[96:99], v16 offset:24576
    v_cvt_pk_bf16_f32 v230, v36, v37
    v_mfma_f32_16x16x32_bf16 v[108:111], a[180:183], v[252:255], v[108:111]
    buffer_load_dwordx4 v2, s[48:51], s23 offen offset:3072 sc1 lds
    v_mfma_f32_16x16x32_bf16 v[112:115], a[184:187], v[248:251], v[112:115]
    v_exp_f32 v38, v142
    v_mfma_f32_16x16x32_bf16 v[120:123], a[184:187], v[252:255], v[120:123]
    s_waitcnt lgkmcnt(5)
    v_exp_f32 v39, v143
    v_mfma_f32_16x16x32_bf16 v[116:119], a[188:191], v[248:251], v[116:119]
    ds_read_b128 a[100:103], v16 offset:25600
    v_cvt_pk_bf16_f32 v231, v38, v39
    v_mfma_f32_16x16x32_bf16 v[124:127], a[188:191], v[252:255], v[124:127]
    s_cbranch_scc1 main_esp18
    s_branch main_eb16
main_esp18:
    s_cmp_eq_u32 s35, 30
    s_cbranch_scc1 main_peel24
    s_mov_b32 s20, s35
    s_add_u32 s35, s35, 1
    s_add_u32 s34, s24, 0x4000
    s_cmp_eq_u32 s20, s19
    s_cbranch_scc1 main_epi33
    s_branch main_maskb35
main_osp19:
    s_mov_b32 s20, s35
    s_add_u32 s35, s35, 1
    s_add_u32 s34, s23, 0x4000
    s_mov_b32 s25, -1
    s_cmp_eq_u32 s35, s19
    s_cbranch_scc1 main_sw31
    s_cmp_gt_u32 s35, s19
    s_cbranch_scc1 main_sig32
main_mask29:
    s_cmp_eq_u32 s15, 0
    s_cselect_b64 vcc, -1, 0
    v_cndmask_b32 v24, v22, v21, vcc
    v_cndmask_b32 v192, v24, v22, s[64:65]
    v_cndmask_b32 v193, v24, v22, s[66:67]
    v_cndmask_b32 v194, v24, v22, s[68:69]
    v_cndmask_b32 v195, v24, v22, s[70:71]
    v_cndmask_b32 v196, v24, v22, s[72:73]
    v_cndmask_b32 v197, v24, v22, s[74:75]
    v_cndmask_b32 v198, v24, v22, s[76:77]
    v_cndmask_b32 v199, v24, v22, s[78:79]
    v_cndmask_b32 v208, v21, v24, s[64:65]
    v_cndmask_b32 v209, v21, v24, s[66:67]
    v_cndmask_b32 v210, v21, v24, s[68:69]
    v_cndmask_b32 v211, v21, v24, s[70:71]
    v_cndmask_b32 v212, v21, v24, s[72:73]
    v_cndmask_b32 v213, v21, v24, s[74:75]
    v_cndmask_b32 v214, v21, v24, s[76:77]
    v_cndmask_b32 v215, v21, v24, s[78:79]
    s_waitcnt lgkmcnt(0)
    s_cmp_lg_u32 s20, -1
    s_cbranch_scc1 main_ob17
    s_branch main_f030
main_maskb35:
    s_cmp_eq_u32 s15, 1
    s_cselect_b64 vcc, -1, 0
    v_cndmask_b32 v24, v23, v21, vcc
    v_cndmask_b32 v200, v24, v23, s[80:81]
    v_cndmask_b32 v201, v24, v23, s[82:83]
    v_cndmask_b32 v202, v24, v23, s[84:85]
    v_cndmask_b32 v203, v24, v23, s[86:87]
    v_cndmask_b32 v204, v24, v23, s[88:89]
    v_cndmask_b32 v205, v24, v23, s[90:91]
    v_cndmask_b32 v206, v24, v23, s[92:93]
    v_cndmask_b32 v207, v24, v23, s[94:95]
    v_cndmask_b32 v216, v21, v24, s[80:81]
    v_cndmask_b32 v217, v21, v24, s[82:83]
    v_cndmask_b32 v218, v21, v24, s[84:85]
    v_cndmask_b32 v219, v21, v24, s[86:87]
    v_cndmask_b32 v220, v21, v24, s[88:89]
    v_cndmask_b32 v221, v21, v24, s[90:91]
    v_cndmask_b32 v222, v21, v24, s[92:93]
    v_cndmask_b32 v223, v21, v24, s[94:95]
    v_mov_b32 v192, v21
    v_mov_b32 v193, v21
    v_mov_b32 v194, v21
    v_mov_b32 v195, v21
    v_mov_b32 v196, v21
    v_mov_b32 v197, v21
    v_mov_b32 v198, v21
    v_mov_b32 v199, v21
    v_mov_b32 v208, v21
    v_mov_b32 v209, v21
    v_mov_b32 v210, v21
    v_mov_b32 v211, v21
    v_mov_b32 v212, v21
    v_mov_b32 v213, v21
    v_mov_b32 v214, v21
    v_mov_b32 v215, v21
    s_branch main_eb16
main_sw31:
    s_mov_b32 s33, -1.0
    v_pk_mov_b32 v[192:193], v[22:23], v[22:23] op_sel:[0,0]
    v_pk_mov_b32 v[194:195], v[22:23], v[22:23] op_sel:[0,0]
    v_pk_mov_b32 v[196:197], v[22:23], v[22:23] op_sel:[0,0]
    v_pk_mov_b32 v[198:199], v[22:23], v[22:23] op_sel:[0,0]
    v_pk_mov_b32 v[200:201], v[22:23], v[22:23] op_sel:[1,1]
    v_pk_mov_b32 v[202:203], v[22:23], v[22:23] op_sel:[1,1]
    v_pk_mov_b32 v[204:205], v[22:23], v[22:23] op_sel:[1,1]
    v_pk_mov_b32 v[206:207], v[22:23], v[22:23] op_sel:[1,1]
    v_pk_mov_b32 v[208:209], v[22:23], v[22:23] op_sel:[0,0]
    v_pk_mov_b32 v[210:211], v[22:23], v[22:23] op_sel:[0,0]
    v_pk_mov_b32 v[212:213], v[22:23], v[22:23] op_sel:[0,0]
    v_pk_mov_b32 v[214:215], v[22:23], v[22:23] op_sel:[0,0]
    v_pk_mov_b32 v[216:217], v[22:23], v[22:23] op_sel:[1,1]
    v_pk_mov_b32 v[218:219], v[22:23], v[22:23] op_sel:[1,1]
    v_pk_mov_b32 v[220:221], v[22:23], v[22:23] op_sel:[1,1]
    v_pk_mov_b32 v[222:223], v[22:23], v[22:23] op_sel:[1,1]
    v_accvgpr_mov_b32 a0, a32
    v_accvgpr_mov_b32 a1, a33
    v_accvgpr_mov_b32 a2, a34
    v_accvgpr_mov_b32 a3, a35
    v_accvgpr_mov_b32 a4, a36
    v_accvgpr_mov_b32 a5, a37
    v_accvgpr_mov_b32 a6, a38
    v_accvgpr_mov_b32 a7, a39
    v_accvgpr_mov_b32 a8, a40
    v_accvgpr_mov_b32 a9, a41
    v_accvgpr_mov_b32 a10, a42
    v_accvgpr_mov_b32 a11, a43
    v_accvgpr_mov_b32 a12, a44
    v_accvgpr_mov_b32 a13, a45
    v_accvgpr_mov_b32 a14, a46
    v_accvgpr_mov_b32 a15, a47
    v_accvgpr_mov_b32 a16, a48
    v_accvgpr_mov_b32 a17, a49
    v_accvgpr_mov_b32 a18, a50
    v_accvgpr_mov_b32 a19, a51
    v_accvgpr_mov_b32 a20, a52
    v_accvgpr_mov_b32 a21, a53
    v_accvgpr_mov_b32 a22, a54
    v_accvgpr_mov_b32 a23, a55
    v_accvgpr_mov_b32 a24, a56
    v_accvgpr_mov_b32 a25, a57
    v_accvgpr_mov_b32 a26, a58
    v_accvgpr_mov_b32 a27, a59
    v_accvgpr_mov_b32 a28, a60
    v_accvgpr_mov_b32 a29, a61
    v_accvgpr_mov_b32 a30, a62
    v_accvgpr_mov_b32 a31, a63
    s_branch main_ob17
main_orare21:
    s_waitcnt lgkmcnt(0)
    s_mov_b32 s59, 0x4e800000
    v_cmp_lt_f32 vcc, s59, v24
    s_nop 1
    s_cbranch_vccnz main_r136
main_init34:
    s_mov_b32 s33, s59
    v_max3_f32 v24, v128, v129, v130
    v_max3_f32 v25, v136, v137, v138
    v_max3_f32 v24, v24, v131, v132
    v_max3_f32 v25, v25, v139, v140
    v_max3_f32 v24, v24, v133, v134
    v_max3_f32 v25, v25, v141, v142
    v_max3_f32 v24, v24, v135, v144
    v_max3_f32 v25, v25, v143, v152
    v_max3_f32 v24, v24, v145, v146
    v_max3_f32 v25, v25, v153, v154
    v_max3_f32 v24, v24, v147, v148
    v_max3_f32 v25, v25, v155, v156
    v_max3_f32 v24, v24, v149, v150
    v_max3_f32 v25, v25, v157, v158
    v_max_f32 v24, v24, v151
    v_max_f32 v25, v25, v159
    v_mov_b64 v[26:27], v[24:25]
    s_nop 1
    v_permlane16_swap_b32 v24, v26
    v_permlane16_swap_b32 v25, v27
    v_max_f32 v24, v24, v26
    v_max_f32 v25, v25, v27
    v_mov_b64 v[26:27], v[24:25]
    s_nop 1
    v_permlane32_swap_b32 v24, v26
    v_permlane32_swap_b32 v25, v27
    v_max_f32 v24, v24, v26
    v_max_f32 v25, v25, v27
    v_pk_add_f32 v[128:129], v[128:129], v[24:25] op_sel:[0,0] op_sel_hi:[1,0] neg_lo:[0,1] neg_hi:[0,1]
    v_pk_add_f32 v[130:131], v[130:131], v[24:25] op_sel:[0,0] op_sel_hi:[1,0] neg_lo:[0,1] neg_hi:[0,1]
    v_pk_add_f32 v[132:133], v[132:133], v[24:25] op_sel:[0,0] op_sel_hi:[1,0] neg_lo:[0,1] neg_hi:[0,1]
    v_pk_add_f32 v[134:135], v[134:135], v[24:25] op_sel:[0,0] op_sel_hi:[1,0] neg_lo:[0,1] neg_hi:[0,1]
    v_pk_add_f32 v[136:137], v[136:137], v[24:25] op_sel:[0,1] op_sel_hi:[1,1] neg_lo:[0,1] neg_hi:[0,1]
    v_pk_add_f32 v[138:139], v[138:139], v[24:25] op_sel:[0,1] op_sel_hi:[1,1] neg_lo:[0,1] neg_hi:[0,1]
    v_pk_add_f32 v[140:141], v[140:141], v[24:25] op_sel:[0,1] op_sel_hi:[1,1] neg_lo:[0,1] neg_hi:[0,1]
    v_pk_add_f32 v[142:143], v[142:143], v[24:25] op_sel:[0,1] op_sel_hi:[1,1] neg_lo:[0,1] neg_hi:[0,1]
    v_pk_add_f32 v[144:145], v[144:145], v[24:25] op_sel:[0,0] op_sel_hi:[1,0] neg_lo:[0,1] neg_hi:[0,1]
    v_pk_add_f32 v[146:147], v[146:147], v[24:25] op_sel:[0,0] op_sel_hi:[1,0] neg_lo:[0,1] neg_hi:[0,1]
    v_pk_add_f32 v[148:149], v[148:149], v[24:25] op_sel:[0,0] op_sel_hi:[1,0] neg_lo:[0,1] neg_hi:[0,1]
    v_pk_add_f32 v[150:151], v[150:151], v[24:25] op_sel:[0,0] op_sel_hi:[1,0] neg_lo:[0,1] neg_hi:[0,1]
    v_pk_add_f32 v[152:153], v[152:153], v[24:25] op_sel:[0,1] op_sel_hi:[1,1] neg_lo:[0,1] neg_hi:[0,1]
    v_pk_add_f32 v[154:155], v[154:155], v[24:25] op_sel:[0,1] op_sel_hi:[1,1] neg_lo:[0,1] neg_hi:[0,1]
    v_pk_add_f32 v[156:157], v[156:157], v[24:25] op_sel:[0,1] op_sel_hi:[1,1] neg_lo:[0,1] neg_hi:[0,1]
    v_pk_add_f32 v[158:159], v[158:159], v[24:25] op_sel:[0,1] op_sel_hi:[1,1] neg_lo:[0,1] neg_hi:[0,1]
    v_pk_add_f32 v[192:193], v[192:193], v[24:25] op_sel:[0,0] op_sel_hi:[1,0] neg_lo:[0,1] neg_hi:[0,1]
    v_pk_add_f32 v[194:195], v[194:195], v[24:25] op_sel:[0,0] op_sel_hi:[1,0] neg_lo:[0,1] neg_hi:[0,1]
    v_pk_add_f32 v[196:197], v[196:197], v[24:25] op_sel:[0,0] op_sel_hi:[1,0] neg_lo:[0,1] neg_hi:[0,1]
    v_pk_add_f32 v[198:199], v[198:199], v[24:25] op_sel:[0,0] op_sel_hi:[1,0] neg_lo:[0,1] neg_hi:[0,1]
    v_pk_add_f32 v[200:201], v[200:201], v[24:25] op_sel:[0,1] op_sel_hi:[1,1] neg_lo:[0,1] neg_hi:[0,1]
    v_pk_add_f32 v[202:203], v[202:203], v[24:25] op_sel:[0,1] op_sel_hi:[1,1] neg_lo:[0,1] neg_hi:[0,1]
    v_pk_add_f32 v[204:205], v[204:205], v[24:25] op_sel:[0,1] op_sel_hi:[1,1] neg_lo:[0,1] neg_hi:[0,1]
    v_pk_add_f32 v[206:207], v[206:207], v[24:25] op_sel:[0,1] op_sel_hi:[1,1] neg_lo:[0,1] neg_hi:[0,1]
    v_pk_add_f32 v[208:209], v[208:209], v[24:25] op_sel:[0,0] op_sel_hi:[1,0] neg_lo:[0,1] neg_hi:[0,1]
    v_pk_add_f32 v[210:211], v[210:211], v[24:25] op_sel:[0,0] op_sel_hi:[1,0] neg_lo:[0,1] neg_hi:[0,1]
    v_pk_add_f32 v[212:213], v[212:213], v[24:25] op_sel:[0,0] op_sel_hi:[1,0] neg_lo:[0,1] neg_hi:[0,1]
    v_pk_add_f32 v[214:215], v[214:215], v[24:25] op_sel:[0,0] op_sel_hi:[1,0] neg_lo:[0,1] neg_hi:[0,1]
    v_pk_add_f32 v[216:217], v[216:217], v[24:25] op_sel:[0,1] op_sel_hi:[1,1] neg_lo:[0,1] neg_hi:[0,1]
    v_pk_add_f32 v[218:219], v[218:219], v[24:25] op_sel:[0,1] op_sel_hi:[1,1] neg_lo:[0,1] neg_hi:[0,1]
    v_pk_add_f32 v[220:221], v[220:221], v[24:25] op_sel:[0,1] op_sel_hi:[1,1] neg_lo:[0,1] neg_hi:[0,1]
    v_pk_add_f32 v[222:223], v[222:223], v[24:25] op_sel:[0,1] op_sel_hi:[1,1] neg_lo:[0,1] neg_hi:[0,1]
    v_pk_add_f32 v[22:23], v[22:23], v[24:25] neg_lo:[0,1] neg_hi:[0,1]
    s_branch main_ocont23
main_epi33:
    v_rcp_f32 v24, v48
    v_rcp_f32 v25, v52
    s_lshl_b32 s62, s17, 17
    s_lshl_b32 s63, s14, 12
    s_add_u32 s62, s62, s63
    v_pk_mul_f32 v[64:65], v[64:65], v[24:25] op_sel:[0,0] op_sel_hi:[1,0]
    v_pk_mul_f32 v[66:67], v[66:67], v[24:25] op_sel:[0,0] op_sel_hi:[1,0]
    v_pk_mul_f32 v[68:69], v[68:69], v[24:25] op_sel:[0,0] op_sel_hi:[1,0]
    v_pk_mul_f32 v[70:71], v[70:71], v[24:25] op_sel:[0,0] op_sel_hi:[1,0]
    v_cvt_pk_bf16_f32 v56, v64, v65
    v_cvt_pk_bf16_f32 v57, v66, v67
    v_cvt_pk_bf16_f32 v58, v68, v69
    v_cvt_pk_bf16_f32 v59, v70, v71
    buffer_store_dwordx4 v[56:59], v2, s[36:39], s62 offen offset:0 sc1
    v_pk_mul_f32 v[72:73], v[72:73], v[24:25] op_sel:[0,1] op_sel_hi:[1,1]
    v_pk_mul_f32 v[74:75], v[74:75], v[24:25] op_sel:[0,1] op_sel_hi:[1,1]
    v_pk_mul_f32 v[76:77], v[76:77], v[24:25] op_sel:[0,1] op_sel_hi:[1,1]
    v_pk_mul_f32 v[78:79], v[78:79], v[24:25] op_sel:[0,1] op_sel_hi:[1,1]
    v_cvt_pk_bf16_f32 v60, v72, v73
    v_cvt_pk_bf16_f32 v61, v74, v75
    v_cvt_pk_bf16_f32 v62, v76, v77
    v_cvt_pk_bf16_f32 v63, v78, v79
    buffer_store_dwordx4 v[60:63], v20, s[36:39], s62 offen offset:0 sc1
    v_pk_mul_f32 v[80:81], v[80:81], v[24:25] op_sel:[0,0] op_sel_hi:[1,0]
    v_pk_mul_f32 v[82:83], v[82:83], v[24:25] op_sel:[0,0] op_sel_hi:[1,0]
    v_pk_mul_f32 v[84:85], v[84:85], v[24:25] op_sel:[0,0] op_sel_hi:[1,0]
    v_pk_mul_f32 v[86:87], v[86:87], v[24:25] op_sel:[0,0] op_sel_hi:[1,0]
    v_cvt_pk_bf16_f32 v56, v80, v81
    v_cvt_pk_bf16_f32 v57, v82, v83
    v_cvt_pk_bf16_f32 v58, v84, v85
    v_cvt_pk_bf16_f32 v59, v86, v87
    buffer_store_dwordx4 v[56:59], v2, s[36:39], s62 offen offset:1024 sc1
    v_pk_mul_f32 v[88:89], v[88:89], v[24:25] op_sel:[0,1] op_sel_hi:[1,1]
    v_pk_mul_f32 v[90:91], v[90:91], v[24:25] op_sel:[0,1] op_sel_hi:[1,1]
    v_pk_mul_f32 v[92:93], v[92:93], v[24:25] op_sel:[0,1] op_sel_hi:[1,1]
    v_pk_mul_f32 v[94:95], v[94:95], v[24:25] op_sel:[0,1] op_sel_hi:[1,1]
    v_cvt_pk_bf16_f32 v60, v88, v89
    v_cvt_pk_bf16_f32 v61, v90, v91
    v_cvt_pk_bf16_f32 v62, v92, v93
    v_cvt_pk_bf16_f32 v63, v94, v95
    buffer_store_dwordx4 v[60:63], v20, s[36:39], s62 offen offset:1024 sc1
    v_pk_mul_f32 v[96:97], v[96:97], v[24:25] op_sel:[0,0] op_sel_hi:[1,0]
    v_pk_mul_f32 v[98:99], v[98:99], v[24:25] op_sel:[0,0] op_sel_hi:[1,0]
    v_pk_mul_f32 v[100:101], v[100:101], v[24:25] op_sel:[0,0] op_sel_hi:[1,0]
    v_pk_mul_f32 v[102:103], v[102:103], v[24:25] op_sel:[0,0] op_sel_hi:[1,0]
    v_cvt_pk_bf16_f32 v56, v96, v97
    v_cvt_pk_bf16_f32 v57, v98, v99
    v_cvt_pk_bf16_f32 v58, v100, v101
    v_cvt_pk_bf16_f32 v59, v102, v103
    buffer_store_dwordx4 v[56:59], v2, s[36:39], s62 offen offset:2048 sc1
    v_pk_mul_f32 v[104:105], v[104:105], v[24:25] op_sel:[0,1] op_sel_hi:[1,1]
    v_pk_mul_f32 v[106:107], v[106:107], v[24:25] op_sel:[0,1] op_sel_hi:[1,1]
    v_pk_mul_f32 v[108:109], v[108:109], v[24:25] op_sel:[0,1] op_sel_hi:[1,1]
    v_pk_mul_f32 v[110:111], v[110:111], v[24:25] op_sel:[0,1] op_sel_hi:[1,1]
    v_cvt_pk_bf16_f32 v60, v104, v105
    v_cvt_pk_bf16_f32 v61, v106, v107
    v_cvt_pk_bf16_f32 v62, v108, v109
    v_cvt_pk_bf16_f32 v63, v110, v111
    buffer_store_dwordx4 v[60:63], v20, s[36:39], s62 offen offset:2048 sc1
    v_pk_mul_f32 v[112:113], v[112:113], v[24:25] op_sel:[0,0] op_sel_hi:[1,0]
    v_pk_mul_f32 v[114:115], v[114:115], v[24:25] op_sel:[0,0] op_sel_hi:[1,0]
    v_pk_mul_f32 v[116:117], v[116:117], v[24:25] op_sel:[0,0] op_sel_hi:[1,0]
    v_pk_mul_f32 v[118:119], v[118:119], v[24:25] op_sel:[0,0] op_sel_hi:[1,0]
    v_cvt_pk_bf16_f32 v56, v112, v113
    v_cvt_pk_bf16_f32 v57, v114, v115
    v_cvt_pk_bf16_f32 v58, v116, v117
    v_cvt_pk_bf16_f32 v59, v118, v119
    buffer_store_dwordx4 v[56:59], v2, s[36:39], s62 offen offset:3072 sc1
    v_pk_mul_f32 v[120:121], v[120:121], v[24:25] op_sel:[0,1] op_sel_hi:[1,1]
    v_pk_mul_f32 v[122:123], v[122:123], v[24:25] op_sel:[0,1] op_sel_hi:[1,1]
    v_pk_mul_f32 v[124:125], v[124:125], v[24:25] op_sel:[0,1] op_sel_hi:[1,1]
    v_pk_mul_f32 v[126:127], v[126:127], v[24:25] op_sel:[0,1] op_sel_hi:[1,1]
    v_cvt_pk_bf16_f32 v60, v120, v121
    v_cvt_pk_bf16_f32 v61, v122, v123
    v_cvt_pk_bf16_f32 v62, v124, v125
    v_cvt_pk_bf16_f32 v63, v126, v127
    buffer_store_dwordx4 v[60:63], v20, s[36:39], s62 offen offset:3072 sc1
    v_mov_b64 v[64:65], 0
    v_mov_b64 v[66:67], 0
    v_mov_b64 v[68:69], 0
    v_mov_b64 v[70:71], 0
    v_mov_b64 v[72:73], 0
    v_mov_b64 v[74:75], 0
    v_mov_b64 v[76:77], 0
    v_mov_b64 v[78:79], 0
    v_mov_b64 v[80:81], 0
    v_mov_b64 v[82:83], 0
    v_mov_b64 v[84:85], 0
    v_mov_b64 v[86:87], 0
    v_mov_b64 v[88:89], 0
    v_mov_b64 v[90:91], 0
    v_mov_b64 v[92:93], 0
    v_mov_b64 v[94:95], 0
    v_mov_b64 v[96:97], 0
    v_mov_b64 v[98:99], 0
    v_mov_b64 v[100:101], 0
    v_mov_b64 v[102:103], 0
    v_mov_b64 v[104:105], 0
    v_mov_b64 v[106:107], 0
    v_mov_b64 v[108:109], 0
    v_mov_b64 v[110:111], 0
    v_mov_b64 v[112:113], 0
    v_mov_b64 v[114:115], 0
    v_mov_b64 v[116:117], 0
    v_mov_b64 v[118:119], 0
    v_mov_b64 v[120:121], 0
    v_mov_b64 v[122:123], 0
    v_mov_b64 v[124:125], 0
    v_mov_b64 v[126:127], 0
    v_mov_b64 v[48:49], 0
    v_mov_b64 v[50:51], 0
    v_mov_b64 v[52:53], 0
    v_mov_b64 v[54:55], 0
    s_branch main_eb16
main_sig32:
    v_mov_b32 v24, 1
    s_waitcnt vmcnt(8)
    s_mov_b64 exec, 1
    buffer_atomic_add v24, off, s[40:43], s54 sc1
    s_mov_b64 exec, -1
    s_mov_b32 s35, 30
    s_sub_u32 s34, 33, s19
    s_lshl_b32 s34, s34, 14
    s_add_u32 s34, s34, s58
    buffer_load_dword v3, v8, s[8:11], s26 offen
    buffer_load_dword v3, v8, s[28:31], s26 offen
    buffer_load_dword v3, v15, s[4:7], s57 offen
    global_load_dword v3, v[10:11], off
    s_branch main_ob17
main_erare20:
    s_waitcnt lgkmcnt(0)
    v_max3_f32 v24, v128, v129, v130
    v_max3_f32 v25, v136, v137, v138
    v_max3_f32 v24, v24, v131, v132
    v_max3_f32 v25, v25, v139, v140
    v_max3_f32 v24, v24, v133, v134
    v_max3_f32 v25, v25, v141, v142
    v_max3_f32 v24, v24, v135, v144
    v_max3_f32 v25, v25, v143, v152
    v_max3_f32 v24, v24, v145, v146
    v_max3_f32 v25, v25, v153, v154
    v_max3_f32 v24, v24, v147, v148
    v_max3_f32 v25, v25, v155, v156
    v_max3_f32 v24, v24, v149, v150
    v_max3_f32 v25, v25, v157, v158
    v_max_f32 v24, v24, v151
    v_max_f32 v25, v25, v159
    v_mov_b64 v[26:27], v[24:25]
    s_nop 1
    v_permlane16_swap_b32 v24, v26
    v_permlane16_swap_b32 v25, v27
    v_max_f32 v24, v24, v26
    v_max_f32 v25, v25, v27
    v_mov_b64 v[26:27], v[24:25]
    s_nop 1
    v_permlane32_swap_b32 v24, v26
    v_permlane32_swap_b32 v25, v27
    v_max_f32 v24, v24, v26
    v_max_f32 v25, v25, v27
    v_max_f32 v24, 0, v24
    v_max_f32 v25, 0, v25
    v_exp_f32 v26, -v24
    v_exp_f32 v27, -v25
    v_pk_add_f32 v[128:129], v[128:129], v[24:25] op_sel:[0,0] op_sel_hi:[1,0] neg_lo:[0,1] neg_hi:[0,1]
    v_pk_add_f32 v[130:131], v[130:131], v[24:25] op_sel:[0,0] op_sel_hi:[1,0] neg_lo:[0,1] neg_hi:[0,1]
    v_pk_add_f32 v[132:133], v[132:133], v[24:25] op_sel:[0,0] op_sel_hi:[1,0] neg_lo:[0,1] neg_hi:[0,1]
    v_pk_add_f32 v[134:135], v[134:135], v[24:25] op_sel:[0,0] op_sel_hi:[1,0] neg_lo:[0,1] neg_hi:[0,1]
    v_pk_add_f32 v[136:137], v[136:137], v[24:25] op_sel:[0,1] op_sel_hi:[1,1] neg_lo:[0,1] neg_hi:[0,1]
    v_pk_add_f32 v[138:139], v[138:139], v[24:25] op_sel:[0,1] op_sel_hi:[1,1] neg_lo:[0,1] neg_hi:[0,1]
    v_pk_add_f32 v[140:141], v[140:141], v[24:25] op_sel:[0,1] op_sel_hi:[1,1] neg_lo:[0,1] neg_hi:[0,1]
    v_pk_add_f32 v[142:143], v[142:143], v[24:25] op_sel:[0,1] op_sel_hi:[1,1] neg_lo:[0,1] neg_hi:[0,1]
    v_pk_add_f32 v[144:145], v[144:145], v[24:25] op_sel:[0,0] op_sel_hi:[1,0] neg_lo:[0,1] neg_hi:[0,1]
    v_pk_add_f32 v[146:147], v[146:147], v[24:25] op_sel:[0,0] op_sel_hi:[1,0] neg_lo:[0,1] neg_hi:[0,1]
    v_pk_add_f32 v[148:149], v[148:149], v[24:25] op_sel:[0,0] op_sel_hi:[1,0] neg_lo:[0,1] neg_hi:[0,1]
    v_pk_add_f32 v[150:151], v[150:151], v[24:25] op_sel:[0,0] op_sel_hi:[1,0] neg_lo:[0,1] neg_hi:[0,1]
    v_pk_add_f32 v[152:153], v[152:153], v[24:25] op_sel:[0,1] op_sel_hi:[1,1] neg_lo:[0,1] neg_hi:[0,1]
    v_pk_add_f32 v[154:155], v[154:155], v[24:25] op_sel:[0,1] op_sel_hi:[1,1] neg_lo:[0,1] neg_hi:[0,1]
    v_pk_add_f32 v[156:157], v[156:157], v[24:25] op_sel:[0,1] op_sel_hi:[1,1] neg_lo:[0,1] neg_hi:[0,1]
    v_pk_add_f32 v[158:159], v[158:159], v[24:25] op_sel:[0,1] op_sel_hi:[1,1] neg_lo:[0,1] neg_hi:[0,1]
    v_pk_add_f32 v[160:161], v[160:161], v[24:25] op_sel:[0,0] op_sel_hi:[1,0] neg_lo:[0,1] neg_hi:[0,1]
    v_pk_add_f32 v[162:163], v[162:163], v[24:25] op_sel:[0,0] op_sel_hi:[1,0] neg_lo:[0,1] neg_hi:[0,1]
    v_pk_add_f32 v[164:165], v[164:165], v[24:25] op_sel:[0,0] op_sel_hi:[1,0] neg_lo:[0,1] neg_hi:[0,1]
    v_pk_add_f32 v[166:167], v[166:167], v[24:25] op_sel:[0,0] op_sel_hi:[1,0] neg_lo:[0,1] neg_hi:[0,1]
    v_pk_add_f32 v[168:169], v[168:169], v[24:25] op_sel:[0,1] op_sel_hi:[1,1] neg_lo:[0,1] neg_hi:[0,1]
    v_pk_add_f32 v[170:171], v[170:171], v[24:25] op_sel:[0,1] op_sel_hi:[1,1] neg_lo:[0,1] neg_hi:[0,1]
    v_pk_add_f32 v[172:173], v[172:173], v[24:25] op_sel:[0,1] op_sel_hi:[1,1] neg_lo:[0,1] neg_hi:[0,1]
    v_pk_add_f32 v[174:175], v[174:175], v[24:25] op_sel:[0,1] op_sel_hi:[1,1] neg_lo:[0,1] neg_hi:[0,1]
    v_pk_add_f32 v[176:177], v[176:177], v[24:25] op_sel:[0,0] op_sel_hi:[1,0] neg_lo:[0,1] neg_hi:[0,1]
    v_pk_add_f32 v[178:179], v[178:179], v[24:25] op_sel:[0,0] op_sel_hi:[1,0] neg_lo:[0,1] neg_hi:[0,1]
    v_pk_add_f32 v[180:181], v[180:181], v[24:25] op_sel:[0,0] op_sel_hi:[1,0] neg_lo:[0,1] neg_hi:[0,1]
    v_pk_add_f32 v[182:183], v[182:183], v[24:25] op_sel:[0,0] op_sel_hi:[1,0] neg_lo:[0,1] neg_hi:[0,1]
    v_pk_add_f32 v[184:185], v[184:185], v[24:25] op_sel:[0,1] op_sel_hi:[1,1] neg_lo:[0,1] neg_hi:[0,1]
    v_pk_add_f32 v[186:187], v[186:187], v[24:25] op_sel:[0,1] op_sel_hi:[1,1] neg_lo:[0,1] neg_hi:[0,1]
    v_pk_add_f32 v[188:189], v[188:189], v[24:25] op_sel:[0,1] op_sel_hi:[1,1] neg_lo:[0,1] neg_hi:[0,1]
    v_pk_add_f32 v[190:191], v[190:191], v[24:25] op_sel:[0,1] op_sel_hi:[1,1] neg_lo:[0,1] neg_hi:[0,1]
    v_pk_add_f32 v[192:193], v[192:193], v[24:25] op_sel:[0,0] op_sel_hi:[1,0] neg_lo:[0,1] neg_hi:[0,1]
    v_pk_add_f32 v[194:195], v[194:195], v[24:25] op_sel:[0,0] op_sel_hi:[1,0] neg_lo:[0,1] neg_hi:[0,1]
    v_pk_add_f32 v[196:197], v[196:197], v[24:25] op_sel:[0,0] op_sel_hi:[1,0] neg_lo:[0,1] neg_hi:[0,1]
    v_pk_add_f32 v[198:199], v[198:199], v[24:25] op_sel:[0,0] op_sel_hi:[1,0] neg_lo:[0,1] neg_hi:[0,1]
    v_pk_add_f32 v[200:201], v[200:201], v[24:25] op_sel:[0,1] op_sel_hi:[1,1] neg_lo:[0,1] neg_hi:[0,1]
    v_pk_add_f32 v[202:203], v[202:203], v[24:25] op_sel:[0,1] op_sel_hi:[1,1] neg_lo:[0,1] neg_hi:[0,1]
    v_pk_add_f32 v[204:205], v[204:205], v[24:25] op_sel:[0,1] op_sel_hi:[1,1] neg_lo:[0,1] neg_hi:[0,1]
    v_pk_add_f32 v[206:207], v[206:207], v[24:25] op_sel:[0,1] op_sel_hi:[1,1] neg_lo:[0,1] neg_hi:[0,1]
    v_pk_add_f32 v[208:209], v[208:209], v[24:25] op_sel:[0,0] op_sel_hi:[1,0] neg_lo:[0,1] neg_hi:[0,1]
    v_pk_add_f32 v[210:211], v[210:211], v[24:25] op_sel:[0,0] op_sel_hi:[1,0] neg_lo:[0,1] neg_hi:[0,1]
    v_pk_add_f32 v[212:213], v[212:213], v[24:25] op_sel:[0,0] op_sel_hi:[1,0] neg_lo:[0,1] neg_hi:[0,1]
    v_pk_add_f32 v[214:215], v[214:215], v[24:25] op_sel:[0,0] op_sel_hi:[1,0] neg_lo:[0,1] neg_hi:[0,1]
    v_pk_add_f32 v[216:217], v[216:217], v[24:25] op_sel:[0,1] op_sel_hi:[1,1] neg_lo:[0,1] neg_hi:[0,1]
    v_pk_add_f32 v[218:219], v[218:219], v[24:25] op_sel:[0,1] op_sel_hi:[1,1] neg_lo:[0,1] neg_hi:[0,1]
    v_pk_add_f32 v[220:221], v[220:221], v[24:25] op_sel:[0,1] op_sel_hi:[1,1] neg_lo:[0,1] neg_hi:[0,1]
    v_pk_add_f32 v[222:223], v[222:223], v[24:25] op_sel:[0,1] op_sel_hi:[1,1] neg_lo:[0,1] neg_hi:[0,1]
    v_pk_add_f32 v[22:23], v[22:23], v[24:25] neg_lo:[0,1] neg_hi:[0,1]
    v_pk_mul_f32 v[64:65], v[64:65], v[26:27] op_sel:[0,0] op_sel_hi:[1,0]
    v_pk_mul_f32 v[66:67], v[66:67], v[26:27] op_sel:[0,0] op_sel_hi:[1,0]
    v_pk_mul_f32 v[68:69], v[68:69], v[26:27] op_sel:[0,0] op_sel_hi:[1,0]
    v_pk_mul_f32 v[70:71], v[70:71], v[26:27] op_sel:[0,0] op_sel_hi:[1,0]
    v_pk_mul_f32 v[72:73], v[72:73], v[26:27] op_sel:[0,1] op_sel_hi:[1,1]
    v_pk_mul_f32 v[74:75], v[74:75], v[26:27] op_sel:[0,1] op_sel_hi:[1,1]
    v_pk_mul_f32 v[76:77], v[76:77], v[26:27] op_sel:[0,1] op_sel_hi:[1,1]
    v_pk_mul_f32 v[78:79], v[78:79], v[26:27] op_sel:[0,1] op_sel_hi:[1,1]
    v_pk_mul_f32 v[80:81], v[80:81], v[26:27] op_sel:[0,0] op_sel_hi:[1,0]
    v_pk_mul_f32 v[82:83], v[82:83], v[26:27] op_sel:[0,0] op_sel_hi:[1,0]
    v_pk_mul_f32 v[84:85], v[84:85], v[26:27] op_sel:[0,0] op_sel_hi:[1,0]
    v_pk_mul_f32 v[86:87], v[86:87], v[26:27] op_sel:[0,0] op_sel_hi:[1,0]
    v_pk_mul_f32 v[88:89], v[88:89], v[26:27] op_sel:[0,1] op_sel_hi:[1,1]
    v_pk_mul_f32 v[90:91], v[90:91], v[26:27] op_sel:[0,1] op_sel_hi:[1,1]
    v_pk_mul_f32 v[92:93], v[92:93], v[26:27] op_sel:[0,1] op_sel_hi:[1,1]
    v_pk_mul_f32 v[94:95], v[94:95], v[26:27] op_sel:[0,1] op_sel_hi:[1,1]
    v_pk_mul_f32 v[96:97], v[96:97], v[26:27] op_sel:[0,0] op_sel_hi:[1,0]
    v_pk_mul_f32 v[98:99], v[98:99], v[26:27] op_sel:[0,0] op_sel_hi:[1,0]
    v_pk_mul_f32 v[100:101], v[100:101], v[26:27] op_sel:[0,0] op_sel_hi:[1,0]
    v_pk_mul_f32 v[102:103], v[102:103], v[26:27] op_sel:[0,0] op_sel_hi:[1,0]
    v_pk_mul_f32 v[104:105], v[104:105], v[26:27] op_sel:[0,1] op_sel_hi:[1,1]
    v_pk_mul_f32 v[106:107], v[106:107], v[26:27] op_sel:[0,1] op_sel_hi:[1,1]
    v_pk_mul_f32 v[108:109], v[108:109], v[26:27] op_sel:[0,1] op_sel_hi:[1,1]
    v_pk_mul_f32 v[110:111], v[110:111], v[26:27] op_sel:[0,1] op_sel_hi:[1,1]
    v_pk_mul_f32 v[112:113], v[112:113], v[26:27] op_sel:[0,0] op_sel_hi:[1,0]
    v_pk_mul_f32 v[114:115], v[114:115], v[26:27] op_sel:[0,0] op_sel_hi:[1,0]
    v_pk_mul_f32 v[116:117], v[116:117], v[26:27] op_sel:[0,0] op_sel_hi:[1,0]
    v_pk_mul_f32 v[118:119], v[118:119], v[26:27] op_sel:[0,0] op_sel_hi:[1,0]
    v_pk_mul_f32 v[120:121], v[120:121], v[26:27] op_sel:[0,1] op_sel_hi:[1,1]
    v_pk_mul_f32 v[122:123], v[122:123], v[26:27] op_sel:[0,1] op_sel_hi:[1,1]
    v_pk_mul_f32 v[124:125], v[124:125], v[26:27] op_sel:[0,1] op_sel_hi:[1,1]
    v_pk_mul_f32 v[126:127], v[126:127], v[26:27] op_sel:[0,1] op_sel_hi:[1,1]
    v_pk_mul_f32 v[48:49], v[48:49], v[26:27] op_sel:[0,0] op_sel_hi:[1,0]
    v_pk_mul_f32 v[50:51], v[50:51], v[26:27] op_sel:[0,0] op_sel_hi:[1,0]
    v_pk_mul_f32 v[52:53], v[52:53], v[26:27] op_sel:[0,1] op_sel_hi:[1,1]
    v_pk_mul_f32 v[54:55], v[54:55], v[26:27] op_sel:[0,1] op_sel_hi:[1,1]
    v_exp_f32 v32, v128
    v_exp_f32 v33, v129
    v_exp_f32 v34, v130
    v_cvt_pk_bf16_f32 v224, v32, v33
    v_exp_f32 v35, v131
    v_exp_f32 v36, v132
    v_cvt_pk_bf16_f32 v225, v34, v35
    v_exp_f32 v37, v133
    v_exp_f32 v38, v134
    v_cvt_pk_bf16_f32 v226, v36, v37
    v_exp_f32 v39, v135
    v_exp_f32 v32, v136
    v_cvt_pk_bf16_f32 v227, v38, v39
    v_exp_f32 v33, v137
    v_exp_f32 v34, v138
    v_cvt_pk_bf16_f32 v228, v32, v33
    v_exp_f32 v35, v139
    v_exp_f32 v36, v140
    v_cvt_pk_bf16_f32 v229, v34, v35
    v_exp_f32 v37, v141
    v_exp_f32 v38, v142
    v_cvt_pk_bf16_f32 v230, v36, v37
    v_exp_f32 v39, v143
    v_exp_f32 v32, v144
    v_cvt_pk_bf16_f32 v231, v38, v39
    v_exp_f32 v33, v145
    v_exp_f32 v34, v146
    v_cvt_pk_bf16_f32 v232, v32, v33
    v_exp_f32 v35, v147
    v_exp_f32 v36, v148
    v_cvt_pk_bf16_f32 v233, v34, v35
    v_exp_f32 v37, v149
    v_exp_f32 v38, v150
    v_cvt_pk_bf16_f32 v234, v36, v37
    v_exp_f32 v39, v151
    v_exp_f32 v32, v152
    v_cvt_pk_bf16_f32 v235, v38, v39
    v_exp_f32 v33, v153
    v_exp_f32 v34, v154
    v_cvt_pk_bf16_f32 v236, v32, v33
    v_exp_f32 v35, v155
    v_exp_f32 v36, v156
    v_cvt_pk_bf16_f32 v237, v34, v35
    v_exp_f32 v37, v157
    v_exp_f32 v38, v158
    v_cvt_pk_bf16_f32 v238, v36, v37
    v_exp_f32 v39, v159
    s_nop 0
    v_cvt_pk_bf16_f32 v239, v38, v39
    v_mfma_f32_16x16x32_bf16 v[40:43], a[192:195], v[224:227], v[48:51]
    v_mfma_f32_16x16x32_bf16 v[44:47], a[192:195], v[228:231], v[52:55]
    v_mfma_f32_16x16x32_bf16 v[40:43], a[192:195], v[232:235], v[40:43]
    v_mfma_f32_16x16x32_bf16 v[44:47], a[192:195], v[236:239], v[44:47]
    s_cmp_eq_u32 s32, 30
    s_cbranch_scc1 main_pc25
    s_cmp_eq_u32 s32, 32
    s_cbranch_scc1 main_pc27
    s_branch main_econt22
main_r136:
    s_waitcnt lgkmcnt(0)
    v_max3_f32 v24, v160, v161, v162
    v_max3_f32 v25, v168, v169, v170
    v_max3_f32 v24, v24, v163, v164
    v_max3_f32 v25, v25, v171, v172
    v_max3_f32 v24, v24, v165, v166
    v_max3_f32 v25, v25, v173, v174
    v_max3_f32 v24, v24, v167, v176
    v_max3_f32 v25, v25, v175, v184
    v_max3_f32 v24, v24, v177, v178
    v_max3_f32 v25, v25, v185, v186
    v_max3_f32 v24, v24, v179, v180
    v_max3_f32 v25, v25, v187, v188
    v_max3_f32 v24, v24, v181, v182
    v_max3_f32 v25, v25, v189, v190
    v_max_f32 v24, v24, v183
    v_max_f32 v25, v25, v191
    v_mov_b64 v[26:27], v[24:25]
    s_nop 1
    v_permlane16_swap_b32 v24, v26
    v_permlane16_swap_b32 v25, v27
    v_max_f32 v24, v24, v26
    v_max_f32 v25, v25, v27
    v_mov_b64 v[26:27], v[24:25]
    s_nop 1
    v_permlane32_swap_b32 v24, v26
    v_permlane32_swap_b32 v25, v27
    v_max_f32 v24, v24, v26
    v_max_f32 v25, v25, v27
    v_max_f32 v24, 0, v24
    v_max_f32 v25, 0, v25
    v_exp_f32 v26, -v24
    v_exp_f32 v27, -v25
    v_pk_add_f32 v[128:129], v[128:129], v[24:25] op_sel:[0,0] op_sel_hi:[1,0] neg_lo:[0,1] neg_hi:[0,1]
    v_pk_add_f32 v[130:131], v[130:131], v[24:25] op_sel:[0,0] op_sel_hi:[1,0] neg_lo:[0,1] neg_hi:[0,1]
    v_pk_add_f32 v[132:133], v[132:133], v[24:25] op_sel:[0,0] op_sel_hi:[1,0] neg_lo:[0,1] neg_hi:[0,1]
    v_pk_add_f32 v[134:135], v[134:135], v[24:25] op_sel:[0,0] op_sel_hi:[1,0] neg_lo:[0,1] neg_hi:[0,1]
    v_pk_add_f32 v[136:137], v[136:137], v[24:25] op_sel:[0,1] op_sel_hi:[1,1] neg_lo:[0,1] neg_hi:[0,1]
    v_pk_add_f32 v[138:139], v[138:139], v[24:25] op_sel:[0,1] op_sel_hi:[1,1] neg_lo:[0,1] neg_hi:[0,1]
    v_pk_add_f32 v[140:141], v[140:141], v[24:25] op_sel:[0,1] op_sel_hi:[1,1] neg_lo:[0,1] neg_hi:[0,1]
    v_pk_add_f32 v[142:143], v[142:143], v[24:25] op_sel:[0,1] op_sel_hi:[1,1] neg_lo:[0,1] neg_hi:[0,1]
    v_pk_add_f32 v[144:145], v[144:145], v[24:25] op_sel:[0,0] op_sel_hi:[1,0] neg_lo:[0,1] neg_hi:[0,1]
    v_pk_add_f32 v[146:147], v[146:147], v[24:25] op_sel:[0,0] op_sel_hi:[1,0] neg_lo:[0,1] neg_hi:[0,1]
    v_pk_add_f32 v[148:149], v[148:149], v[24:25] op_sel:[0,0] op_sel_hi:[1,0] neg_lo:[0,1] neg_hi:[0,1]
    v_pk_add_f32 v[150:151], v[150:151], v[24:25] op_sel:[0,0] op_sel_hi:[1,0] neg_lo:[0,1] neg_hi:[0,1]
    v_pk_add_f32 v[152:153], v[152:153], v[24:25] op_sel:[0,1] op_sel_hi:[1,1] neg_lo:[0,1] neg_hi:[0,1]
    v_pk_add_f32 v[154:155], v[154:155], v[24:25] op_sel:[0,1] op_sel_hi:[1,1] neg_lo:[0,1] neg_hi:[0,1]
    v_pk_add_f32 v[156:157], v[156:157], v[24:25] op_sel:[0,1] op_sel_hi:[1,1] neg_lo:[0,1] neg_hi:[0,1]
    v_pk_add_f32 v[158:159], v[158:159], v[24:25] op_sel:[0,1] op_sel_hi:[1,1] neg_lo:[0,1] neg_hi:[0,1]
    v_pk_add_f32 v[160:161], v[160:161], v[24:25] op_sel:[0,0] op_sel_hi:[1,0] neg_lo:[0,1] neg_hi:[0,1]
    v_pk_add_f32 v[162:163], v[162:163], v[24:25] op_sel:[0,0] op_sel_hi:[1,0] neg_lo:[0,1] neg_hi:[0,1]
    v_pk_add_f32 v[164:165], v[164:165], v[24:25] op_sel:[0,0] op_sel_hi:[1,0] neg_lo:[0,1] neg_hi:[0,1]
    v_pk_add_f32 v[166:167], v[166:167], v[24:25] op_sel:[0,0] op_sel_hi:[1,0] neg_lo:[0,1] neg_hi:[0,1]
    v_pk_add_f32 v[168:169], v[168:169], v[24:25] op_sel:[0,1] op_sel_hi:[1,1] neg_lo:[0,1] neg_hi:[0,1]
    v_pk_add_f32 v[170:171], v[170:171], v[24:25] op_sel:[0,1] op_sel_hi:[1,1] neg_lo:[0,1] neg_hi:[0,1]
    v_pk_add_f32 v[172:173], v[172:173], v[24:25] op_sel:[0,1] op_sel_hi:[1,1] neg_lo:[0,1] neg_hi:[0,1]
    v_pk_add_f32 v[174:175], v[174:175], v[24:25] op_sel:[0,1] op_sel_hi:[1,1] neg_lo:[0,1] neg_hi:[0,1]
    v_pk_add_f32 v[176:177], v[176:177], v[24:25] op_sel:[0,0] op_sel_hi:[1,0] neg_lo:[0,1] neg_hi:[0,1]
    v_pk_add_f32 v[178:179], v[178:179], v[24:25] op_sel:[0,0] op_sel_hi:[1,0] neg_lo:[0,1] neg_hi:[0,1]
    v_pk_add_f32 v[180:181], v[180:181], v[24:25] op_sel:[0,0] op_sel_hi:[1,0] neg_lo:[0,1] neg_hi:[0,1]
    v_pk_add_f32 v[182:183], v[182:183], v[24:25] op_sel:[0,0] op_sel_hi:[1,0] neg_lo:[0,1] neg_hi:[0,1]
    v_pk_add_f32 v[184:185], v[184:185], v[24:25] op_sel:[0,1] op_sel_hi:[1,1] neg_lo:[0,1] neg_hi:[0,1]
    v_pk_add_f32 v[186:187], v[186:187], v[24:25] op_sel:[0,1] op_sel_hi:[1,1] neg_lo:[0,1] neg_hi:[0,1]
    v_pk_add_f32 v[188:189], v[188:189], v[24:25] op_sel:[0,1] op_sel_hi:[1,1] neg_lo:[0,1] neg_hi:[0,1]
    v_pk_add_f32 v[190:191], v[190:191], v[24:25] op_sel:[0,1] op_sel_hi:[1,1] neg_lo:[0,1] neg_hi:[0,1]
    v_pk_add_f32 v[192:193], v[192:193], v[24:25] op_sel:[0,0] op_sel_hi:[1,0] neg_lo:[0,1] neg_hi:[0,1]
    v_pk_add_f32 v[194:195], v[194:195], v[24:25] op_sel:[0,0] op_sel_hi:[1,0] neg_lo:[0,1] neg_hi:[0,1]
    v_pk_add_f32 v[196:197], v[196:197], v[24:25] op_sel:[0,0] op_sel_hi:[1,0] neg_lo:[0,1] neg_hi:[0,1]
    v_pk_add_f32 v[198:199], v[198:199], v[24:25] op_sel:[0,0] op_sel_hi:[1,0] neg_lo:[0,1] neg_hi:[0,1]
    v_pk_add_f32 v[200:201], v[200:201], v[24:25] op_sel:[0,1] op_sel_hi:[1,1] neg_lo:[0,1] neg_hi:[0,1]
    v_pk_add_f32 v[202:203], v[202:203], v[24:25] op_sel:[0,1] op_sel_hi:[1,1] neg_lo:[0,1] neg_hi:[0,1]
    v_pk_add_f32 v[204:205], v[204:205], v[24:25] op_sel:[0,1] op_sel_hi:[1,1] neg_lo:[0,1] neg_hi:[0,1]
    v_pk_add_f32 v[206:207], v[206:207], v[24:25] op_sel:[0,1] op_sel_hi:[1,1] neg_lo:[0,1] neg_hi:[0,1]
    v_pk_add_f32 v[208:209], v[208:209], v[24:25] op_sel:[0,0] op_sel_hi:[1,0] neg_lo:[0,1] neg_hi:[0,1]
    v_pk_add_f32 v[210:211], v[210:211], v[24:25] op_sel:[0,0] op_sel_hi:[1,0] neg_lo:[0,1] neg_hi:[0,1]
    v_pk_add_f32 v[212:213], v[212:213], v[24:25] op_sel:[0,0] op_sel_hi:[1,0] neg_lo:[0,1] neg_hi:[0,1]
    v_pk_add_f32 v[214:215], v[214:215], v[24:25] op_sel:[0,0] op_sel_hi:[1,0] neg_lo:[0,1] neg_hi:[0,1]
    v_pk_add_f32 v[216:217], v[216:217], v[24:25] op_sel:[0,1] op_sel_hi:[1,1] neg_lo:[0,1] neg_hi:[0,1]
    v_pk_add_f32 v[218:219], v[218:219], v[24:25] op_sel:[0,1] op_sel_hi:[1,1] neg_lo:[0,1] neg_hi:[0,1]
    v_pk_add_f32 v[220:221], v[220:221], v[24:25] op_sel:[0,1] op_sel_hi:[1,1] neg_lo:[0,1] neg_hi:[0,1]
    v_pk_add_f32 v[222:223], v[222:223], v[24:25] op_sel:[0,1] op_sel_hi:[1,1] neg_lo:[0,1] neg_hi:[0,1]
    v_pk_add_f32 v[22:23], v[22:23], v[24:25] neg_lo:[0,1] neg_hi:[0,1]
    v_pk_mul_f32 v[64:65], v[64:65], v[26:27] op_sel:[0,0] op_sel_hi:[1,0]
    v_pk_mul_f32 v[66:67], v[66:67], v[26:27] op_sel:[0,0] op_sel_hi:[1,0]
    v_pk_mul_f32 v[68:69], v[68:69], v[26:27] op_sel:[0,0] op_sel_hi:[1,0]
    v_pk_mul_f32 v[70:71], v[70:71], v[26:27] op_sel:[0,0] op_sel_hi:[1,0]
    v_pk_mul_f32 v[72:73], v[72:73], v[26:27] op_sel:[0,1] op_sel_hi:[1,1]
    v_pk_mul_f32 v[74:75], v[74:75], v[26:27] op_sel:[0,1] op_sel_hi:[1,1]
    v_pk_mul_f32 v[76:77], v[76:77], v[26:27] op_sel:[0,1] op_sel_hi:[1,1]
    v_pk_mul_f32 v[78:79], v[78:79], v[26:27] op_sel:[0,1] op_sel_hi:[1,1]
    v_pk_mul_f32 v[80:81], v[80:81], v[26:27] op_sel:[0,0] op_sel_hi:[1,0]
    v_pk_mul_f32 v[82:83], v[82:83], v[26:27] op_sel:[0,0] op_sel_hi:[1,0]
    v_pk_mul_f32 v[84:85], v[84:85], v[26:27] op_sel:[0,0] op_sel_hi:[1,0]
    v_pk_mul_f32 v[86:87], v[86:87], v[26:27] op_sel:[0,0] op_sel_hi:[1,0]
    v_pk_mul_f32 v[88:89], v[88:89], v[26:27] op_sel:[0,1] op_sel_hi:[1,1]
    v_pk_mul_f32 v[90:91], v[90:91], v[26:27] op_sel:[0,1] op_sel_hi:[1,1]
    v_pk_mul_f32 v[92:93], v[92:93], v[26:27] op_sel:[0,1] op_sel_hi:[1,1]
    v_pk_mul_f32 v[94:95], v[94:95], v[26:27] op_sel:[0,1] op_sel_hi:[1,1]
    v_pk_mul_f32 v[96:97], v[96:97], v[26:27] op_sel:[0,0] op_sel_hi:[1,0]
    v_pk_mul_f32 v[98:99], v[98:99], v[26:27] op_sel:[0,0] op_sel_hi:[1,0]
    v_pk_mul_f32 v[100:101], v[100:101], v[26:27] op_sel:[0,0] op_sel_hi:[1,0]
    v_pk_mul_f32 v[102:103], v[102:103], v[26:27] op_sel:[0,0] op_sel_hi:[1,0]
    v_pk_mul_f32 v[104:105], v[104:105], v[26:27] op_sel:[0,1] op_sel_hi:[1,1]
    v_pk_mul_f32 v[106:107], v[106:107], v[26:27] op_sel:[0,1] op_sel_hi:[1,1]
    v_pk_mul_f32 v[108:109], v[108:109], v[26:27] op_sel:[0,1] op_sel_hi:[1,1]
    v_pk_mul_f32 v[110:111], v[110:111], v[26:27] op_sel:[0,1] op_sel_hi:[1,1]
    v_pk_mul_f32 v[112:113], v[112:113], v[26:27] op_sel:[0,0] op_sel_hi:[1,0]
    v_pk_mul_f32 v[114:115], v[114:115], v[26:27] op_sel:[0,0] op_sel_hi:[1,0]
    v_pk_mul_f32 v[116:117], v[116:117], v[26:27] op_sel:[0,0] op_sel_hi:[1,0]
    v_pk_mul_f32 v[118:119], v[118:119], v[26:27] op_sel:[0,0] op_sel_hi:[1,0]
    v_pk_mul_f32 v[120:121], v[120:121], v[26:27] op_sel:[0,1] op_sel_hi:[1,1]
    v_pk_mul_f32 v[122:123], v[122:123], v[26:27] op_sel:[0,1] op_sel_hi:[1,1]
    v_pk_mul_f32 v[124:125], v[124:125], v[26:27] op_sel:[0,1] op_sel_hi:[1,1]
    v_pk_mul_f32 v[126:127], v[126:127], v[26:27] op_sel:[0,1] op_sel_hi:[1,1]
    v_pk_mul_f32 v[40:41], v[40:41], v[26:27] op_sel:[0,0] op_sel_hi:[1,0]
    v_pk_mul_f32 v[42:43], v[42:43], v[26:27] op_sel:[0,0] op_sel_hi:[1,0]
    v_pk_mul_f32 v[44:45], v[44:45], v[26:27] op_sel:[0,1] op_sel_hi:[1,1]
    v_pk_mul_f32 v[46:47], v[46:47], v[26:27] op_sel:[0,1] op_sel_hi:[1,1]
    v_exp_f32 v32, v160
    v_exp_f32 v33, v161
    v_exp_f32 v34, v162
    v_cvt_pk_bf16_f32 v240, v32, v33
    v_exp_f32 v35, v163
    v_exp_f32 v36, v164
    v_cvt_pk_bf16_f32 v241, v34, v35
    v_exp_f32 v37, v165
    v_exp_f32 v38, v166
    v_cvt_pk_bf16_f32 v242, v36, v37
    v_exp_f32 v39, v167
    v_exp_f32 v32, v168
    v_cvt_pk_bf16_f32 v243, v38, v39
    v_exp_f32 v33, v169
    v_exp_f32 v34, v170
    v_cvt_pk_bf16_f32 v244, v32, v33
    v_exp_f32 v35, v171
    v_exp_f32 v36, v172
    v_cvt_pk_bf16_f32 v245, v34, v35
    v_exp_f32 v37, v173
    v_exp_f32 v38, v174
    v_cvt_pk_bf16_f32 v246, v36, v37
    v_exp_f32 v39, v175
    v_exp_f32 v32, v176
    v_cvt_pk_bf16_f32 v247, v38, v39
    v_exp_f32 v33, v177
    v_exp_f32 v34, v178
    v_cvt_pk_bf16_f32 v248, v32, v33
    v_exp_f32 v35, v179
    v_exp_f32 v36, v180
    v_cvt_pk_bf16_f32 v249, v34, v35
    v_exp_f32 v37, v181
    v_exp_f32 v38, v182
    v_cvt_pk_bf16_f32 v250, v36, v37
    v_exp_f32 v39, v183
    v_exp_f32 v32, v184
    v_cvt_pk_bf16_f32 v251, v38, v39
    v_exp_f32 v33, v185
    v_exp_f32 v34, v186
    v_cvt_pk_bf16_f32 v252, v32, v33
    v_exp_f32 v35, v187
    v_exp_f32 v36, v188
    v_cvt_pk_bf16_f32 v253, v34, v35
    v_exp_f32 v37, v189
    v_exp_f32 v38, v190
    v_cvt_pk_bf16_f32 v254, v36, v37
    v_exp_f32 v39, v191
    s_nop 0
    v_cvt_pk_bf16_f32 v255, v38, v39
    v_mfma_f32_16x16x32_bf16 v[48:51], a[192:195], v[240:243], v[40:43]
    v_mfma_f32_16x16x32_bf16 v[52:55], a[192:195], v[244:247], v[44:47]
    v_mfma_f32_16x16x32_bf16 v[48:51], a[192:195], v[248:251], v[48:51]
    v_mfma_f32_16x16x32_bf16 v[52:55], a[192:195], v[252:255], v[52:55]
    s_cmp_eq_u32 s32, 31
    s_cbranch_scc1 main_pc26
    s_cmp_eq_u32 s32, 33
    s_cbranch_scc1 main_pc28
    s_cmp_lg_u32 s33, s59
    s_cbranch_scc1 main_init34
    s_branch main_ocont23
main_peel24:
    s_waitcnt lgkmcnt(0)
    buffer_load_dword v28, off, s[40:43], s56 sc1
    global_load_dword v3, v[10:11], off
    v_mfma_f32_16x16x32_bf16 v[160:163], a[64:67], a[0:3], v[192:195]
    s_add_u32 m0, s55, 32768
    v_exp_f32 v32, v144
    v_mfma_f32_16x16x32_bf16 v[168:171], a[64:67], a[16:19], v[200:203]
    s_xor_b32 s60, s52, 0
    v_exp_f32 v33, v145
    v_mfma_f32_16x16x32_bf16 v[160:163], a[68:71], a[4:7], v[160:163]
    ds_read_b128 a[104:107], v16 offset:26624
    v_cvt_pk_bf16_f32 v232, v32, v33
    v_mfma_f32_16x16x32_bf16 v[168:171], a[68:71], a[20:23], v[168:171]
    s_mov_b32 s32, 30
    v_exp_f32 v34, v146
    v_mfma_f32_16x16x32_bf16 v[40:43], a[192:195], v[224:227], v[48:51]
    v_exp_f32 v35, v147
    v_mfma_f32_16x16x32_bf16 v[44:47], a[192:195], v[228:231], v[52:55]
    ds_read_b128 a[108:111], v16 offset:27648
    v_cvt_pk_bf16_f32 v233, v34, v35
    v_mfma_f32_16x16x32_bf16 v[160:163], a[72:75], a[8:11], v[160:163]
    buffer_load_dwordx4 v4, s[4:7], s60 offen offset:0 lds
    v_mfma_f32_16x16x32_bf16 v[168:171], a[72:75], a[24:27], v[168:171]
    v_exp_f32 v36, v148
    v_mfma_f32_16x16x32_bf16 v[160:163], a[76:79], a[12:15], v[160:163]
    v_exp_f32 v37, v149
    v_mfma_f32_16x16x32_bf16 v[168:171], a[76:79], a[28:31], v[168:171]
    ds_read_b128 a[112:115], v16 offset:28672
    v_cvt_pk_bf16_f32 v234, v36, v37
    v_mfma_f32_16x16x32_bf16 v[164:167], a[80:83], a[0:3], v[196:199]
    v_exp_f32 v38, v150
    v_mfma_f32_16x16x32_bf16 v[172:175], a[80:83], a[16:19], v[204:207]
    v_exp_f32 v39, v151
    v_mfma_f32_16x16x32_bf16 v[164:167], a[84:87], a[4:7], v[164:167]
    ds_read_b128 a[116:119], v16 offset:29696
    v_cvt_pk_bf16_f32 v235, v38, v39
    v_mfma_f32_16x16x32_bf16 v[172:175], a[84:87], a[20:23], v[172:175]
    buffer_load_dwordx4 v5, s[4:7], s60 offen offset:1024 lds
    v_mfma_f32_16x16x32_bf16 v[164:167], a[88:91], a[8:11], v[164:167]
    v_exp_f32 v32, v152
    v_mfma_f32_16x16x32_bf16 v[172:175], a[88:91], a[24:27], v[172:175]
    v_exp_f32 v33, v153
    v_mfma_f32_16x16x32_bf16 v[40:43], a[192:195], v[232:235], v[40:43]
    ds_read_b128 a[120:123], v16 offset:30720
    v_cvt_pk_bf16_f32 v236, v32, v33
    v_mfma_f32_16x16x32_bf16 v[164:167], a[92:95], a[12:15], v[164:167]
    v_exp_f32 v34, v154
    v_mfma_f32_16x16x32_bf16 v[172:175], a[92:95], a[28:31], v[172:175]
    v_exp_f32 v35, v155
    v_mfma_f32_16x16x32_bf16 v[176:179], a[96:99], a[0:3], v[208:211]
    ds_read_b128 a[124:127], v16 offset:31744
    v_cvt_pk_bf16_f32 v237, v34, v35
    v_mfma_f32_16x16x32_bf16 v[184:187], a[96:99], a[16:19], v[216:219]
    buffer_load_dwordx4 v6, s[4:7], s60 offen offset:2048 lds
    v_mfma_f32_16x16x32_bf16 v[176:179], a[100:103], a[4:7], v[176:179]
    v_exp_f32 v36, v156
    v_mfma_f32_16x16x32_bf16 v[184:187], a[100:103], a[20:23], v[184:187]
    s_waitcnt lgkmcnt(2)
    v_exp_f32 v37, v157
    v_mfma_f32_16x16x32_bf16 v[176:179], a[104:107], a[8:11], v[176:179]
    ds_read_b128 a[128:131], v17 offset:0
    v_cvt_pk_bf16_f32 v238, v36, v37
    v_mfma_f32_16x16x32_bf16 v[184:187], a[104:107], a[24:27], v[184:187]
    buffer_load_dwordx4 v7, s[4:7], s60 offen offset:3072 lds
    v_mfma_f32_16x16x32_bf16 v[176:179], a[108:111], a[12:15], v[176:179]
    v_exp_f32 v38, v158
    v_mfma_f32_16x16x32_bf16 v[184:187], a[108:111], a[28:31], v[184:187]
    s_add_u32 m0, s22, 0x10000
    v_exp_f32 v39, v159
    v_mfma_f32_16x16x32_bf16 v[180:183], a[112:115], a[0:3], v[212:215]
    ds_read_b128 a[132:135], v17 offset:1024
    v_cvt_pk_bf16_f32 v239, v38, v39
    v_mfma_f32_16x16x32_bf16 v[188:191], a[112:115], a[16:19], v[220:223]
    s_nop 0
    ds_read_b128 a[136:139], v17 offset:2048
    ds_read_b128 a[140:143], v17 offset:3072
    v_mfma_f32_16x16x32_bf16 v[44:47], a[192:195], v[236:239], v[44:47]
    s_nop 0
    ds_read_b128 a[144:147], v17 offset:4096
    ds_read_b128 a[148:151], v17 offset:5120
    v_mfma_f32_16x16x32_bf16 v[180:183], a[116:119], a[4:7], v[180:183]
    s_nop 0
    ds_read_b128 a[152:155], v17 offset:6144
    ds_read_b128 a[156:159], v17 offset:7168
    v_mfma_f32_16x16x32_bf16 v[188:191], a[116:119], a[20:23], v[188:191]
    s_nop 0
    s_waitcnt lgkmcnt(7)
    ds_read_b128 a[160:163], v17 offset:8192
    ds_read_b128 a[164:167], v17 offset:9216
    v_mfma_f32_16x16x32_bf16 v[180:183], a[120:123], a[8:11], v[180:183]
    ds_read_b128 a[168:171], v17 offset:10240
    v_max_f32 v24, v40, v44
    v_mfma_f32_16x16x32_bf16 v[188:191], a[120:123], a[24:27], v[188:191]
    ds_read_b128 a[172:175], v17 offset:11264
    v_cmp_lt_f32 vcc, s33, v24
    v_mfma_f32_16x16x32_bf16 v[180:183], a[124:127], a[12:15], v[180:183]
    s_nop 0
    ds_read_b128 a[176:179], v17 offset:12288
    ds_read_b128 a[180:183], v17 offset:13312
    v_mfma_f32_16x16x32_bf16 v[188:191], a[124:127], a[28:31], v[188:191]
    s_cbranch_vccnz main_erare20
main_pc25:
    v_mfma_f32_16x16x32_bf16 v[64:67], a[128:131], v[224:227], v[64:67]
    v_exp_f32 v32, v160
    v_mfma_f32_16x16x32_bf16 v[72:75], a[128:131], v[228:231], v[72:75]
    s_waitcnt lgkmcnt(10)
    v_exp_f32 v33, v161
    v_mfma_f32_16x16x32_bf16 v[68:71], a[132:135], v[224:227], v[68:71]
    ds_read_b128 a[184:187], v17 offset:14336
    v_cvt_pk_bf16_f32 v240, v32, v33
    v_mfma_f32_16x16x32_bf16 v[76:79], a[132:135], v[228:231], v[76:79]
    v_exp_f32 v34, v162
    v_mfma_f32_16x16x32_bf16 v[80:83], a[136:139], v[224:227], v[80:83]
    v_exp_f32 v35, v163
    v_mfma_f32_16x16x32_bf16 v[88:91], a[136:139], v[228:231], v[88:91]
    ds_read_b128 a[188:191], v17 offset:15360
    v_cvt_pk_bf16_f32 v241, v34, v35
    v_mfma_f32_16x16x32_bf16 v[84:87], a[140:143], v[224:227], v[84:87]
    v_xor_b32 v16, 0x8000, v16
    v_mfma_f32_16x16x32_bf16 v[92:95], a[140:143], v[228:231], v[92:95]
    s_waitcnt vmcnt(12)
    s_waitcnt lgkmcnt(4)
    v_exp_f32 v36, v164
    v_mfma_f32_16x16x32_bf16 v[96:99], a[144:147], v[224:227], v[96:99]
    s_barrier
    v_exp_f32 v37, v165
    v_mfma_f32_16x16x32_bf16 v[104:107], a[144:147], v[228:231], v[104:107]
    ds_read_b128 a[64:67], v16 offset:0
    v_cvt_pk_bf16_f32 v242, v36, v37
    v_mfma_f32_16x16x32_bf16 v[100:103], a[148:151], v[224:227], v[100:103]
    buffer_load_dwordx4 v2, s[48:51], s24 offen offset:0 sc1 lds
    v_mfma_f32_16x16x32_bf16 v[108:111], a[148:151], v[228:231], v[108:111]
    v_exp_f32 v38, v166
    v_mfma_f32_16x16x32_bf16 v[112:115], a[152:155], v[224:227], v[112:115]
    v_exp_f32 v39, v167
    v_mfma_f32_16x16x32_bf16 v[120:123], a[152:155], v[228:231], v[120:123]
    ds_read_b128 a[68:71], v16 offset:1024
    v_cvt_pk_bf16_f32 v243, v38, v39
    v_mfma_f32_16x16x32_bf16 v[116:119], a[156:159], v[224:227], v[116:119]
    s_nop 0
    ds_read_b128 a[72:75], v16 offset:2048
    ds_read_b128 a[76:79], v16 offset:3072
    v_mfma_f32_16x16x32_bf16 v[124:127], a[156:159], v[228:231], v[124:127]
    v_exp_f32 v32, v168
    v_mfma_f32_16x16x32_bf16 v[64:67], a[160:163], v[232:235], v[64:67]
    v_exp_f32 v33, v169
    v_mfma_f32_16x16x32_bf16 v[72:75], a[160:163], v[236:239], v[72:75]
    ds_read_b128 a[80:83], v16 offset:4096
    v_cvt_pk_bf16_f32 v244, v32, v33
    v_mfma_f32_16x16x32_bf16 v[68:71], a[164:167], v[232:235], v[68:71]
    buffer_load_dwordx4 v2, s[48:51], s24 offen offset:1024 sc1 lds
    v_mfma_f32_16x16x32_bf16 v[76:79], a[164:167], v[236:239], v[76:79]
    v_exp_f32 v34, v170
    v_mfma_f32_16x16x32_bf16 v[80:83], a[168:171], v[232:235], v[80:83]
    v_exp_f32 v35, v171
    v_mfma_f32_16x16x32_bf16 v[88:91], a[168:171], v[236:239], v[88:91]
    ds_read_b128 a[84:87], v16 offset:5120
    v_cvt_pk_bf16_f32 v245, v34, v35
    v_mfma_f32_16x16x32_bf16 v[84:87], a[172:175], v[232:235], v[84:87]
    buffer_load_dwordx4 v2, s[48:51], s24 offen offset:2048 sc1 lds
    v_mfma_f32_16x16x32_bf16 v[92:95], a[172:175], v[236:239], v[92:95]
    s_nop 0
    s_waitcnt lgkmcnt(3)
    ds_read_b128 a[88:91], v16 offset:6144
    ds_read_b128 a[92:95], v16 offset:7168
    v_mfma_f32_16x16x32_bf16 v[96:99], a[176:179], v[232:235], v[96:99]
    v_exp_f32 v36, v172
    v_mfma_f32_16x16x32_bf16 v[104:107], a[176:179], v[236:239], v[104:107]
    v_exp_f32 v37, v173
    v_mfma_f32_16x16x32_bf16 v[100:103], a[180:183], v[232:235], v[100:103]
    ds_read_b128 a[96:99], v16 offset:8192
    v_cvt_pk_bf16_f32 v246, v36, v37
    v_mfma_f32_16x16x32_bf16 v[108:111], a[180:183], v[236:239], v[108:111]
    buffer_load_dwordx4 v2, s[48:51], s24 offen offset:3072 sc1 lds
    v_mfma_f32_16x16x32_bf16 v[112:115], a[184:187], v[232:235], v[112:115]
    v_exp_f32 v38, v174
    v_mfma_f32_16x16x32_bf16 v[120:123], a[184:187], v[236:239], v[120:123]
    v_exp_f32 v39, v175
    v_mfma_f32_16x16x32_bf16 v[116:119], a[188:191], v[232:235], v[116:119]
    ds_read_b128 a[100:103], v16 offset:9216
    v_cvt_pk_bf16_f32 v247, v38, v39
    v_mfma_f32_16x16x32_bf16 v[124:127], a[188:191], v[236:239], v[124:127]
    s_waitcnt vmcnt(9)
    v_cmp_gt_u32 vcc, 32, v28
    s_nop 1
    s_cbranch_vccnz main_spin37
main_back38:
    s_cmp_eq_u32 s15, 0
    s_cselect_b64 vcc, -1, 0
    v_cndmask_b32 v24, v22, v21, vcc
    v_cndmask_b32 v192, v24, v22, s[64:65]
    v_cndmask_b32 v193, v24, v22, s[66:67]
    v_cndmask_b32 v194, v24, v22, s[68:69]
    v_cndmask_b32 v195, v24, v22, s[70:71]
    v_cndmask_b32 v196, v24, v22, s[72:73]
    v_cndmask_b32 v197, v24, v22, s[74:75]
    v_cndmask_b32 v198, v24, v22, s[76:77]
    v_cndmask_b32 v199, v24, v22, s[78:79]
    v_cndmask_b32 v208, v21, v24, s[64:65]
    v_cndmask_b32 v209, v21, v24, s[66:67]
    v_cndmask_b32 v210, v21, v24, s[68:69]
    v_cndmask_b32 v211, v21, v24, s[70:71]
    v_cndmask_b32 v212, v21, v24, s[72:73]
    v_cndmask_b32 v213, v21, v24, s[74:75]
    v_cndmask_b32 v214, v21, v24, s[76:77]
    v_cndmask_b32 v215, v21, v24, s[78:79]
    v_mfma_f32_16x16x32_bf16 v[128:131], a[64:67], a[0:3], v[192:195]
    s_add_u32 m0, s55, 49152
    v_exp_f32 v32, v176
    v_mfma_f32_16x16x32_bf16 v[136:139], a[64:67], a[16:19], v[200:203]
    s_xor_b32 s60, s52, 65536
    v_exp_f32 v33, v177
    v_mfma_f32_16x16x32_bf16 v[128:131], a[68:71], a[4:7], v[128:131]
    ds_read_b128 a[104:107], v16 offset:10240
    v_cvt_pk_bf16_f32 v248, v32, v33
    v_mfma_f32_16x16x32_bf16 v[136:139], a[68:71], a[20:23], v[136:139]
    s_mov_b32 s32, 31
    v_exp_f32 v34, v178
    v_mfma_f32_16x16x32_bf16 v[48:51], a[192:195], v[240:243], v[40:43]
    v_exp_f32 v35, v179
    v_mfma_f32_16x16x32_bf16 v[52:55], a[192:195], v[244:247], v[44:47]
    ds_read_b128 a[108:111], v16 offset:11264
    v_cvt_pk_bf16_f32 v249, v34, v35
    v_mfma_f32_16x16x32_bf16 v[128:131], a[72:75], a[8:11], v[128:131]
    buffer_load_dwordx4 v4, s[4:7], s60 offen offset:0 lds
    v_mfma_f32_16x16x32_bf16 v[136:139], a[72:75], a[24:27], v[136:139]
    s_waitcnt lgkmcnt(2)
    v_exp_f32 v36, v180
    v_mfma_f32_16x16x32_bf16 v[128:131], a[76:79], a[12:15], v[128:131]
    v_exp_f32 v37, v181
    v_mfma_f32_16x16x32_bf16 v[136:139], a[76:79], a[28:31], v[136:139]
    ds_read_b128 a[112:115], v16 offset:12288
    v_cvt_pk_bf16_f32 v250, v36, v37
    v_mfma_f32_16x16x32_bf16 v[132:135], a[80:83], a[0:3], v[196:199]
    v_exp_f32 v38, v182
    v_mfma_f32_16x16x32_bf16 v[140:143], a[80:83], a[16:19], v[204:207]
    v_exp_f32 v39, v183
    v_mfma_f32_16x16x32_bf16 v[132:135], a[84:87], a[4:7], v[132:135]
    ds_read_b128 a[116:119], v16 offset:13312
    v_cvt_pk_bf16_f32 v251, v38, v39
    v_mfma_f32_16x16x32_bf16 v[140:143], a[84:87], a[20:23], v[140:143]
    buffer_load_dwordx4 v5, s[4:7], s60 offen offset:1024 lds
    v_mfma_f32_16x16x32_bf16 v[132:135], a[88:91], a[8:11], v[132:135]
    v_exp_f32 v32, v184
    v_mfma_f32_16x16x32_bf16 v[140:143], a[88:91], a[24:27], v[140:143]
    v_exp_f32 v33, v185
    v_mfma_f32_16x16x32_bf16 v[48:51], a[192:195], v[248:251], v[48:51]
    ds_read_b128 a[120:123], v16 offset:14336
    v_cvt_pk_bf16_f32 v252, v32, v33
    v_mfma_f32_16x16x32_bf16 v[132:135], a[92:95], a[12:15], v[132:135]
    v_exp_f32 v34, v186
    v_mfma_f32_16x16x32_bf16 v[140:143], a[92:95], a[28:31], v[140:143]
    v_exp_f32 v35, v187
    v_mfma_f32_16x16x32_bf16 v[144:147], a[96:99], a[0:3], v[208:211]
    ds_read_b128 a[124:127], v16 offset:15360
    v_cvt_pk_bf16_f32 v253, v34, v35
    v_mfma_f32_16x16x32_bf16 v[152:155], a[96:99], a[16:19], v[216:219]
    buffer_load_dwordx4 v6, s[4:7], s60 offen offset:2048 lds
    v_mfma_f32_16x16x32_bf16 v[144:147], a[100:103], a[4:7], v[144:147]
    v_exp_f32 v36, v188
    v_mfma_f32_16x16x32_bf16 v[152:155], a[100:103], a[20:23], v[152:155]
    s_waitcnt lgkmcnt(2)
    v_exp_f32 v37, v189
    v_mfma_f32_16x16x32_bf16 v[144:147], a[104:107], a[8:11], v[144:147]
    ds_read_b128 a[128:131], v17 offset:16384
    v_cvt_pk_bf16_f32 v254, v36, v37
    v_mfma_f32_16x16x32_bf16 v[152:155], a[104:107], a[24:27], v[152:155]
    buffer_load_dwordx4 v7, s[4:7], s60 offen offset:3072 lds
    v_mfma_f32_16x16x32_bf16 v[144:147], a[108:111], a[12:15], v[144:147]
    v_exp_f32 v38, v190
    v_mfma_f32_16x16x32_bf16 v[152:155], a[108:111], a[28:31], v[152:155]
    v_exp_f32 v39, v191
    v_mfma_f32_16x16x32_bf16 v[148:151], a[112:115], a[0:3], v[212:215]
    ds_read_b128 a[132:135], v17 offset:17408
    v_cvt_pk_bf16_f32 v255, v38, v39
    v_mfma_f32_16x16x32_bf16 v[156:159], a[112:115], a[16:19], v[220:223]
    s_nop 0
    ds_read_b128 a[136:139], v17 offset:18432
    ds_read_b128 a[140:143], v17 offset:19456
    v_mfma_f32_16x16x32_bf16 v[52:55], a[192:195], v[252:255], v[52:55]
    s_nop 0
    ds_read_b128 a[144:147], v17 offset:20480
    ds_read_b128 a[148:151], v17 offset:21504
    v_mfma_f32_16x16x32_bf16 v[148:151], a[116:119], a[4:7], v[148:151]
    s_nop 0
    ds_read_b128 a[152:155], v17 offset:22528
    ds_read_b128 a[156:159], v17 offset:23552
    v_mfma_f32_16x16x32_bf16 v[156:159], a[116:119], a[20:23], v[156:159]
    s_nop 0
    s_waitcnt lgkmcnt(8)
    ds_read_b128 a[160:163], v17 offset:24576
    ds_read_b128 a[164:167], v17 offset:25600
    v_mfma_f32_16x16x32_bf16 v[148:151], a[120:123], a[8:11], v[148:151]
    ds_read_b128 a[168:171], v17 offset:26624
    v_max_f32 v24, v48, v52
    v_mfma_f32_16x16x32_bf16 v[156:159], a[120:123], a[24:27], v[156:159]
    ds_read_b128 a[172:175], v17 offset:27648
    v_cmp_lt_f32 vcc, s33, v24
    v_mfma_f32_16x16x32_bf16 v[148:151], a[124:127], a[12:15], v[148:151]
    s_nop 0
    ds_read_b128 a[176:179], v17 offset:28672
    ds_read_b128 a[180:183], v17 offset:29696
    v_mfma_f32_16x16x32_bf16 v[156:159], a[124:127], a[28:31], v[156:159]
    s_cbranch_vccnz main_orare21
main_pc26:
    s_waitcnt lgkmcnt(12)
    v_mfma_f32_16x16x32_bf16 v[64:67], a[128:131], v[240:243], v[64:67]
    v_exp_f32 v32, v128
    v_mfma_f32_16x16x32_bf16 v[72:75], a[128:131], v[244:247], v[72:75]
    v_exp_f32 v33, v129
    v_mfma_f32_16x16x32_bf16 v[68:71], a[132:135], v[240:243], v[68:71]
    ds_read_b128 a[184:187], v17 offset:30720
    v_cvt_pk_bf16_f32 v224, v32, v33
    v_mfma_f32_16x16x32_bf16 v[76:79], a[132:135], v[244:247], v[76:79]
    s_add_u32 m0, s55, 98304
    s_waitcnt lgkmcnt(7)
    v_exp_f32 v34, v130
    v_mfma_f32_16x16x32_bf16 v[80:83], a[136:139], v[240:243], v[80:83]
    s_xor_b32 s60, s52, 131072
    v_exp_f32 v35, v131
    v_mfma_f32_16x16x32_bf16 v[88:91], a[136:139], v[244:247], v[88:91]
    ds_read_b128 a[188:191], v17 offset:31744
    v_cvt_pk_bf16_f32 v225, v34, v35
    v_mfma_f32_16x16x32_bf16 v[84:87], a[140:143], v[240:243], v[84:87]
    v_xor_b32 v17, 0x8000, v17
    v_mfma_f32_16x16x32_bf16 v[92:95], a[140:143], v[244:247], v[92:95]
    s_waitcnt vmcnt(12)
    v_exp_f32 v36, v132
    v_mfma_f32_16x16x32_bf16 v[96:99], a[144:147], v[240:243], v[96:99]
    s_barrier
    v_exp_f32 v37, v133
    v_mfma_f32_16x16x32_bf16 v[104:107], a[144:147], v[244:247], v[104:107]
    ds_read_b128 a[64:67], v16 offset:16384
    v_cvt_pk_bf16_f32 v226, v36, v37
    v_mfma_f32_16x16x32_bf16 v[100:103], a[148:151], v[240:243], v[100:103]
    buffer_load_dwordx4 v4, s[4:7], s60 offen offset:0 lds
    v_mfma_f32_16x16x32_bf16 v[108:111], a[148:151], v[244:247], v[108:111]
    v_exp_f32 v38, v134
    v_mfma_f32_16x16x32_bf16 v[112:115], a[152:155], v[240:243], v[112:115]
    v_exp_f32 v39, v135
    v_mfma_f32_16x16x32_bf16 v[120:123], a[152:155], v[244:247], v[120:123]
    ds_read_b128 a[68:71], v16 offset:17408
    v_cvt_pk_bf16_f32 v227, v38, v39
    v_mfma_f32_16x16x32_bf16 v[116:119], a[156:159], v[240:243], v[116:119]
    s_nop 0
    ds_read_b128 a[72:75], v16 offset:18432
    ds_read_b128 a[76:79], v16 offset:19456
    v_mfma_f32_16x16x32_bf16 v[124:127], a[156:159], v[244:247], v[124:127]
    s_waitcnt lgkmcnt(4)
    v_exp_f32 v32, v136
    v_mfma_f32_16x16x32_bf16 v[64:67], a[160:163], v[248:251], v[64:67]
    v_exp_f32 v33, v137
    v_mfma_f32_16x16x32_bf16 v[72:75], a[160:163], v[252:255], v[72:75]
    ds_read_b128 a[80:83], v16 offset:20480
    v_cvt_pk_bf16_f32 v228, v32, v33
    v_mfma_f32_16x16x32_bf16 v[68:71], a[164:167], v[248:251], v[68:71]
    buffer_load_dwordx4 v5, s[4:7], s60 offen offset:1024 lds
    v_mfma_f32_16x16x32_bf16 v[76:79], a[164:167], v[252:255], v[76:79]
    v_exp_f32 v34, v138
    v_mfma_f32_16x16x32_bf16 v[80:83], a[168:171], v[248:251], v[80:83]
    v_exp_f32 v35, v139
    v_mfma_f32_16x16x32_bf16 v[88:91], a[168:171], v[252:255], v[88:91]
    ds_read_b128 a[84:87], v16 offset:21504
    v_cvt_pk_bf16_f32 v229, v34, v35
    v_mfma_f32_16x16x32_bf16 v[84:87], a[172:175], v[248:251], v[84:87]
    buffer_load_dwordx4 v6, s[4:7], s60 offen offset:2048 lds
    v_mfma_f32_16x16x32_bf16 v[92:95], a[172:175], v[252:255], v[92:95]
    s_nop 0
    ds_read_b128 a[88:91], v16 offset:22528
    ds_read_b128 a[92:95], v16 offset:23552
    v_mfma_f32_16x16x32_bf16 v[96:99], a[176:179], v[248:251], v[96:99]
    v_exp_f32 v36, v140
    v_mfma_f32_16x16x32_bf16 v[104:107], a[176:179], v[252:255], v[104:107]
    v_exp_f32 v37, v141
    v_mfma_f32_16x16x32_bf16 v[100:103], a[180:183], v[248:251], v[100:103]
    ds_read_b128 a[96:99], v16 offset:24576
    v_cvt_pk_bf16_f32 v230, v36, v37
    v_mfma_f32_16x16x32_bf16 v[108:111], a[180:183], v[252:255], v[108:111]
    buffer_load_dwordx4 v7, s[4:7], s60 offen offset:3072 lds
    v_mfma_f32_16x16x32_bf16 v[112:115], a[184:187], v[248:251], v[112:115]
    v_exp_f32 v38, v142
    v_mfma_f32_16x16x32_bf16 v[120:123], a[184:187], v[252:255], v[120:123]
    v_exp_f32 v39, v143
    v_mfma_f32_16x16x32_bf16 v[116:119], a[188:191], v[248:251], v[116:119]
    ds_read_b128 a[100:103], v16 offset:25600
    v_cvt_pk_bf16_f32 v231, v38, v39
    v_mfma_f32_16x16x32_bf16 v[124:127], a[188:191], v[252:255], v[124:127]
    s_cmp_eq_u32 s15, 1
    s_cselect_b64 vcc, -1, 0
    v_cndmask_b32 v24, v23, v21, vcc
    v_cndmask_b32 v200, v24, v23, s[80:81]
    v_cndmask_b32 v201, v24, v23, s[82:83]
    v_cndmask_b32 v202, v24, v23, s[84:85]
    v_cndmask_b32 v203, v24, v23, s[86:87]
    v_cndmask_b32 v204, v24, v23, s[88:89]
    v_cndmask_b32 v205, v24, v23, s[90:91]
    v_cndmask_b32 v206, v24, v23, s[92:93]
    v_cndmask_b32 v207, v24, v23, s[94:95]
    v_cndmask_b32 v216, v21, v24, s[80:81]
    v_cndmask_b32 v217, v21, v24, s[82:83]
    v_cndmask_b32 v218, v21, v24, s[84:85]
    v_cndmask_b32 v219, v21, v24, s[86:87]
    v_cndmask_b32 v220, v21, v24, s[88:89]
    v_cndmask_b32 v221, v21, v24, s[90:91]
    v_cndmask_b32 v222, v21, v24, s[92:93]
    v_cndmask_b32 v223, v21, v24, s[94:95]
    v_mov_b32 v160, v21
    v_mov_b32 v161, v21
    v_mov_b32 v162, v21
    v_mov_b32 v163, v21
    v_mov_b32 v164, v21
    v_mov_b32 v165, v21
    v_mov_b32 v166, v21
    v_mov_b32 v167, v21
    v_mov_b32 v176, v21
    v_mov_b32 v177, v21
    v_mov_b32 v178, v21
    v_mov_b32 v179, v21
    v_mov_b32 v180, v21
    v_mov_b32 v181, v21
    v_mov_b32 v182, v21
    v_mov_b32 v183, v21
    s_add_u32 m0, s55, 0
    v_exp_f32 v32, v144
    s_waitcnt lgkmcnt(0)
    v_mfma_f32_16x16x32_bf16 v[168:171], a[64:67], a[16:19], v[200:203]
    s_xor_b32 s60, s52, 196608
    ds_read_b128 a[104:107], v16 offset:26624
    v_exp_f32 v33, v145
    s_nop 0
    v_cvt_pk_bf16_f32 v232, v32, v33
    v_mfma_f32_16x16x32_bf16 v[168:171], a[68:71], a[20:23], v[168:171]
    s_mov_b32 s32, 32
    v_exp_f32 v34, v146
    v_mfma_f32_16x16x32_bf16 v[40:43], a[192:195], v[224:227], v[48:51]
    v_exp_f32 v35, v147
    v_mfma_f32_16x16x32_bf16 v[44:47], a[192:195], v[228:231], v[52:55]
    ds_read_b128 a[108:111], v16 offset:27648
    buffer_load_dwordx4 v4, s[4:7], s60 offen offset:0 lds
    v_cvt_pk_bf16_f32 v233, v34, v35
    v_mfma_f32_16x16x32_bf16 v[168:171], a[72:75], a[24:27], v[168:171]
    v_exp_f32 v36, v148
    v_exp_f32 v37, v149
    v_mfma_f32_16x16x32_bf16 v[168:171], a[76:79], a[28:31], v[168:171]
    ds_read_b128 a[112:115], v16 offset:28672
    v_cvt_pk_bf16_f32 v234, v36, v37
    v_exp_f32 v38, v150
    v_mfma_f32_16x16x32_bf16 v[172:175], a[80:83], a[16:19], v[204:207]
    ds_read_b128 a[116:119], v16 offset:29696
    v_exp_f32 v39, v151
    s_nop 0
    v_cvt_pk_bf16_f32 v235, v38, v39
    v_mfma_f32_16x16x32_bf16 v[172:175], a[84:87], a[20:23], v[172:175]
    buffer_load_dwordx4 v5, s[4:7], s60 offen offset:1024 lds
    v_exp_f32 v32, v152
    v_mfma_f32_16x16x32_bf16 v[172:175], a[88:91], a[24:27], v[172:175]
    v_exp_f32 v33, v153
    v_mfma_f32_16x16x32_bf16 v[40:43], a[192:195], v[232:235], v[40:43]
    ds_read_b128 a[120:123], v16 offset:30720
    v_cvt_pk_bf16_f32 v236, v32, v33
    v_exp_f32 v34, v154
    v_mfma_f32_16x16x32_bf16 v[172:175], a[92:95], a[28:31], v[172:175]
    ds_read_b128 a[124:127], v16 offset:31744
    v_exp_f32 v35, v155
    s_nop 0
    v_cvt_pk_bf16_f32 v237, v34, v35
    v_mfma_f32_16x16x32_bf16 v[184:187], a[96:99], a[16:19], v[216:219]
    buffer_load_dwordx4 v6, s[4:7], s60 offen offset:2048 lds
    v_exp_f32 v36, v156
    v_mfma_f32_16x16x32_bf16 v[184:187], a[100:103], a[20:23], v[184:187]
    s_waitcnt lgkmcnt(3)
    ds_read_b128 a[128:131], v17 offset:0
    v_exp_f32 v37, v157
    s_nop 0
    v_cvt_pk_bf16_f32 v238, v36, v37
    v_mfma_f32_16x16x32_bf16 v[184:187], a[104:107], a[24:27], v[184:187]
    buffer_load_dwordx4 v7, s[4:7], s60 offen offset:3072 lds
    v_exp_f32 v38, v158
    v_mfma_f32_16x16x32_bf16 v[184:187], a[108:111], a[28:31], v[184:187]
    ds_read_b128 a[132:135], v17 offset:1024
    v_exp_f32 v39, v159
    s_nop 0
    v_cvt_pk_bf16_f32 v239, v38, v39
    v_mfma_f32_16x16x32_bf16 v[188:191], a[112:115], a[16:19], v[220:223]
    s_nop 0
    ds_read_b128 a[136:139], v17 offset:2048
    ds_read_b128 a[140:143], v17 offset:3072
    v_mfma_f32_16x16x32_bf16 v[44:47], a[192:195], v[236:239], v[44:47]
    s_nop 0
    s_waitcnt lgkmcnt(5)
    ds_read_b128 a[144:147], v17 offset:4096
    ds_read_b128 a[148:151], v17 offset:5120
    ds_read_b128 a[152:155], v17 offset:6144
    ds_read_b128 a[156:159], v17 offset:7168
    v_mfma_f32_16x16x32_bf16 v[188:191], a[116:119], a[20:23], v[188:191]
    s_nop 0
    ds_read_b128 a[160:163], v17 offset:8192
    ds_read_b128 a[164:167], v17 offset:9216
    ds_read_b128 a[168:171], v17 offset:10240
    v_max_f32 v24, v40, v44
    v_mfma_f32_16x16x32_bf16 v[188:191], a[120:123], a[24:27], v[188:191]
    s_waitcnt lgkmcnt(11)
    ds_read_b128 a[172:175], v17 offset:11264
    ds_read_b128 a[176:179], v17 offset:12288
    ds_read_b128 a[180:183], v17 offset:13312
    v_cmp_lt_f32 vcc, s33, v24
    v_mfma_f32_16x16x32_bf16 v[188:191], a[124:127], a[28:31], v[188:191]
    s_nop 0
    s_cbranch_vccnz main_erare20
main_pc27:
    s_waitcnt lgkmcnt(13)
    v_mfma_f32_16x16x32_bf16 v[64:67], a[128:131], v[224:227], v[64:67]
    v_mfma_f32_16x16x32_bf16 v[72:75], a[128:131], v[228:231], v[72:75]
    s_waitcnt lgkmcnt(12)
    v_exp_f32 v32, v168
    v_mfma_f32_16x16x32_bf16 v[68:71], a[132:135], v[224:227], v[68:71]
    ds_read_b128 a[184:187], v17 offset:14336
    v_mfma_f32_16x16x32_bf16 v[76:79], a[132:135], v[228:231], v[76:79]
    s_add_u32 m0, s55, 114688
    s_waitcnt lgkmcnt(11)
    v_mfma_f32_16x16x32_bf16 v[80:83], a[136:139], v[224:227], v[80:83]
    s_xor_b32 s60, s53, 0
    v_exp_f32 v33, v169
    v_mfma_f32_16x16x32_bf16 v[88:91], a[136:139], v[228:231], v[88:91]
    ds_read_b128 a[188:191], v17 offset:15360
    v_cvt_pk_bf16_f32 v244, v32, v33
    v_mfma_f32_16x16x32_bf16 v[84:87], a[140:143], v[224:227], v[84:87]
    v_xor_b32 v16, 0x8000, v16
    v_mfma_f32_16x16x32_bf16 v[92:95], a[140:143], v[228:231], v[92:95]
    s_waitcnt vmcnt(12)
    s_waitcnt lgkmcnt(3)
    v_mfma_f32_16x16x32_bf16 v[96:99], a[144:147], v[224:227], v[96:99]
    s_barrier
    v_exp_f32 v34, v170
    v_mfma_f32_16x16x32_bf16 v[104:107], a[144:147], v[228:231], v[104:107]
    v_mfma_f32_16x16x32_bf16 v[100:103], a[148:151], v[224:227], v[100:103]
    buffer_load_dwordx4 v2, s[36:39], s60 offen offset:0 sc1 lds
    v_mfma_f32_16x16x32_bf16 v[108:111], a[148:151], v[228:231], v[108:111]
    v_mfma_f32_16x16x32_bf16 v[112:115], a[152:155], v[224:227], v[112:115]
    v_exp_f32 v35, v171
    v_mfma_f32_16x16x32_bf16 v[120:123], a[152:155], v[228:231], v[120:123]
    v_cvt_pk_bf16_f32 v245, v34, v35
    v_mfma_f32_16x16x32_bf16 v[116:119], a[156:159], v[224:227], v[116:119]
    v_mfma_f32_16x16x32_bf16 v[124:127], a[156:159], v[228:231], v[124:127]
    v_mfma_f32_16x16x32_bf16 v[64:67], a[160:163], v[232:235], v[64:67]
    v_exp_f32 v36, v172
    v_mfma_f32_16x16x32_bf16 v[72:75], a[160:163], v[236:239], v[72:75]
    v_mfma_f32_16x16x32_bf16 v[68:71], a[164:167], v[232:235], v[68:71]
    buffer_load_dwordx4 v2, s[36:39], s60 offen offset:1024 sc1 lds
    v_mfma_f32_16x16x32_bf16 v[76:79], a[164:167], v[236:239], v[76:79]
    v_mfma_f32_16x16x32_bf16 v[80:83], a[168:171], v[232:235], v[80:83]
    v_exp_f32 v37, v173
    v_mfma_f32_16x16x32_bf16 v[88:91], a[168:171], v[236:239], v[88:91]
    v_cvt_pk_bf16_f32 v246, v36, v37
    v_mfma_f32_16x16x32_bf16 v[84:87], a[172:175], v[232:235], v[84:87]
    buffer_load_dwordx4 v2, s[36:39], s60 offen offset:2048 sc1 lds
    v_mfma_f32_16x16x32_bf16 v[92:95], a[172:175], v[236:239], v[92:95]
    v_mfma_f32_16x16x32_bf16 v[96:99], a[176:179], v[232:235], v[96:99]
    v_mfma_f32_16x16x32_bf16 v[104:107], a[176:179], v[236:239], v[104:107]
    s_waitcnt lgkmcnt(0)
    v_exp_f32 v38, v174
    v_mfma_f32_16x16x32_bf16 v[100:103], a[180:183], v[232:235], v[100:103]
    v_mfma_f32_16x16x32_bf16 v[108:111], a[180:183], v[236:239], v[108:111]
    buffer_load_dwordx4 v2, s[36:39], s60 offen offset:3072 sc1 lds
    v_mfma_f32_16x16x32_bf16 v[112:115], a[184:187], v[232:235], v[112:115]
    v_mfma_f32_16x16x32_bf16 v[120:123], a[184:187], v[236:239], v[120:123]
    v_exp_f32 v39, v175
    v_mfma_f32_16x16x32_bf16 v[116:119], a[188:191], v[232:235], v[116:119]
    v_cvt_pk_bf16_f32 v247, v38, v39
    v_mfma_f32_16x16x32_bf16 v[124:127], a[188:191], v[236:239], v[124:127]
    s_add_u32 m0, s55, 131072
    s_xor_b32 s60, s52, 262144
    buffer_load_dwordx4 v4, s[4:7], s60 offen offset:0 lds
    buffer_load_dwordx4 v5, s[4:7], s60 offen offset:1024 lds
    buffer_load_dwordx4 v6, s[4:7], s60 offen offset:2048 lds
    buffer_load_dwordx4 v7, s[4:7], s60 offen offset:3072 lds
    s_add_u32 m0, s55, 147456
    s_xor_b32 s60, s52, 327680
    buffer_load_dwordx4 v4, s[4:7], s60 offen offset:0 lds
    buffer_load_dwordx4 v5, s[4:7], s60 offen offset:1024 lds
    buffer_load_dwordx4 v6, s[4:7], s60 offen offset:2048 lds
    buffer_load_dwordx4 v7, s[4:7], s60 offen offset:3072 lds
    s_add_u32 m0, s55, 16384
    s_xor_b32 s60, s53, 4096
    s_mov_b32 s32, 33
    v_mfma_f32_16x16x32_bf16 v[52:55], a[192:195], v[244:247], v[44:47]
    buffer_load_dwordx4 v2, s[36:39], s60 offen offset:0 sc1 lds
    buffer_load_dwordx4 v2, s[36:39], s60 offen offset:1024 sc1 lds
    v_exp_f32 v32, v184
    v_exp_f32 v33, v185
    v_mov_b32 v48, v40
    v_cvt_pk_bf16_f32 v252, v32, v33
    v_exp_f32 v34, v186
    v_exp_f32 v35, v187
    s_nop 0
    v_cvt_pk_bf16_f32 v253, v34, v35
    buffer_load_dwordx4 v2, s[36:39], s60 offen offset:2048 sc1 lds
    v_exp_f32 v36, v188
    v_exp_f32 v37, v189
    ds_read_b128 a[128:131], v17 offset:16384
    v_cvt_pk_bf16_f32 v254, v36, v37
    buffer_load_dwordx4 v2, s[36:39], s60 offen offset:3072 sc1 lds
    v_exp_f32 v38, v190
    v_exp_f32 v39, v191
    ds_read_b128 a[132:135], v17 offset:17408
    v_cvt_pk_bf16_f32 v255, v38, v39
    ds_read_b128 a[136:139], v17 offset:18432
    ds_read_b128 a[140:143], v17 offset:19456
    v_mfma_f32_16x16x32_bf16 v[52:55], a[192:195], v[252:255], v[52:55]
    s_nop 0
    ds_read_b128 a[144:147], v17 offset:20480
    ds_read_b128 a[148:151], v17 offset:21504
    ds_read_b128 a[152:155], v17 offset:22528
    ds_read_b128 a[156:159], v17 offset:23552
    ds_read_b128 a[160:163], v17 offset:24576
    ds_read_b128 a[164:167], v17 offset:25600
    ds_read_b128 a[168:171], v17 offset:26624
    v_max_f32 v24, v48, v52
    ds_read_b128 a[172:175], v17 offset:27648
    v_cmp_lt_f32 vcc, s33, v24
    ds_read_b128 a[176:179], v17 offset:28672
    ds_read_b128 a[180:183], v17 offset:29696
    s_cbranch_vccnz main_orare21
main_pc28:
    s_waitcnt lgkmcnt(13)
    v_mfma_f32_16x16x32_bf16 v[72:75], a[128:131], v[244:247], v[72:75]
    s_waitcnt lgkmcnt(12)
    ds_read_b128 a[184:187], v17 offset:30720
    v_mfma_f32_16x16x32_bf16 v[76:79], a[132:135], v[244:247], v[76:79]
    s_add_u32 m0, s55, 65536
    s_xor_b32 s60, s53, 8192
    s_waitcnt lgkmcnt(12)
    v_mfma_f32_16x16x32_bf16 v[88:91], a[136:139], v[244:247], v[88:91]
    s_waitcnt lgkmcnt(11)
    ds_read_b128 a[188:191], v17 offset:31744
    v_xor_b32 v17, 0x8000, v17
    v_mfma_f32_16x16x32_bf16 v[92:95], a[140:143], v[244:247], v[92:95]
    s_waitcnt vmcnt(16)
    s_barrier
    s_waitcnt lgkmcnt(11)
    v_mfma_f32_16x16x32_bf16 v[104:107], a[144:147], v[244:247], v[104:107]
    s_waitcnt lgkmcnt(10)
    ds_read_b64_tr_b16 a[44:45], v30 offset:40960
    ds_read_b64_tr_b16 a[40:41], v29 offset:40960
    buffer_load_dwordx4 v2, s[36:39], s60 offen offset:0 sc1 lds
    v_mfma_f32_16x16x32_bf16 v[108:111], a[148:151], v[244:247], v[108:111]
    s_nop 0
    ds_read_b64_tr_b16 a[0:1], v12 offset:32768
    ds_read_b64_tr_b16 a[2:3], v12 offset:36864
    ds_read_b64_tr_b16 a[4:5], v13 offset:32768
    ds_read_b64_tr_b16 a[6:7], v13 offset:36864
    s_waitcnt lgkmcnt(15)
    v_mfma_f32_16x16x32_bf16 v[120:123], a[152:155], v[244:247], v[120:123]
    s_nop 0
    ds_read_b64_tr_b16 a[46:47], v30 offset:45056
    ds_read_b64_tr_b16 a[42:43], v29 offset:45056
    ds_read_b64_tr_b16 a[48:49], v12 offset:0
    ds_read_b64_tr_b16 a[50:51], v12 offset:4096
    s_waitcnt lgkmcnt(15)
    v_mfma_f32_16x16x32_bf16 v[124:127], a[156:159], v[244:247], v[124:127]
    s_nop 0
    ds_read_b64_tr_b16 a[8:9], v12 offset:40960
    ds_read_b64_tr_b16 a[10:11], v12 offset:45056
    ds_read_b64_tr_b16 a[12:13], v13 offset:40960
    ds_read_b64_tr_b16 a[14:15], v13 offset:45056
    v_mfma_f32_16x16x32_bf16 v[72:75], a[160:163], v[252:255], v[72:75]
    ds_read_b64_tr_b16 a[52:53], v13 offset:0
    buffer_load_dwordx4 v2, s[36:39], s60 offen offset:1024 sc1 lds
    v_mfma_f32_16x16x32_bf16 v[76:79], a[164:167], v[252:255], v[76:79]
    s_nop 0
    ds_read_b64_tr_b16 a[16:17], v12 offset:49152
    ds_read_b64_tr_b16 a[18:19], v12 offset:53248
    ds_read_b64_tr_b16 a[20:21], v13 offset:49152
    ds_read_b64_tr_b16 a[22:23], v13 offset:53248
    v_mfma_f32_16x16x32_bf16 v[88:91], a[168:171], v[252:255], v[88:91]
    ds_read_b64_tr_b16 a[54:55], v13 offset:4096
    s_waitcnt lgkmcnt(15)
    buffer_load_dwordx4 v2, s[36:39], s60 offen offset:2048 sc1 lds
    v_mfma_f32_16x16x32_bf16 v[92:95], a[172:175], v[252:255], v[92:95]
    s_nop 0
    ds_read_b64_tr_b16 a[56:57], v12 offset:8192
    ds_read_b64_tr_b16 a[58:59], v12 offset:12288
    ds_read_b64_tr_b16 a[24:25], v12 offset:57344
    ds_read_b64_tr_b16 a[26:27], v12 offset:61440
    v_mfma_f32_16x16x32_bf16 v[104:107], a[176:179], v[252:255], v[104:107]
    s_nop 0
    ds_read_b64_tr_b16 a[28:29], v13 offset:57344
    ds_read_b64_tr_b16 a[30:31], v13 offset:61440
    ds_read_b64_tr_b16 a[60:61], v13 offset:8192
    v_mfma_f32_16x16x32_bf16 v[108:111], a[180:183], v[252:255], v[108:111]
    s_nop 0
    ds_read_b64_tr_b16 a[32:33], v29 offset:32768
    ds_read_b64_tr_b16 a[34:35], v29 offset:36864
    buffer_load_dwordx4 v2, s[36:39], s60 offen offset:3072 sc1 lds
    v_mfma_f32_16x16x32_bf16 v[120:123], a[184:187], v[252:255], v[120:123]
    s_nop 0
    ds_read_b64_tr_b16 a[36:37], v30 offset:32768
    ds_read_b64_tr_b16 a[38:39], v30 offset:36864
    ds_read_b64_tr_b16 a[62:63], v13 offset:12288
    v_mfma_f32_16x16x32_bf16 v[124:127], a[188:191], v[252:255], v[124:127]
    s_load_dwordx2 s[72:73], s[0:1], 0
    s_load_dwordx8 s[88:95], s[0:1], 56
    s_load_dwordx2 s[74:75], s[0:1], 104
    v_rcp_f32 v24, v48
    v_rcp_f32 v25, v52
    s_lshl_b32 s62, s18, 17
    s_lshl_b32 s63, s14, 12
    s_add_u32 s62, s62, s63
    v_pk_mul_f32 v[64:65], v[64:65], v[24:25] op_sel:[0,0] op_sel_hi:[1,0]
    v_pk_mul_f32 v[66:67], v[66:67], v[24:25] op_sel:[0,0] op_sel_hi:[1,0]
    v_pk_mul_f32 v[68:69], v[68:69], v[24:25] op_sel:[0,0] op_sel_hi:[1,0]
    v_pk_mul_f32 v[70:71], v[70:71], v[24:25] op_sel:[0,0] op_sel_hi:[1,0]
    v_cvt_pk_bf16_f32 v56, v64, v65
    v_cvt_pk_bf16_f32 v57, v66, v67
    v_cvt_pk_bf16_f32 v58, v68, v69
    v_cvt_pk_bf16_f32 v59, v70, v71
    buffer_store_dwordx4 v[56:59], v2, s[36:39], s62 offen offset:0 sc1
    v_pk_mul_f32 v[72:73], v[72:73], v[24:25] op_sel:[0,1] op_sel_hi:[1,1]
    v_pk_mul_f32 v[74:75], v[74:75], v[24:25] op_sel:[0,1] op_sel_hi:[1,1]
    v_pk_mul_f32 v[76:77], v[76:77], v[24:25] op_sel:[0,1] op_sel_hi:[1,1]
    v_pk_mul_f32 v[78:79], v[78:79], v[24:25] op_sel:[0,1] op_sel_hi:[1,1]
    v_cvt_pk_bf16_f32 v60, v72, v73
    v_cvt_pk_bf16_f32 v61, v74, v75
    v_cvt_pk_bf16_f32 v62, v76, v77
    v_cvt_pk_bf16_f32 v63, v78, v79
    buffer_store_dwordx4 v[60:63], v20, s[36:39], s62 offen offset:0 sc1
    v_pk_mul_f32 v[80:81], v[80:81], v[24:25] op_sel:[0,0] op_sel_hi:[1,0]
    v_pk_mul_f32 v[82:83], v[82:83], v[24:25] op_sel:[0,0] op_sel_hi:[1,0]
    v_pk_mul_f32 v[84:85], v[84:85], v[24:25] op_sel:[0,0] op_sel_hi:[1,0]
    v_pk_mul_f32 v[86:87], v[86:87], v[24:25] op_sel:[0,0] op_sel_hi:[1,0]
    v_cvt_pk_bf16_f32 v56, v80, v81
    v_cvt_pk_bf16_f32 v57, v82, v83
    v_cvt_pk_bf16_f32 v58, v84, v85
    v_cvt_pk_bf16_f32 v59, v86, v87
    buffer_store_dwordx4 v[56:59], v2, s[36:39], s62 offen offset:1024 sc1
    v_pk_mul_f32 v[88:89], v[88:89], v[24:25] op_sel:[0,1] op_sel_hi:[1,1]
    v_pk_mul_f32 v[90:91], v[90:91], v[24:25] op_sel:[0,1] op_sel_hi:[1,1]
    v_pk_mul_f32 v[92:93], v[92:93], v[24:25] op_sel:[0,1] op_sel_hi:[1,1]
    v_pk_mul_f32 v[94:95], v[94:95], v[24:25] op_sel:[0,1] op_sel_hi:[1,1]
    v_cvt_pk_bf16_f32 v60, v88, v89
    v_cvt_pk_bf16_f32 v61, v90, v91
    v_cvt_pk_bf16_f32 v62, v92, v93
    v_cvt_pk_bf16_f32 v63, v94, v95
    buffer_store_dwordx4 v[60:63], v20, s[36:39], s62 offen offset:1024 sc1
    v_pk_mul_f32 v[96:97], v[96:97], v[24:25] op_sel:[0,0] op_sel_hi:[1,0]
    v_pk_mul_f32 v[98:99], v[98:99], v[24:25] op_sel:[0,0] op_sel_hi:[1,0]
    v_pk_mul_f32 v[100:101], v[100:101], v[24:25] op_sel:[0,0] op_sel_hi:[1,0]
    v_pk_mul_f32 v[102:103], v[102:103], v[24:25] op_sel:[0,0] op_sel_hi:[1,0]
    v_cvt_pk_bf16_f32 v56, v96, v97
    v_cvt_pk_bf16_f32 v57, v98, v99
    v_cvt_pk_bf16_f32 v58, v100, v101
    v_cvt_pk_bf16_f32 v59, v102, v103
    buffer_store_dwordx4 v[56:59], v2, s[36:39], s62 offen offset:2048 sc1
    v_pk_mul_f32 v[104:105], v[104:105], v[24:25] op_sel:[0,1] op_sel_hi:[1,1]
    v_pk_mul_f32 v[106:107], v[106:107], v[24:25] op_sel:[0,1] op_sel_hi:[1,1]
    v_pk_mul_f32 v[108:109], v[108:109], v[24:25] op_sel:[0,1] op_sel_hi:[1,1]
    v_pk_mul_f32 v[110:111], v[110:111], v[24:25] op_sel:[0,1] op_sel_hi:[1,1]
    v_cvt_pk_bf16_f32 v60, v104, v105
    v_cvt_pk_bf16_f32 v61, v106, v107
    v_cvt_pk_bf16_f32 v62, v108, v109
    v_cvt_pk_bf16_f32 v63, v110, v111
    buffer_store_dwordx4 v[60:63], v20, s[36:39], s62 offen offset:2048 sc1
    v_pk_mul_f32 v[112:113], v[112:113], v[24:25] op_sel:[0,0] op_sel_hi:[1,0]
    v_pk_mul_f32 v[114:115], v[114:115], v[24:25] op_sel:[0,0] op_sel_hi:[1,0]
    v_pk_mul_f32 v[116:117], v[116:117], v[24:25] op_sel:[0,0] op_sel_hi:[1,0]
    v_pk_mul_f32 v[118:119], v[118:119], v[24:25] op_sel:[0,0] op_sel_hi:[1,0]
    v_cvt_pk_bf16_f32 v56, v112, v113
    v_cvt_pk_bf16_f32 v57, v114, v115
    v_cvt_pk_bf16_f32 v58, v116, v117
    v_cvt_pk_bf16_f32 v59, v118, v119
    buffer_store_dwordx4 v[56:59], v2, s[36:39], s62 offen offset:3072 sc1
    v_pk_mul_f32 v[120:121], v[120:121], v[24:25] op_sel:[0,1] op_sel_hi:[1,1]
    v_pk_mul_f32 v[122:123], v[122:123], v[24:25] op_sel:[0,1] op_sel_hi:[1,1]
    v_pk_mul_f32 v[124:125], v[124:125], v[24:25] op_sel:[0,1] op_sel_hi:[1,1]
    v_pk_mul_f32 v[126:127], v[126:127], v[24:25] op_sel:[0,1] op_sel_hi:[1,1]
    v_cvt_pk_bf16_f32 v60, v120, v121
    v_cvt_pk_bf16_f32 v61, v122, v123
    v_cvt_pk_bf16_f32 v62, v124, v125
    v_cvt_pk_bf16_f32 v63, v126, v127
    buffer_store_dwordx4 v[60:63], v20, s[36:39], s62 offen offset:3072 sc1
main_tail2:
    s_waitcnt lgkmcnt(0)
    s_waitcnt vmcnt(8)
    s_barrier
    s_mov_b32 s84, s12
    s_mov_b32 s85, s13
    s_mov_b32 s86, 0x20000
    s_mov_b32 s87, 0x20000
    s_lshr_b32 s58, s14, 3
    s_lshr_b32 s59, s18, 3
    s_lshl_b32 s59, s59, 2
    s_add_u32 s58, s59, s58
    s_lshl_b32 s58, s58, 7
    s_add_u32 s58, s58, 83968
    s_add_u32 s57, s56, 4096
    s_bfe_u32 s16, s2, 0x20001
    s_bfe_u32 s15, s2, 0x20003
    s_and_b32 s14, s2, 1
    s_lshl_b32 s14, s14, 3
    s_lshr_b32 s17, s2, 5
    s_add_u32 s14, s14, s17
    s_lshl_b32 s17, s14, 2
    v_and_b32 v23, 3, v1
    v_lshlrev_b32 v23, 7, v23
    v_add_u32 v23, 92160, v23
    v_add_u32 v14, 0x10000, v14
    ds_read_b128 v[32:35], v14 offset:49152
    ds_read_b128 v[36:39], v14 offset:53248
    ds_read_b128 v[40:43], v14 offset:57344
    ds_read_b128 v[44:47], v14 offset:61440
    ds_read_b128 v[48:51], v14 offset:50176
    ds_read_b128 v[52:55], v14 offset:54272
    s_waitcnt lgkmcnt(5)
    v_mfma_f32_16x16x32_bf16 v[160:163], a[0:3], v[32:35], 0
    s_add_u32 s44, s12, 0x4000000
    s_addc_u32 s45, s13, 0
    ds_read_b128 v[56:59], v14 offset:58368
    v_mfma_f32_16x16x32_bf16 v[164:167], a[4:7], v[32:35], 0
    s_add_u32 m0, s55, 81920
    s_xor_b32 s60, s52, 393216
    s_waitcnt lgkmcnt(5)
    v_mfma_f32_16x16x32_bf16 v[168:171], a[0:3], v[36:39], 0
    s_mov_b32 s46, 0x800000
    ds_read_b128 v[60:63], v14 offset:62464
    v_mfma_f32_16x16x32_bf16 v[172:175], a[4:7], v[36:39], 0
    s_waitcnt lgkmcnt(5)
    buffer_load_dwordx4 v4, s[4:7], s60 offen offset:0 lds
    v_mfma_f32_16x16x32_bf16 v[176:179], a[0:3], v[40:43], 0
    s_mov_b32 s47, 0x20000
    ds_read_b128 v[96:99], v14 offset:51200
    v_mfma_f32_16x16x32_bf16 v[180:183], a[4:7], v[40:43], 0
    s_waitcnt lgkmcnt(5)
    buffer_load_dwordx4 v5, s[4:7], s60 offen offset:1024 lds
    v_mfma_f32_16x16x32_bf16 v[184:187], a[0:3], v[44:47], 0
    ds_read_b128 v[100:103], v14 offset:55296
    v_bfe_u32 v18, v1, 2, 2
    v_mfma_f32_16x16x32_bf16 v[188:191], a[4:7], v[44:47], 0
    s_waitcnt lgkmcnt(5)
    buffer_load_dwordx4 v6, s[4:7], s60 offen offset:2048 lds
    v_mfma_f32_16x16x32_bf16 v[160:163], a[8:11], v[48:51], v[160:163]
    ds_read_b128 v[104:107], v14 offset:59392
    v_lshlrev_b32 v15, 8, v18
    v_mfma_f32_16x16x32_bf16 v[164:167], a[12:15], v[48:51], v[164:167]
    buffer_load_dwordx4 v7, s[4:7], s60 offen offset:3072 lds
    s_add_u32 m0, s55, 32768
    s_waitcnt lgkmcnt(5)
    v_mfma_f32_16x16x32_bf16 v[168:171], a[8:11], v[52:55], v[168:171]
    ds_read_b128 v[108:111], v14 offset:63488
    v_lshrrev_b32 v18, 4, v1
    v_mfma_f32_16x16x32_bf16 v[172:175], a[12:15], v[52:55], v[172:175]
    s_xor_b32 s60, s53, 12288
    s_waitcnt lgkmcnt(5)
    buffer_load_dwordx4 v2, s[36:39], s60 offen offset:0 sc1 lds
    v_mfma_f32_16x16x32_bf16 v[176:179], a[8:11], v[56:59], v[176:179]
    ds_read_b128 v[32:35], v14 offset:52224
    v_lshl_add_u32 v15, v18, 6, v15
    v_mfma_f32_16x16x32_bf16 v[180:183], a[12:15], v[56:59], v[180:183]
    s_waitcnt lgkmcnt(5)
    buffer_load_dwordx4 v2, s[36:39], s60 offen offset:1024 sc1 lds
    v_mfma_f32_16x16x32_bf16 v[184:187], a[8:11], v[60:63], v[184:187]
    ds_read_b128 v[36:39], v14 offset:56320
    v_and_b32 v18, 3, v1
    v_mfma_f32_16x16x32_bf16 v[188:191], a[12:15], v[60:63], v[188:191]
    s_waitcnt lgkmcnt(5)
    buffer_load_dwordx4 v2, s[36:39], s60 offen offset:2048 sc1 lds
    v_mfma_f32_16x16x32_bf16 v[160:163], a[16:19], v[96:99], v[160:163]
    ds_read_b128 v[40:43], v14 offset:60416
    v_lshl_add_u32 v15, v18, 4, v15
    v_mfma_f32_16x16x32_bf16 v[164:167], a[20:23], v[96:99], v[164:167]
    buffer_load_dwordx4 v2, s[36:39], s60 offen offset:3072 sc1 lds
    s_add_u32 m0, s55, 49152
    s_waitcnt lgkmcnt(5)
    v_mfma_f32_16x16x32_bf16 v[168:171], a[16:19], v[100:103], v[168:171]
    s_add_u32 s19, s17, s16
    ds_read_b128 v[44:47], v14 offset:64512
    v_mfma_f32_16x16x32_bf16 v[172:175], a[20:23], v[100:103], v[172:175]
    s_xor_b32 s60, s52, 458752
    buffer_load_dwordx4 v4, s[4:7], s60 offen offset:0 lds
    s_barrier
    s_waitcnt lgkmcnt(5)
    v_mfma_f32_16x16x32_bf16 v[176:179], a[16:19], v[104:107], v[176:179]
    s_and_b32 s20, s16, 1
    v_add_u32 v14, 0xffff0000, v14
    ds_read_b128 v[48:51], v14 offset:16384
    v_mfma_f32_16x16x32_bf16 v[180:183], a[20:23], v[104:107], v[180:183]
    s_waitcnt lgkmcnt(5)
    buffer_load_dwordx4 v5, s[4:7], s60 offen offset:1024 lds
    v_mfma_f32_16x16x32_bf16 v[184:187], a[16:19], v[108:111], v[184:187]
    s_lshl_b32 s20, s20, 4
    ds_read_b128 v[52:55], v14 offset:20480
    v_mfma_f32_16x16x32_bf16 v[188:191], a[20:23], v[108:111], v[188:191]
    s_waitcnt lgkmcnt(5)
    buffer_load_dwordx4 v6, s[4:7], s60 offen offset:2048 lds
    v_mfma_f32_16x16x32_bf16 v[160:163], a[24:27], v[32:35], v[160:163]
    s_lshl_b32 s18, s15, 2
    ds_read_b128 v[56:59], v14 offset:24576
    v_mfma_f32_16x16x32_bf16 v[164:167], a[28:31], v[32:35], v[164:167]
    buffer_load_dwordx4 v7, s[4:7], s60 offen offset:3072 lds
    s_add_u32 m0, s55, 98304
    s_waitcnt lgkmcnt(5)
    v_mfma_f32_16x16x32_bf16 v[168:171], a[24:27], v[36:39], v[168:171]
    s_add_u32 s20, s20, s18
    ds_read_b128 v[60:63], v14 offset:28672
    v_mfma_f32_16x16x32_bf16 v[172:175], a[28:31], v[36:39], v[172:175]
    s_xor_b32 s60, s52, 524288
    s_waitcnt lgkmcnt(5)
    buffer_load_dwordx4 v4, s[4:7], s60 offen offset:0 lds
    v_mfma_f32_16x16x32_bf16 v[176:179], a[24:27], v[40:43], v[176:179]
    ds_read_b128 v[96:99], v14 offset:17408
    v_add_u32 v18, s20, v18
    v_mfma_f32_16x16x32_bf16 v[180:183], a[28:31], v[40:43], v[180:183]
    s_waitcnt lgkmcnt(5)
    buffer_load_dwordx4 v5, s[4:7], s60 offen offset:1024 lds
    v_mfma_f32_16x16x32_bf16 v[184:187], a[24:27], v[44:47], v[184:187]
    ds_read_b128 v[100:103], v14 offset:21504
    v_and_b32 v19, 4, v18
    v_mfma_f32_16x16x32_bf16 v[188:191], a[28:31], v[44:47], v[188:191]
    s_waitcnt lgkmcnt(5)
    buffer_load_dwordx4 v6, s[4:7], s60 offen offset:2048 lds
    v_mfma_f32_16x16x32_bf16 v[160:163], a[32:35], v[48:51], v[160:163]
    ds_read_b128 v[104:107], v14 offset:25600
    v_lshlrev_b32 v19, 1, v19
    v_mfma_f32_16x16x32_bf16 v[164:167], a[36:39], v[48:51], v[164:167]
    buffer_load_dwordx4 v7, s[4:7], s60 offen offset:3072 lds
    s_add_u32 m0, s55, 0
    s_waitcnt lgkmcnt(5)
    v_mfma_f32_16x16x32_bf16 v[168:171], a[32:35], v[52:55], v[168:171]
    ds_read_b128 v[108:111], v14 offset:29696
    v_and_b32 v21, 8, v18
    v_mfma_f32_16x16x32_bf16 v[172:175], a[36:39], v[52:55], v[172:175]
    s_xor_b32 s60, s53, 16384
    s_waitcnt lgkmcnt(5)
    buffer_load_dwordx4 v2, s[36:39], s60 offen offset:0 sc1 lds
    v_mfma_f32_16x16x32_bf16 v[176:179], a[32:35], v[56:59], v[176:179]
    ds_read_b128 v[32:35], v14 offset:18432
    v_lshrrev_b32 v21, 1, v21
    v_mfma_f32_16x16x32_bf16 v[180:183], a[36:39], v[56:59], v[180:183]
    s_waitcnt lgkmcnt(5)
    buffer_load_dwordx4 v2, s[36:39], s60 offen offset:1024 sc1 lds
    v_mfma_f32_16x16x32_bf16 v[184:187], a[32:35], v[60:63], v[184:187]
    ds_read_b128 v[36:39], v14 offset:22528
    v_or_b32 v19, v19, v21
    v_mfma_f32_16x16x32_bf16 v[188:191], a[36:39], v[60:63], v[188:191]
    s_waitcnt lgkmcnt(5)
    buffer_load_dwordx4 v2, s[36:39], s60 offen offset:2048 sc1 lds
    v_mfma_f32_16x16x32_bf16 v[160:163], a[40:43], v[96:99], v[160:163]
    ds_read_b128 v[40:43], v14 offset:26624
    v_and_b32 v21, 0xfffffff3, v18
    v_mfma_f32_16x16x32_bf16 v[164:167], a[44:47], v[96:99], v[164:167]
    s_waitcnt lgkmcnt(5)
    buffer_load_dwordx4 v2, s[36:39], s60 offen offset:3072 sc1 lds
    v_mfma_f32_16x16x32_bf16 v[168:171], a[40:43], v[100:103], v[168:171]
    ds_read_b128 v[44:47], v14 offset:30720
    v_or_b32 v21, v21, v19
    v_mfma_f32_16x16x32_bf16 v[172:175], a[44:47], v[100:103], v[172:175]
    s_waitcnt lgkmcnt(5)
    v_lshlrev_b32 v21, 10, v21
    v_and_b32 v20, 15, v1
    v_mfma_f32_16x16x32_bf16 v[176:179], a[40:43], v[104:107], v[176:179]
    ds_read_b128 v[48:51], v14 offset:19456
    v_lshlrev_b32 v20, 4, v20
    v_mfma_f32_16x16x32_bf16 v[180:183], a[44:47], v[104:107], v[180:183]
    s_waitcnt lgkmcnt(5)
    v_lshrrev_b32 v18, 4, v1
    v_lshl_add_u32 v20, v18, 10, v20
    v_mfma_f32_16x16x32_bf16 v[184:187], a[40:43], v[108:111], v[184:187]
    ds_read_b128 v[52:55], v14 offset:23552
    v_lshlrev_b32 v22, 5, v18
    v_mfma_f32_16x16x32_bf16 v[188:191], a[44:47], v[108:111], v[188:191]
    s_waitcnt lgkmcnt(5)
    v_bfe_u32 v19, v1, 2, 2
    v_lshl_add_u32 v22, v19, 2, v22
    v_mfma_f32_16x16x32_bf16 v[160:163], a[48:51], v[32:35], v[160:163]
    ds_read_b128 v[56:59], v14 offset:27648
    v_lshl_add_u32 v21, v22, 1, v21
    v_mfma_f32_16x16x32_bf16 v[164:167], a[52:55], v[32:35], v[164:167]
    s_mov_b32 s24, s72
    s_waitcnt lgkmcnt(5)
    v_lshlrev_b32 v22, 2, v22
    v_mfma_f32_16x16x32_bf16 v[168:171], a[48:51], v[36:39], v[168:171]
    s_mov_b32 s25, s73
    ds_read_b128 v[60:63], v14 offset:31744
    v_mfma_f32_16x16x32_bf16 v[172:175], a[52:55], v[36:39], v[172:175]
    s_mov_b32 s26, 0x200000
    s_mov_b32 s27, 0x20000
    s_waitcnt vmcnt(16)
    s_barrier
    s_cmp_lg_u32 s3, 0
    s_cbranch_scc1 main_skip39
    v_mov_b32 v3, 1
    s_mov_b64 exec, 1
    buffer_atomic_add v3, off, s[84:87], s58 sc1
    s_mov_b64 exec, -1
main_skip39:
    s_waitcnt lgkmcnt(5)
    v_mfma_f32_16x16x32_bf16 v[176:179], a[48:51], v[40:43], v[176:179]
    v_add_u32 v14, 0x10000, v14
    ds_read_b128 v[96:99], v14 offset:0
    v_add_u32 v12, 0x20000, v12
    v_mfma_f32_16x16x32_bf16 v[180:183], a[52:55], v[40:43], v[180:183]
    s_add_u32 m0, s55, 114688
    s_xor_b32 s60, s52, 589824
    s_waitcnt lgkmcnt(5)
    v_mfma_f32_16x16x32_bf16 v[184:187], a[48:51], v[44:47], v[184:187]
    ds_read_b128 v[100:103], v14 offset:4096
    v_add_u32 v13, 0x20000, v13
    v_mfma_f32_16x16x32_bf16 v[188:191], a[52:55], v[44:47], v[188:191]
    s_waitcnt lgkmcnt(5)
    buffer_load_dwordx4 v4, s[4:7], s60 offen offset:0 lds
    v_mfma_f32_16x16x32_bf16 v[160:163], a[56:59], v[48:51], v[160:163]
    s_nop 0
    ds_read_b128 v[104:107], v14 offset:8192
    ds_read_b64_tr_b16 a[64:65], v12 offset:0
    v_mfma_f32_16x16x32_bf16 v[164:167], a[60:63], v[48:51], v[164:167]
    s_waitcnt lgkmcnt(6)
    buffer_load_dwordx4 v5, s[4:7], s60 offen offset:1024 lds
    v_mfma_f32_16x16x32_bf16 v[168:171], a[56:59], v[52:55], v[168:171]
    s_nop 0
    ds_read_b128 v[108:111], v14 offset:12288
    ds_read_b64_tr_b16 a[66:67], v12 offset:4096
    v_mfma_f32_16x16x32_bf16 v[172:175], a[60:63], v[52:55], v[172:175]
    s_waitcnt lgkmcnt(7)
    buffer_load_dwordx4 v6, s[4:7], s60 offen offset:2048 lds
    v_mfma_f32_16x16x32_bf16 v[176:179], a[56:59], v[56:59], v[176:179]
    s_nop 0
    ds_read_b128 v[32:35], v14 offset:1024
    ds_read_b64_tr_b16 a[68:69], v13 offset:0
    v_mfma_f32_16x16x32_bf16 v[180:183], a[60:63], v[56:59], v[180:183]
    s_waitcnt lgkmcnt(8)
    buffer_load_dwordx4 v7, s[4:7], s60 offen offset:3072 lds
    v_mfma_f32_16x16x32_bf16 v[184:187], a[56:59], v[60:63], v[184:187]
    s_nop 0
    ds_read_b128 v[36:39], v14 offset:5120
    ds_read_b64_tr_b16 a[70:71], v13 offset:4096
    v_mfma_f32_16x16x32_bf16 v[188:191], a[60:63], v[60:63], v[188:191]
    s_waitcnt lgkmcnt(4)
    ds_read_b64_tr_b16 a[72:73], v12 offset:8192
    ds_read_b64_tr_b16 a[74:75], v12 offset:12288
    v_mfma_f32_16x16x32_bf16 v[160:163], a[64:67], v[96:99], v[160:163]
    s_waitcnt lgkmcnt(2)
    ds_read_b128 v[40:43], v14 offset:9216
    ds_read_b64_tr_b16 a[76:77], v13 offset:8192
    v_mfma_f32_16x16x32_bf16 v[164:167], a[68:71], v[96:99], v[164:167]
    s_nop 0
    ds_read_b64_tr_b16 a[78:79], v13 offset:12288
    ds_read_b64_tr_b16 a[80:81], v12 offset:16384
    v_mfma_f32_16x16x32_bf16 v[168:171], a[64:67], v[100:103], v[168:171]
    s_nop 0
    ds_read_b128 v[44:47], v14 offset:13312
    ds_read_b64_tr_b16 a[82:83], v12 offset:20480
    v_mfma_f32_16x16x32_bf16 v[172:175], a[68:71], v[100:103], v[172:175]
    s_nop 0
    ds_read_b64_tr_b16 a[84:85], v13 offset:16384
    ds_read_b64_tr_b16 a[86:87], v13 offset:20480
    v_mfma_f32_16x16x32_bf16 v[176:179], a[64:67], v[104:107], v[176:179]
    s_nop 0
    ds_read_b128 v[48:51], v14 offset:2048
    ds_read_b64_tr_b16 a[88:89], v12 offset:24576
    v_mfma_f32_16x16x32_bf16 v[180:183], a[68:71], v[104:107], v[180:183]
    s_nop 0
    ds_read_b64_tr_b16 a[90:91], v12 offset:28672
    ds_read_b64_tr_b16 a[92:93], v13 offset:24576
    v_mfma_f32_16x16x32_bf16 v[184:187], a[64:67], v[108:111], v[184:187]
    s_nop 0
    ds_read_b128 v[52:55], v14 offset:6144
    ds_read_b64_tr_b16 a[94:95], v13 offset:28672
    v_mfma_f32_16x16x32_bf16 v[188:191], a[68:71], v[108:111], v[188:191]
    s_lshr_b32 s21, s19, 1
    s_lshl_b32 s21, s21, 15
    s_waitcnt lgkmcnt(14)
    v_mfma_f32_16x16x32_bf16 v[160:163], a[72:75], v[32:35], v[160:163]
    s_lshl_b32 s22, s3, 8
    s_waitcnt lgkmcnt(11)
    ds_read_b128 v[56:59], v14 offset:10240
    v_mfma_f32_16x16x32_bf16 v[164:167], a[76:79], v[32:35], v[164:167]
    s_add_u32 s21, s21, s22
    s_lshl_b32 s22, s3, 9
    v_mfma_f32_16x16x32_bf16 v[168:171], a[72:75], v[36:39], v[168:171]
    s_lshl_b32 s23, s19, 14
    ds_read_b128 v[60:63], v14 offset:14336
    v_mfma_f32_16x16x32_bf16 v[172:175], a[76:79], v[36:39], v[172:175]
    s_add_u32 s23, s23, s55
    s_lshl_b32 s18, s15, 8
    v_mfma_f32_16x16x32_bf16 v[176:179], a[72:75], v[40:43], v[176:179]
    s_add_u32 s23, s23, s18
    ds_read_b128 v[96:99], v14 offset:3072
    v_mfma_f32_16x16x32_bf16 v[180:183], a[76:79], v[40:43], v[180:183]
    s_lshl_b32 s62, s16, 21
    s_lshl_b32 s63, s17, 14
    s_waitcnt lgkmcnt(12)
    v_mfma_f32_16x16x32_bf16 v[184:187], a[72:75], v[44:47], v[184:187]
    s_add_u32 s62, s62, s63
    ds_read_b128 v[100:103], v14 offset:7168
    v_mfma_f32_16x16x32_bf16 v[188:191], a[76:79], v[44:47], v[188:191]
    s_lshl_b32 s63, s15, 12
    s_add_u32 s62, s62, s63
    s_waitcnt lgkmcnt(9)
    v_mfma_f32_16x16x32_bf16 v[160:163], a[80:83], v[48:51], v[160:163]
    s_lshl_b32 s63, s3, 10
    ds_read_b128 v[104:107], v14 offset:11264
    v_mfma_f32_16x16x32_bf16 v[164:167], a[84:87], v[48:51], v[164:167]
    s_add_u32 s62, s62, s63
    s_lshl_b32 s77, s14, 7
    s_waitcnt lgkmcnt(6)
    v_mfma_f32_16x16x32_bf16 v[168:171], a[80:83], v[52:55], v[168:171]
    s_add_u32 s77, s77, 71680
    ds_read_b128 v[108:111], v14 offset:15360
    v_mfma_f32_16x16x32_bf16 v[172:175], a[84:87], v[52:55], v[172:175]
    s_add_u32 s76, s77, 2048
    s_add_u32 s78, s76, 4096
    s_waitcnt lgkmcnt(6)
    s_waitcnt vmcnt(12)
    s_barrier
    s_waitcnt lgkmcnt(5)
    v_mfma_f32_16x16x32_bf16 v[176:179], a[80:83], v[56:59], v[176:179]
    v_add_u32 v14, 0xffff0000, v14
    ds_read_b128 v[32:35], v14 offset:32768
    v_add_u32 v12, 0xffff0000, v12
    v_mfma_f32_16x16x32_bf16 v[180:183], a[84:87], v[56:59], v[180:183]
    s_add_u32 m0, s55, 131072
    s_xor_b32 s60, s52, 655360
    s_waitcnt lgkmcnt(5)
    v_mfma_f32_16x16x32_bf16 v[184:187], a[80:83], v[60:63], v[184:187]
    ds_read_b128 v[36:39], v14 offset:36864
    v_add_u32 v13, 0xffff0000, v13
    v_mfma_f32_16x16x32_bf16 v[188:191], a[84:87], v[60:63], v[188:191]
    s_waitcnt lgkmcnt(5)
    buffer_load_dwordx4 v4, s[4:7], s60 offen offset:0 lds
    v_mfma_f32_16x16x32_bf16 v[160:163], a[88:91], v[96:99], v[160:163]
    s_nop 0
    ds_read_b128 v[40:43], v14 offset:40960
    ds_read_b64_tr_b16 a[96:97], v12 offset:16384
    v_mfma_f32_16x16x32_bf16 v[164:167], a[92:95], v[96:99], v[164:167]
    s_waitcnt lgkmcnt(6)
    buffer_load_dwordx4 v5, s[4:7], s60 offen offset:1024 lds
    v_mfma_f32_16x16x32_bf16 v[168:171], a[88:91], v[100:103], v[168:171]
    s_nop 0
    ds_read_b128 v[44:47], v14 offset:45056
    ds_read_b64_tr_b16 a[98:99], v12 offset:20480
    v_mfma_f32_16x16x32_bf16 v[172:175], a[92:95], v[100:103], v[172:175]
    s_waitcnt lgkmcnt(7)
    buffer_load_dwordx4 v6, s[4:7], s60 offen offset:2048 lds
    v_mfma_f32_16x16x32_bf16 v[176:179], a[88:91], v[104:107], v[176:179]
    s_nop 0
    ds_read_b128 v[48:51], v14 offset:33792
    ds_read_b64_tr_b16 a[100:101], v13 offset:16384
    v_mfma_f32_16x16x32_bf16 v[180:183], a[92:95], v[104:107], v[180:183]
    buffer_load_dwordx4 v7, s[4:7], s60 offen offset:3072 lds
    s_add_u32 m0, s55, 147456
    s_waitcnt lgkmcnt(8)
    v_mfma_f32_16x16x32_bf16 v[184:187], a[88:91], v[108:111], v[184:187]
    s_nop 0
    ds_read_b128 v[52:55], v14 offset:37888
    ds_read_b64_tr_b16 a[102:103], v13 offset:20480
    v_mfma_f32_16x16x32_bf16 v[188:191], a[92:95], v[108:111], v[188:191]
    s_xor_b32 s60, s53, 20480
    s_waitcnt lgkmcnt(4)
    buffer_load_dwordx4 v2, s[36:39], s60 offen offset:0 sc1 lds
    v_mfma_f32_16x16x32_bf16 v[160:163], a[96:99], v[32:35], v[160:163]
    s_waitcnt lgkmcnt(0)
    ds_read_b128 v[56:59], v14 offset:41984
    ds_read_b64_tr_b16 a[104:105], v12 offset:24576
    v_mfma_f32_16x16x32_bf16 v[164:167], a[100:103], v[32:35], v[164:167]
    buffer_load_dwordx4 v2, s[36:39], s60 offen offset:1024 sc1 lds
    v_mfma_f32_16x16x32_bf16 v[168:171], a[96:99], v[36:39], v[168:171]
    s_nop 0
    ds_read_b128 v[60:63], v14 offset:46080
    ds_read_b64_tr_b16 a[106:107], v12 offset:28672
    v_mfma_f32_16x16x32_bf16 v[172:175], a[100:103], v[36:39], v[172:175]
    buffer_load_dwordx4 v2, s[36:39], s60 offen offset:2048 sc1 lds
    v_mfma_f32_16x16x32_bf16 v[176:179], a[96:99], v[40:43], v[176:179]
    s_nop 0
    ds_read_b128 v[96:99], v14 offset:34816
    ds_read_b64_tr_b16 a[108:109], v13 offset:24576
    v_mfma_f32_16x16x32_bf16 v[180:183], a[100:103], v[40:43], v[180:183]
    buffer_load_dwordx4 v2, s[36:39], s60 offen offset:3072 sc1 lds
    s_add_u32 m0, s55, 16384
    v_mfma_f32_16x16x32_bf16 v[184:187], a[96:99], v[44:47], v[184:187]
    s_nop 0
    ds_read_b128 v[100:103], v14 offset:38912
    ds_read_b64_tr_b16 a[110:111], v13 offset:28672
    v_mfma_f32_16x16x32_bf16 v[188:191], a[100:103], v[44:47], v[188:191]
    s_xor_b32 s60, s52, 720896
    s_waitcnt lgkmcnt(4)
    buffer_load_dwordx4 v4, s[4:7], s60 offen offset:0 lds
    v_mfma_f32_16x16x32_bf16 v[160:163], a[104:107], v[48:51], v[160:163]
    s_waitcnt lgkmcnt(0)
    ds_read_b128 v[104:107], v14 offset:43008
    v_add_u32 v12, 0xffff0000, v12
    v_mfma_f32_16x16x32_bf16 v[164:167], a[108:111], v[48:51], v[164:167]
    buffer_load_dwordx4 v5, s[4:7], s60 offen offset:1024 lds
    v_mfma_f32_16x16x32_bf16 v[168:171], a[104:107], v[52:55], v[168:171]
    ds_read_b128 v[108:111], v14 offset:47104
    v_add_u32 v13, 0xffff0000, v13
    v_mfma_f32_16x16x32_bf16 v[172:175], a[108:111], v[52:55], v[172:175]
    buffer_load_dwordx4 v6, s[4:7], s60 offen offset:2048 lds
    v_mfma_f32_16x16x32_bf16 v[176:179], a[104:107], v[56:59], v[176:179]
    s_nop 0
    ds_read_b128 v[32:35], v14 offset:35840
    ds_read_b64_tr_b16 a[112:113], v12 offset:49152
    v_mfma_f32_16x16x32_bf16 v[180:183], a[108:111], v[56:59], v[180:183]
    buffer_load_dwordx4 v7, s[4:7], s60 offen offset:3072 lds
    v_mfma_f32_16x16x32_bf16 v[184:187], a[104:107], v[60:63], v[184:187]
    s_nop 0
    ds_read_b128 v[36:39], v14 offset:39936
    ds_read_b64_tr_b16 a[114:115], v12 offset:53248
    v_mfma_f32_16x16x32_bf16 v[188:191], a[108:111], v[60:63], v[188:191]
    s_waitcnt lgkmcnt(0)
    ds_read_b64_tr_b16 a[116:117], v13 offset:49152
    ds_read_b64_tr_b16 a[118:119], v13 offset:53248
    v_mfma_f32_16x16x32_bf16 v[160:163], a[112:115], v[96:99], v[160:163]
    s_waitcnt lgkmcnt(0)
    ds_read_b128 v[40:43], v14 offset:44032
    ds_read_b64_tr_b16 a[120:121], v12 offset:57344
    v_mfma_f32_16x16x32_bf16 v[164:167], a[116:119], v[96:99], v[164:167]
    s_nop 0
    ds_read_b64_tr_b16 a[122:123], v12 offset:61440
    ds_read_b64_tr_b16 a[124:125], v13 offset:57344
    v_mfma_f32_16x16x32_bf16 v[168:171], a[112:115], v[100:103], v[168:171]
    s_nop 0
    ds_read_b128 v[44:47], v14 offset:48128
    ds_read_b64_tr_b16 a[126:127], v13 offset:61440
    v_mfma_f32_16x16x32_bf16 v[172:175], a[116:119], v[100:103], v[172:175]
    s_add_u32 s35, s77, 4096
    s_and_b32 s14, s2, 15
    s_waitcnt lgkmcnt(0)
    s_waitcnt vmcnt(12)
    s_barrier
    v_mfma_f32_16x16x32_bf16 v[176:179], a[112:115], v[104:107], v[176:179]
    ds_read_b128 v[48:51], v14 offset:0
    v_add_u32 v12, 0x10000, v12
    v_mfma_f32_16x16x32_bf16 v[180:183], a[116:119], v[104:107], v[180:183]
    s_add_u32 m0, s55, 81920
    s_xor_b32 s60, s52, 786432
    v_mfma_f32_16x16x32_bf16 v[184:187], a[112:115], v[108:111], v[184:187]
    ds_read_b128 v[52:55], v14 offset:4096
    v_add_u32 v13, 0x10000, v13
    v_mfma_f32_16x16x32_bf16 v[188:191], a[116:119], v[108:111], v[188:191]
    buffer_load_dwordx4 v4, s[4:7], s60 offen offset:0 lds
    v_mfma_f32_16x16x32_bf16 v[160:163], a[120:123], v[32:35], v[160:163]
    s_nop 0
    ds_read_b128 v[56:59], v14 offset:8192
    ds_read_b64_tr_b16 a[128:129], v12 offset:32768
    v_mfma_f32_16x16x32_bf16 v[164:167], a[124:127], v[32:35], v[164:167]
    buffer_load_dwordx4 v5, s[4:7], s60 offen offset:1024 lds
    v_mfma_f32_16x16x32_bf16 v[168:171], a[120:123], v[36:39], v[168:171]
    s_nop 0
    ds_read_b128 v[60:63], v14 offset:12288
    ds_read_b64_tr_b16 a[130:131], v12 offset:36864
    v_mfma_f32_16x16x32_bf16 v[172:175], a[124:127], v[36:39], v[172:175]
    buffer_load_dwordx4 v6, s[4:7], s60 offen offset:2048 lds
    v_mfma_f32_16x16x32_bf16 v[176:179], a[120:123], v[40:43], v[176:179]
    s_nop 0
    ds_read_b128 v[96:99], v14 offset:1024
    ds_read_b64_tr_b16 a[132:133], v13 offset:32768
    v_mfma_f32_16x16x32_bf16 v[180:183], a[124:127], v[40:43], v[180:183]
    buffer_load_dwordx4 v7, s[4:7], s60 offen offset:3072 lds
    s_add_u32 m0, s55, 49152
    v_mfma_f32_16x16x32_bf16 v[184:187], a[120:123], v[44:47], v[184:187]
    s_nop 0
    ds_read_b128 v[100:103], v14 offset:5120
    ds_read_b64_tr_b16 a[134:135], v13 offset:36864
    v_mfma_f32_16x16x32_bf16 v[188:191], a[124:127], v[44:47], v[188:191]
    s_xor_b32 s60, s53, 24576
    s_waitcnt lgkmcnt(4)
    buffer_load_dwordx4 v2, s[36:39], s60 offen offset:0 sc1 lds
    v_mfma_f32_16x16x32_bf16 v[160:163], a[128:131], v[48:51], v[160:163]
    s_waitcnt lgkmcnt(0)
    ds_read_b128 v[104:107], v14 offset:9216
    ds_read_b64_tr_b16 a[136:137], v12 offset:40960
    v_mfma_f32_16x16x32_bf16 v[164:167], a[132:135], v[48:51], v[164:167]
    buffer_load_dwordx4 v2, s[36:39], s60 offen offset:1024 sc1 lds
    v_mfma_f32_16x16x32_bf16 v[168:171], a[128:131], v[52:55], v[168:171]
    s_nop 0
    ds_read_b128 v[108:111], v14 offset:13312
    ds_read_b64_tr_b16 a[138:139], v12 offset:45056
    v_mfma_f32_16x16x32_bf16 v[172:175], a[132:135], v[52:55], v[172:175]
    buffer_load_dwordx4 v2, s[36:39], s60 offen offset:2048 sc1 lds
    v_mfma_f32_16x16x32_bf16 v[176:179], a[128:131], v[56:59], v[176:179]
    s_nop 0
    ds_read_b128 v[32:35], v14 offset:2048
    ds_read_b64_tr_b16 a[140:141], v13 offset:40960
    v_mfma_f32_16x16x32_bf16 v[180:183], a[132:135], v[56:59], v[180:183]
    buffer_load_dwordx4 v2, s[36:39], s60 offen offset:3072 sc1 lds
    s_add_u32 m0, s55, 65536
    v_mfma_f32_16x16x32_bf16 v[184:187], a[128:131], v[60:63], v[184:187]
    s_nop 0
    ds_read_b128 v[36:39], v14 offset:6144
    ds_read_b64_tr_b16 a[142:143], v13 offset:45056
    v_mfma_f32_16x16x32_bf16 v[188:191], a[132:135], v[60:63], v[188:191]
    s_xor_b32 s60, s52, 851968
    s_waitcnt lgkmcnt(4)
    buffer_load_dwordx4 v4, s[4:7], s60 offen offset:0 lds
    v_mfma_f32_16x16x32_bf16 v[160:163], a[136:139], v[96:99], v[160:163]
    s_waitcnt lgkmcnt(0)
    ds_read_b128 v[40:43], v14 offset:10240
    ds_read_b64_tr_b16 a[144:145], v12 offset:49152
    v_mfma_f32_16x16x32_bf16 v[164:167], a[140:143], v[96:99], v[164:167]
    buffer_load_dwordx4 v5, s[4:7], s60 offen offset:1024 lds
    v_mfma_f32_16x16x32_bf16 v[168:171], a[136:139], v[100:103], v[168:171]
    s_nop 0
    ds_read_b128 v[44:47], v14 offset:14336
    ds_read_b64_tr_b16 a[146:147], v12 offset:53248
    v_mfma_f32_16x16x32_bf16 v[172:175], a[140:143], v[100:103], v[172:175]
    buffer_load_dwordx4 v6, s[4:7], s60 offen offset:2048 lds
    v_mfma_f32_16x16x32_bf16 v[176:179], a[136:139], v[104:107], v[176:179]
    s_nop 0
    ds_read_b128 v[48:51], v14 offset:3072
    ds_read_b64_tr_b16 a[148:149], v13 offset:49152
    v_mfma_f32_16x16x32_bf16 v[180:183], a[140:143], v[104:107], v[180:183]
    buffer_load_dwordx4 v7, s[4:7], s60 offen offset:3072 lds
    v_mfma_f32_16x16x32_bf16 v[184:187], a[136:139], v[108:111], v[184:187]
    s_nop 0
    ds_read_b128 v[52:55], v14 offset:7168
    ds_read_b64_tr_b16 a[150:151], v13 offset:53248
    v_mfma_f32_16x16x32_bf16 v[188:191], a[140:143], v[108:111], v[188:191]
    s_waitcnt lgkmcnt(4)
    buffer_load_dword v28, off, s[40:43], s57 sc1
    v_mfma_f32_16x16x32_bf16 v[160:163], a[144:147], v[32:35], v[160:163]
    s_waitcnt lgkmcnt(0)
    ds_read_b128 v[56:59], v14 offset:11264
    ds_read_b64_tr_b16 a[152:153], v12 offset:57344
    v_mfma_f32_16x16x32_bf16 v[164:167], a[148:151], v[32:35], v[164:167]
    buffer_load_dword v24, v23, s[84:87], 0 offen sc1
    v_mfma_f32_16x16x32_bf16 v[168:171], a[144:147], v[36:39], v[168:171]
    s_nop 0
    ds_read_b128 v[60:63], v14 offset:15360
    ds_read_b64_tr_b16 a[154:155], v12 offset:61440
    v_mfma_f32_16x16x32_bf16 v[172:175], a[148:151], v[36:39], v[172:175]
    s_nop 0
    ds_read_b64_tr_b16 a[156:157], v13 offset:57344
    ds_read_b64_tr_b16 a[158:159], v13 offset:61440
    s_waitcnt lgkmcnt(0)
    s_waitcnt vmcnt(14)
    s_barrier
    v_mfma_f32_16x16x32_bf16 v[176:179], a[144:147], v[40:43], v[176:179]
    v_add_u32 v14, 0x20000, v14
    ds_read_b128 v[96:99], v14 offset:16384
    v_add_u32 v12, 0x10000, v12
    v_mfma_f32_16x16x32_bf16 v[180:183], a[148:151], v[40:43], v[180:183]
    s_add_u32 m0, s55, 98304
    s_xor_b32 s60, s52, 917504
    v_mfma_f32_16x16x32_bf16 v[184:187], a[144:147], v[44:47], v[184:187]
    ds_read_b128 v[100:103], v14 offset:20480
    v_add_u32 v13, 0x10000, v13
    v_mfma_f32_16x16x32_bf16 v[188:191], a[148:151], v[44:47], v[188:191]
    buffer_load_dwordx4 v4, s[4:7], s60 offen offset:0 lds
    v_mfma_f32_16x16x32_bf16 v[160:163], a[152:155], v[48:51], v[160:163]
    s_nop 0
    ds_read_b128 v[104:107], v14 offset:24576
    ds_read_b64_tr_b16 a[160:161], v12 offset:0
    v_mfma_f32_16x16x32_bf16 v[164:167], a[156:159], v[48:51], v[164:167]
    buffer_load_dwordx4 v5, s[4:7], s60 offen offset:1024 lds
    v_mfma_f32_16x16x32_bf16 v[168:171], a[152:155], v[52:55], v[168:171]
    s_nop 0
    ds_read_b128 v[108:111], v14 offset:28672
    ds_read_b64_tr_b16 a[162:163], v12 offset:4096
    v_mfma_f32_16x16x32_bf16 v[172:175], a[156:159], v[52:55], v[172:175]
    buffer_load_dwordx4 v6, s[4:7], s60 offen offset:2048 lds
    v_mfma_f32_16x16x32_bf16 v[176:179], a[152:155], v[56:59], v[176:179]
    s_nop 0
    ds_read_b128 v[32:35], v14 offset:17408
    ds_read_b64_tr_b16 a[164:165], v13 offset:0
    v_mfma_f32_16x16x32_bf16 v[180:183], a[156:159], v[56:59], v[180:183]
    buffer_load_dwordx4 v7, s[4:7], s60 offen offset:3072 lds
    s_add_u32 m0, s55, 114688
    v_mfma_f32_16x16x32_bf16 v[184:187], a[152:155], v[60:63], v[184:187]
    s_nop 0
    ds_read_b128 v[36:39], v14 offset:21504
    ds_read_b64_tr_b16 a[166:167], v13 offset:4096
    v_mfma_f32_16x16x32_bf16 v[188:191], a[156:159], v[60:63], v[188:191]
    s_xor_b32 s60, s53, 28672
    s_waitcnt lgkmcnt(4)
    buffer_load_dwordx4 v2, s[36:39], s60 offen offset:0 sc1 lds
    v_mfma_f32_16x16x32_bf16 v[160:163], a[160:163], v[96:99], v[160:163]
    s_waitcnt lgkmcnt(0)
    ds_read_b128 v[40:43], v14 offset:25600
    ds_read_b64_tr_b16 a[168:169], v12 offset:8192
    v_mfma_f32_16x16x32_bf16 v[164:167], a[164:167], v[96:99], v[164:167]
    buffer_load_dwordx4 v2, s[36:39], s60 offen offset:1024 sc1 lds
    v_mfma_f32_16x16x32_bf16 v[168:171], a[160:163], v[100:103], v[168:171]
    s_nop 0
    ds_read_b128 v[44:47], v14 offset:29696
    ds_read_b64_tr_b16 a[170:171], v12 offset:12288
    v_mfma_f32_16x16x32_bf16 v[172:175], a[164:167], v[100:103], v[172:175]
    s_nop 0
    ds_read_b64_tr_b16 a[172:173], v13 offset:8192
    ds_read_b64_tr_b16 a[174:175], v13 offset:12288
    v_mfma_f32_16x16x32_bf16 v[176:179], a[160:163], v[104:107], v[176:179]
    ds_read_b128 v[48:51], v14 offset:18432
    v_add_u32 v12, 0xfffe0000, v12
    v_mfma_f32_16x16x32_bf16 v[180:183], a[164:167], v[104:107], v[180:183]
    buffer_load_dwordx4 v2, s[36:39], s60 offen offset:2048 sc1 lds
    v_mfma_f32_16x16x32_bf16 v[184:187], a[160:163], v[108:111], v[184:187]
    ds_read_b128 v[52:55], v14 offset:22528
    v_add_u32 v13, 0xfffe0000, v13
    v_mfma_f32_16x16x32_bf16 v[188:191], a[164:167], v[108:111], v[188:191]
    s_waitcnt lgkmcnt(4)
    ds_read_b64_tr_b16 a[176:177], v12 offset:16384
    ds_read_b64_tr_b16 a[178:179], v12 offset:20480
    v_mfma_f32_16x16x32_bf16 v[160:163], a[168:171], v[32:35], v[160:163]
    s_waitcnt lgkmcnt(4)
    ds_read_b128 v[56:59], v14 offset:26624
    ds_read_b64_tr_b16 a[180:181], v13 offset:16384
    v_mfma_f32_16x16x32_bf16 v[164:167], a[172:175], v[32:35], v[164:167]
    buffer_load_dwordx4 v2, s[36:39], s60 offen offset:3072 sc1 lds
    s_add_u32 m0, s55, 32768
    v_mfma_f32_16x16x32_bf16 v[168:171], a[168:171], v[36:39], v[168:171]
    s_nop 0
    ds_read_b128 v[60:63], v14 offset:30720
    ds_read_b64_tr_b16 a[182:183], v13 offset:20480
    v_mfma_f32_16x16x32_bf16 v[172:175], a[172:175], v[36:39], v[172:175]
    s_xor_b32 s60, s52, 983040
    v_mfma_f32_16x16x32_bf16 v[176:179], a[168:171], v[40:43], v[176:179]
    s_nop 0
    ds_read_b128 v[96:99], v14 offset:19456
    ds_read_b64_tr_b16 a[184:185], v12 offset:24576
    v_mfma_f32_16x16x32_bf16 v[180:183], a[172:175], v[40:43], v[180:183]
    buffer_load_dwordx4 v4, s[4:7], s60 offen offset:0 lds
    v_mfma_f32_16x16x32_bf16 v[184:187], a[168:171], v[44:47], v[184:187]
    s_nop 0
    ds_read_b128 v[100:103], v14 offset:23552
    ds_read_b64_tr_b16 a[186:187], v12 offset:28672
    v_mfma_f32_16x16x32_bf16 v[188:191], a[172:175], v[44:47], v[188:191]
    s_waitcnt lgkmcnt(8)
    ds_read_b64_tr_b16 a[188:189], v13 offset:24576
    ds_read_b64_tr_b16 a[190:191], v13 offset:28672
    v_mfma_f32_16x16x32_bf16 v[160:163], a[176:179], v[48:51], v[160:163]
    s_lshr_b32 s15, s2, 4
    s_waitcnt lgkmcnt(6)
    ds_read_b128 v[104:107], v14 offset:27648
    v_mfma_f32_16x16x32_bf16 v[164:167], a[180:183], v[48:51], v[164:167]
    buffer_load_dwordx4 v5, s[4:7], s60 offen offset:1024 lds
    v_mfma_f32_16x16x32_bf16 v[168:171], a[176:179], v[52:55], v[168:171]
    s_mul_i32 s59, s3, 44032
    ds_read_b128 v[108:111], v14 offset:31744
    v_mfma_f32_16x16x32_bf16 v[172:175], a[180:183], v[52:55], v[172:175]
    s_mul_i32 s69, s15, 192
    s_add_u32 s59, s59, s69
    s_waitcnt lgkmcnt(2)
    s_waitcnt vmcnt(12)
    s_barrier
    v_mfma_f32_16x16x32_bf16 v[176:179], a[176:179], v[56:59], v[176:179]
    v_add_u32 v14, 0xfffe0000, v14
    ds_read_b128 v[32:35], v14 offset:49152
    v_add_u32 v12, 0x10000, v12
    v_mfma_f32_16x16x32_bf16 v[180:183], a[180:183], v[56:59], v[180:183]
    buffer_load_dwordx4 v6, s[4:7], s60 offen offset:2048 lds
    v_mfma_f32_16x16x32_bf16 v[184:187], a[176:179], v[60:63], v[184:187]
    ds_read_b128 v[36:39], v14 offset:53248
    v_add_u32 v13, 0x10000, v13
    v_mfma_f32_16x16x32_bf16 v[188:191], a[180:183], v[60:63], v[188:191]
    s_nop 0
    ds_read_b64_tr_b16 a[192:193], v12 offset:16384
    ds_read_b64_tr_b16 a[194:195], v12 offset:20480
    v_mfma_f32_16x16x32_bf16 v[160:163], a[184:187], v[96:99], v[160:163]
    s_nop 0
    ds_read_b128 v[40:43], v14 offset:57344
    ds_read_b64_tr_b16 a[196:197], v13 offset:16384
    v_mfma_f32_16x16x32_bf16 v[164:167], a[188:191], v[96:99], v[164:167]
    buffer_load_dwordx4 v7, s[4:7], s60 offen offset:3072 lds
    s_waitcnt vmcnt(13)
    v_cmp_gt_u32 vcc, 8, v28
    s_nop 1
    s_cbranch_vccnz main_spin40
main_back41:
    v_mfma_f32_16x16x32_bf16 v[168:171], a[184:187], v[100:103], v[168:171]
    s_nop 0
    ds_read_b128 v[44:47], v14 offset:61440
    ds_read_b64_tr_b16 a[198:199], v13 offset:20480
    v_mfma_f32_16x16x32_bf16 v[172:175], a[188:191], v[100:103], v[172:175]
    s_add_u32 m0, s55, 131072
    s_xor_b32 s60, s53, 8388608
    s_waitcnt lgkmcnt(9)
    v_mfma_f32_16x16x32_bf16 v[176:179], a[184:187], v[104:107], v[176:179]
    s_nop 0
    ds_read_b128 v[48:51], v14 offset:50176
    ds_read_b64_tr_b16 a[200:201], v12 offset:24576
    v_mfma_f32_16x16x32_bf16 v[180:183], a[188:191], v[104:107], v[180:183]
    s_waitcnt lgkmcnt(10)
    buffer_load_dwordx4 v2, s[36:39], s60 offen offset:0 sc1 lds
    v_mfma_f32_16x16x32_bf16 v[184:187], a[184:187], v[108:111], v[184:187]
    s_nop 0
    ds_read_b128 v[52:55], v14 offset:54272
    ds_read_b64_tr_b16 a[202:203], v12 offset:28672
    v_mfma_f32_16x16x32_bf16 v[188:191], a[188:191], v[108:111], v[188:191]
    s_waitcnt lgkmcnt(8)
    ds_read_b64_tr_b16 a[204:205], v13 offset:24576
    ds_read_b64_tr_b16 a[206:207], v13 offset:28672
    v_mfma_f32_16x16x32_bf16 v[160:163], a[192:195], v[32:35], v[160:163]
    s_waitcnt lgkmcnt(6)
    ds_read_b128 v[56:59], v14 offset:58368
    ds_read_b64_tr_b16 a[208:209], v12 offset:0
    v_mfma_f32_16x16x32_bf16 v[164:167], a[196:199], v[32:35], v[164:167]
    buffer_load_dwordx4 v2, s[36:39], s60 offen offset:1024 sc1 lds
    v_mfma_f32_16x16x32_bf16 v[168:171], a[192:195], v[36:39], v[168:171]
    s_nop 0
    ds_read_b128 v[60:63], v14 offset:62464
    ds_read_b64_tr_b16 a[210:211], v12 offset:4096
    v_mfma_f32_16x16x32_bf16 v[172:175], a[196:199], v[36:39], v[172:175]
    s_nop 0
    ds_read_b64_tr_b16 a[212:213], v13 offset:0
    ds_read_b64_tr_b16 a[214:215], v13 offset:4096
    v_mfma_f32_16x16x32_bf16 v[176:179], a[192:195], v[40:43], v[176:179]
    s_nop 0
    ds_read_b128 v[96:99], v14 offset:51200
    ds_read_b64_tr_b16 a[216:217], v12 offset:8192
    v_mfma_f32_16x16x32_bf16 v[180:183], a[196:199], v[40:43], v[180:183]
    buffer_load_dwordx4 v2, s[36:39], s60 offen offset:2048 sc1 lds
    v_mfma_f32_16x16x32_bf16 v[184:187], a[192:195], v[44:47], v[184:187]
    s_nop 0
    ds_read_b128 v[100:103], v14 offset:55296
    ds_read_b64_tr_b16 a[218:219], v12 offset:12288
    v_mfma_f32_16x16x32_bf16 v[188:191], a[196:199], v[44:47], v[188:191]
    s_waitcnt lgkmcnt(12)
    ds_read_b64_tr_b16 a[220:221], v13 offset:8192
    ds_read_b64_tr_b16 a[222:223], v13 offset:12288
    v_mfma_f32_16x16x32_bf16 v[160:163], a[200:203], v[48:51], v[160:163]
    s_waitcnt lgkmcnt(12)
    ds_read_b128 v[104:107], v14 offset:59392
    v_add_u32 v18, 0, v1
    v_mfma_f32_16x16x32_bf16 v[164:167], a[204:207], v[48:51], v[164:167]
    buffer_load_dwordx4 v2, s[36:39], s60 offen offset:3072 sc1 lds
    s_add_u32 m0, s55, 16384
    v_mfma_f32_16x16x32_bf16 v[168:171], a[200:203], v[52:55], v[168:171]
    ds_read_b128 v[108:111], v14 offset:63488
    v_mul_u32_u24 v19, 0xaaab, v18
    v_mfma_f32_16x16x32_bf16 v[172:175], a[204:207], v[52:55], v[172:175]
    s_xor_b32 s60, s53, 8392704
    s_waitcnt lgkmcnt(13)
    v_mfma_f32_16x16x32_bf16 v[176:179], a[200:203], v[56:59], v[176:179]
    ds_read_b128 v[32:35], v14 offset:52224
    v_lshrrev_b32 v19, 19, v19
    v_mfma_f32_16x16x32_bf16 v[180:183], a[204:207], v[56:59], v[180:183]
    s_waitcnt lgkmcnt(12)
    buffer_load_dwordx4 v2, s[36:39], s60 offen offset:0 sc1 lds
    v_mfma_f32_16x16x32_bf16 v[184:187], a[200:203], v[60:63], v[184:187]
    ds_read_b128 v[36:39], v14 offset:56320
    v_mul_u32_u24 v143, 12, v19
    v_mfma_f32_16x16x32_bf16 v[188:191], a[204:207], v[60:63], v[188:191]
    s_waitcnt lgkmcnt(9)
    v_sub_u32 v18, v18, v143
    v_bfe_u32 v143, v19, 2, 1
    v_mfma_f32_16x16x32_bf16 v[160:163], a[208:211], v[96:99], v[160:163]
    ds_read_b128 v[40:43], v14 offset:60416
    v_lshlrev_b32 v143, 1, v143
    v_mfma_f32_16x16x32_bf16 v[164:167], a[212:215], v[96:99], v[164:167]
    s_waitcnt lgkmcnt(8)
    buffer_load_dwordx4 v2, s[36:39], s60 offen offset:1024 sc1 lds
    v_mfma_f32_16x16x32_bf16 v[168:171], a[208:211], v[100:103], v[168:171]
    ds_read_b128 v[44:47], v14 offset:64512
    v_xor_b32 v18, v18, v143
    v_mfma_f32_16x16x32_bf16 v[172:175], a[212:215], v[100:103], v[172:175]
    v_mul_u32_u24 v19, 2752, v19
    v_lshl_add_u32 v18, v18, 4, v19
    s_waitcnt lgkmcnt(6)
    s_waitcnt vmcnt(6)
    s_barrier
    v_add_u32 v18, s59, v18
    v_subrev_u32 v140, 0, v18
    v_add_u32 v18, 64, v1
    v_mul_u32_u24 v19, 0xaaab, v18
    v_lshrrev_b32 v19, 19, v19
    v_mul_u32_u24 v143, 12, v19
    v_sub_u32 v18, v18, v143
    v_bfe_u32 v143, v19, 2, 1
    v_lshlrev_b32 v143, 1, v143
    v_xor_b32 v18, v18, v143
    v_mul_u32_u24 v19, 2752, v19
    v_lshl_add_u32 v18, v18, 4, v19
    v_add_u32 v18, s59, v18
    v_subrev_u32 v141, 1024, v18
    v_add_u32 v18, 128, v1
    v_mul_u32_u24 v19, 0xaaab, v18
    v_lshrrev_b32 v19, 19, v19
    v_mul_u32_u24 v143, 12, v19
    v_sub_u32 v18, v18, v143
    v_bfe_u32 v143, v19, 2, 1
    v_lshlrev_b32 v143, 1, v143
    v_xor_b32 v18, v18, v143
    v_mul_u32_u24 v19, 2752, v19
    v_lshl_add_u32 v18, v18, 4, v19
    v_add_u32 v18, s59, v18
    v_subrev_u32 v142, 2048, v18
    s_mul_i32 s68, s3, 3072
    s_cmp_lt_u32 s15, 15
    s_cselect_b32 s79, 0, 0x40000000
    s_and_b32 s64, s2, 31
    s_lshr_b32 s65, s2, 5
    s_mul_i32 s66, s3, 11
    v_lshrrev_b32 v19, 4, v1
    v_lshlrev_b32 v19, 1, v19
    v_and_b32 v18, 7, v1
    v_xor_b32 v18, v18, v19
    v_lshrrev_b32 v112, 3, v1
    v_lshlrev_b32 v112, 10, v112
    v_lshl_add_u32 v112, v18, 4, v112
    v_add_u32 v113, 7168, v112
    v_add_u32 v114, 14336, v112
    v_add_u32 v115, 21504, v112
    s_lshl_b32 s67, s66, 15
    s_lshl_b32 s59, s65, 7
    s_add_u32 s67, s67, s59
    v_lshrrev_b32 v18, 2, v1
    v_lshlrev_b32 v116, 7, v18
    v_bfe_u32 v18, v1, 3, 2
    v_lshl_add_u32 v116, v18, 5, v116
    v_and_b32 v18, 3, v1
    v_lshl_add_u32 v116, v18, 3, v116
    v_add_u32 v116, s55, v116
    v_xor_b32 v117, 32, v116
    v_xor_b32 v118, 64, v116
    v_xor_b32 v119, 96, v116
    s_add_u32 s80, s12, 0x4800000
    s_addc_u32 s81, s13, 0
    s_mov_b32 s82, 0x400000
    s_mov_b32 s83, 0x20000
    s_add_u32 s48, s12, 0x5000000
    s_addc_u32 s49, s13, 0
    s_mov_b32 s50, 0x200000
    s_mov_b32 s51, 0x20000
    s_waitcnt lgkmcnt(0)
    v_mfma_f32_16x16x32_bf16 v[176:179], a[208:211], v[104:107], v[176:179]
    v_add_u32 v14, 0x10000, v14
    ds_read_b128 v[48:51], v14 offset:49152
    ds_read_b64_tr_b16 a[224:225], v12 offset:32768
    v_mfma_f32_16x16x32_bf16 v[180:183], a[212:215], v[104:107], v[180:183]
    buffer_load_dwordx4 v2, s[36:39], s60 offen offset:2048 sc1 lds
    v_mfma_f32_16x16x32_bf16 v[184:187], a[208:211], v[108:111], v[184:187]
    s_nop 0
    ds_read_b128 v[52:55], v14 offset:53248
    ds_read_b64_tr_b16 a[226:227], v12 offset:36864
    v_mfma_f32_16x16x32_bf16 v[188:191], a[212:215], v[108:111], v[188:191]
    s_nop 0
    ds_read_b64_tr_b16 a[228:229], v13 offset:32768
    ds_read_b64_tr_b16 a[230:231], v13 offset:36864
    v_mfma_f32_16x16x32_bf16 v[160:163], a[216:219], v[32:35], v[160:163]
    s_nop 0
    ds_read_b128 v[56:59], v14 offset:57344
    ds_read_b64_tr_b16 a[232:233], v12 offset:40960
    v_mfma_f32_16x16x32_bf16 v[164:167], a[220:223], v[32:35], v[164:167]
    buffer_load_dwordx4 v2, s[36:39], s60 offen offset:3072 sc1 lds
    s_add_u32 m0, s55, 0
    v_mfma_f32_16x16x32_bf16 v[168:171], a[216:219], v[36:39], v[168:171]
    s_nop 0
    ds_read_b128 v[60:63], v14 offset:61440
    ds_read_b64_tr_b16 a[234:235], v12 offset:45056
    v_mfma_f32_16x16x32_bf16 v[172:175], a[220:223], v[36:39], v[172:175]
    s_xor_b32 s60, s53, 8396800
    v_mfma_f32_16x16x32_bf16 v[176:179], a[216:219], v[40:43], v[176:179]
    s_nop 0
    ds_read_b128 v[96:99], v14 offset:50176
    ds_read_b64_tr_b16 a[236:237], v13 offset:40960
    v_mfma_f32_16x16x32_bf16 v[180:183], a[220:223], v[40:43], v[180:183]
    buffer_load_dwordx4 v2, s[36:39], s60 offen offset:0 sc1 lds
    v_mfma_f32_16x16x32_bf16 v[184:187], a[216:219], v[44:47], v[184:187]
    s_nop 0
    ds_read_b128 v[100:103], v14 offset:54272
    ds_read_b64_tr_b16 a[238:239], v13 offset:45056
    v_mfma_f32_16x16x32_bf16 v[188:191], a[220:223], v[44:47], v[188:191]
    s_waitcnt lgkmcnt(10)
    v_add_u32 v12, 0xffff0000, v12
    v_add_u32 v13, 0xffff0000, v13
    v_mfma_f32_16x16x32_bf16 v[160:163], a[224:227], v[48:51], v[160:163]
    s_waitcnt lgkmcnt(8)
    ds_read_b128 v[104:107], v14 offset:58368
    ds_read_b64_tr_b16 a[240:241], v12 offset:32768
    v_mfma_f32_16x16x32_bf16 v[164:167], a[228:231], v[48:51], v[164:167]
    buffer_load_dwordx4 v2, s[36:39], s60 offen offset:1024 sc1 lds
    v_mfma_f32_16x16x32_bf16 v[168:171], a[224:227], v[52:55], v[168:171]
    s_nop 0
    ds_read_b128 v[108:111], v14 offset:62464
    ds_read_b64_tr_b16 a[242:243], v12 offset:36864
    v_mfma_f32_16x16x32_bf16 v[172:175], a[228:231], v[52:55], v[172:175]
    s_waitcnt lgkmcnt(11)
    ds_read_b64_tr_b16 a[244:245], v13 offset:32768
    ds_read_b64_tr_b16 a[246:247], v13 offset:36864
    v_mfma_f32_16x16x32_bf16 v[176:179], a[224:227], v[56:59], v[176:179]
    s_nop 0
    ds_read_b128 v[32:35], v14 offset:51200
    ds_read_b64_tr_b16 a[248:249], v12 offset:40960
    v_mfma_f32_16x16x32_bf16 v[180:183], a[228:231], v[56:59], v[180:183]
    s_waitcnt lgkmcnt(13)
    buffer_load_dwordx4 v2, s[36:39], s60 offen offset:2048 sc1 lds
    v_mfma_f32_16x16x32_bf16 v[184:187], a[224:227], v[60:63], v[184:187]
    s_nop 0
    ds_read_b128 v[36:39], v14 offset:55296
    ds_read_b64_tr_b16 a[250:251], v12 offset:45056
    v_mfma_f32_16x16x32_bf16 v[188:191], a[228:231], v[60:63], v[188:191]
    s_nop 0
    ds_read_b64_tr_b16 a[252:253], v13 offset:40960
    ds_read_b64_tr_b16 a[254:255], v13 offset:45056
    s_waitcnt lgkmcnt(15)
    v_mfma_f32_16x16x32_bf16 v[160:163], a[232:235], v[96:99], v[160:163]
    s_waitcnt lgkmcnt(12)
    ds_read_b128 v[40:43], v14 offset:59392
    v_mfma_f32_16x16x32_bf16 v[164:167], a[236:239], v[96:99], v[164:167]
    buffer_load_dwordx4 v2, s[36:39], s60 offen offset:3072 sc1 lds
    s_add_u32 m0, s55, 81920
    v_mfma_f32_16x16x32_bf16 v[168:171], a[232:235], v[100:103], v[168:171]
    ds_read_b128 v[44:47], v14 offset:63488
    v_mfma_f32_16x16x32_bf16 v[172:175], a[236:239], v[100:103], v[172:175]
    s_xor_b32 s60, s53, 8400896
    s_waitcnt lgkmcnt(13)
    v_mfma_f32_16x16x32_bf16 v[176:179], a[232:235], v[104:107], v[176:179]
    ds_read_b128 v[48:51], v14 offset:52224
    v_mfma_f32_16x16x32_bf16 v[180:183], a[236:239], v[104:107], v[180:183]
    s_waitcnt lgkmcnt(12)
    buffer_load_dwordx4 v2, s[36:39], s60 offen offset:0 sc1 lds
    v_mfma_f32_16x16x32_bf16 v[184:187], a[232:235], v[108:111], v[184:187]
    ds_read_b128 v[52:55], v14 offset:56320
    v_mfma_f32_16x16x32_bf16 v[188:191], a[236:239], v[108:111], v[188:191]
    s_waitcnt lgkmcnt(9)
    v_mfma_f32_16x16x32_bf16 v[160:163], a[240:243], v[32:35], v[160:163]
    ds_read_b128 v[56:59], v14 offset:60416
    v_mfma_f32_16x16x32_bf16 v[164:167], a[244:247], v[32:35], v[164:167]
    s_waitcnt lgkmcnt(8)
    buffer_load_dwordx4 v2, s[36:39], s60 offen offset:1024 sc1 lds
    v_mfma_f32_16x16x32_bf16 v[168:171], a[240:243], v[36:39], v[168:171]
    ds_read_b128 v[60:63], v14 offset:64512
    v_mfma_f32_16x16x32_bf16 v[172:175], a[244:247], v[36:39], v[172:175]
    s_waitcnt lgkmcnt(6)
    s_waitcnt vmcnt(10)
    s_barrier
    s_waitcnt lgkmcnt(5)
    v_mfma_f32_16x16x32_bf16 v[176:179], a[240:243], v[40:43], v[176:179]
    v_add_u32 v14, 0x10000, v14
    ds_read_b128 v[96:99], v14 offset:0
    v_mfma_f32_16x16x32_bf16 v[180:183], a[244:247], v[40:43], v[180:183]
    s_waitcnt lgkmcnt(5)
    buffer_load_dwordx4 v2, s[36:39], s60 offen offset:2048 sc1 lds
    v_mfma_f32_16x16x32_bf16 v[184:187], a[240:243], v[44:47], v[184:187]
    ds_read_b128 v[100:103], v14 offset:4096
    v_mfma_f32_16x16x32_bf16 v[188:191], a[244:247], v[44:47], v[188:191]
    s_waitcnt lgkmcnt(5)
    v_mfma_f32_16x16x32_bf16 v[160:163], a[248:251], v[48:51], v[160:163]
    ds_read_b128 v[104:107], v14 offset:8192
    v_mfma_f32_16x16x32_bf16 v[164:167], a[252:255], v[48:51], v[164:167]
    buffer_load_dwordx4 v2, s[36:39], s60 offen offset:3072 sc1 lds
    s_add_u32 m0, s55, 147456
    s_waitcnt lgkmcnt(5)
    v_mfma_f32_16x16x32_bf16 v[168:171], a[248:251], v[52:55], v[168:171]
    ds_read_b128 v[108:111], v14 offset:12288
    v_mfma_f32_16x16x32_bf16 v[172:175], a[252:255], v[52:55], v[172:175]
    s_xor_b32 s60, s53, 8404992
    s_waitcnt lgkmcnt(5)
    v_mfma_f32_16x16x32_bf16 v[176:179], a[248:251], v[56:59], v[176:179]
    ds_read_b128 v[32:35], v14 offset:1024
    v_mfma_f32_16x16x32_bf16 v[180:183], a[252:255], v[56:59], v[180:183]
    s_waitcnt lgkmcnt(5)
    buffer_load_dwordx4 v2, s[36:39], s60 offen offset:0 sc1 lds
    v_mfma_f32_16x16x32_bf16 v[184:187], a[248:251], v[60:63], v[184:187]
    ds_read_b128 v[36:39], v14 offset:5120
    v_mfma_f32_16x16x32_bf16 v[188:191], a[252:255], v[60:63], v[188:191]
    s_waitcnt lgkmcnt(5)
    v_mfma_f32_16x16x32_bf16 v[64:67], a[0:3], v[96:99], 0
    ds_read_b128 v[40:43], v14 offset:9216
    v_cmp_gt_u32 vcc, 64, v24
    v_mfma_f32_16x16x32_bf16 v[68:71], a[4:7], v[96:99], 0
    s_waitcnt lgkmcnt(5)
    buffer_load_dwordx4 v2, s[36:39], s60 offen offset:1024 sc1 lds
    v_mfma_f32_16x16x32_bf16 v[72:75], a[0:3], v[100:103], 0
    ds_read_b128 v[44:47], v14 offset:13312
    s_nop 1
    s_cbranch_vccnz main_spin42
main_back43:
    v_mfma_f32_16x16x32_bf16 v[76:79], a[4:7], v[100:103], 0
    s_waitcnt lgkmcnt(5)
    v_cvt_pk_bf16_f32 v160, v160, v161
    v_cvt_pk_bf16_f32 v161, v162, v163
    v_mfma_f32_16x16x32_bf16 v[80:83], a[0:3], v[104:107], 0
    ds_read_b128 v[48:51], v14 offset:2048
    v_cvt_pk_bf16_f32 v162, v164, v165
    v_mfma_f32_16x16x32_bf16 v[84:87], a[4:7], v[104:107], 0
    s_waitcnt lgkmcnt(5)
    buffer_load_dwordx4 v2, s[36:39], s60 offen offset:2048 sc1 lds
    v_mfma_f32_16x16x32_bf16 v[88:91], a[0:3], v[108:111], 0
    ds_read_b128 v[52:55], v14 offset:6144
    v_cvt_pk_bf16_f32 v163, v166, v167
    v_mfma_f32_16x16x32_bf16 v[92:95], a[4:7], v[108:111], 0
    s_add_u32 s63, s62, 0
    s_waitcnt lgkmcnt(5)
    buffer_store_dwordx4 v[160:163], v15, s[44:47], s63 offen sc1
    v_mfma_f32_16x16x32_bf16 v[64:67], a[8:11], v[32:35], v[64:67]
    ds_read_b128 v[56:59], v14 offset:10240
    v_cvt_pk_bf16_f32 v168, v168, v169
    v_mfma_f32_16x16x32_bf16 v[68:71], a[12:15], v[32:35], v[68:71]
    buffer_load_dwordx4 v2, s[36:39], s60 offen offset:3072 sc1 lds
    s_add_u32 m0, s55, 98304
    s_waitcnt lgkmcnt(5)
    v_mfma_f32_16x16x32_bf16 v[72:75], a[8:11], v[36:39], v[72:75]
    ds_read_b128 v[60:63], v14 offset:14336
    v_cvt_pk_bf16_f32 v169, v170, v171
    v_mfma_f32_16x16x32_bf16 v[76:79], a[12:15], v[36:39], v[76:79]
    s_xor_b32 s60, s53, 8409088
    s_waitcnt lgkmcnt(5)
    v_mfma_f32_16x16x32_bf16 v[80:83], a[8:11], v[40:43], v[80:83]
    ds_read_b128 v[96:99], v14 offset:3072
    v_cvt_pk_bf16_f32 v170, v172, v173
    v_mfma_f32_16x16x32_bf16 v[84:87], a[12:15], v[40:43], v[84:87]
    s_waitcnt lgkmcnt(5)
    buffer_load_dwordx4 v2, s[36:39], s60 offen offset:0 sc1 lds
    v_mfma_f32_16x16x32_bf16 v[88:91], a[8:11], v[44:47], v[88:91]
    ds_read_b128 v[100:103], v14 offset:7168
    v_cvt_pk_bf16_f32 v171, v174, v175
    v_mfma_f32_16x16x32_bf16 v[92:95], a[12:15], v[44:47], v[92:95]
    s_add_u32 s63, s62, 16384
    s_waitcnt lgkmcnt(5)
    buffer_store_dwordx4 v[168:171], v15, s[44:47], s63 offen sc1
    v_mfma_f32_16x16x32_bf16 v[64:67], a[16:19], v[48:51], v[64:67]
    ds_read_b128 v[104:107], v14 offset:11264
    v_cvt_pk_bf16_f32 v176, v176, v177
    v_mfma_f32_16x16x32_bf16 v[68:71], a[20:23], v[48:51], v[68:71]
    s_waitcnt lgkmcnt(5)
    buffer_load_dwordx4 v2, s[36:39], s60 offen offset:1024 sc1 lds
    v_mfma_f32_16x16x32_bf16 v[72:75], a[16:19], v[52:55], v[72:75]
    ds_read_b128 v[108:111], v14 offset:15360
    v_cvt_pk_bf16_f32 v177, v178, v179
    v_mfma_f32_16x16x32_bf16 v[76:79], a[20:23], v[52:55], v[76:79]
    s_waitcnt vmcnt(16)
    v_cvt_pk_bf16_f32 v178, v180, v181
    v_cvt_pk_bf16_f32 v179, v182, v183
    s_barrier
    s_waitcnt lgkmcnt(5)
    v_mfma_f32_16x16x32_bf16 v[80:83], a[16:19], v[56:59], v[80:83]
    s_add_u32 s63, s62, 32768
    v_add_u32 v14, 0xfffe0000, v14
    ds_read_b128 v[32:35], v14 offset:16384
    v_mfma_f32_16x16x32_bf16 v[84:87], a[20:23], v[56:59], v[84:87]
    s_waitcnt lgkmcnt(5)
    buffer_load_dwordx4 v2, s[36:39], s60 offen offset:2048 sc1 lds
    v_mfma_f32_16x16x32_bf16 v[88:91], a[16:19], v[60:63], v[88:91]
    ds_read_b128 v[36:39], v14 offset:20480
    buffer_store_dwordx4 v[176:179], v15, s[44:47], s63 offen sc1
    v_mfma_f32_16x16x32_bf16 v[92:95], a[20:23], v[60:63], v[92:95]
    s_waitcnt lgkmcnt(5)
    v_cvt_pk_bf16_f32 v184, v184, v185
    v_cvt_pk_bf16_f32 v185, v186, v187
    v_mfma_f32_16x16x32_bf16 v[64:67], a[24:27], v[96:99], v[64:67]
    ds_read_b128 v[40:43], v14 offset:24576
    v_cvt_pk_bf16_f32 v186, v188, v189
    v_mfma_f32_16x16x32_bf16 v[68:71], a[28:31], v[96:99], v[68:71]
    buffer_load_dwordx4 v2, s[36:39], s60 offen offset:3072 sc1 lds
    s_add_u32 m0, s68, 36864
    s_waitcnt lgkmcnt(5)
    v_mfma_f32_16x16x32_bf16 v[72:75], a[24:27], v[100:103], v[72:75]
    ds_read_b128 v[44:47], v14 offset:28672
    v_cvt_pk_bf16_f32 v187, v190, v191
    v_mfma_f32_16x16x32_bf16 v[76:79], a[28:31], v[100:103], v[76:79]
    s_add_u32 s60, s79, 528384
    s_waitcnt lgkmcnt(5)
    v_mfma_f32_16x16x32_bf16 v[80:83], a[24:27], v[104:107], v[80:83]
    s_add_u32 s63, s62, 49152
    ds_read_b128 v[48:51], v14 offset:17408
    v_mfma_f32_16x16x32_bf16 v[84:87], a[28:31], v[104:107], v[84:87]
    s_waitcnt lgkmcnt(5)
    buffer_load_dwordx4 v140, s[8:11], s60 offen offset:0 lds
    v_mfma_f32_16x16x32_bf16 v[88:91], a[24:27], v[108:111], v[88:91]
    ds_read_b128 v[52:55], v14 offset:21504
    buffer_store_dwordx4 v[184:187], v15, s[44:47], s63 offen sc1
    v_mfma_f32_16x16x32_bf16 v[92:95], a[28:31], v[108:111], v[92:95]
    s_waitcnt lgkmcnt(5)
    v_mfma_f32_16x16x32_bf16 v[64:67], a[32:35], v[32:35], v[64:67]
    ds_read_b128 v[56:59], v14 offset:25600
    v_mfma_f32_16x16x32_bf16 v[68:71], a[36:39], v[32:35], v[68:71]
    s_waitcnt lgkmcnt(5)
    buffer_load_dwordx4 v141, s[8:11], s60 offen offset:1024 lds
    v_mfma_f32_16x16x32_bf16 v[72:75], a[32:35], v[36:39], v[72:75]
    ds_read_b128 v[60:63], v14 offset:29696
    v_mfma_f32_16x16x32_bf16 v[76:79], a[36:39], v[36:39], v[76:79]
    s_waitcnt lgkmcnt(5)
    v_mfma_f32_16x16x32_bf16 v[80:83], a[32:35], v[40:43], v[80:83]
    ds_read_b128 v[96:99], v14 offset:18432
    v_mfma_f32_16x16x32_bf16 v[84:87], a[36:39], v[40:43], v[84:87]
    buffer_load_dwordx4 v142, s[8:11], s60 offen offset:2048 lds
    s_add_u32 m0, s68, 49152
    s_waitcnt lgkmcnt(5)
    v_mfma_f32_16x16x32_bf16 v[88:91], a[32:35], v[44:47], v[88:91]
    ds_read_b128 v[100:103], v14 offset:22528
    v_mfma_f32_16x16x32_bf16 v[92:95], a[36:39], v[44:47], v[92:95]
    s_add_u32 s60, s79, 704512
    s_waitcnt lgkmcnt(5)
    v_mfma_f32_16x16x32_bf16 v[64:67], a[40:43], v[48:51], v[64:67]
    ds_read_b128 v[104:107], v14 offset:26624
    v_mfma_f32_16x16x32_bf16 v[68:71], a[44:47], v[48:51], v[68:71]
    s_waitcnt lgkmcnt(5)
    buffer_load_dwordx4 v140, s[8:11], s60 offen offset:0 lds
    v_mfma_f32_16x16x32_bf16 v[72:75], a[40:43], v[52:55], v[72:75]
    ds_read_b128 v[108:111], v14 offset:30720
    v_mfma_f32_16x16x32_bf16 v[76:79], a[44:47], v[52:55], v[76:79]
    s_waitcnt lgkmcnt(5)
    v_mfma_f32_16x16x32_bf16 v[80:83], a[40:43], v[56:59], v[80:83]
    ds_read_b128 v[32:35], v14 offset:19456
    v_mfma_f32_16x16x32_bf16 v[84:87], a[44:47], v[56:59], v[84:87]
    s_waitcnt lgkmcnt(5)
    buffer_load_dwordx4 v141, s[8:11], s60 offen offset:1024 lds
    v_mfma_f32_16x16x32_bf16 v[88:91], a[40:43], v[60:63], v[88:91]
    ds_read_b128 v[36:39], v14 offset:23552
    v_mfma_f32_16x16x32_bf16 v[92:95], a[44:47], v[60:63], v[92:95]
    s_waitcnt lgkmcnt(5)
    v_mfma_f32_16x16x32_bf16 v[64:67], a[48:51], v[96:99], v[64:67]
    ds_read_b128 v[40:43], v14 offset:27648
    v_mfma_f32_16x16x32_bf16 v[68:71], a[52:55], v[96:99], v[68:71]
    buffer_load_dwordx4 v142, s[8:11], s60 offen offset:2048 lds
    s_add_u32 m0, s68, 61440
    s_waitcnt lgkmcnt(5)
    v_mfma_f32_16x16x32_bf16 v[72:75], a[48:51], v[100:103], v[72:75]
    ds_read_b128 v[44:47], v14 offset:31744
    v_mfma_f32_16x16x32_bf16 v[76:79], a[52:55], v[100:103], v[76:79]
    s_add_u32 s60, s79, 880640
    s_waitcnt vmcnt(22)
    s_barrier
    s_waitcnt lgkmcnt(5)
    v_mfma_f32_16x16x32_bf16 v[80:83], a[48:51], v[104:107], v[80:83]
    ds_read_b128 v[48:51], v14 offset:0
    v_mfma_f32_16x16x32_bf16 v[84:87], a[52:55], v[104:107], v[84:87]
    s_waitcnt lgkmcnt(5)
    buffer_load_dwordx4 v140, s[8:11], s60 offen offset:0 lds
    v_mfma_f32_16x16x32_bf16 v[88:91], a[48:51], v[108:111], v[88:91]
    ds_read_b128 v[52:55], v14 offset:4096
    v_mfma_f32_16x16x32_bf16 v[92:95], a[52:55], v[108:111], v[92:95]
    s_waitcnt lgkmcnt(5)
    v_mfma_f32_16x16x32_bf16 v[64:67], a[56:59], v[32:35], v[64:67]
    ds_read_b128 v[56:59], v14 offset:8192
    v_mfma_f32_16x16x32_bf16 v[68:71], a[60:63], v[32:35], v[68:71]
    s_waitcnt lgkmcnt(5)
    buffer_load_dwordx4 v141, s[8:11], s60 offen offset:1024 lds
    v_mfma_f32_16x16x32_bf16 v[72:75], a[56:59], v[36:39], v[72:75]
    ds_read_b128 v[60:63], v14 offset:12288
    v_mfma_f32_16x16x32_bf16 v[76:79], a[60:63], v[36:39], v[76:79]
    s_waitcnt lgkmcnt(5)
    v_mfma_f32_16x16x32_bf16 v[80:83], a[56:59], v[40:43], v[80:83]
    ds_read_b128 v[96:99], v14 offset:1024
    v_mfma_f32_16x16x32_bf16 v[84:87], a[60:63], v[40:43], v[84:87]
    buffer_load_dwordx4 v142, s[8:11], s60 offen offset:2048 lds
    s_add_u32 m0, s55, 114688
    s_waitcnt lgkmcnt(5)
    v_mfma_f32_16x16x32_bf16 v[88:91], a[56:59], v[44:47], v[88:91]
    ds_read_b128 v[100:103], v14 offset:5120
    v_mfma_f32_16x16x32_bf16 v[92:95], a[60:63], v[44:47], v[92:95]
    s_xor_b32 s60, s53, 8413184
    s_waitcnt lgkmcnt(5)
    v_mfma_f32_16x16x32_bf16 v[64:67], a[64:67], v[48:51], v[64:67]
    ds_read_b128 v[104:107], v14 offset:9216
    v_mfma_f32_16x16x32_bf16 v[68:71], a[68:71], v[48:51], v[68:71]
    s_waitcnt lgkmcnt(5)
    buffer_load_dwordx4 v2, s[36:39], s60 offen offset:0 sc1 lds
    v_mfma_f32_16x16x32_bf16 v[72:75], a[64:67], v[52:55], v[72:75]
    ds_read_b128 v[108:111], v14 offset:13312
    v_mfma_f32_16x16x32_bf16 v[76:79], a[68:71], v[52:55], v[76:79]
    s_waitcnt lgkmcnt(5)
    v_mfma_f32_16x16x32_bf16 v[80:83], a[64:67], v[56:59], v[80:83]
    ds_read_b128 v[32:35], v14 offset:2048
    v_mfma_f32_16x16x32_bf16 v[84:87], a[68:71], v[56:59], v[84:87]
    s_waitcnt lgkmcnt(5)
    buffer_load_dwordx4 v2, s[36:39], s60 offen offset:1024 sc1 lds
    v_mfma_f32_16x16x32_bf16 v[88:91], a[64:67], v[60:63], v[88:91]
    ds_read_b128 v[36:39], v14 offset:6144
    v_mfma_f32_16x16x32_bf16 v[92:95], a[68:71], v[60:63], v[92:95]
    s_waitcnt lgkmcnt(5)
    v_mfma_f32_16x16x32_bf16 v[64:67], a[72:75], v[96:99], v[64:67]
    ds_read_b128 v[40:43], v14 offset:10240
    v_mfma_f32_16x16x32_bf16 v[68:71], a[76:79], v[96:99], v[68:71]
    s_waitcnt lgkmcnt(5)
    buffer_load_dwordx4 v2, s[36:39], s60 offen offset:2048 sc1 lds
    v_mfma_f32_16x16x32_bf16 v[72:75], a[72:75], v[100:103], v[72:75]
    ds_read_b128 v[44:47], v14 offset:14336
    v_mfma_f32_16x16x32_bf16 v[76:79], a[76:79], v[100:103], v[76:79]
    s_waitcnt lgkmcnt(5)
    v_mfma_f32_16x16x32_bf16 v[80:83], a[72:75], v[104:107], v[80:83]
    ds_read_b128 v[48:51], v14 offset:3072
    v_mfma_f32_16x16x32_bf16 v[84:87], a[76:79], v[104:107], v[84:87]
    s_add_u32 s61, s21, 0x100000
    s_waitcnt lgkmcnt(5)
    buffer_load_dwordx4 v2, s[36:39], s60 offen offset:3072 sc1 lds
    v_mfma_f32_16x16x32_bf16 v[88:91], a[72:75], v[108:111], v[88:91]
    ds_read_b128 v[52:55], v14 offset:7168
    v_mfma_f32_16x16x32_bf16 v[92:95], a[76:79], v[108:111], v[92:95]
    s_waitcnt lgkmcnt(5)
    v_mfma_f32_16x16x32_bf16 v[64:67], a[80:83], v[32:35], v[64:67]
    ds_read_b128 v[56:59], v14 offset:11264
    v_mfma_f32_16x16x32_bf16 v[68:71], a[84:87], v[32:35], v[68:71]
    s_waitcnt lgkmcnt(5)
    buffer_load_dwordx2 v[128:129], v21, s[24:27], s21 offen offset:0
    v_mfma_f32_16x16x32_bf16 v[72:75], a[80:83], v[36:39], v[72:75]
    ds_read_b128 v[60:63], v14 offset:15360
    v_mfma_f32_16x16x32_bf16 v[76:79], a[84:87], v[36:39], v[76:79]
    s_waitcnt vmcnt(26)
    s_barrier
    s_waitcnt lgkmcnt(5)
    v_mfma_f32_16x16x32_bf16 v[80:83], a[80:83], v[40:43], v[80:83]
    v_add_u32 v14, 0x10000, v14
    ds_read_b128 v[96:99], v14 offset:16384
    v_mfma_f32_16x16x32_bf16 v[84:87], a[84:87], v[40:43], v[84:87]
    s_waitcnt lgkmcnt(5)
    buffer_load_dwordx2 v[130:131], v21, s[24:27], s21 offen offset:32
    v_mfma_f32_16x16x32_bf16 v[88:91], a[80:83], v[44:47], v[88:91]
    ds_read_b128 v[100:103], v14 offset:20480
    v_mfma_f32_16x16x32_bf16 v[92:95], a[84:87], v[44:47], v[92:95]
    s_waitcnt lgkmcnt(5)
    v_mfma_f32_16x16x32_bf16 v[64:67], a[88:91], v[48:51], v[64:67]
    ds_read_b128 v[104:107], v14 offset:24576
    v_mfma_f32_16x16x32_bf16 v[68:71], a[92:95], v[48:51], v[68:71]
    s_waitcnt lgkmcnt(5)
    buffer_load_dwordx2 v[132:133], v21, s[24:27], s61 offen offset:0
    v_mfma_f32_16x16x32_bf16 v[72:75], a[88:91], v[52:55], v[72:75]
    ds_read_b128 v[108:111], v14 offset:28672
    v_mfma_f32_16x16x32_bf16 v[76:79], a[92:95], v[52:55], v[76:79]
    s_waitcnt lgkmcnt(5)
    v_mfma_f32_16x16x32_bf16 v[80:83], a[88:91], v[56:59], v[80:83]
    ds_read_b128 v[32:35], v14 offset:17408
    v_mfma_f32_16x16x32_bf16 v[84:87], a[92:95], v[56:59], v[84:87]
    buffer_load_dwordx2 v[134:135], v21, s[24:27], s61 offen offset:32
    s_add_u32 s61, s22, 4096
    s_waitcnt lgkmcnt(5)
    v_mfma_f32_16x16x32_bf16 v[88:91], a[88:91], v[60:63], v[88:91]
    ds_read_b128 v[36:39], v14 offset:21504
    v_mfma_f32_16x16x32_bf16 v[92:95], a[92:95], v[60:63], v[92:95]
    s_waitcnt lgkmcnt(5)
    v_mfma_f32_16x16x32_bf16 v[64:67], a[96:99], v[96:99], v[64:67]
    ds_read_b128 v[40:43], v14 offset:25600
    v_mfma_f32_16x16x32_bf16 v[68:71], a[100:103], v[96:99], v[68:71]
    s_waitcnt lgkmcnt(5)
    buffer_load_dwordx4 v[192:195], v22, s[84:87], s61 offen offset:0 sc1
    v_mfma_f32_16x16x32_bf16 v[72:75], a[96:99], v[100:103], v[72:75]
    ds_read_b128 v[44:47], v14 offset:29696
    v_mfma_f32_16x16x32_bf16 v[76:79], a[100:103], v[100:103], v[76:79]
    s_waitcnt lgkmcnt(5)
    v_mfma_f32_16x16x32_bf16 v[80:83], a[96:99], v[104:107], v[80:83]
    ds_read_b128 v[48:51], v14 offset:18432
    v_mfma_f32_16x16x32_bf16 v[84:87], a[100:103], v[104:107], v[84:87]
    buffer_load_dwordx4 v[196:199], v22, s[84:87], s61 offen offset:64 sc1
    s_add_u32 s61, s22, 6144
    s_waitcnt lgkmcnt(5)
    v_mfma_f32_16x16x32_bf16 v[88:91], a[96:99], v[108:111], v[88:91]
    ds_read_b128 v[52:55], v14 offset:22528
    v_mfma_f32_16x16x32_bf16 v[92:95], a[100:103], v[108:111], v[92:95]
    s_waitcnt lgkmcnt(5)
    v_mfma_f32_16x16x32_bf16 v[64:67], a[104:107], v[32:35], v[64:67]
    ds_read_b128 v[56:59], v14 offset:26624
    v_mfma_f32_16x16x32_bf16 v[68:71], a[108:111], v[32:35], v[68:71]
    s_waitcnt lgkmcnt(5)
    buffer_load_dwordx4 v[200:203], v22, s[84:87], s61 offen offset:0 sc1
    v_mfma_f32_16x16x32_bf16 v[72:75], a[104:107], v[36:39], v[72:75]
    ds_read_b128 v[60:63], v14 offset:30720
    v_mfma_f32_16x16x32_bf16 v[76:79], a[108:111], v[36:39], v[76:79]
    s_waitcnt lgkmcnt(5)
    v_mfma_f32_16x16x32_bf16 v[80:83], a[104:107], v[40:43], v[80:83]
    ds_read_b128 v[96:99], v14 offset:19456
    v_mfma_f32_16x16x32_bf16 v[84:87], a[108:111], v[40:43], v[84:87]
    buffer_load_dwordx4 v[204:207], v22, s[84:87], s61 offen offset:64 sc1
    s_add_u32 s61, s22, 8192
    s_waitcnt lgkmcnt(5)
    v_mfma_f32_16x16x32_bf16 v[88:91], a[104:107], v[44:47], v[88:91]
    ds_read_b128 v[100:103], v14 offset:23552
    v_mfma_f32_16x16x32_bf16 v[92:95], a[108:111], v[44:47], v[92:95]
    s_waitcnt lgkmcnt(5)
    v_mfma_f32_16x16x32_bf16 v[64:67], a[112:115], v[48:51], v[64:67]
    ds_read_b128 v[104:107], v14 offset:27648
    v_mfma_f32_16x16x32_bf16 v[68:71], a[116:119], v[48:51], v[68:71]
    s_waitcnt lgkmcnt(5)
    buffer_load_dwordx4 v[208:211], v22, s[84:87], s61 offen offset:0 sc1
    v_mfma_f32_16x16x32_bf16 v[72:75], a[112:115], v[52:55], v[72:75]
    ds_read_b128 v[108:111], v14 offset:31744
    v_mfma_f32_16x16x32_bf16 v[76:79], a[116:119], v[52:55], v[76:79]
    s_waitcnt vmcnt(29)
    s_waitcnt vmcnt(21)
    s_barrier
    s_cmp_lg_u32 s3, 0
    s_cbranch_scc1 main_skip44
    v_mov_b32 v3, 1
    s_mov_b64 exec, 1
    buffer_atomic_add v3, off, s[84:87], s77 sc1
    s_mov_b64 exec, -1
main_skip44:
    s_waitcnt lgkmcnt(5)
    v_mfma_f32_16x16x32_bf16 v[80:83], a[112:115], v[56:59], v[80:83]
    v_add_u32 v14, 0x10000, v14
    ds_read_b128 v[32:35], v14 offset:16384
    v_mfma_f32_16x16x32_bf16 v[84:87], a[116:119], v[56:59], v[84:87]
    s_add_u32 m0, s55, 131072
    s_waitcnt lgkmcnt(5)
    buffer_load_dwordx4 v[212:215], v22, s[84:87], s61 offen offset:64 sc1
    v_mfma_f32_16x16x32_bf16 v[88:91], a[112:115], v[60:63], v[88:91]
    ds_read_b128 v[36:39], v14 offset:20480
    v_mfma_f32_16x16x32_bf16 v[92:95], a[116:119], v[60:63], v[92:95]
    s_xor_b32 s60, s53, 8417280
    s_waitcnt lgkmcnt(5)
    v_mfma_f32_16x16x32_bf16 v[64:67], a[120:123], v[96:99], v[64:67]
    ds_read_b128 v[40:43], v14 offset:24576
    v_mfma_f32_16x16x32_bf16 v[68:71], a[124:127], v[96:99], v[68:71]
    s_waitcnt lgkmcnt(5)
    buffer_load_dwordx4 v2, s[36:39], s60 offen offset:0 sc1 lds
    v_mfma_f32_16x16x32_bf16 v[72:75], a[120:123], v[100:103], v[72:75]
    ds_read_b128 v[44:47], v14 offset:28672
    v_mfma_f32_16x16x32_bf16 v[76:79], a[124:127], v[100:103], v[76:79]
    s_waitcnt lgkmcnt(5)
    v_mfma_f32_16x16x32_bf16 v[80:83], a[120:123], v[104:107], v[80:83]
    ds_read_b128 v[48:51], v14 offset:17408
    v_mfma_f32_16x16x32_bf16 v[84:87], a[124:127], v[104:107], v[84:87]
    s_waitcnt lgkmcnt(5)
    buffer_load_dwordx4 v2, s[36:39], s60 offen offset:1024 sc1 lds
    v_mfma_f32_16x16x32_bf16 v[88:91], a[120:123], v[108:111], v[88:91]
    ds_read_b128 v[52:55], v14 offset:21504
    v_mfma_f32_16x16x32_bf16 v[92:95], a[124:127], v[108:111], v[92:95]
    s_waitcnt lgkmcnt(5)
    v_mfma_f32_16x16x32_bf16 v[64:67], a[128:131], v[32:35], v[64:67]
    ds_read_b128 v[56:59], v14 offset:25600
    v_mfma_f32_16x16x32_bf16 v[68:71], a[132:135], v[32:35], v[68:71]
    s_waitcnt lgkmcnt(5)
    buffer_load_dwordx4 v2, s[36:39], s60 offen offset:2048 sc1 lds
    v_mfma_f32_16x16x32_bf16 v[72:75], a[128:131], v[36:39], v[72:75]
    ds_read_b128 v[60:63], v14 offset:29696
    v_mfma_f32_16x16x32_bf16 v[76:79], a[132:135], v[36:39], v[76:79]
    s_waitcnt lgkmcnt(5)
    v_mfma_f32_16x16x32_bf16 v[80:83], a[128:131], v[40:43], v[80:83]
    ds_read_b128 v[96:99], v14 offset:18432
    v_mfma_f32_16x16x32_bf16 v[84:87], a[132:135], v[40:43], v[84:87]
    buffer_load_dwordx4 v2, s[36:39], s60 offen offset:3072 sc1 lds
    s_add_u32 m0, s68, 24576
    s_waitcnt lgkmcnt(5)
    v_mfma_f32_16x16x32_bf16 v[88:91], a[128:131], v[44:47], v[88:91]
    ds_read_b128 v[100:103], v14 offset:22528
    v_mfma_f32_16x16x32_bf16 v[92:95], a[132:135], v[44:47], v[92:95]
    s_add_u32 s60, s79, 352256
    s_waitcnt lgkmcnt(5)
    v_mfma_f32_16x16x32_bf16 v[64:67], a[136:139], v[48:51], v[64:67]
    ds_read_b128 v[104:107], v14 offset:26624
    v_mfma_f32_16x16x32_bf16 v[68:71], a[140:143], v[48:51], v[68:71]
    s_waitcnt lgkmcnt(5)
    buffer_load_dwordx4 v140, s[8:11], s60 offen offset:0 lds
    v_mfma_f32_16x16x32_bf16 v[72:75], a[136:139], v[52:55], v[72:75]
    ds_read_b128 v[108:111], v14 offset:30720
    v_mfma_f32_16x16x32_bf16 v[76:79], a[140:143], v[52:55], v[76:79]
    s_waitcnt lgkmcnt(5)
    v_mfma_f32_16x16x32_bf16 v[80:83], a[136:139], v[56:59], v[80:83]
    ds_read_b128 v[32:35], v14 offset:19456
    v_mfma_f32_16x16x32_bf16 v[84:87], a[140:143], v[56:59], v[84:87]
    s_waitcnt lgkmcnt(5)
    buffer_load_dwordx4 v141, s[8:11], s60 offen offset:1024 lds
    v_mfma_f32_16x16x32_bf16 v[88:91], a[136:139], v[60:63], v[88:91]
    ds_read_b128 v[36:39], v14 offset:23552
    v_mfma_f32_16x16x32_bf16 v[92:95], a[140:143], v[60:63], v[92:95]
    s_waitcnt lgkmcnt(5)
    v_mfma_f32_16x16x32_bf16 v[64:67], a[144:147], v[96:99], v[64:67]
    ds_read_b128 v[40:43], v14 offset:27648
    v_mfma_f32_16x16x32_bf16 v[68:71], a[148:151], v[96:99], v[68:71]
    buffer_load_dwordx4 v142, s[8:11], s60 offen offset:2048 lds
    s_add_u32 m0, s68, 0
    s_waitcnt lgkmcnt(5)
    v_mfma_f32_16x16x32_bf16 v[72:75], a[144:147], v[100:103], v[72:75]
    ds_read_b128 v[44:47], v14 offset:31744
    v_mfma_f32_16x16x32_bf16 v[76:79], a[148:151], v[100:103], v[76:79]
    s_add_u32 s60, s79, 0
    s_barrier
    s_waitcnt lgkmcnt(5)
    v_mfma_f32_16x16x32_bf16 v[80:83], a[144:147], v[104:107], v[80:83]
    v_add_u32 v14, 0xffff0000, v14
    ds_read_b128 v[48:51], v14 offset:32768
    v_mfma_f32_16x16x32_bf16 v[84:87], a[148:151], v[104:107], v[84:87]
    s_waitcnt lgkmcnt(5)
    buffer_load_dwordx4 v140, s[8:11], s60 offen offset:0 lds
    v_mfma_f32_16x16x32_bf16 v[88:91], a[144:147], v[108:111], v[88:91]
    ds_read_b128 v[52:55], v14 offset:36864
    v_mfma_f32_16x16x32_bf16 v[92:95], a[148:151], v[108:111], v[92:95]
    s_waitcnt lgkmcnt(5)
    v_mfma_f32_16x16x32_bf16 v[64:67], a[152:155], v[32:35], v[64:67]
    ds_read_b128 v[56:59], v14 offset:40960
    v_mfma_f32_16x16x32_bf16 v[68:71], a[156:159], v[32:35], v[68:71]
    s_waitcnt lgkmcnt(5)
    buffer_load_dwordx4 v141, s[8:11], s60 offen offset:1024 lds
    v_mfma_f32_16x16x32_bf16 v[72:75], a[152:155], v[36:39], v[72:75]
    ds_read_b128 v[60:63], v14 offset:45056
    v_mfma_f32_16x16x32_bf16 v[76:79], a[156:159], v[36:39], v[76:79]
    s_waitcnt lgkmcnt(5)
    v_mfma_f32_16x16x32_bf16 v[80:83], a[152:155], v[40:43], v[80:83]
    ds_read_b128 v[96:99], v14 offset:33792
    v_mfma_f32_16x16x32_bf16 v[84:87], a[156:159], v[40:43], v[84:87]
    buffer_load_dwordx4 v142, s[8:11], s60 offen offset:2048 lds
    s_add_u32 m0, s68, 12288
    s_waitcnt lgkmcnt(5)
    v_mfma_f32_16x16x32_bf16 v[88:91], a[152:155], v[44:47], v[88:91]
    ds_read_b128 v[100:103], v14 offset:37888
    v_mfma_f32_16x16x32_bf16 v[92:95], a[156:159], v[44:47], v[92:95]
    s_add_u32 s60, s79, 176128
    s_waitcnt lgkmcnt(5)
    v_mfma_f32_16x16x32_bf16 v[64:67], a[160:163], v[48:51], v[64:67]
    ds_read_b128 v[104:107], v14 offset:41984
    v_mfma_f32_16x16x32_bf16 v[68:71], a[164:167], v[48:51], v[68:71]
    s_waitcnt lgkmcnt(5)
    buffer_load_dwordx4 v140, s[8:11], s60 offen offset:0 lds
    v_mfma_f32_16x16x32_bf16 v[72:75], a[160:163], v[52:55], v[72:75]
    ds_read_b128 v[108:111], v14 offset:46080
    v_mfma_f32_16x16x32_bf16 v[76:79], a[164:167], v[52:55], v[76:79]
    s_waitcnt lgkmcnt(5)
    v_mfma_f32_16x16x32_bf16 v[80:83], a[160:163], v[56:59], v[80:83]
    ds_read_b128 v[32:35], v14 offset:34816
    v_mfma_f32_16x16x32_bf16 v[84:87], a[164:167], v[56:59], v[84:87]
    s_waitcnt lgkmcnt(5)
    buffer_load_dwordx4 v141, s[8:11], s60 offen offset:1024 lds
    v_mfma_f32_16x16x32_bf16 v[88:91], a[160:163], v[60:63], v[88:91]
    ds_read_b128 v[36:39], v14 offset:38912
    v_mfma_f32_16x16x32_bf16 v[92:95], a[164:167], v[60:63], v[92:95]
    s_waitcnt lgkmcnt(5)
    v_mfma_f32_16x16x32_bf16 v[64:67], a[168:171], v[96:99], v[64:67]
    ds_read_b128 v[40:43], v14 offset:43008
    v_mfma_f32_16x16x32_bf16 v[68:71], a[172:175], v[96:99], v[68:71]
    buffer_load_dwordx4 v142, s[8:11], s60 offen offset:2048 lds
    s_add_u32 m0, s68, 73728
    s_waitcnt lgkmcnt(5)
    v_mfma_f32_16x16x32_bf16 v[72:75], a[168:171], v[100:103], v[72:75]
    ds_read_b128 v[44:47], v14 offset:47104
    v_mfma_f32_16x16x32_bf16 v[76:79], a[172:175], v[100:103], v[76:79]
    s_add_u32 s60, s79, 1056768
    s_waitcnt lgkmcnt(5)
    v_mfma_f32_16x16x32_bf16 v[80:83], a[168:171], v[104:107], v[80:83]
    ds_read_b128 v[48:51], v14 offset:35840
    v_mfma_f32_16x16x32_bf16 v[84:87], a[172:175], v[104:107], v[84:87]
    s_waitcnt lgkmcnt(5)
    buffer_load_dwordx4 v140, s[8:11], s60 offen offset:0 lds
    v_mfma_f32_16x16x32_bf16 v[88:91], a[168:171], v[108:111], v[88:91]
    ds_read_b128 v[52:55], v14 offset:39936
    v_mfma_f32_16x16x32_bf16 v[92:95], a[172:175], v[108:111], v[92:95]
    s_waitcnt lgkmcnt(5)
    v_mfma_f32_16x16x32_bf16 v[64:67], a[176:179], v[32:35], v[64:67]
    ds_read_b128 v[56:59], v14 offset:44032
    v_mfma_f32_16x16x32_bf16 v[68:71], a[180:183], v[32:35], v[68:71]
    s_waitcnt lgkmcnt(5)
    buffer_load_dwordx4 v141, s[8:11], s60 offen offset:1024 lds
    v_mfma_f32_16x16x32_bf16 v[72:75], a[176:179], v[36:39], v[72:75]
    ds_read_b128 v[60:63], v14 offset:48128
    v_mfma_f32_16x16x32_bf16 v[76:79], a[180:183], v[36:39], v[76:79]
    s_waitcnt vmcnt(25)
    s_barrier
    s_waitcnt lgkmcnt(5)
    v_mfma_f32_16x16x32_bf16 v[80:83], a[176:179], v[40:43], v[80:83]
    ds_read_b128 v[96:99], v14 offset:49152
    v_mfma_f32_16x16x32_bf16 v[84:87], a[180:183], v[40:43], v[84:87]
    buffer_load_dwordx4 v142, s[8:11], s60 offen offset:2048 lds
    s_add_u32 m0, s68, 86016
    s_waitcnt lgkmcnt(5)
    v_mfma_f32_16x16x32_bf16 v[88:91], a[176:179], v[44:47], v[88:91]
    ds_read_b128 v[100:103], v14 offset:53248
    v_mfma_f32_16x16x32_bf16 v[92:95], a[180:183], v[44:47], v[92:95]
    s_add_u32 s60, s79, 1232896
    s_waitcnt lgkmcnt(5)
    v_mfma_f32_16x16x32_bf16 v[64:67], a[184:187], v[48:51], v[64:67]
    ds_read_b128 v[104:107], v14 offset:57344
    v_mfma_f32_16x16x32_bf16 v[68:71], a[188:191], v[48:51], v[68:71]
    s_waitcnt lgkmcnt(5)
    buffer_load_dwordx4 v140, s[8:11], s60 offen offset:0 lds
    v_mfma_f32_16x16x32_bf16 v[72:75], a[184:187], v[52:55], v[72:75]
    ds_read_b128 v[108:111], v14 offset:61440
    v_mfma_f32_16x16x32_bf16 v[76:79], a[188:191], v[52:55], v[76:79]
    s_waitcnt lgkmcnt(5)
    v_mfma_f32_16x16x32_bf16 v[80:83], a[184:187], v[56:59], v[80:83]
    ds_read_b128 v[32:35], v14 offset:50176
    v_mfma_f32_16x16x32_bf16 v[84:87], a[188:191], v[56:59], v[84:87]
    s_waitcnt lgkmcnt(5)
    buffer_load_dwordx4 v141, s[8:11], s60 offen offset:1024 lds
    v_mfma_f32_16x16x32_bf16 v[88:91], a[184:187], v[60:63], v[88:91]
    ds_read_b128 v[36:39], v14 offset:54272
    v_mfma_f32_16x16x32_bf16 v[92:95], a[188:191], v[60:63], v[92:95]
    s_waitcnt lgkmcnt(5)
    v_mfma_f32_16x16x32_bf16 v[64:67], a[192:195], v[96:99], v[64:67]
    ds_read_b128 v[40:43], v14 offset:58368
    v_mfma_f32_16x16x32_bf16 v[68:71], a[196:199], v[96:99], v[68:71]
    s_waitcnt lgkmcnt(5)
    buffer_load_dwordx4 v142, s[8:11], s60 offen offset:2048 lds
    v_mfma_f32_16x16x32_bf16 v[72:75], a[192:195], v[100:103], v[72:75]
    ds_read_b128 v[44:47], v14 offset:62464
    v_mfma_f32_16x16x32_bf16 v[76:79], a[196:199], v[100:103], v[76:79]
    s_waitcnt lgkmcnt(5)
    v_mfma_f32_16x16x32_bf16 v[80:83], a[192:195], v[104:107], v[80:83]
    ds_read_b128 v[48:51], v14 offset:51200
    v_mfma_f32_16x16x32_bf16 v[84:87], a[196:199], v[104:107], v[84:87]
    s_waitcnt lgkmcnt(5)
    v_mfma_f32_16x16x32_bf16 v[88:91], a[192:195], v[108:111], v[88:91]
    ds_read_b128 v[52:55], v14 offset:55296
    v_mfma_f32_16x16x32_bf16 v[92:95], a[196:199], v[108:111], v[92:95]
    s_waitcnt lgkmcnt(5)
    v_mfma_f32_16x16x32_bf16 v[64:67], a[200:203], v[32:35], v[64:67]
    ds_read_b128 v[56:59], v14 offset:59392
    v_mfma_f32_16x16x32_bf16 v[68:71], a[204:207], v[32:35], v[68:71]
    s_waitcnt lgkmcnt(5)
    v_mfma_f32_16x16x32_bf16 v[72:75], a[200:203], v[36:39], v[72:75]
    ds_read_b128 v[60:63], v14 offset:63488
    v_mfma_f32_16x16x32_bf16 v[76:79], a[204:207], v[36:39], v[76:79]
    s_waitcnt lgkmcnt(5)
    v_mfma_f32_16x16x32_bf16 v[80:83], a[200:203], v[40:43], v[80:83]
    ds_read_b128 v[96:99], v14 offset:52224
    v_mfma_f32_16x16x32_bf16 v[84:87], a[204:207], v[40:43], v[84:87]
    s_waitcnt lgkmcnt(5)
    v_mfma_f32_16x16x32_bf16 v[88:91], a[200:203], v[44:47], v[88:91]
    ds_read_b128 v[100:103], v14 offset:56320
    v_mfma_f32_16x16x32_bf16 v[92:95], a[204:207], v[44:47], v[92:95]
    s_waitcnt lgkmcnt(5)
    v_mfma_f32_16x16x32_bf16 v[64:67], a[208:211], v[48:51], v[64:67]
    ds_read_b128 v[104:107], v14 offset:60416
    v_mfma_f32_16x16x32_bf16 v[68:71], a[212:215], v[48:51], v[68:71]
    s_waitcnt lgkmcnt(5)
    v_mfma_f32_16x16x32_bf16 v[72:75], a[208:211], v[52:55], v[72:75]
    ds_read_b128 v[108:111], v14 offset:64512
    v_mfma_f32_16x16x32_bf16 v[76:79], a[212:215], v[52:55], v[76:79]
    s_waitcnt vmcnt(15)
    s_barrier
    s_waitcnt lgkmcnt(5)
    v_mfma_f32_16x16x32_bf16 v[80:83], a[208:211], v[56:59], v[80:83]
    v_add_u32 v14, 0x10000, v14
    ds_read_b128 v[32:35], v14 offset:0
    v_mfma_f32_16x16x32_bf16 v[84:87], a[212:215], v[56:59], v[84:87]
    s_waitcnt lgkmcnt(5)
    v_mfma_f32_16x16x32_bf16 v[88:91], a[208:211], v[60:63], v[88:91]
    ds_read_b128 v[36:39], v14 offset:4096
    v_mfma_f32_16x16x32_bf16 v[92:95], a[212:215], v[60:63], v[92:95]
    s_waitcnt lgkmcnt(5)
    v_mfma_f32_16x16x32_bf16 v[64:67], a[216:219], v[96:99], v[64:67]
    ds_read_b128 v[40:43], v14 offset:8192
    v_mfma_f32_16x16x32_bf16 v[68:71], a[220:223], v[96:99], v[68:71]
    s_waitcnt lgkmcnt(5)
    v_mfma_f32_16x16x32_bf16 v[72:75], a[216:219], v[100:103], v[72:75]
    ds_read_b128 v[44:47], v14 offset:12288
    v_mfma_f32_16x16x32_bf16 v[76:79], a[220:223], v[100:103], v[76:79]
    s_waitcnt lgkmcnt(5)
    v_mfma_f32_16x16x32_bf16 v[80:83], a[216:219], v[104:107], v[80:83]
    ds_read_b128 v[48:51], v14 offset:1024
    v_mfma_f32_16x16x32_bf16 v[84:87], a[220:223], v[104:107], v[84:87]
    s_waitcnt lgkmcnt(5)
    v_mfma_f32_16x16x32_bf16 v[88:91], a[216:219], v[108:111], v[88:91]
    ds_read_b128 v[52:55], v14 offset:5120
    v_mfma_f32_16x16x32_bf16 v[92:95], a[220:223], v[108:111], v[92:95]
    s_waitcnt lgkmcnt(5)
    v_mfma_f32_16x16x32_bf16 v[64:67], a[224:227], v[32:35], v[64:67]
    ds_read_b128 v[56:59], v14 offset:9216
    v_mfma_f32_16x16x32_bf16 v[68:71], a[228:231], v[32:35], v[68:71]
    s_waitcnt lgkmcnt(5)
    v_mfma_f32_16x16x32_bf16 v[72:75], a[224:227], v[36:39], v[72:75]
    ds_read_b128 v[60:63], v14 offset:13312
    v_mfma_f32_16x16x32_bf16 v[76:79], a[228:231], v[36:39], v[76:79]
    s_waitcnt lgkmcnt(5)
    v_mfma_f32_16x16x32_bf16 v[80:83], a[224:227], v[40:43], v[80:83]
    ds_read_b128 v[96:99], v14 offset:2048
    v_mfma_f32_16x16x32_bf16 v[84:87], a[228:231], v[40:43], v[84:87]
    s_waitcnt lgkmcnt(5)
    v_mfma_f32_16x16x32_bf16 v[88:91], a[224:227], v[44:47], v[88:91]
    ds_read_b128 v[100:103], v14 offset:6144
    v_mfma_f32_16x16x32_bf16 v[92:95], a[228:231], v[44:47], v[92:95]
    s_waitcnt lgkmcnt(5)
    v_mfma_f32_16x16x32_bf16 v[64:67], a[232:235], v[48:51], v[64:67]
    ds_read_b128 v[104:107], v14 offset:10240
    v_mfma_f32_16x16x32_bf16 v[68:71], a[236:239], v[48:51], v[68:71]
    s_waitcnt lgkmcnt(5)
    v_mfma_f32_16x16x32_bf16 v[72:75], a[232:235], v[52:55], v[72:75]
    ds_read_b128 v[108:111], v14 offset:14336
    v_mfma_f32_16x16x32_bf16 v[76:79], a[236:239], v[52:55], v[76:79]
    s_waitcnt lgkmcnt(5)
    v_mfma_f32_16x16x32_bf16 v[80:83], a[232:235], v[56:59], v[80:83]
    ds_read_b128 v[32:35], v14 offset:3072
    v_mfma_f32_16x16x32_bf16 v[84:87], a[236:239], v[56:59], v[84:87]
    s_waitcnt lgkmcnt(5)
    buffer_load_dword v30, off, s[84:87], s77 sc1
    v_mfma_f32_16x16x32_bf16 v[88:91], a[232:235], v[60:63], v[88:91]
    ds_read_b128 v[36:39], v14 offset:7168
    v_mfma_f32_16x16x32_bf16 v[92:95], a[236:239], v[60:63], v[92:95]
    s_waitcnt lgkmcnt(5)
    v_mfma_f32_16x16x32_bf16 v[64:67], a[240:243], v[96:99], v[64:67]
    ds_read_b128 v[40:43], v14 offset:11264
    v_mfma_f32_16x16x32_bf16 v[68:71], a[244:247], v[96:99], v[68:71]
    s_waitcnt lgkmcnt(5)
    v_mfma_f32_16x16x32_bf16 v[72:75], a[240:243], v[100:103], v[72:75]
    ds_read_b128 v[44:47], v14 offset:15360
    v_mfma_f32_16x16x32_bf16 v[76:79], a[244:247], v[100:103], v[76:79]
    s_waitcnt lgkmcnt(5)
    v_mfma_f32_16x16x32_bf16 v[80:83], a[240:243], v[104:107], v[80:83]
    v_mfma_f32_16x16x32_bf16 v[84:87], a[244:247], v[104:107], v[84:87]
    s_waitcnt lgkmcnt(4)
    v_mfma_f32_16x16x32_bf16 v[88:91], a[240:243], v[108:111], v[88:91]
    v_mfma_f32_16x16x32_bf16 v[92:95], a[244:247], v[108:111], v[92:95]
    s_waitcnt lgkmcnt(3)
    v_mfma_f32_16x16x32_bf16 v[64:67], a[248:251], v[32:35], v[64:67]
    v_mfma_f32_16x16x32_bf16 v[68:71], a[252:255], v[32:35], v[68:71]
    s_waitcnt lgkmcnt(2)
    v_mfma_f32_16x16x32_bf16 v[72:75], a[248:251], v[36:39], v[72:75]
    v_mfma_f32_16x16x32_bf16 v[76:79], a[252:255], v[36:39], v[76:79]
    s_waitcnt lgkmcnt(1)
    v_mfma_f32_16x16x32_bf16 v[80:83], a[248:251], v[40:43], v[80:83]
    v_mfma_f32_16x16x32_bf16 v[84:87], a[252:255], v[40:43], v[84:87]
    s_waitcnt lgkmcnt(0)
    v_mfma_f32_16x16x32_bf16 v[88:91], a[248:251], v[44:47], v[88:91]
    v_mfma_f32_16x16x32_bf16 v[92:95], a[252:255], v[44:47], v[92:95]
    v_cvt_pk_bf16_f32 v64, v64, v65
    v_cvt_pk_bf16_f32 v65, v66, v67
    v_cvt_pk_bf16_f32 v66, v68, v69
    v_cvt_pk_bf16_f32 v67, v70, v71
    s_add_u32 s63, s62, 1048576
    buffer_store_dwordx4 v[64:67], v15, s[44:47], s63 offen sc1
    v_cvt_pk_bf16_f32 v72, v72, v73
    v_cvt_pk_bf16_f32 v73, v74, v75
    v_cvt_pk_bf16_f32 v74, v76, v77
    v_cvt_pk_bf16_f32 v75, v78, v79
    s_add_u32 s63, s62, 1064960
    buffer_store_dwordx4 v[72:75], v15, s[44:47], s63 offen sc1
    v_cvt_pk_bf16_f32 v80, v80, v81
    v_cvt_pk_bf16_f32 v81, v82, v83
    v_cvt_pk_bf16_f32 v82, v84, v85
    v_cvt_pk_bf16_f32 v83, v86, v87
    s_add_u32 s63, s62, 1081344
    buffer_store_dwordx4 v[80:83], v15, s[44:47], s63 offen sc1
    v_cvt_pk_bf16_f32 v88, v88, v89
    v_cvt_pk_bf16_f32 v89, v90, v91
    v_cvt_pk_bf16_f32 v90, v92, v93
    v_cvt_pk_bf16_f32 v91, v94, v95
    s_add_u32 s63, s62, 1097728
    buffer_store_dwordx4 v[88:91], v15, s[44:47], s63 offen sc1
    s_waitcnt vmcnt(4)
    v_cmp_gt_u32 vcc, 16, v30
    s_nop 1
    s_cbranch_vccnz main_spin45
main_back46:
    s_add_u32 s60, s23, 0
    buffer_load_dwordx4 v[216:219], v20, s[44:47], s60 offen sc1
    s_add_u32 s60, s23, 2097152
    buffer_load_dwordx4 v[220:223], v20, s[44:47], s60 offen sc1
    s_add_u32 s60, s23, 4194304
    buffer_load_dwordx4 v[224:227], v20, s[44:47], s60 offen sc1
    s_add_u32 s60, s23, 6291456
    buffer_load_dwordx4 v[228:231], v20, s[44:47], s60 offen sc1
    v_and_b32 v24, 3, v1
    v_lshlrev_b32 v24, 5, v24
    v_add_u32 v24, 98304, v24
    s_lshl_b32 s60, s3, 3
    v_add_u32 v25, s60, v24
    s_waitcnt vmcnt(4)
    s_barrier
    s_cmp_lg_u32 s3, 0
    s_cbranch_scc1 main_skip47
    v_mov_b32 v3, 1
    s_mov_b64 exec, 1
    buffer_atomic_add v3, off, s[84:87], s76 sc1
    s_mov_b64 exec, -1
main_skip47:
    s_add_u32 m0, s55, 114688
    s_add_u32 s60, s67, 0
    buffer_load_dwordx4 v112, s[28:31], s60 offen offset:0 lds
    v_and_b32 v153, 0xffff0000, v128
    v_lshlrev_b32 v152, 16, v128
    v_and_b32 v155, 0xffff0000, v129
    v_lshlrev_b32 v154, 16, v129
    v_and_b32 v157, 0xffff0000, v130
    v_lshlrev_b32 v156, 16, v130
    buffer_load_dwordx4 v113, s[28:31], s60 offen offset:1024 lds
    v_and_b32 v159, 0xffff0000, v131
    v_lshlrev_b32 v158, 16, v131
    s_waitcnt vmcnt(5)
    v_and_b32 v145, 0xffff0000, v216
    v_lshlrev_b32 v144, 16, v216
    v_and_b32 v147, 0xffff0000, v217
    v_lshlrev_b32 v146, 16, v217
    buffer_load_dwordx4 v114, s[28:31], s60 offen offset:2048 lds
    v_and_b32 v149, 0xffff0000, v218
    v_lshlrev_b32 v148, 16, v218
    v_and_b32 v151, 0xffff0000, v219
    v_lshlrev_b32 v150, 16, v219
    s_waitcnt vmcnt(5)
    v_and_b32 v19, 0xffff0000, v220
    v_lshlrev_b32 v18, 16, v220
    buffer_load_dwordx4 v115, s[28:31], s60 offen offset:3072 lds
    v_pk_add_f32 v[144:145], v[144:145], v[18:19]
    v_and_b32 v19, 0xffff0000, v221
    v_lshlrev_b32 v18, 16, v221
    v_pk_add_f32 v[146:147], v[146:147], v[18:19]
    v_and_b32 v19, 0xffff0000, v222
    v_lshlrev_b32 v18, 16, v222
    s_add_u32 m0, s55, 131072
    s_add_u32 s60, s67, 32768
    buffer_load_dwordx4 v112, s[28:31], s60 offen offset:0 lds
    v_pk_add_f32 v[148:149], v[148:149], v[18:19]
    v_and_b32 v19, 0xffff0000, v223
    v_lshlrev_b32 v18, 16, v223
    v_pk_add_f32 v[150:151], v[150:151], v[18:19]
    s_waitcnt vmcnt(6)
    v_and_b32 v19, 0xffff0000, v224
    v_lshlrev_b32 v18, 16, v224
    buffer_load_dwordx4 v113, s[28:31], s60 offen offset:1024 lds
    v_pk_add_f32 v[144:145], v[144:145], v[18:19]
    v_and_b32 v19, 0xffff0000, v225
    v_lshlrev_b32 v18, 16, v225
    v_pk_add_f32 v[146:147], v[146:147], v[18:19]
    v_and_b32 v19, 0xffff0000, v226
    v_lshlrev_b32 v18, 16, v226
    buffer_load_dwordx4 v114, s[28:31], s60 offen offset:2048 lds
    v_pk_add_f32 v[148:149], v[148:149], v[18:19]
    v_and_b32 v19, 0xffff0000, v227
    v_lshlrev_b32 v18, 16, v227
    v_pk_add_f32 v[150:151], v[150:151], v[18:19]
    s_waitcnt vmcnt(7)
    v_and_b32 v19, 0xffff0000, v228
    v_lshlrev_b32 v18, 16, v228
    buffer_load_dwordx4 v115, s[28:31], s60 offen offset:3072 lds
    v_pk_add_f32 v[144:145], v[144:145], v[18:19]
    v_and_b32 v19, 0xffff0000, v229
    v_lshlrev_b32 v18, 16, v229
    v_pk_add_f32 v[146:147], v[146:147], v[18:19]
    v_and_b32 v19, 0xffff0000, v230
    v_lshlrev_b32 v18, 16, v230
    s_add_u32 m0, s55, 147456
    s_add_u32 s60, s67, 65536
    buffer_load_dwordx4 v112, s[28:31], s60 offen offset:0 lds
    v_pk_add_f32 v[148:149], v[148:149], v[18:19]
    v_and_b32 v19, 0xffff0000, v231
    v_lshlrev_b32 v18, 16, v231
    v_pk_add_f32 v[150:151], v[150:151], v[18:19]
    v_pk_fma_f32 v[144:145], v[144:145], v[192:193], v[152:153]
    v_pk_fma_f32 v[146:147], v[146:147], v[194:195], v[154:155]
    buffer_load_dwordx4 v113, s[28:31], s60 offen offset:1024 lds
    v_pk_fma_f32 v[148:149], v[148:149], v[196:197], v[156:157]
    v_pk_fma_f32 v[150:151], v[150:151], v[198:199], v[158:159]
    v_cvt_pk_bf16_f32 v216, v144, v145
    v_cvt_pk_bf16_f32 v217, v146, v147
    v_cvt_pk_bf16_f32 v218, v148, v149
    v_cvt_pk_bf16_f32 v219, v150, v151
    buffer_load_dwordx4 v114, s[28:31], s60 offen offset:2048 lds
    s_add_u32 s62, s23, 0
    buffer_store_dwordx4 v[216:219], v20, s[80:83], s62 offen sc1
    v_pk_add_f32 v[26:27], v[144:145], v[146:147]
    v_pk_mul_f32 v[28:29], v[144:145], v[144:145]
    v_pk_fma_f32 v[28:29], v[146:147], v[146:147], v[28:29]
    v_pk_add_f32 v[26:27], v[26:27], v[148:149]
    buffer_load_dwordx4 v115, s[28:31], s60 offen offset:3072 lds
    v_pk_fma_f32 v[28:29], v[148:149], v[148:149], v[28:29]
    v_pk_add_f32 v[26:27], v[26:27], v[150:151]
    v_pk_fma_f32 v[28:29], v[150:151], v[150:151], v[28:29]
    v_add_f32 v26, v26, v27
    v_add_f32 v27, v28, v29
    s_nop 0
    v_add_f32_dpp v26, v26, v26 row_ror:4 row_mask:0xf bank_mask:0xf
    v_add_f32_dpp v27, v27, v27 row_ror:4 row_mask:0xf bank_mask:0xf
    s_nop 0
    v_add_f32_dpp v26, v26, v26 row_ror:8 row_mask:0xf bank_mask:0xf
    v_add_f32_dpp v27, v27, v27 row_ror:8 row_mask:0xf bank_mask:0xf
    v_mov_b64 v[28:29], v[26:27]
    s_nop 1
    v_permlane16_swap_b32 v26, v28
    v_permlane16_swap_b32 v27, v29
    v_pk_add_f32 v[26:27], v[26:27], v[28:29]
    v_mov_b64 v[28:29], v[26:27]
    s_nop 1
    v_permlane32_swap_b32 v26, v28
    v_permlane32_swap_b32 v27, v29
    v_pk_add_f32 v[26:27], v[26:27], v[28:29]
    ds_write_b64 v25, v[26:27] offset:0
    s_waitcnt lgkmcnt(0)
    s_barrier
    ds_read_b128 v[152:155], v24 offset:0
    ds_read_b128 v[156:159], v24 offset:16
    s_waitcnt lgkmcnt(1)
    v_pk_add_f32 v[152:153], v[152:153], v[154:155]
    s_waitcnt lgkmcnt(0)
    v_pk_add_f32 v[156:157], v[156:157], v[158:159]
    v_pk_add_f32 v[26:27], v[152:153], v[156:157]
    v_mul_f32 v26, 0x3b000000, v26
    v_mul_f32 v27, 0x3b000000, v27
    v_fma_f32 v27, -v26, v26, v27
    v_max_f32 v27, 0, v27
    v_add_f32 v27, 0x3727c5ac, v27
    v_rsq_f32 v28, v27
    v_pk_add_f32 v[144:145], v[144:145], v[26:27] op_sel_hi:[1,0] neg_lo:[0,1] neg_hi:[0,1]
    v_pk_add_f32 v[146:147], v[146:147], v[26:27] op_sel_hi:[1,0] neg_lo:[0,1] neg_hi:[0,1]
    v_pk_add_f32 v[148:149], v[148:149], v[26:27] op_sel_hi:[1,0] neg_lo:[0,1] neg_hi:[0,1]
    v_pk_add_f32 v[150:151], v[150:151], v[26:27] op_sel_hi:[1,0] neg_lo:[0,1] neg_hi:[0,1]
    v_pk_mul_f32 v[144:145], v[144:145], v[28:29] op_sel_hi:[1,0]
    v_pk_mul_f32 v[146:147], v[146:147], v[28:29] op_sel_hi:[1,0]
    v_pk_mul_f32 v[148:149], v[148:149], v[28:29] op_sel_hi:[1,0]
    v_pk_mul_f32 v[150:151], v[150:151], v[28:29] op_sel_hi:[1,0]
    v_pk_fma_f32 v[144:145], v[144:145], v[208:209], v[200:201]
    v_pk_fma_f32 v[146:147], v[146:147], v[210:211], v[202:203]
    v_pk_fma_f32 v[148:149], v[148:149], v[212:213], v[204:205]
    v_pk_fma_f32 v[150:151], v[150:151], v[214:215], v[206:207]
    v_pk_add_f32 v[26:27], v[144:145], v[146:147]
    v_pk_mul_f32 v[28:29], v[144:145], v[144:145]
    v_pk_fma_f32 v[28:29], v[146:147], v[146:147], v[28:29]
    v_pk_add_f32 v[26:27], v[26:27], v[148:149]
    v_pk_fma_f32 v[28:29], v[148:149], v[148:149], v[28:29]
    v_pk_add_f32 v[26:27], v[26:27], v[150:151]
    v_pk_fma_f32 v[28:29], v[150:151], v[150:151], v[28:29]
    v_add_f32 v26, v26, v27
    v_add_f32 v27, v28, v29
    s_nop 0
    v_add_f32_dpp v26, v26, v26 row_ror:4 row_mask:0xf bank_mask:0xf
    v_add_f32_dpp v27, v27, v27 row_ror:4 row_mask:0xf bank_mask:0xf
    s_nop 0
    v_add_f32_dpp v26, v26, v26 row_ror:8 row_mask:0xf bank_mask:0xf
    v_add_f32_dpp v27, v27, v27 row_ror:8 row_mask:0xf bank_mask:0xf
    v_mov_b64 v[28:29], v[26:27]
    s_nop 1
    v_permlane16_swap_b32 v26, v28
    v_permlane16_swap_b32 v27, v29
    v_pk_add_f32 v[26:27], v[26:27], v[28:29]
    v_mov_b64 v[28:29], v[26:27]
    s_nop 1
    v_permlane32_swap_b32 v26, v28
    v_permlane32_swap_b32 v27, v29
    v_pk_add_f32 v[26:27], v[26:27], v[28:29]
    ds_write_b64 v25, v[26:27] offset:128
    buffer_load_dword v30, off, s[84:87], s76 sc1
    s_waitcnt lgkmcnt(0)
    s_barrier
    ds_read_b128 v[152:155], v24 offset:128
    ds_read_b128 v[156:159], v24 offset:144
    s_waitcnt lgkmcnt(1)
    v_pk_add_f32 v[152:153], v[152:153], v[154:155]
    s_waitcnt lgkmcnt(0)
    v_pk_add_f32 v[156:157], v[156:157], v[158:159]
    v_pk_add_f32 v[26:27], v[152:153], v[156:157]
    v_mul_f32 v26, 0x3b000000, v26
    v_mul_f32 v27, 0x3b000000, v27
    v_fma_f32 v27, -v26, v26, v27
    v_max_f32 v27, 0, v27
    v_add_f32 v27, 0x3727c5ac, v27
    v_rsq_f32 v28, v27
    v_pk_add_f32 v[144:145], v[144:145], v[26:27] op_sel_hi:[1,0] neg_lo:[0,1] neg_hi:[0,1]
    v_pk_add_f32 v[146:147], v[146:147], v[26:27] op_sel_hi:[1,0] neg_lo:[0,1] neg_hi:[0,1]
    v_pk_add_f32 v[148:149], v[148:149], v[26:27] op_sel_hi:[1,0] neg_lo:[0,1] neg_hi:[0,1]
    v_pk_add_f32 v[150:151], v[150:151], v[26:27] op_sel_hi:[1,0] neg_lo:[0,1] neg_hi:[0,1]
    v_pk_mul_f32 v[144:145], v[144:145], v[28:29] op_sel_hi:[1,0]
    v_pk_mul_f32 v[146:147], v[146:147], v[28:29] op_sel_hi:[1,0]
    v_pk_mul_f32 v[148:149], v[148:149], v[28:29] op_sel_hi:[1,0]
    v_pk_mul_f32 v[150:151], v[150:151], v[28:29] op_sel_hi:[1,0]
    v_cvt_pk_bf16_f32 v220, v144, v145
    v_cvt_pk_bf16_f32 v221, v146, v147
    v_cvt_pk_bf16_f32 v222, v148, v149
    v_cvt_pk_bf16_f32 v223, v150, v151
    buffer_store_dwordx4 v[220:223], v20, s[48:51], s62 offen sc1
    s_waitcnt vmcnt(1)
    v_cmp_gt_u32 vcc, 16, v30
    s_nop 1
    s_cbranch_vccnz main_spin48
main_back49:
    s_add_u32 s60, s23, 1048576
    buffer_load_dwordx4 v[232:235], v20, s[44:47], s60 offen sc1
    s_add_u32 s60, s23, 3145728
    buffer_load_dwordx4 v[236:239], v20, s[44:47], s60 offen sc1
    s_add_u32 s60, s23, 5242880
    buffer_load_dwordx4 v[240:243], v20, s[44:47], s60 offen sc1
    s_add_u32 s60, s23, 7340032
    buffer_load_dwordx4 v[244:247], v20, s[44:47], s60 offen sc1
    s_waitcnt vmcnt(4)
    s_barrier
    s_cmp_lg_u32 s3, 0
    s_cbranch_scc1 main_skip50
    v_mov_b32 v3, 1
    s_mov_b64 exec, 1
    buffer_atomic_add v3, off, s[84:87], s35 sc1
    s_mov_b64 exec, -1
main_skip50:
    s_lshl_b32 s70, s14, 7
    s_add_u32 s70, s70, 75776
    s_add_u32 s71, s70, 2048
    s_lshl_b32 s17, s14, 2
    s_add_u32 s17, s17, s3
    s_lshl_b32 s56, s17, 14
    s_mov_b32 s24, s90
    s_mov_b32 s25, s91
    s_mov_b32 s26, 0xac0
    s_mov_b32 s27, 0x20000
    s_add_u32 s44, s12, 0x5400000
    s_addc_u32 s45, s13, 0
    s_mov_b32 s46, 0x560000
    s_mov_b32 s47, 0x20000
    v_lshrrev_b32 v16, 4, v1
    v_lshlrev_b32 v16, 3, v16
    buffer_load_dwordx2 v[32:33], v16, s[24:27], s69 offen offset:0
    buffer_load_dwordx2 v[34:35], v16, s[24:27], s69 offen offset:32
    buffer_load_dwordx2 v[36:37], v16, s[24:27], s69 offen offset:64
    buffer_load_dwordx2 v[38:39], v16, s[24:27], s69 offen offset:96
    buffer_load_dwordx2 v[40:41], v16, s[24:27], s69 offen offset:128
    buffer_load_dwordx2 v[42:43], v16, s[24:27], s69 offen offset:160
    v_lshrrev_b32 v18, 2, v1
    v_mul_u32_u24 v8, 192, v18
    v_and_b32 v18, 3, v1
    v_lshl_add_u32 v8, v18, 3, v8
    v_bfe_u32 v18, v1, 4, 1
    v_lshlrev_b32 v18, 5, v18
    v_sub_u32 v9, v8, v18
    v_add_u32 v8, v8, v18
    v_add_u32 v9, 32, v9
    s_mul_i32 s18, s17, 44032
    s_mul_i32 s61, s15, 3072
    s_add_u32 s18, s18, s61
    s_or_b32 s18, s18, s79
    s_cmp_eq_u32 s15, 14
    s_cselect_b32 s19, 0x40000000, 0
    s_add_u32 s76, s70, 4096
    s_add_u32 s77, s71, 4096
    s_lshr_b32 s72, s64, 1
    s_lshl_b32 s72, s72, 7
    s_add_u32 s72, s72, 79872
    s_add_u32 s73, s72, 2048
    v_and_b32 v153, 0xffff0000, v132
    v_lshlrev_b32 v152, 16, v132
    v_and_b32 v155, 0xffff0000, v133
    v_lshlrev_b32 v154, 16, v133
    v_and_b32 v157, 0xffff0000, v134
    v_lshlrev_b32 v156, 16, v134
    v_and_b32 v159, 0xffff0000, v135
    v_lshlrev_b32 v158, 16, v135
    s_waitcnt vmcnt(9)
    v_and_b32 v145, 0xffff0000, v232
    v_lshlrev_b32 v144, 16, v232
    v_and_b32 v147, 0xffff0000, v233
    v_lshlrev_b32 v146, 16, v233
    v_and_b32 v149, 0xffff0000, v234
    v_lshlrev_b32 v148, 16, v234
    v_and_b32 v151, 0xffff0000, v235
    v_lshlrev_b32 v150, 16, v235
    s_waitcnt vmcnt(8)
    v_and_b32 v19, 0xffff0000, v236
    v_lshlrev_b32 v18, 16, v236
    v_pk_add_f32 v[144:145], v[144:145], v[18:19]
    v_and_b32 v19, 0xffff0000, v237
    v_lshlrev_b32 v18, 16, v237
    v_pk_add_f32 v[146:147], v[146:147], v[18:19]
    v_and_b32 v19, 0xffff0000, v238
    v_lshlrev_b32 v18, 16, v238
    v_pk_add_f32 v[148:149], v[148:149], v[18:19]
    v_and_b32 v19, 0xffff0000, v239
    v_lshlrev_b32 v18, 16, v239
    v_pk_add_f32 v[150:151], v[150:151], v[18:19]
    s_waitcnt vmcnt(7)
    v_and_b32 v19, 0xffff0000, v240
    v_lshlrev_b32 v18, 16, v240
    v_pk_add_f32 v[144:145], v[144:145], v[18:19]
    v_and_b32 v19, 0xffff0000, v241
    v_lshlrev_b32 v18, 16, v241
    v_pk_add_f32 v[146:147], v[146:147], v[18:19]
    v_and_b32 v19, 0xffff0000, v242
    v_lshlrev_b32 v18, 16, v242
    v_pk_add_f32 v[148:149], v[148:149], v[18:19]
    v_and_b32 v19, 0xffff0000, v243
    v_lshlrev_b32 v18, 16, v243
    v_pk_add_f32 v[150:151], v[150:151], v[18:19]
    s_waitcnt vmcnt(6)
    v_and_b32 v19, 0xffff0000, v244
    v_lshlrev_b32 v18, 16, v244
    v_pk_add_f32 v[144:145], v[144:145], v[18:19]
    v_and_b32 v19, 0xffff0000, v245
    v_lshlrev_b32 v18, 16, v245
    v_pk_add_f32 v[146:147], v[146:147], v[18:19]
    v_and_b32 v19, 0xffff0000, v246
    v_lshlrev_b32 v18, 16, v246
    v_pk_add_f32 v[148:149], v[148:149], v[18:19]
    v_and_b32 v19, 0xffff0000, v247
    v_lshlrev_b32 v18, 16, v247
    v_pk_add_f32 v[150:151], v[150:151], v[18:19]
    v_pk_fma_f32 v[144:145], v[144:145], v[192:193], v[152:153]
    v_pk_fma_f32 v[146:147], v[146:147], v[194:195], v[154:155]
    v_pk_fma_f32 v[148:149], v[148:149], v[196:197], v[156:157]
    v_pk_fma_f32 v[150:151], v[150:151], v[198:199], v[158:159]
    v_cvt_pk_bf16_f32 v232, v144, v145
    v_cvt_pk_bf16_f32 v233, v146, v147
    v_cvt_pk_bf16_f32 v234, v148, v149
    v_cvt_pk_bf16_f32 v235, v150, v151
    s_add_u32 s62, s23, 1048576
    buffer_store_dwordx4 v[232:235], v20, s[80:83], s62 offen sc1
    v_pk_add_f32 v[26:27], v[144:145], v[146:147]
    v_pk_mul_f32 v[28:29], v[144:145], v[144:145]
    v_pk_fma_f32 v[28:29], v[146:147], v[146:147], v[28:29]
    v_pk_add_f32 v[26:27], v[26:27], v[148:149]
    v_pk_fma_f32 v[28:29], v[148:149], v[148:149], v[28:29]
    v_pk_add_f32 v[26:27], v[26:27], v[150:151]
    v_pk_fma_f32 v[28:29], v[150:151], v[150:151], v[28:29]
    v_add_f32 v26, v26, v27
    v_add_f32 v27, v28, v29
    s_nop 0
    v_add_f32_dpp v26, v26, v26 row_ror:4 row_mask:0xf bank_mask:0xf
    v_add_f32_dpp v27, v27, v27 row_ror:4 row_mask:0xf bank_mask:0xf
    s_nop 0
    v_add_f32_dpp v26, v26, v26 row_ror:8 row_mask:0xf bank_mask:0xf
    v_add_f32_dpp v27, v27, v27 row_ror:8 row_mask:0xf bank_mask:0xf
    v_mov_b64 v[28:29], v[26:27]
    s_nop 1
    v_permlane16_swap_b32 v26, v28
    v_permlane16_swap_b32 v27, v29
    v_pk_add_f32 v[26:27], v[26:27], v[28:29]
    v_mov_b64 v[28:29], v[26:27]
    s_nop 1
    v_permlane32_swap_b32 v26, v28
    v_permlane32_swap_b32 v27, v29
    v_pk_add_f32 v[26:27], v[26:27], v[28:29]
    ds_write_b64 v25, v[26:27] offset:256
    s_waitcnt lgkmcnt(0)
    s_barrier
    ds_read_b128 v[152:155], v24 offset:256
    ds_read_b128 v[156:159], v24 offset:272
    s_waitcnt lgkmcnt(1)
    v_pk_add_f32 v[152:153], v[152:153], v[154:155]
    s_waitcnt lgkmcnt(0)
    v_pk_add_f32 v[156:157], v[156:157], v[158:159]
    v_pk_add_f32 v[26:27], v[152:153], v[156:157]
    v_mul_f32 v26, 0x3b000000, v26
    v_mul_f32 v27, 0x3b000000, v27
    v_fma_f32 v27, -v26, v26, v27
    v_max_f32 v27, 0, v27
    v_add_f32 v27, 0x3727c5ac, v27
    v_rsq_f32 v28, v27
    v_pk_add_f32 v[144:145], v[144:145], v[26:27] op_sel_hi:[1,0] neg_lo:[0,1] neg_hi:[0,1]
    v_pk_add_f32 v[146:147], v[146:147], v[26:27] op_sel_hi:[1,0] neg_lo:[0,1] neg_hi:[0,1]
    v_pk_add_f32 v[148:149], v[148:149], v[26:27] op_sel_hi:[1,0] neg_lo:[0,1] neg_hi:[0,1]
    v_pk_add_f32 v[150:151], v[150:151], v[26:27] op_sel_hi:[1,0] neg_lo:[0,1] neg_hi:[0,1]
    v_pk_mul_f32 v[144:145], v[144:145], v[28:29] op_sel_hi:[1,0]
    v_pk_mul_f32 v[146:147], v[146:147], v[28:29] op_sel_hi:[1,0]
    v_pk_mul_f32 v[148:149], v[148:149], v[28:29] op_sel_hi:[1,0]
    v_pk_mul_f32 v[150:151], v[150:151], v[28:29] op_sel_hi:[1,0]
    v_pk_fma_f32 v[144:145], v[144:145], v[208:209], v[200:201]
    v_pk_fma_f32 v[146:147], v[146:147], v[210:211], v[202:203]
    v_pk_fma_f32 v[148:149], v[148:149], v[212:213], v[204:205]
    v_pk_fma_f32 v[150:151], v[150:151], v[214:215], v[206:207]
    v_pk_add_f32 v[26:27], v[144:145], v[146:147]
    v_pk_mul_f32 v[28:29], v[144:145], v[144:145]
    v_pk_fma_f32 v[28:29], v[146:147], v[146:147], v[28:29]
    v_pk_add_f32 v[26:27], v[26:27], v[148:149]
    v_pk_fma_f32 v[28:29], v[148:149], v[148:149], v[28:29]
    v_pk_add_f32 v[26:27], v[26:27], v[150:151]
    v_pk_fma_f32 v[28:29], v[150:151], v[150:151], v[28:29]
    v_add_f32 v26, v26, v27
    v_add_f32 v27, v28, v29
    s_nop 0
    v_add_f32_dpp v26, v26, v26 row_ror:4 row_mask:0xf bank_mask:0xf
    v_add_f32_dpp v27, v27, v27 row_ror:4 row_mask:0xf bank_mask:0xf
    s_nop 0
    v_add_f32_dpp v26, v26, v26 row_ror:8 row_mask:0xf bank_mask:0xf
    v_add_f32_dpp v27, v27, v27 row_ror:8 row_mask:0xf bank_mask:0xf
    v_mov_b64 v[28:29], v[26:27]
    s_nop 1
    v_permlane16_swap_b32 v26, v28
    v_permlane16_swap_b32 v27, v29
    v_pk_add_f32 v[26:27], v[26:27], v[28:29]
    v_mov_b64 v[28:29], v[26:27]
    s_nop 1
    v_permlane32_swap_b32 v26, v28
    v_permlane32_swap_b32 v27, v29
    v_pk_add_f32 v[26:27], v[26:27], v[28:29]
    ds_write_b64 v25, v[26:27] offset:384
    buffer_load_dword v30, off, s[84:87], s70 sc1
    s_waitcnt lgkmcnt(0)
    s_barrier
    ds_read_b128 v[152:155], v24 offset:384
    ds_read_b128 v[156:159], v24 offset:400
    s_waitcnt lgkmcnt(1)
    v_pk_add_f32 v[152:153], v[152:153], v[154:155]
    s_waitcnt lgkmcnt(0)
    v_pk_add_f32 v[156:157], v[156:157], v[158:159]
    v_pk_add_f32 v[26:27], v[152:153], v[156:157]
    v_mul_f32 v26, 0x3b000000, v26
    v_mul_f32 v27, 0x3b000000, v27
    v_fma_f32 v27, -v26, v26, v27
    v_max_f32 v27, 0, v27
    v_add_f32 v27, 0x3727c5ac, v27
    v_rsq_f32 v28, v27
    v_pk_add_f32 v[144:145], v[144:145], v[26:27] op_sel_hi:[1,0] neg_lo:[0,1] neg_hi:[0,1]
    v_pk_add_f32 v[146:147], v[146:147], v[26:27] op_sel_hi:[1,0] neg_lo:[0,1] neg_hi:[0,1]
    v_pk_add_f32 v[148:149], v[148:149], v[26:27] op_sel_hi:[1,0] neg_lo:[0,1] neg_hi:[0,1]
    v_pk_add_f32 v[150:151], v[150:151], v[26:27] op_sel_hi:[1,0] neg_lo:[0,1] neg_hi:[0,1]
    v_pk_mul_f32 v[144:145], v[144:145], v[28:29] op_sel_hi:[1,0]
    v_pk_mul_f32 v[146:147], v[146:147], v[28:29] op_sel_hi:[1,0]
    v_pk_mul_f32 v[148:149], v[148:149], v[28:29] op_sel_hi:[1,0]
    v_pk_mul_f32 v[150:151], v[150:151], v[28:29] op_sel_hi:[1,0]
    v_cvt_pk_bf16_f32 v236, v144, v145
    v_cvt_pk_bf16_f32 v237, v146, v147
    v_cvt_pk_bf16_f32 v238, v148, v149
    v_cvt_pk_bf16_f32 v239, v150, v151
    buffer_store_dwordx4 v[236:239], v20, s[48:51], s62 offen sc1
    s_waitcnt vmcnt(1)
    v_cmp_gt_u32 vcc, 16, v30
    s_nop 1
    s_cbranch_vccnz main_spin51
main_back52:
    s_add_u32 s60, s56, 0
    buffer_load_dwordx4 v[128:131], v15, s[48:51], s60 offen offset:0 sc1
    buffer_load_dwordx4 v[132:135], v15, s[48:51], s60 offen offset:1024 sc1
    buffer_load_dwordx4 v[136:139], v15, s[48:51], s60 offen offset:2048 sc1
    buffer_load_dwordx4 v[140:143], v15, s[48:51], s60 offen offset:3072 sc1
    s_add_u32 s60, s56, 4096
    buffer_load_dwordx4 v[144:147], v15, s[48:51], s60 offen offset:0 sc1
    buffer_load_dwordx4 v[148:151], v15, s[48:51], s60 offen offset:1024 sc1
    buffer_load_dwordx4 v[152:155], v15, s[48:51], s60 offen offset:2048 sc1
    buffer_load_dwordx4 v[156:159], v15, s[48:51], s60 offen offset:3072 sc1
    v_and_b32 v65, 0xffff0000, v32
    v_lshlrev_b32 v64, 16, v32
    v_and_b32 v67, 0xffff0000, v33
    v_lshlrev_b32 v66, 16, v33
    v_and_b32 v69, 0xffff0000, v34
    v_lshlrev_b32 v68, 16, v34
    v_and_b32 v71, 0xffff0000, v35
    v_lshlrev_b32 v70, 16, v35
    v_and_b32 v73, 0xffff0000, v36
    v_lshlrev_b32 v72, 16, v36
    v_and_b32 v75, 0xffff0000, v37
    v_lshlrev_b32 v74, 16, v37
    v_and_b32 v77, 0xffff0000, v38
    v_lshlrev_b32 v76, 16, v38
    v_and_b32 v79, 0xffff0000, v39
    v_lshlrev_b32 v78, 16, v39
    v_and_b32 v81, 0xffff0000, v40
    v_lshlrev_b32 v80, 16, v40
    v_and_b32 v83, 0xffff0000, v41
    v_lshlrev_b32 v82, 16, v41
    v_and_b32 v85, 0xffff0000, v42
    v_lshlrev_b32 v84, 16, v42
    v_and_b32 v87, 0xffff0000, v43
    v_lshlrev_b32 v86, 16, v43
    v_and_b32 v89, 0xffff0000, v32
    v_lshlrev_b32 v88, 16, v32
    v_and_b32 v91, 0xffff0000, v33
    v_lshlrev_b32 v90, 16, v33
    v_and_b32 v93, 0xffff0000, v34
    v_lshlrev_b32 v92, 16, v34
    v_and_b32 v95, 0xffff0000, v35
    v_lshlrev_b32 v94, 16, v35
    v_and_b32 v97, 0xffff0000, v36
    v_lshlrev_b32 v96, 16, v36
    v_and_b32 v99, 0xffff0000, v37
    v_lshlrev_b32 v98, 16, v37
    v_and_b32 v101, 0xffff0000, v38
    v_lshlrev_b32 v100, 16, v38
    v_and_b32 v103, 0xffff0000, v39
    v_lshlrev_b32 v102, 16, v39
    v_and_b32 v105, 0xffff0000, v40
    v_lshlrev_b32 v104, 16, v40
    v_and_b32 v107, 0xffff0000, v41
    v_lshlrev_b32 v106, 16, v41
    v_and_b32 v109, 0xffff0000, v42
    v_lshlrev_b32 v108, 16, v42
    v_and_b32 v111, 0xffff0000, v43
    v_lshlrev_b32 v110, 16, v43
    s_waitcnt vmcnt(8)
    s_barrier
    s_cmp_lg_u32 s3, 0
    s_cbranch_scc1 main_skip53
    v_mov_b32 v3, 1
    s_mov_b64 exec, 1
    buffer_atomic_add v3, off, s[84:87], s78 sc1
    s_mov_b64 exec, -1
main_skip53:
    s_add_u32 s60, s56, 8192
    buffer_load_dwordx4 v[160:163], v15, s[48:51], s60 offen offset:0 sc1
    buffer_load_dwordx4 v[164:167], v15, s[48:51], s60 offen offset:1024 sc1
    buffer_load_dwordx4 v[168:171], v15, s[48:51], s60 offen offset:2048 sc1
    buffer_load_dwordx4 v[172:175], v15, s[48:51], s60 offen offset:3072 sc1
    s_add_u32 s60, s56, 12288
    buffer_load_dwordx4 v[176:179], v15, s[48:51], s60 offen offset:0 sc1
    buffer_load_dwordx4 v[180:183], v15, s[48:51], s60 offen offset:1024 sc1
    buffer_load_dwordx4 v[184:187], v15, s[48:51], s60 offen offset:2048 sc1
    buffer_load_dwordx4 v[188:191], v15, s[48:51], s60 offen offset:3072 sc1
    v_add_u32 v116, 0x10000, v116
    v_add_u32 v117, 0x10000, v117
    v_add_u32 v118, 0x10000, v118
    v_add_u32 v119, 0x10000, v119
    ds_read_b64_tr_b16 a[0:1], v116 offset:49152
    ds_read_b64_tr_b16 a[2:3], v116 offset:51200
    ds_read_b64_tr_b16 a[4:5], v117 offset:49152
    ds_read_b64_tr_b16 a[6:7], v117 offset:51200
    ds_read_b64_tr_b16 a[8:9], v118 offset:49152
    ds_read_b64_tr_b16 a[10:11], v118 offset:51200
    ds_read_b64_tr_b16 a[12:13], v119 offset:49152
    ds_read_b64_tr_b16 a[14:15], v119 offset:51200
    v_add_u32 v116, 0x10000, v116
    v_add_u32 v117, 0x10000, v117
    v_add_u32 v118, 0x10000, v118
    v_add_u32 v119, 0x10000, v119
    ds_read_b64_tr_b16 a[16:17], v116 offset:0
    ds_read_b64_tr_b16 a[18:19], v116 offset:2048
    ds_read_b64_tr_b16 a[20:21], v117 offset:0
    ds_read_b64_tr_b16 a[22:23], v117 offset:2048
    ds_read_b64_tr_b16 a[24:25], v118 offset:0
    ds_read_b64_tr_b16 a[26:27], v118 offset:2048
    ds_read_b64_tr_b16 a[28:29], v119 offset:0
    ds_read_b64_tr_b16 a[30:31], v119 offset:2048
    ds_read_b64_tr_b16 a[32:33], v116 offset:16384
    ds_read_b64_tr_b16 a[34:35], v116 offset:18432
    ds_read_b64_tr_b16 a[36:37], v117 offset:16384
    ds_read_b64_tr_b16 a[38:39], v117 offset:18432
    ds_read_b64_tr_b16 a[40:41], v118 offset:16384
    ds_read_b64_tr_b16 a[42:43], v118 offset:18432
    ds_read_b64_tr_b16 a[44:45], v119 offset:16384
    ds_read_b64_tr_b16 a[46:47], v119 offset:18432
    v_mov_b32 v22, 0xc0135761
    v_mov_b32 v24, 0xbdd2d3e8
    v_mov_b32 v26, 1.0
    ds_read_b64_tr_b16 v[32:33], v8 offset:0
    ds_read_b64_tr_b16 v[34:35], v8 offset:3072
    ds_read_b64_tr_b16 v[36:37], v9 offset:0
    ds_read_b64_tr_b16 v[38:39], v9 offset:3072
    ds_read_b64_tr_b16 v[40:41], v8 offset:64
    ds_read_b64_tr_b16 v[42:43], v8 offset:3136
    ds_read_b64_tr_b16 v[44:45], v9 offset:64
    ds_read_b64_tr_b16 v[46:47], v9 offset:3136
    ds_read_b64_tr_b16 v[48:49], v8 offset:128
    ds_read_b64_tr_b16 v[50:51], v8 offset:3200
    ds_read_b64_tr_b16 v[52:53], v9 offset:128
    ds_read_b64_tr_b16 v[54:55], v9 offset:3200
    ds_read_b64_tr_b16 v[56:57], v8 offset:6144
    ds_read_b64_tr_b16 v[58:59], v8 offset:9216
    s_waitcnt lgkmcnt(14)
    s_waitcnt vmcnt(15) lgkmcnt(12)
    v_mfma_f32_16x16x32_bf16 v[64:67], v[32:35], v[128:131], v[64:67]
    s_add_u32 m0, s55, 98304
    s_waitcnt lgkmcnt(10)
    ds_read_b64_tr_b16 v[60:61], v9 offset:6144
    ds_read_b64_tr_b16 v[62:63], v9 offset:9216
    v_mfma_f32_16x16x32_bf16 v[68:71], v[36:39], v[128:131], v[68:71]
    s_add_u32 s60, s67, 98304
    s_waitcnt lgkmcnt(10)
    ds_read_b64_tr_b16 v[32:33], v8 offset:6208
    ds_read_b64_tr_b16 v[34:35], v8 offset:9280
    v_mfma_f32_16x16x32_bf16 v[72:75], v[40:43], v[128:131], v[72:75]
    s_waitcnt lgkmcnt(10)
    ds_read_b64_tr_b16 v[36:37], v9 offset:6208
    ds_read_b64_tr_b16 v[38:39], v9 offset:9280
    buffer_load_dwordx4 v112, s[28:31], s60 offen offset:0 lds
    v_mfma_f32_16x16x32_bf16 v[76:79], v[44:47], v[128:131], v[76:79]
    s_waitcnt lgkmcnt(10)
    ds_read_b64_tr_b16 v[40:41], v8 offset:6272
    ds_read_b64_tr_b16 v[42:43], v8 offset:9344
    v_mfma_f32_16x16x32_bf16 v[80:83], v[48:51], v[128:131], v[80:83]
    s_waitcnt lgkmcnt(10)
    ds_read_b64_tr_b16 v[44:45], v9 offset:6272
    ds_read_b64_tr_b16 v[46:47], v9 offset:9344
    v_mfma_f32_16x16x32_bf16 v[84:87], v[52:55], v[128:131], v[84:87]
    s_waitcnt vmcnt(15) lgkmcnt(10)
    ds_read_b64_tr_b16 v[48:49], v8 offset:12288
    ds_read_b64_tr_b16 v[50:51], v8 offset:15360
    v_mfma_f32_16x16x32_bf16 v[64:67], v[56:59], v[132:135], v[64:67]
    s_waitcnt lgkmcnt(10)
    ds_read_b64_tr_b16 v[52:53], v9 offset:12288
    ds_read_b64_tr_b16 v[54:55], v9 offset:15360
    v_mfma_f32_16x16x32_bf16 v[68:71], v[60:63], v[132:135], v[68:71]
    s_waitcnt lgkmcnt(10)
    ds_read_b64_tr_b16 v[56:57], v8 offset:12352
    ds_read_b64_tr_b16 v[58:59], v8 offset:15424
    buffer_load_dwordx4 v113, s[28:31], s60 offen offset:1024 lds
    v_mfma_f32_16x16x32_bf16 v[72:75], v[32:35], v[132:135], v[72:75]
    s_waitcnt lgkmcnt(10)
    ds_read_b64_tr_b16 v[60:61], v9 offset:12352
    ds_read_b64_tr_b16 v[62:63], v9 offset:15424
    v_mfma_f32_16x16x32_bf16 v[76:79], v[36:39], v[132:135], v[76:79]
    s_waitcnt lgkmcnt(10)
    ds_read_b64_tr_b16 v[32:33], v8 offset:12416
    ds_read_b64_tr_b16 v[34:35], v8 offset:15488
    v_mfma_f32_16x16x32_bf16 v[80:83], v[40:43], v[132:135], v[80:83]
    s_waitcnt lgkmcnt(10)
    ds_read_b64_tr_b16 v[36:37], v9 offset:12416
    ds_read_b64_tr_b16 v[38:39], v9 offset:15488
    v_mfma_f32_16x16x32_bf16 v[84:87], v[44:47], v[132:135], v[84:87]
    s_waitcnt vmcnt(15) lgkmcnt(10)
    ds_read_b64_tr_b16 v[40:41], v8 offset:18432
    ds_read_b64_tr_b16 v[42:43], v8 offset:21504
    v_mfma_f32_16x16x32_bf16 v[64:67], v[48:51], v[136:139], v[64:67]
    s_waitcnt lgkmcnt(10)
    ds_read_b64_tr_b16 v[44:45], v9 offset:18432
    ds_read_b64_tr_b16 v[46:47], v9 offset:21504
    buffer_load_dwordx4 v114, s[28:31], s60 offen offset:2048 lds
    v_mfma_f32_16x16x32_bf16 v[68:71], v[52:55], v[136:139], v[68:71]
    s_waitcnt lgkmcnt(10)
    ds_read_b64_tr_b16 v[48:49], v8 offset:18496
    ds_read_b64_tr_b16 v[50:51], v8 offset:21568
    v_mfma_f32_16x16x32_bf16 v[72:75], v[56:59], v[136:139], v[72:75]
    s_waitcnt lgkmcnt(10)
    ds_read_b64_tr_b16 v[52:53], v9 offset:18496
    ds_read_b64_tr_b16 v[54:55], v9 offset:21568
    v_mfma_f32_16x16x32_bf16 v[76:79], v[60:63], v[136:139], v[76:79]
    s_waitcnt lgkmcnt(10)
    ds_read_b64_tr_b16 v[56:57], v8 offset:18560
    ds_read_b64_tr_b16 v[58:59], v8 offset:21632
    v_mfma_f32_16x16x32_bf16 v[80:83], v[32:35], v[136:139], v[80:83]
    s_waitcnt lgkmcnt(10)
    ds_read_b64_tr_b16 v[60:61], v9 offset:18560
    ds_read_b64_tr_b16 v[62:63], v9 offset:21632
    v_mfma_f32_16x16x32_bf16 v[84:87], v[36:39], v[136:139], v[84:87]
    s_waitcnt vmcnt(15) lgkmcnt(10)
    ds_read_b64_tr_b16 v[32:33], v8 offset:24576
    ds_read_b64_tr_b16 v[34:35], v8 offset:27648
    buffer_load_dwordx4 v115, s[28:31], s60 offen offset:3072 lds
    v_mfma_f32_16x16x32_bf16 v[64:67], v[40:43], v[140:143], v[64:67]
    s_add_u32 m0, s55, 114688
    s_waitcnt lgkmcnt(10)
    ds_read_b64_tr_b16 v[36:37], v9 offset:24576
    ds_read_b64_tr_b16 v[38:39], v9 offset:27648
    v_mfma_f32_16x16x32_bf16 v[68:71], v[44:47], v[140:143], v[68:71]
    s_add_u32 s60, s67, 131072
    s_waitcnt lgkmcnt(10)
    ds_read_b64_tr_b16 v[40:41], v8 offset:24640
    ds_read_b64_tr_b16 v[42:43], v8 offset:27712
    v_mfma_f32_16x16x32_bf16 v[72:75], v[48:51], v[140:143], v[72:75]
    s_waitcnt lgkmcnt(10)
    ds_read_b64_tr_b16 v[44:45], v9 offset:24640
    ds_read_b64_tr_b16 v[46:47], v9 offset:27712
    v_mfma_f32_16x16x32_bf16 v[76:79], v[52:55], v[140:143], v[76:79]
    s_waitcnt lgkmcnt(10)
    ds_read_b64_tr_b16 v[48:49], v8 offset:24704
    ds_read_b64_tr_b16 v[50:51], v8 offset:27776
    v_mfma_f32_16x16x32_bf16 v[80:83], v[56:59], v[140:143], v[80:83]
    s_waitcnt lgkmcnt(10)
    ds_read_b64_tr_b16 v[52:53], v9 offset:24704
    ds_read_b64_tr_b16 v[54:55], v9 offset:27776
    buffer_load_dwordx4 v112, s[28:31], s60 offen offset:0 lds
    v_mfma_f32_16x16x32_bf16 v[84:87], v[60:63], v[140:143], v[84:87]
    s_waitcnt vmcnt(16) lgkmcnt(10)
    ds_read_b64_tr_b16 v[56:57], v8 offset:30720
    ds_read_b64_tr_b16 v[58:59], v8 offset:33792
    v_mfma_f32_16x16x32_bf16 v[64:67], v[32:35], v[144:147], v[64:67]
    s_waitcnt lgkmcnt(10)
    ds_read_b64_tr_b16 v[60:61], v9 offset:30720
    ds_read_b64_tr_b16 v[62:63], v9 offset:33792
    v_mfma_f32_16x16x32_bf16 v[68:71], v[36:39], v[144:147], v[68:71]
    s_waitcnt lgkmcnt(10)
    ds_read_b64_tr_b16 v[32:33], v8 offset:30784
    ds_read_b64_tr_b16 v[34:35], v8 offset:33856
    v_mfma_f32_16x16x32_bf16 v[72:75], v[40:43], v[144:147], v[72:75]
    s_waitcnt lgkmcnt(10)
    ds_read_b64_tr_b16 v[36:37], v9 offset:30784
    ds_read_b64_tr_b16 v[38:39], v9 offset:33856
    v_mfma_f32_16x16x32_bf16 v[76:79], v[44:47], v[144:147], v[76:79]
    s_waitcnt lgkmcnt(10)
    ds_read_b64_tr_b16 v[40:41], v8 offset:30848
    ds_read_b64_tr_b16 v[42:43], v8 offset:33920
    buffer_load_dwordx4 v113, s[28:31], s60 offen offset:1024 lds
    v_mfma_f32_16x16x32_bf16 v[80:83], v[48:51], v[144:147], v[80:83]
    s_waitcnt lgkmcnt(10)
    ds_read_b64_tr_b16 v[44:45], v9 offset:30848
    ds_read_b64_tr_b16 v[46:47], v9 offset:33920
    v_mfma_f32_16x16x32_bf16 v[84:87], v[52:55], v[144:147], v[84:87]
    s_waitcnt vmcnt(16) lgkmcnt(10)
    ds_read_b64_tr_b16 v[48:49], v8 offset:36864
    ds_read_b64_tr_b16 v[50:51], v8 offset:39936
    v_mfma_f32_16x16x32_bf16 v[64:67], v[56:59], v[148:151], v[64:67]
    s_waitcnt lgkmcnt(10)
    ds_read_b64_tr_b16 v[52:53], v9 offset:36864
    ds_read_b64_tr_b16 v[54:55], v9 offset:39936
    v_mfma_f32_16x16x32_bf16 v[68:71], v[60:63], v[148:151], v[68:71]
    s_waitcnt lgkmcnt(10)
    ds_read_b64_tr_b16 v[56:57], v8 offset:36928
    ds_read_b64_tr_b16 v[58:59], v8 offset:40000
    v_mfma_f32_16x16x32_bf16 v[72:75], v[32:35], v[148:151], v[72:75]
    s_waitcnt lgkmcnt(10)
    ds_read_b64_tr_b16 v[60:61], v9 offset:36928
    ds_read_b64_tr_b16 v[62:63], v9 offset:40000
    buffer_load_dwordx4 v114, s[28:31], s60 offen offset:2048 lds
    v_mfma_f32_16x16x32_bf16 v[76:79], v[36:39], v[148:151], v[76:79]
    s_waitcnt lgkmcnt(10)
    ds_read_b64_tr_b16 v[32:33], v8 offset:36992
    ds_read_b64_tr_b16 v[34:35], v8 offset:40064
    v_mfma_f32_16x16x32_bf16 v[80:83], v[40:43], v[148:151], v[80:83]
    s_waitcnt lgkmcnt(10)
    ds_read_b64_tr_b16 v[36:37], v9 offset:36992
    ds_read_b64_tr_b16 v[38:39], v9 offset:40064
    v_mfma_f32_16x16x32_bf16 v[84:87], v[44:47], v[148:151], v[84:87]
    s_waitcnt vmcnt(16) lgkmcnt(10)
    ds_read_b64_tr_b16 v[40:41], v8 offset:43008
    ds_read_b64_tr_b16 v[42:43], v8 offset:46080
    v_mfma_f32_16x16x32_bf16 v[64:67], v[48:51], v[152:155], v[64:67]
    s_waitcnt lgkmcnt(10)
    ds_read_b64_tr_b16 v[44:45], v9 offset:43008
    ds_read_b64_tr_b16 v[46:47], v9 offset:46080
    v_mfma_f32_16x16x32_bf16 v[68:71], v[52:55], v[152:155], v[68:71]
    s_waitcnt lgkmcnt(10)
    ds_read_b64_tr_b16 v[48:49], v8 offset:43072
    ds_read_b64_tr_b16 v[50:51], v8 offset:46144
    buffer_load_dwordx4 v115, s[28:31], s60 offen offset:3072 lds
    v_mfma_f32_16x16x32_bf16 v[72:75], v[56:59], v[152:155], v[72:75]
    s_add_u32 m0, s55, 131072
    s_waitcnt lgkmcnt(10)
    ds_read_b64_tr_b16 v[52:53], v9 offset:43072
    ds_read_b64_tr_b16 v[54:55], v9 offset:46144
    v_mfma_f32_16x16x32_bf16 v[76:79], v[60:63], v[152:155], v[76:79]
    s_add_u32 s60, s67, 163840
    s_waitcnt lgkmcnt(10)
    ds_read_b64_tr_b16 v[56:57], v8 offset:43136
    ds_read_b64_tr_b16 v[58:59], v8 offset:46208
    v_mfma_f32_16x16x32_bf16 v[80:83], v[32:35], v[152:155], v[80:83]
    s_waitcnt lgkmcnt(10)
    ds_read_b64_tr_b16 v[60:61], v9 offset:43136
    ds_read_b64_tr_b16 v[62:63], v9 offset:46208
    v_mfma_f32_16x16x32_bf16 v[84:87], v[36:39], v[152:155], v[84:87]
    s_waitcnt vmcnt(16) lgkmcnt(10)
    ds_read_b64_tr_b16 v[32:33], v8 offset:49152
    ds_read_b64_tr_b16 v[34:35], v8 offset:52224
    v_mfma_f32_16x16x32_bf16 v[64:67], v[40:43], v[156:159], v[64:67]
    s_waitcnt lgkmcnt(10)
    ds_read_b64_tr_b16 v[36:37], v9 offset:49152
    ds_read_b64_tr_b16 v[38:39], v9 offset:52224
    buffer_load_dwordx4 v112, s[28:31], s60 offen offset:0 lds
    v_mfma_f32_16x16x32_bf16 v[68:71], v[44:47], v[156:159], v[68:71]
    s_waitcnt lgkmcnt(10)
    ds_read_b64_tr_b16 v[40:41], v8 offset:49216
    ds_read_b64_tr_b16 v[42:43], v8 offset:52288
    v_mfma_f32_16x16x32_bf16 v[72:75], v[48:51], v[156:159], v[72:75]
    s_waitcnt lgkmcnt(10)
    ds_read_b64_tr_b16 v[44:45], v9 offset:49216
    ds_read_b64_tr_b16 v[46:47], v9 offset:52288
    v_mfma_f32_16x16x32_bf16 v[76:79], v[52:55], v[156:159], v[76:79]
    s_waitcnt lgkmcnt(10)
    ds_read_b64_tr_b16 v[48:49], v8 offset:49280
    ds_read_b64_tr_b16 v[50:51], v8 offset:52352
    v_mfma_f32_16x16x32_bf16 v[80:83], v[56:59], v[156:159], v[80:83]
    s_waitcnt lgkmcnt(10)
    ds_read_b64_tr_b16 v[52:53], v9 offset:49280
    ds_read_b64_tr_b16 v[54:55], v9 offset:52352
    v_mfma_f32_16x16x32_bf16 v[84:87], v[60:63], v[156:159], v[84:87]
    s_waitcnt vmcnt(16) lgkmcnt(10)
    ds_read_b64_tr_b16 v[56:57], v8 offset:55296
    ds_read_b64_tr_b16 v[58:59], v8 offset:58368
    buffer_load_dwordx4 v113, s[28:31], s60 offen offset:1024 lds
    v_mfma_f32_16x16x32_bf16 v[64:67], v[32:35], v[160:163], v[64:67]
    s_waitcnt lgkmcnt(10)
    ds_read_b64_tr_b16 v[60:61], v9 offset:55296
    ds_read_b64_tr_b16 v[62:63], v9 offset:58368
    v_mfma_f32_16x16x32_bf16 v[68:71], v[36:39], v[160:163], v[68:71]
    s_waitcnt lgkmcnt(10)
    ds_read_b64_tr_b16 v[32:33], v8 offset:55360
    ds_read_b64_tr_b16 v[34:35], v8 offset:58432
    v_mfma_f32_16x16x32_bf16 v[72:75], v[40:43], v[160:163], v[72:75]
    s_waitcnt lgkmcnt(10)
    ds_read_b64_tr_b16 v[36:37], v9 offset:55360
    ds_read_b64_tr_b16 v[38:39], v9 offset:58432
    v_mfma_f32_16x16x32_bf16 v[76:79], v[44:47], v[160:163], v[76:79]
    s_waitcnt lgkmcnt(10)
    ds_read_b64_tr_b16 v[40:41], v8 offset:55424
    ds_read_b64_tr_b16 v[42:43], v8 offset:58496
    v_mfma_f32_16x16x32_bf16 v[80:83], v[48:51], v[160:163], v[80:83]
    s_waitcnt lgkmcnt(10)
    ds_read_b64_tr_b16 v[44:45], v9 offset:55424
    ds_read_b64_tr_b16 v[46:47], v9 offset:58496
    buffer_load_dwordx4 v114, s[28:31], s60 offen offset:2048 lds
    v_mfma_f32_16x16x32_bf16 v[84:87], v[52:55], v[160:163], v[84:87]
    s_waitcnt vmcnt(17) lgkmcnt(10)
    ds_read_b64_tr_b16 v[48:49], v8 offset:61440
    ds_read_b64_tr_b16 v[50:51], v8 offset:64512
    v_mfma_f32_16x16x32_bf16 v[64:67], v[56:59], v[164:167], v[64:67]
    s_waitcnt lgkmcnt(10)
    ds_read_b64_tr_b16 v[52:53], v9 offset:61440
    ds_read_b64_tr_b16 v[54:55], v9 offset:64512
    v_mfma_f32_16x16x32_bf16 v[68:71], v[60:63], v[164:167], v[68:71]
    s_waitcnt lgkmcnt(10)
    ds_read_b64_tr_b16 v[56:57], v8 offset:61504
    ds_read_b64_tr_b16 v[58:59], v8 offset:64576
    v_mfma_f32_16x16x32_bf16 v[72:75], v[32:35], v[164:167], v[72:75]
    s_waitcnt lgkmcnt(10)
    ds_read_b64_tr_b16 v[60:61], v9 offset:61504
    ds_read_b64_tr_b16 v[62:63], v9 offset:64576
    v_mfma_f32_16x16x32_bf16 v[76:79], v[36:39], v[164:167], v[76:79]
    s_waitcnt lgkmcnt(10)
    ds_read_b64_tr_b16 v[32:33], v8 offset:61568
    ds_read_b64_tr_b16 v[34:35], v8 offset:64640
    buffer_load_dwordx4 v115, s[28:31], s60 offen offset:3072 lds
    v_mfma_f32_16x16x32_bf16 v[80:83], v[40:43], v[164:167], v[80:83]
    s_add_u32 m0, s55, 147456
    s_waitcnt lgkmcnt(10)
    ds_read_b64_tr_b16 v[36:37], v9 offset:61568
    ds_read_b64_tr_b16 v[38:39], v9 offset:64640
    v_mfma_f32_16x16x32_bf16 v[84:87], v[44:47], v[164:167], v[84:87]
    s_add_u32 s60, s67, 196608
    s_waitcnt vmcnt(17) lgkmcnt(10)
    v_add_u32 v8, 0x10000, v8
    ds_read_b64_tr_b16 v[40:41], v8 offset:2048
    ds_read_b64_tr_b16 v[42:43], v8 offset:5120
    v_add_u32 v9, 0x10000, v9
    v_mfma_f32_16x16x32_bf16 v[64:67], v[48:51], v[168:171], v[64:67]
    s_waitcnt lgkmcnt(10)
    ds_read_b64_tr_b16 v[44:45], v9 offset:2048
    ds_read_b64_tr_b16 v[46:47], v9 offset:5120
    v_mfma_f32_16x16x32_bf16 v[68:71], v[52:55], v[168:171], v[68:71]
    s_waitcnt lgkmcnt(10)
    ds_read_b64_tr_b16 v[48:49], v8 offset:2112
    ds_read_b64_tr_b16 v[50:51], v8 offset:5184
    v_mfma_f32_16x16x32_bf16 v[72:75], v[56:59], v[168:171], v[72:75]
    s_waitcnt lgkmcnt(10)
    ds_read_b64_tr_b16 v[52:53], v9 offset:2112
    ds_read_b64_tr_b16 v[54:55], v9 offset:5184
    buffer_load_dword v28, off, s[84:87], s71 sc1
    v_mfma_f32_16x16x32_bf16 v[76:79], v[60:63], v[168:171], v[76:79]
    s_waitcnt lgkmcnt(10)
    ds_read_b64_tr_b16 v[56:57], v8 offset:2176
    ds_read_b64_tr_b16 v[58:59], v8 offset:5248
    v_mfma_f32_16x16x32_bf16 v[80:83], v[32:35], v[168:171], v[80:83]
    s_waitcnt lgkmcnt(10)
    ds_read_b64_tr_b16 v[60:61], v9 offset:2176
    ds_read_b64_tr_b16 v[62:63], v9 offset:5248
    v_mfma_f32_16x16x32_bf16 v[84:87], v[36:39], v[168:171], v[84:87]
    s_waitcnt vmcnt(17) lgkmcnt(10)
    ds_read_b64_tr_b16 v[32:33], v8 offset:8192
    ds_read_b64_tr_b16 v[34:35], v8 offset:11264
    v_mfma_f32_16x16x32_bf16 v[64:67], v[40:43], v[172:175], v[64:67]
    s_waitcnt lgkmcnt(10)
    ds_read_b64_tr_b16 v[36:37], v9 offset:8192
    ds_read_b64_tr_b16 v[38:39], v9 offset:11264
    v_mfma_f32_16x16x32_bf16 v[68:71], v[44:47], v[172:175], v[68:71]
    s_waitcnt lgkmcnt(10)
    ds_read_b64_tr_b16 v[40:41], v8 offset:8256
    ds_read_b64_tr_b16 v[42:43], v8 offset:11328
    buffer_load_dwordx4 v112, s[28:31], s60 offen offset:0 lds
    v_mfma_f32_16x16x32_bf16 v[72:75], v[48:51], v[172:175], v[72:75]
    s_waitcnt lgkmcnt(10)
    ds_read_b64_tr_b16 v[44:45], v9 offset:8256
    ds_read_b64_tr_b16 v[46:47], v9 offset:11328
    v_mfma_f32_16x16x32_bf16 v[76:79], v[52:55], v[172:175], v[76:79]
    s_waitcnt lgkmcnt(10)
    ds_read_b64_tr_b16 v[48:49], v8 offset:8320
    ds_read_b64_tr_b16 v[50:51], v8 offset:11392
    v_mfma_f32_16x16x32_bf16 v[80:83], v[56:59], v[172:175], v[80:83]
    s_waitcnt lgkmcnt(10)
    ds_read_b64_tr_b16 v[52:53], v9 offset:8320
    ds_read_b64_tr_b16 v[54:55], v9 offset:11392
    v_mfma_f32_16x16x32_bf16 v[84:87], v[60:63], v[172:175], v[84:87]
    s_waitcnt vmcnt(17) lgkmcnt(10)
    ds_read_b64_tr_b16 v[56:57], v8 offset:14336
    ds_read_b64_tr_b16 v[58:59], v8 offset:17408
    v_mfma_f32_16x16x32_bf16 v[64:67], v[32:35], v[176:179], v[64:67]
    s_waitcnt lgkmcnt(10)
    ds_read_b64_tr_b16 v[60:61], v9 offset:14336
    ds_read_b64_tr_b16 v[62:63], v9 offset:17408
    buffer_load_dwordx4 v113, s[28:31], s60 offen offset:1024 lds
    v_mfma_f32_16x16x32_bf16 v[68:71], v[36:39], v[176:179], v[68:71]
    s_waitcnt lgkmcnt(10)
    ds_read_b64_tr_b16 v[32:33], v8 offset:14400
    ds_read_b64_tr_b16 v[34:35], v8 offset:17472
    v_mfma_f32_16x16x32_bf16 v[72:75], v[40:43], v[176:179], v[72:75]
    s_waitcnt lgkmcnt(10)
    ds_read_b64_tr_b16 v[36:37], v9 offset:14400
    ds_read_b64_tr_b16 v[38:39], v9 offset:17472
    v_mfma_f32_16x16x32_bf16 v[76:79], v[44:47], v[176:179], v[76:79]
    s_waitcnt lgkmcnt(10)
    ds_read_b64_tr_b16 v[40:41], v8 offset:14464
    ds_read_b64_tr_b16 v[42:43], v8 offset:17536
    v_mfma_f32_16x16x32_bf16 v[80:83], v[48:51], v[176:179], v[80:83]
    s_waitcnt lgkmcnt(10)
    ds_read_b64_tr_b16 v[44:45], v9 offset:14464
    ds_read_b64_tr_b16 v[46:47], v9 offset:17536
    v_mfma_f32_16x16x32_bf16 v[84:87], v[52:55], v[176:179], v[84:87]
    s_waitcnt vmcnt(17) lgkmcnt(10)
    ds_read_b64_tr_b16 v[48:49], v8 offset:20480
    ds_read_b64_tr_b16 v[50:51], v8 offset:23552
    buffer_load_dwordx4 v114, s[28:31], s60 offen offset:2048 lds
    v_mfma_f32_16x16x32_bf16 v[64:67], v[56:59], v[180:183], v[64:67]
    s_waitcnt lgkmcnt(10)
    ds_read_b64_tr_b16 v[52:53], v9 offset:20480
    ds_read_b64_tr_b16 v[54:55], v9 offset:23552
    v_mfma_f32_16x16x32_bf16 v[68:71], v[60:63], v[180:183], v[68:71]
    s_waitcnt lgkmcnt(10)
    ds_read_b64_tr_b16 v[56:57], v8 offset:20544
    ds_read_b64_tr_b16 v[58:59], v8 offset:23616
    v_mfma_f32_16x16x32_bf16 v[72:75], v[32:35], v[180:183], v[72:75]
    s_waitcnt lgkmcnt(10)
    ds_read_b64_tr_b16 v[60:61], v9 offset:20544
    ds_read_b64_tr_b16 v[62:63], v9 offset:23616
    v_mfma_f32_16x16x32_bf16 v[76:79], v[36:39], v[180:183], v[76:79]
    s_waitcnt lgkmcnt(10)
    ds_read_b64_tr_b16 v[32:33], v8 offset:20608
    ds_read_b64_tr_b16 v[34:35], v8 offset:23680
    v_mfma_f32_16x16x32_bf16 v[80:83], v[40:43], v[180:183], v[80:83]
    s_waitcnt lgkmcnt(10)
    ds_read_b64_tr_b16 v[36:37], v9 offset:20608
    ds_read_b64_tr_b16 v[38:39], v9 offset:23680
    buffer_load_dwordx4 v115, s[28:31], s60 offen offset:3072 lds
    v_mfma_f32_16x16x32_bf16 v[84:87], v[44:47], v[180:183], v[84:87]
    s_waitcnt vmcnt(18) lgkmcnt(10)
    ds_read_b64_tr_b16 v[40:41], v8 offset:26624
    ds_read_b64_tr_b16 v[42:43], v8 offset:29696
    v_mfma_f32_16x16x32_bf16 v[64:67], v[48:51], v[184:187], v[64:67]
    s_waitcnt lgkmcnt(10)
    ds_read_b64_tr_b16 v[44:45], v9 offset:26624
    ds_read_b64_tr_b16 v[46:47], v9 offset:29696
    v_mfma_f32_16x16x32_bf16 v[68:71], v[52:55], v[184:187], v[68:71]
    s_waitcnt lgkmcnt(10)
    ds_read_b64_tr_b16 v[48:49], v8 offset:26688
    ds_read_b64_tr_b16 v[50:51], v8 offset:29760
    v_mfma_f32_16x16x32_bf16 v[72:75], v[56:59], v[184:187], v[72:75]
    s_waitcnt lgkmcnt(10)
    ds_read_b64_tr_b16 v[52:53], v9 offset:26688
    ds_read_b64_tr_b16 v[54:55], v9 offset:29760
    v_mfma_f32_16x16x32_bf16 v[76:79], v[60:63], v[184:187], v[76:79]
    s_waitcnt lgkmcnt(10)
    ds_read_b64_tr_b16 v[56:57], v8 offset:26752
    ds_read_b64_tr_b16 v[58:59], v8 offset:29824
    v_mfma_f32_16x16x32_bf16 v[80:83], v[32:35], v[184:187], v[80:83]
    s_waitcnt lgkmcnt(10)
    ds_read_b64_tr_b16 v[60:61], v9 offset:26752
    ds_read_b64_tr_b16 v[62:63], v9 offset:29824
    v_mfma_f32_16x16x32_bf16 v[84:87], v[36:39], v[184:187], v[84:87]
    s_waitcnt vmcnt(17) lgkmcnt(10)
    v_add_u32 v8, 0xffff0000, v8
    ds_read_b64_tr_b16 v[32:33], v8 offset:0
    ds_read_b64_tr_b16 v[34:35], v8 offset:3072
    v_add_u32 v9, 0xffff0000, v9
    v_mfma_f32_16x16x32_bf16 v[64:67], v[40:43], v[188:191], v[64:67]
    s_waitcnt lgkmcnt(10)
    ds_read_b64_tr_b16 v[36:37], v9 offset:0
    ds_read_b64_tr_b16 v[38:39], v9 offset:3072
    v_mfma_f32_16x16x32_bf16 v[68:71], v[44:47], v[188:191], v[68:71]
    s_waitcnt lgkmcnt(10)
    ds_read_b64_tr_b16 v[40:41], v8 offset:64
    ds_read_b64_tr_b16 v[42:43], v8 offset:3136
    v_mfma_f32_16x16x32_bf16 v[72:75], v[48:51], v[188:191], v[72:75]
    s_waitcnt lgkmcnt(10)
    ds_read_b64_tr_b16 v[44:45], v9 offset:64
    ds_read_b64_tr_b16 v[46:47], v9 offset:3136
    v_mfma_f32_16x16x32_bf16 v[76:79], v[52:55], v[188:191], v[76:79]
    s_waitcnt lgkmcnt(10)
    ds_read_b64_tr_b16 v[48:49], v8 offset:128
    ds_read_b64_tr_b16 v[50:51], v8 offset:3200
    v_mfma_f32_16x16x32_bf16 v[80:83], v[56:59], v[188:191], v[80:83]
    s_waitcnt lgkmcnt(10)
    ds_read_b64_tr_b16 v[52:53], v9 offset:128
    ds_read_b64_tr_b16 v[54:55], v9 offset:3200
    v_mfma_f32_16x16x32_bf16 v[84:87], v[60:63], v[188:191], v[84:87]
    ds_read_b64_tr_b16 v[56:57], v8 offset:6144
    ds_read_b64_tr_b16 v[58:59], v8 offset:9216
    s_waitcnt vmcnt(4)
    v_cmp_gt_u32 vcc, 16, v28
    s_nop 1
    s_cbranch_vccnz main_spin54
main_back55:
    s_add_u32 s60, s56, 1048576
    buffer_load_dwordx4 v[192:195], v15, s[48:51], s60 offen offset:0 sc1
    v_pk_mul_f32 v[128:129], v[64:65], v[64:65]
    v_pk_mul_f32 v[130:131], v[66:67], v[66:67]
    v_pk_mul_f32 v[132:133], v[68:69], v[68:69]
    v_pk_mul_f32 v[134:135], v[70:71], v[70:71]
    buffer_load_dwordx4 v[196:199], v15, s[48:51], s60 offen offset:1024 sc1
    v_pk_mul_f32 v[136:137], v[72:73], v[72:73]
    v_pk_mul_f32 v[138:139], v[74:75], v[74:75]
    v_pk_mul_f32 v[140:141], v[76:77], v[76:77]
    v_pk_mul_f32 v[142:143], v[78:79], v[78:79]
    buffer_load_dwordx4 v[200:203], v15, s[48:51], s60 offen offset:2048 sc1
    v_pk_mul_f32 v[144:145], v[80:81], v[80:81]
    v_pk_mul_f32 v[146:147], v[82:83], v[82:83]
    v_pk_mul_f32 v[148:149], v[84:85], v[84:85]
    v_pk_mul_f32 v[150:151], v[86:87], v[86:87]
    buffer_load_dwordx4 v[204:207], v15, s[48:51], s60 offen offset:3072 sc1
    v_pk_fma_f32 v[128:129], v[128:129], v[24:25], v[22:23] op_sel_hi:[1,0,0]
    v_pk_fma_f32 v[130:131], v[130:131], v[24:25], v[22:23] op_sel_hi:[1,0,0]
    v_pk_fma_f32 v[132:133], v[132:133], v[24:25], v[22:23] op_sel_hi:[1,0,0]
    v_pk_fma_f32 v[134:135], v[134:135], v[24:25], v[22:23] op_sel_hi:[1,0,0]
    s_add_u32 s60, s56, 1052672
    buffer_load_dwordx4 v[208:211], v15, s[48:51], s60 offen offset:0 sc1
    v_pk_fma_f32 v[136:137], v[136:137], v[24:25], v[22:23] op_sel_hi:[1,0,0]
    v_pk_fma_f32 v[138:139], v[138:139], v[24:25], v[22:23] op_sel_hi:[1,0,0]
    v_pk_fma_f32 v[140:141], v[140:141], v[24:25], v[22:23] op_sel_hi:[1,0,0]
    v_pk_fma_f32 v[142:143], v[142:143], v[24:25], v[22:23] op_sel_hi:[1,0,0]
    buffer_load_dwordx4 v[212:215], v15, s[48:51], s60 offen offset:1024 sc1
    v_pk_fma_f32 v[144:145], v[144:145], v[24:25], v[22:23] op_sel_hi:[1,0,0]
    v_pk_fma_f32 v[146:147], v[146:147], v[24:25], v[22:23] op_sel_hi:[1,0,0]
    v_pk_fma_f32 v[148:149], v[148:149], v[24:25], v[22:23] op_sel_hi:[1,0,0]
    v_pk_fma_f32 v[150:151], v[150:151], v[24:25], v[22:23] op_sel_hi:[1,0,0]
    buffer_load_dwordx4 v[216:219], v15, s[48:51], s60 offen offset:2048 sc1
    v_pk_mul_f32 v[128:129], v[128:129], v[64:65]
    v_pk_mul_f32 v[130:131], v[130:131], v[66:67]
    v_pk_mul_f32 v[132:133], v[132:133], v[68:69]
    v_pk_mul_f32 v[134:135], v[134:135], v[70:71]
    buffer_load_dwordx4 v[220:223], v15, s[48:51], s60 offen offset:3072 sc1
    v_pk_mul_f32 v[136:137], v[136:137], v[72:73]
    v_pk_mul_f32 v[138:139], v[138:139], v[74:75]
    v_pk_mul_f32 v[140:141], v[140:141], v[76:77]
    v_pk_mul_f32 v[142:143], v[142:143], v[78:79]
    s_add_u32 s60, s56, 1056768
    buffer_load_dwordx4 v[224:227], v15, s[48:51], s60 offen offset:0 sc1
    v_pk_mul_f32 v[144:145], v[144:145], v[80:81]
    v_pk_mul_f32 v[146:147], v[146:147], v[82:83]
    v_pk_mul_f32 v[148:149], v[148:149], v[84:85]
    v_pk_mul_f32 v[150:151], v[150:151], v[86:87]
    buffer_load_dwordx4 v[228:231], v15, s[48:51], s60 offen offset:1024 sc1
    v_exp_f32 v128, v128
    v_exp_f32 v129, v129
    v_exp_f32 v130, v130
    v_exp_f32 v131, v131
    buffer_load_dwordx4 v[232:235], v15, s[48:51], s60 offen offset:2048 sc1
    v_exp_f32 v132, v132
    v_exp_f32 v133, v133
    v_exp_f32 v134, v134
    v_exp_f32 v135, v135
    buffer_load_dwordx4 v[236:239], v15, s[48:51], s60 offen offset:3072 sc1
    v_exp_f32 v136, v136
    v_exp_f32 v137, v137
    v_exp_f32 v138, v138
    v_exp_f32 v139, v139
    s_add_u32 s60, s56, 1060864
    buffer_load_dwordx4 v[240:243], v15, s[48:51], s60 offen offset:0 sc1
    v_exp_f32 v140, v140
    v_exp_f32 v141, v141
    v_exp_f32 v142, v142
    v_exp_f32 v143, v143
    buffer_load_dwordx4 v[244:247], v15, s[48:51], s60 offen offset:1024 sc1
    v_exp_f32 v144, v144
    v_exp_f32 v145, v145
    v_exp_f32 v146, v146
    v_exp_f32 v147, v147
    buffer_load_dwordx4 v[248:251], v15, s[48:51], s60 offen offset:2048 sc1
    v_exp_f32 v148, v148
    v_exp_f32 v149, v149
    v_exp_f32 v150, v150
    v_exp_f32 v151, v151
    buffer_load_dwordx4 v[252:255], v15, s[48:51], s60 offen offset:3072 sc1
    v_pk_add_f32 v[128:129], v[128:129], v[26:27] op_sel_hi:[1,0]
    v_pk_add_f32 v[130:131], v[130:131], v[26:27] op_sel_hi:[1,0]
    v_pk_add_f32 v[132:133], v[132:133], v[26:27] op_sel_hi:[1,0]
    v_pk_add_f32 v[134:135], v[134:135], v[26:27] op_sel_hi:[1,0]
    v_add_u32 v116, 0xffff0000, v116
    v_add_u32 v117, 0xffff0000, v117
    v_add_u32 v118, 0xffff0000, v118
    v_add_u32 v119, 0xffff0000, v119
    ds_read_b64_tr_b16 a[48:49], v116 offset:32768
    v_pk_add_f32 v[136:137], v[136:137], v[26:27] op_sel_hi:[1,0]
    v_pk_add_f32 v[138:139], v[138:139], v[26:27] op_sel_hi:[1,0]
    ds_read_b64_tr_b16 a[50:51], v116 offset:34816
    v_pk_add_f32 v[140:141], v[140:141], v[26:27] op_sel_hi:[1,0]
    v_pk_add_f32 v[142:143], v[142:143], v[26:27] op_sel_hi:[1,0]
    ds_read_b64_tr_b16 a[52:53], v117 offset:32768
    v_pk_add_f32 v[144:145], v[144:145], v[26:27] op_sel_hi:[1,0]
    v_pk_add_f32 v[146:147], v[146:147], v[26:27] op_sel_hi:[1,0]
    ds_read_b64_tr_b16 a[54:55], v117 offset:34816
    v_pk_add_f32 v[148:149], v[148:149], v[26:27] op_sel_hi:[1,0]
    v_pk_add_f32 v[150:151], v[150:151], v[26:27] op_sel_hi:[1,0]
    ds_read_b64_tr_b16 a[56:57], v118 offset:32768
    v_rcp_f32 v128, v128
    v_rcp_f32 v129, v129
    ds_read_b64_tr_b16 a[58:59], v118 offset:34816
    v_rcp_f32 v130, v130
    v_rcp_f32 v131, v131
    ds_read_b64_tr_b16 a[60:61], v119 offset:32768
    v_rcp_f32 v132, v132
    v_rcp_f32 v133, v133
    ds_read_b64_tr_b16 a[62:63], v119 offset:34816
    v_rcp_f32 v134, v134
    v_rcp_f32 v135, v135
    ds_read_b64_tr_b16 a[64:65], v116 offset:49152
    v_rcp_f32 v136, v136
    v_rcp_f32 v137, v137
    ds_read_b64_tr_b16 a[66:67], v116 offset:51200
    v_rcp_f32 v138, v138
    v_rcp_f32 v139, v139
    ds_read_b64_tr_b16 a[68:69], v117 offset:49152
    v_rcp_f32 v140, v140
    v_rcp_f32 v141, v141
    ds_read_b64_tr_b16 a[70:71], v117 offset:51200
    v_rcp_f32 v142, v142
    v_rcp_f32 v143, v143
    ds_read_b64_tr_b16 a[72:73], v118 offset:49152
    v_rcp_f32 v144, v144
    v_rcp_f32 v145, v145
    ds_read_b64_tr_b16 a[74:75], v118 offset:51200
    v_rcp_f32 v146, v146
    v_rcp_f32 v147, v147
    ds_read_b64_tr_b16 a[76:77], v119 offset:49152
    v_rcp_f32 v148, v148
    v_rcp_f32 v149, v149
    ds_read_b64_tr_b16 a[78:79], v119 offset:51200
    v_rcp_f32 v150, v150
    v_rcp_f32 v151, v151
    v_add_u32 v116, 0x10000, v116
    v_add_u32 v117, 0x10000, v117
    v_add_u32 v118, 0x10000, v118
    v_add_u32 v119, 0x10000, v119
    ds_read_b64_tr_b16 a[80:81], v116 offset:0
    v_pk_mul_f32 v[64:65], v[64:65], v[128:129]
    v_pk_mul_f32 v[66:67], v[66:67], v[130:131]
    ds_read_b64_tr_b16 a[82:83], v116 offset:2048
    v_pk_mul_f32 v[68:69], v[68:69], v[132:133]
    v_pk_mul_f32 v[70:71], v[70:71], v[134:135]
    ds_read_b64_tr_b16 a[84:85], v117 offset:0
    v_pk_mul_f32 v[72:73], v[72:73], v[136:137]
    v_pk_mul_f32 v[74:75], v[74:75], v[138:139]
    ds_read_b64_tr_b16 a[86:87], v117 offset:2048
    v_pk_mul_f32 v[76:77], v[76:77], v[140:141]
    v_pk_mul_f32 v[78:79], v[78:79], v[142:143]
    ds_read_b64_tr_b16 a[88:89], v118 offset:0
    v_pk_mul_f32 v[80:81], v[80:81], v[144:145]
    v_pk_mul_f32 v[82:83], v[82:83], v[146:147]
    ds_read_b64_tr_b16 a[90:91], v118 offset:2048
    v_pk_mul_f32 v[84:85], v[84:85], v[148:149]
    v_pk_mul_f32 v[86:87], v[86:87], v[150:151]
    ds_read_b64_tr_b16 a[92:93], v119 offset:0
    s_add_u32 s62, s18, 0
    s_or_b32 s63, s62, s19
    ds_read_b64_tr_b16 a[94:95], v119 offset:2048
    v_cvt_pk_bf16_f32 v64, v64, v65
    v_cvt_pk_bf16_f32 v65, v66, v67
    s_waitcnt vmcnt(16)
    ds_read_b64_tr_b16 a[96:97], v116 offset:16384
    v_cvt_pk_bf16_f32 v66, v68, v69
    v_cvt_pk_bf16_f32 v67, v70, v71
    ds_read_b64_tr_b16 a[98:99], v116 offset:18432
    buffer_store_dwordx4 v[64:67], v2, s[44:47], s62 offen offset:0 sc1
    v_cvt_pk_bf16_f32 v72, v72, v73
    ds_read_b64_tr_b16 a[100:101], v117 offset:16384
    v_cvt_pk_bf16_f32 v73, v74, v75
    v_cvt_pk_bf16_f32 v74, v76, v77
    ds_read_b64_tr_b16 a[102:103], v117 offset:18432
    v_cvt_pk_bf16_f32 v75, v78, v79
    buffer_store_dwordx4 v[72:75], v2, s[44:47], s63 offen offset:1024 sc1
    ds_read_b64_tr_b16 a[104:105], v118 offset:16384
    v_cvt_pk_bf16_f32 v80, v80, v81
    v_cvt_pk_bf16_f32 v81, v82, v83
    ds_read_b64_tr_b16 a[106:107], v118 offset:18432
    v_cvt_pk_bf16_f32 v82, v84, v85
    v_cvt_pk_bf16_f32 v83, v86, v87
    ds_read_b64_tr_b16 a[108:109], v119 offset:16384
    buffer_store_dwordx4 v[80:83], v2, s[44:47], s63 offen offset:2048 sc1
    ds_read_b64_tr_b16 a[110:111], v119 offset:18432
    s_waitcnt lgkmcnt(0)
    s_waitcnt vmcnt(18)
    v_mfma_f32_16x16x32_bf16 v[88:91], v[32:35], v[192:195], v[88:91]
    s_add_u32 m0, s55, 98304
    ds_read_b64_tr_b16 v[60:61], v9 offset:6144
    ds_read_b64_tr_b16 v[62:63], v9 offset:9216
    v_mfma_f32_16x16x32_bf16 v[92:95], v[36:39], v[192:195], v[92:95]
    s_add_u32 s60, s67, 229376
    ds_read_b64_tr_b16 v[32:33], v8 offset:6208
    ds_read_b64_tr_b16 v[34:35], v8 offset:9280
    v_mfma_f32_16x16x32_bf16 v[96:99], v[40:43], v[192:195], v[96:99]
    s_nop 0
    ds_read_b64_tr_b16 v[36:37], v9 offset:6208
    ds_read_b64_tr_b16 v[38:39], v9 offset:9280
    buffer_load_dwordx4 v112, s[28:31], s60 offen offset:0 lds
    v_mfma_f32_16x16x32_bf16 v[100:103], v[44:47], v[192:195], v[100:103]
    s_nop 0
    ds_read_b64_tr_b16 v[40:41], v8 offset:6272
    ds_read_b64_tr_b16 v[42:43], v8 offset:9344
    v_mfma_f32_16x16x32_bf16 v[104:107], v[48:51], v[192:195], v[104:107]
    s_nop 0
    ds_read_b64_tr_b16 v[44:45], v9 offset:6272
    ds_read_b64_tr_b16 v[46:47], v9 offset:9344
    v_mfma_f32_16x16x32_bf16 v[108:111], v[52:55], v[192:195], v[108:111]
    s_waitcnt vmcnt(18)
    ds_read_b64_tr_b16 v[48:49], v8 offset:12288
    ds_read_b64_tr_b16 v[50:51], v8 offset:15360
    v_mfma_f32_16x16x32_bf16 v[88:91], v[56:59], v[196:199], v[88:91]
    s_waitcnt lgkmcnt(10)
    ds_read_b64_tr_b16 v[52:53], v9 offset:12288
    ds_read_b64_tr_b16 v[54:55], v9 offset:15360
    v_mfma_f32_16x16x32_bf16 v[92:95], v[60:63], v[196:199], v[92:95]
    s_waitcnt lgkmcnt(10)
    ds_read_b64_tr_b16 v[56:57], v8 offset:12352
    ds_read_b64_tr_b16 v[58:59], v8 offset:15424
    buffer_load_dwordx4 v113, s[28:31], s60 offen offset:1024 lds
    v_mfma_f32_16x16x32_bf16 v[96:99], v[32:35], v[196:199], v[96:99]
    s_waitcnt lgkmcnt(10)
    ds_read_b64_tr_b16 v[60:61], v9 offset:12352
    ds_read_b64_tr_b16 v[62:63], v9 offset:15424
    v_mfma_f32_16x16x32_bf16 v[100:103], v[36:39], v[196:199], v[100:103]
    s_waitcnt lgkmcnt(10)
    ds_read_b64_tr_b16 v[32:33], v8 offset:12416
    ds_read_b64_tr_b16 v[34:35], v8 offset:15488
    v_mfma_f32_16x16x32_bf16 v[104:107], v[40:43], v[196:199], v[104:107]
    s_waitcnt lgkmcnt(10)
    ds_read_b64_tr_b16 v[36:37], v9 offset:12416
    ds_read_b64_tr_b16 v[38:39], v9 offset:15488
    v_mfma_f32_16x16x32_bf16 v[108:111], v[44:47], v[196:199], v[108:111]
    s_waitcnt vmcnt(18) lgkmcnt(10)
    ds_read_b64_tr_b16 v[40:41], v8 offset:18432
    ds_read_b64_tr_b16 v[42:43], v8 offset:21504
    v_mfma_f32_16x16x32_bf16 v[88:91], v[48:51], v[200:203], v[88:91]
    s_waitcnt lgkmcnt(10)
    ds_read_b64_tr_b16 v[44:45], v9 offset:18432
    ds_read_b64_tr_b16 v[46:47], v9 offset:21504
    buffer_load_dwordx4 v114, s[28:31], s60 offen offset:2048 lds
    v_mfma_f32_16x16x32_bf16 v[92:95], v[52:55], v[200:203], v[92:95]
    s_waitcnt lgkmcnt(10)
    ds_read_b64_tr_b16 v[48:49], v8 offset:18496
    ds_read_b64_tr_b16 v[50:51], v8 offset:21568
    v_mfma_f32_16x16x32_bf16 v[96:99], v[56:59], v[200:203], v[96:99]
    s_waitcnt lgkmcnt(10)
    ds_read_b64_tr_b16 v[52:53], v9 offset:18496
    ds_read_b64_tr_b16 v[54:55], v9 offset:21568
    v_mfma_f32_16x16x32_bf16 v[100:103], v[60:63], v[200:203], v[100:103]
    s_waitcnt lgkmcnt(10)
    ds_read_b64_tr_b16 v[56:57], v8 offset:18560
    ds_read_b64_tr_b16 v[58:59], v8 offset:21632
    v_mfma_f32_16x16x32_bf16 v[104:107], v[32:35], v[200:203], v[104:107]
    s_waitcnt lgkmcnt(10)
    ds_read_b64_tr_b16 v[60:61], v9 offset:18560
    ds_read_b64_tr_b16 v[62:63], v9 offset:21632
    v_mfma_f32_16x16x32_bf16 v[108:111], v[36:39], v[200:203], v[108:111]
    s_waitcnt vmcnt(18) lgkmcnt(10)
    ds_read_b64_tr_b16 v[32:33], v8 offset:24576
    ds_read_b64_tr_b16 v[34:35], v8 offset:27648
    buffer_load_dwordx4 v115, s[28:31], s60 offen offset:3072 lds
    v_mfma_f32_16x16x32_bf16 v[88:91], v[40:43], v[204:207], v[88:91]
    s_add_u32 m0, s55, 114688
    s_waitcnt lgkmcnt(10)
    ds_read_b64_tr_b16 v[36:37], v9 offset:24576
    ds_read_b64_tr_b16 v[38:39], v9 offset:27648
    v_mfma_f32_16x16x32_bf16 v[92:95], v[44:47], v[204:207], v[92:95]
    s_add_u32 s60, s67, 262144
    s_waitcnt lgkmcnt(10)
    ds_read_b64_tr_b16 v[40:41], v8 offset:24640
    ds_read_b64_tr_b16 v[42:43], v8 offset:27712
    v_mfma_f32_16x16x32_bf16 v[96:99], v[48:51], v[204:207], v[96:99]
    s_waitcnt lgkmcnt(10)
    ds_read_b64_tr_b16 v[44:45], v9 offset:24640
    ds_read_b64_tr_b16 v[46:47], v9 offset:27712
    v_mfma_f32_16x16x32_bf16 v[100:103], v[52:55], v[204:207], v[100:103]
    s_waitcnt lgkmcnt(10)
    ds_read_b64_tr_b16 v[48:49], v8 offset:24704
    ds_read_b64_tr_b16 v[50:51], v8 offset:27776
    v_mfma_f32_16x16x32_bf16 v[104:107], v[56:59], v[204:207], v[104:107]
    s_waitcnt lgkmcnt(10)
    ds_read_b64_tr_b16 v[52:53], v9 offset:24704
    ds_read_b64_tr_b16 v[54:55], v9 offset:27776
    buffer_load_dwordx4 v112, s[28:31], s60 offen offset:0 lds
    v_mfma_f32_16x16x32_bf16 v[108:111], v[60:63], v[204:207], v[108:111]
    ds_read_b64_tr_b16 v[56:57], v8 offset:30720
    ds_read_b64_tr_b16 v[58:59], v8 offset:33792
    s_waitcnt vmcnt(5)
    s_barrier
    s_cmp_lg_u32 s3, 0
    s_cbranch_scc1 main_skip56
    v_mov_b32 v3, 1
    s_mov_b64 exec, 1
    buffer_atomic_add v3, off, s[84:87], s76 sc1
    s_mov_b64 exec, -1
main_skip56:
    s_waitcnt lgkmcnt(12)
    v_mfma_f32_16x16x32_bf16 v[88:91], v[32:35], v[208:211], v[88:91]
    s_waitcnt lgkmcnt(10)
    ds_read_b64_tr_b16 v[60:61], v9 offset:30720
    ds_read_b64_tr_b16 v[62:63], v9 offset:33792
    v_mfma_f32_16x16x32_bf16 v[92:95], v[36:39], v[208:211], v[92:95]
    s_waitcnt lgkmcnt(10)
    ds_read_b64_tr_b16 v[32:33], v8 offset:30784
    ds_read_b64_tr_b16 v[34:35], v8 offset:33856
    v_mfma_f32_16x16x32_bf16 v[96:99], v[40:43], v[208:211], v[96:99]
    s_waitcnt lgkmcnt(10)
    ds_read_b64_tr_b16 v[36:37], v9 offset:30784
    ds_read_b64_tr_b16 v[38:39], v9 offset:33856
    v_mfma_f32_16x16x32_bf16 v[100:103], v[44:47], v[208:211], v[100:103]
    s_waitcnt lgkmcnt(10)
    ds_read_b64_tr_b16 v[40:41], v8 offset:30848
    ds_read_b64_tr_b16 v[42:43], v8 offset:33920
    buffer_load_dwordx4 v113, s[28:31], s60 offen offset:1024 lds
    v_mfma_f32_16x16x32_bf16 v[104:107], v[48:51], v[208:211], v[104:107]
    s_waitcnt lgkmcnt(10)
    ds_read_b64_tr_b16 v[44:45], v9 offset:30848
    ds_read_b64_tr_b16 v[46:47], v9 offset:33920
    v_mfma_f32_16x16x32_bf16 v[108:111], v[52:55], v[208:211], v[108:111]
    s_waitcnt lgkmcnt(10)
    ds_read_b64_tr_b16 v[48:49], v8 offset:36864
    ds_read_b64_tr_b16 v[50:51], v8 offset:39936
    v_mfma_f32_16x16x32_bf16 v[88:91], v[56:59], v[212:215], v[88:91]
    s_waitcnt lgkmcnt(10)
    ds_read_b64_tr_b16 v[52:53], v9 offset:36864
    ds_read_b64_tr_b16 v[54:55], v9 offset:39936
    v_mfma_f32_16x16x32_bf16 v[92:95], v[60:63], v[212:215], v[92:95]
    s_waitcnt lgkmcnt(10)
    ds_read_b64_tr_b16 v[56:57], v8 offset:36928
    ds_read_b64_tr_b16 v[58:59], v8 offset:40000
    v_mfma_f32_16x16x32_bf16 v[96:99], v[32:35], v[212:215], v[96:99]
    s_waitcnt lgkmcnt(10)
    ds_read_b64_tr_b16 v[60:61], v9 offset:36928
    ds_read_b64_tr_b16 v[62:63], v9 offset:40000
    buffer_load_dwordx4 v114, s[28:31], s60 offen offset:2048 lds
    v_mfma_f32_16x16x32_bf16 v[100:103], v[36:39], v[212:215], v[100:103]
    s_waitcnt lgkmcnt(10)
    ds_read_b64_tr_b16 v[32:33], v8 offset:36992
    ds_read_b64_tr_b16 v[34:35], v8 offset:40064
    v_mfma_f32_16x16x32_bf16 v[104:107], v[40:43], v[212:215], v[104:107]
    s_waitcnt lgkmcnt(10)
    ds_read_b64_tr_b16 v[36:37], v9 offset:36992
    ds_read_b64_tr_b16 v[38:39], v9 offset:40064
    v_mfma_f32_16x16x32_bf16 v[108:111], v[44:47], v[212:215], v[108:111]
    s_waitcnt lgkmcnt(10)
    ds_read_b64_tr_b16 v[40:41], v8 offset:43008
    ds_read_b64_tr_b16 v[42:43], v8 offset:46080
    v_mfma_f32_16x16x32_bf16 v[88:91], v[48:51], v[216:219], v[88:91]
    s_waitcnt lgkmcnt(10)
    ds_read_b64_tr_b16 v[44:45], v9 offset:43008
    ds_read_b64_tr_b16 v[46:47], v9 offset:46080
    v_mfma_f32_16x16x32_bf16 v[92:95], v[52:55], v[216:219], v[92:95]
    s_waitcnt lgkmcnt(10)
    ds_read_b64_tr_b16 v[48:49], v8 offset:43072
    ds_read_b64_tr_b16 v[50:51], v8 offset:46144
    buffer_load_dwordx4 v115, s[28:31], s60 offen offset:3072 lds
    v_mfma_f32_16x16x32_bf16 v[96:99], v[56:59], v[216:219], v[96:99]
    s_add_u32 m0, s55, 131072
    s_waitcnt lgkmcnt(10)
    ds_read_b64_tr_b16 v[52:53], v9 offset:43072
    ds_read_b64_tr_b16 v[54:55], v9 offset:46144
    v_mfma_f32_16x16x32_bf16 v[100:103], v[60:63], v[216:219], v[100:103]
    s_add_u32 s60, s67, 294912
    s_waitcnt lgkmcnt(10)
    ds_read_b64_tr_b16 v[56:57], v8 offset:43136
    ds_read_b64_tr_b16 v[58:59], v8 offset:46208
    v_mfma_f32_16x16x32_bf16 v[104:107], v[32:35], v[216:219], v[104:107]
    s_waitcnt lgkmcnt(10)
    ds_read_b64_tr_b16 v[60:61], v9 offset:43136
    ds_read_b64_tr_b16 v[62:63], v9 offset:46208
    v_mfma_f32_16x16x32_bf16 v[108:111], v[36:39], v[216:219], v[108:111]
    s_waitcnt lgkmcnt(10)
    ds_read_b64_tr_b16 v[32:33], v8 offset:49152
    ds_read_b64_tr_b16 v[34:35], v8 offset:52224
    v_mfma_f32_16x16x32_bf16 v[88:91], v[40:43], v[220:223], v[88:91]
    s_waitcnt lgkmcnt(10)
    ds_read_b64_tr_b16 v[36:37], v9 offset:49152
    ds_read_b64_tr_b16 v[38:39], v9 offset:52224
    buffer_load_dwordx4 v112, s[28:31], s60 offen offset:0 lds
    v_mfma_f32_16x16x32_bf16 v[92:95], v[44:47], v[220:223], v[92:95]
    s_waitcnt lgkmcnt(10)
    ds_read_b64_tr_b16 v[40:41], v8 offset:49216
    ds_read_b64_tr_b16 v[42:43], v8 offset:52288
    v_mfma_f32_16x16x32_bf16 v[96:99], v[48:51], v[220:223], v[96:99]
    s_waitcnt lgkmcnt(10)
    ds_read_b64_tr_b16 v[44:45], v9 offset:49216
    ds_read_b64_tr_b16 v[46:47], v9 offset:52288
    v_mfma_f32_16x16x32_bf16 v[100:103], v[52:55], v[220:223], v[100:103]
    s_waitcnt lgkmcnt(10)
    ds_read_b64_tr_b16 v[48:49], v8 offset:49280
    ds_read_b64_tr_b16 v[50:51], v8 offset:52352
    v_mfma_f32_16x16x32_bf16 v[104:107], v[56:59], v[220:223], v[104:107]
    s_waitcnt lgkmcnt(10)
    ds_read_b64_tr_b16 v[52:53], v9 offset:49280
    ds_read_b64_tr_b16 v[54:55], v9 offset:52352
    v_mfma_f32_16x16x32_bf16 v[108:111], v[60:63], v[220:223], v[108:111]
    s_waitcnt lgkmcnt(10)
    ds_read_b64_tr_b16 v[56:57], v8 offset:55296
    ds_read_b64_tr_b16 v[58:59], v8 offset:58368
    buffer_load_dwordx4 v113, s[28:31], s60 offen offset:1024 lds
    v_mfma_f32_16x16x32_bf16 v[88:91], v[32:35], v[224:227], v[88:91]
    s_waitcnt lgkmcnt(10)
    ds_read_b64_tr_b16 v[60:61], v9 offset:55296
    ds_read_b64_tr_b16 v[62:63], v9 offset:58368
    v_mfma_f32_16x16x32_bf16 v[92:95], v[36:39], v[224:227], v[92:95]
    s_waitcnt lgkmcnt(10)
    ds_read_b64_tr_b16 v[32:33], v8 offset:55360
    ds_read_b64_tr_b16 v[34:35], v8 offset:58432
    v_mfma_f32_16x16x32_bf16 v[96:99], v[40:43], v[224:227], v[96:99]
    s_waitcnt lgkmcnt(10)
    ds_read_b64_tr_b16 v[36:37], v9 offset:55360
    ds_read_b64_tr_b16 v[38:39], v9 offset:58432
    v_mfma_f32_16x16x32_bf16 v[100:103], v[44:47], v[224:227], v[100:103]
    s_waitcnt lgkmcnt(10)
    ds_read_b64_tr_b16 v[40:41], v8 offset:55424
    ds_read_b64_tr_b16 v[42:43], v8 offset:58496
    v_mfma_f32_16x16x32_bf16 v[104:107], v[48:51], v[224:227], v[104:107]
    s_waitcnt lgkmcnt(10)
    ds_read_b64_tr_b16 v[44:45], v9 offset:55424
    ds_read_b64_tr_b16 v[46:47], v9 offset:58496
    buffer_load_dwordx4 v114, s[28:31], s60 offen offset:2048 lds
    v_mfma_f32_16x16x32_bf16 v[108:111], v[52:55], v[224:227], v[108:111]
    s_waitcnt lgkmcnt(10)
    ds_read_b64_tr_b16 v[48:49], v8 offset:61440
    ds_read_b64_tr_b16 v[50:51], v8 offset:64512
    v_mfma_f32_16x16x32_bf16 v[88:91], v[56:59], v[228:231], v[88:91]
    s_waitcnt lgkmcnt(10)
    ds_read_b64_tr_b16 v[52:53], v9 offset:61440
    ds_read_b64_tr_b16 v[54:55], v9 offset:64512
    v_mfma_f32_16x16x32_bf16 v[92:95], v[60:63], v[228:231], v[92:95]
    s_waitcnt lgkmcnt(10)
    ds_read_b64_tr_b16 v[56:57], v8 offset:61504
    ds_read_b64_tr_b16 v[58:59], v8 offset:64576
    v_mfma_f32_16x16x32_bf16 v[96:99], v[32:35], v[228:231], v[96:99]
    s_waitcnt lgkmcnt(10)
    ds_read_b64_tr_b16 v[60:61], v9 offset:61504
    ds_read_b64_tr_b16 v[62:63], v9 offset:64576
    v_mfma_f32_16x16x32_bf16 v[100:103], v[36:39], v[228:231], v[100:103]
    s_waitcnt lgkmcnt(10)
    ds_read_b64_tr_b16 v[32:33], v8 offset:61568
    ds_read_b64_tr_b16 v[34:35], v8 offset:64640
    buffer_load_dwordx4 v115, s[28:31], s60 offen offset:3072 lds
    v_mfma_f32_16x16x32_bf16 v[104:107], v[40:43], v[228:231], v[104:107]
    s_add_u32 m0, s55, 147456
    s_waitcnt lgkmcnt(10)
    ds_read_b64_tr_b16 v[36:37], v9 offset:61568
    ds_read_b64_tr_b16 v[38:39], v9 offset:64640
    v_mfma_f32_16x16x32_bf16 v[108:111], v[44:47], v[228:231], v[108:111]
    s_add_u32 s60, s67, 327680
    s_waitcnt lgkmcnt(10)
    v_add_u32 v8, 0x10000, v8
    ds_read_b64_tr_b16 v[40:41], v8 offset:2048
    ds_read_b64_tr_b16 v[42:43], v8 offset:5120
    v_add_u32 v9, 0x10000, v9
    v_mfma_f32_16x16x32_bf16 v[88:91], v[48:51], v[232:235], v[88:91]
    s_waitcnt lgkmcnt(10)
    ds_read_b64_tr_b16 v[44:45], v9 offset:2048
    ds_read_b64_tr_b16 v[46:47], v9 offset:5120
    v_mfma_f32_16x16x32_bf16 v[92:95], v[52:55], v[232:235], v[92:95]
    s_waitcnt lgkmcnt(10)
    ds_read_b64_tr_b16 v[48:49], v8 offset:2112
    ds_read_b64_tr_b16 v[50:51], v8 offset:5184
    v_mfma_f32_16x16x32_bf16 v[96:99], v[56:59], v[232:235], v[96:99]
    s_waitcnt lgkmcnt(10)
    ds_read_b64_tr_b16 v[52:53], v9 offset:2112
    ds_read_b64_tr_b16 v[54:55], v9 offset:5184
    buffer_load_dwordx4 v112, s[28:31], s60 offen offset:0 lds
    v_mfma_f32_16x16x32_bf16 v[100:103], v[60:63], v[232:235], v[100:103]
    s_waitcnt lgkmcnt(10)
    ds_read_b64_tr_b16 v[56:57], v8 offset:2176
    ds_read_b64_tr_b16 v[58:59], v8 offset:5248
    v_mfma_f32_16x16x32_bf16 v[104:107], v[32:35], v[232:235], v[104:107]
    s_waitcnt lgkmcnt(10)
    ds_read_b64_tr_b16 v[60:61], v9 offset:2176
    ds_read_b64_tr_b16 v[62:63], v9 offset:5248
    v_mfma_f32_16x16x32_bf16 v[108:111], v[36:39], v[232:235], v[108:111]
    s_waitcnt lgkmcnt(10)
    ds_read_b64_tr_b16 v[32:33], v8 offset:8192
    ds_read_b64_tr_b16 v[34:35], v8 offset:11264
    v_mfma_f32_16x16x32_bf16 v[88:91], v[40:43], v[236:239], v[88:91]
    s_waitcnt lgkmcnt(10)
    ds_read_b64_tr_b16 v[36:37], v9 offset:8192
    ds_read_b64_tr_b16 v[38:39], v9 offset:11264
    v_mfma_f32_16x16x32_bf16 v[92:95], v[44:47], v[236:239], v[92:95]
    s_waitcnt lgkmcnt(10)
    ds_read_b64_tr_b16 v[40:41], v8 offset:8256
    ds_read_b64_tr_b16 v[42:43], v8 offset:11328
    buffer_load_dwordx4 v113, s[28:31], s60 offen offset:1024 lds
    v_mfma_f32_16x16x32_bf16 v[96:99], v[48:51], v[236:239], v[96:99]
    s_waitcnt lgkmcnt(10)
    ds_read_b64_tr_b16 v[44:45], v9 offset:8256
    ds_read_b64_tr_b16 v[46:47], v9 offset:11328
    v_mfma_f32_16x16x32_bf16 v[100:103], v[52:55], v[236:239], v[100:103]
    s_waitcnt lgkmcnt(10)
    ds_read_b64_tr_b16 v[48:49], v8 offset:8320
    ds_read_b64_tr_b16 v[50:51], v8 offset:11392
    v_mfma_f32_16x16x32_bf16 v[104:107], v[56:59], v[236:239], v[104:107]
    s_waitcnt lgkmcnt(10)
    ds_read_b64_tr_b16 v[52:53], v9 offset:8320
    ds_read_b64_tr_b16 v[54:55], v9 offset:11392
    v_mfma_f32_16x16x32_bf16 v[108:111], v[60:63], v[236:239], v[108:111]
    s_waitcnt lgkmcnt(10)
    ds_read_b64_tr_b16 v[56:57], v8 offset:14336
    ds_read_b64_tr_b16 v[58:59], v8 offset:17408
    v_mfma_f32_16x16x32_bf16 v[88:91], v[32:35], v[240:243], v[88:91]
    s_waitcnt lgkmcnt(10)
    ds_read_b64_tr_b16 v[60:61], v9 offset:14336
    ds_read_b64_tr_b16 v[62:63], v9 offset:17408
    buffer_load_dwordx4 v114, s[28:31], s60 offen offset:2048 lds
    v_mfma_f32_16x16x32_bf16 v[92:95], v[36:39], v[240:243], v[92:95]
    s_waitcnt lgkmcnt(10)
    ds_read_b64_tr_b16 v[32:33], v8 offset:14400
    ds_read_b64_tr_b16 v[34:35], v8 offset:17472
    v_mfma_f32_16x16x32_bf16 v[96:99], v[40:43], v[240:243], v[96:99]
    s_waitcnt lgkmcnt(10)
    ds_read_b64_tr_b16 v[36:37], v9 offset:14400
    ds_read_b64_tr_b16 v[38:39], v9 offset:17472
    v_mfma_f32_16x16x32_bf16 v[100:103], v[44:47], v[240:243], v[100:103]
    s_waitcnt lgkmcnt(10)
    ds_read_b64_tr_b16 v[40:41], v8 offset:14464
    ds_read_b64_tr_b16 v[42:43], v8 offset:17536
    v_mfma_f32_16x16x32_bf16 v[104:107], v[48:51], v[240:243], v[104:107]
    s_waitcnt lgkmcnt(10)
    ds_read_b64_tr_b16 v[44:45], v9 offset:14464
    ds_read_b64_tr_b16 v[46:47], v9 offset:17536
    v_mfma_f32_16x16x32_bf16 v[108:111], v[52:55], v[240:243], v[108:111]
    s_waitcnt lgkmcnt(10)
    ds_read_b64_tr_b16 v[48:49], v8 offset:20480
    ds_read_b64_tr_b16 v[50:51], v8 offset:23552
    buffer_load_dword v28, off, s[84:87], s72 sc1
    v_mfma_f32_16x16x32_bf16 v[88:91], v[56:59], v[244:247], v[88:91]
    s_waitcnt lgkmcnt(10)
    ds_read_b64_tr_b16 v[52:53], v9 offset:20480
    ds_read_b64_tr_b16 v[54:55], v9 offset:23552
    v_mfma_f32_16x16x32_bf16 v[92:95], v[60:63], v[244:247], v[92:95]
    s_waitcnt lgkmcnt(10)
    ds_read_b64_tr_b16 v[56:57], v8 offset:20544
    ds_read_b64_tr_b16 v[58:59], v8 offset:23616
    v_mfma_f32_16x16x32_bf16 v[96:99], v[32:35], v[244:247], v[96:99]
    s_waitcnt lgkmcnt(10)
    ds_read_b64_tr_b16 v[60:61], v9 offset:20544
    ds_read_b64_tr_b16 v[62:63], v9 offset:23616
    v_mfma_f32_16x16x32_bf16 v[100:103], v[36:39], v[244:247], v[100:103]
    s_waitcnt lgkmcnt(10)
    ds_read_b64_tr_b16 v[32:33], v8 offset:20608
    ds_read_b64_tr_b16 v[34:35], v8 offset:23680
    v_mfma_f32_16x16x32_bf16 v[104:107], v[40:43], v[244:247], v[104:107]
    s_waitcnt lgkmcnt(10)
    ds_read_b64_tr_b16 v[36:37], v9 offset:20608
    ds_read_b64_tr_b16 v[38:39], v9 offset:23680
    buffer_load_dwordx4 v115, s[28:31], s60 offen offset:3072 lds
    v_mfma_f32_16x16x32_bf16 v[108:111], v[44:47], v[244:247], v[108:111]
    s_waitcnt lgkmcnt(10)
    ds_read_b64_tr_b16 v[40:41], v8 offset:26624
    ds_read_b64_tr_b16 v[42:43], v8 offset:29696
    v_mfma_f32_16x16x32_bf16 v[88:91], v[48:51], v[248:251], v[88:91]
    s_waitcnt lgkmcnt(10)
    ds_read_b64_tr_b16 v[44:45], v9 offset:26624
    ds_read_b64_tr_b16 v[46:47], v9 offset:29696
    v_mfma_f32_16x16x32_bf16 v[92:95], v[52:55], v[248:251], v[92:95]
    s_waitcnt lgkmcnt(10)
    ds_read_b64_tr_b16 v[48:49], v8 offset:26688
    ds_read_b64_tr_b16 v[50:51], v8 offset:29760
    v_mfma_f32_16x16x32_bf16 v[96:99], v[56:59], v[248:251], v[96:99]
    s_waitcnt lgkmcnt(10)
    ds_read_b64_tr_b16 v[52:53], v9 offset:26688
    ds_read_b64_tr_b16 v[54:55], v9 offset:29760
    v_mfma_f32_16x16x32_bf16 v[100:103], v[60:63], v[248:251], v[100:103]
    s_waitcnt lgkmcnt(10)
    ds_read_b64_tr_b16 v[56:57], v8 offset:26752
    ds_read_b64_tr_b16 v[58:59], v8 offset:29824
    v_mfma_f32_16x16x32_bf16 v[104:107], v[32:35], v[248:251], v[104:107]
    s_waitcnt lgkmcnt(10)
    ds_read_b64_tr_b16 v[60:61], v9 offset:26752
    ds_read_b64_tr_b16 v[62:63], v9 offset:29824
    v_mfma_f32_16x16x32_bf16 v[108:111], v[36:39], v[248:251], v[108:111]
    s_waitcnt lgkmcnt(10)
    v_mfma_f32_16x16x32_bf16 v[88:91], v[40:43], v[252:255], v[88:91]
    s_waitcnt lgkmcnt(8)
    v_mfma_f32_16x16x32_bf16 v[92:95], v[44:47], v[252:255], v[92:95]
    s_waitcnt lgkmcnt(6)
    v_mfma_f32_16x16x32_bf16 v[96:99], v[48:51], v[252:255], v[96:99]
    s_waitcnt lgkmcnt(4)
    v_mfma_f32_16x16x32_bf16 v[100:103], v[52:55], v[252:255], v[100:103]
    s_waitcnt lgkmcnt(2)
    v_mfma_f32_16x16x32_bf16 v[104:107], v[56:59], v[252:255], v[104:107]
    s_waitcnt lgkmcnt(0)
    v_mfma_f32_16x16x32_bf16 v[108:111], v[60:63], v[252:255], v[108:111]
    s_lshl_b32 s16, s64, 1
    s_mul_i32 s56, s16, 44032
    s_lshl_b32 s57, s66, 10
    s_add_u32 s56, s56, s57
    v_add_u32 v4, 44032, v2
    s_waitcnt vmcnt(1)
    v_cmp_gt_u32 vcc, 16, v28
    s_nop 1
    s_cbranch_vccnz main_spin57
main_back58:
    s_add_u32 s60, s56, 0
    buffer_load_dwordx4 v[128:131], v2, s[44:47], s60 offen offset:0 sc1
    v_pk_mul_f32 v[224:225], v[88:89], v[88:89]
    v_pk_mul_f32 v[226:227], v[90:91], v[90:91]
    v_pk_mul_f32 v[228:229], v[92:93], v[92:93]
    v_pk_mul_f32 v[230:231], v[94:95], v[94:95]
    v_pk_mul_f32 v[232:233], v[96:97], v[96:97]
    buffer_load_dwordx4 v[132:135], v4, s[44:47], s60 offen offset:0 sc1
    v_pk_mul_f32 v[234:235], v[98:99], v[98:99]
    v_pk_mul_f32 v[236:237], v[100:101], v[100:101]
    v_pk_mul_f32 v[238:239], v[102:103], v[102:103]
    v_pk_mul_f32 v[240:241], v[104:105], v[104:105]
    v_pk_mul_f32 v[242:243], v[106:107], v[106:107]
    buffer_load_dwordx4 v[136:139], v2, s[44:47], s60 offen offset:1024 sc1
    v_pk_mul_f32 v[244:245], v[108:109], v[108:109]
    v_pk_mul_f32 v[246:247], v[110:111], v[110:111]
    v_pk_fma_f32 v[224:225], v[224:225], v[24:25], v[22:23] op_sel_hi:[1,0,0]
    v_pk_fma_f32 v[226:227], v[226:227], v[24:25], v[22:23] op_sel_hi:[1,0,0]
    v_pk_fma_f32 v[228:229], v[228:229], v[24:25], v[22:23] op_sel_hi:[1,0,0]
    buffer_load_dwordx4 v[140:143], v4, s[44:47], s60 offen offset:1024 sc1
    v_pk_fma_f32 v[230:231], v[230:231], v[24:25], v[22:23] op_sel_hi:[1,0,0]
    v_pk_fma_f32 v[232:233], v[232:233], v[24:25], v[22:23] op_sel_hi:[1,0,0]
    v_pk_fma_f32 v[234:235], v[234:235], v[24:25], v[22:23] op_sel_hi:[1,0,0]
    v_pk_fma_f32 v[236:237], v[236:237], v[24:25], v[22:23] op_sel_hi:[1,0,0]
    v_pk_fma_f32 v[238:239], v[238:239], v[24:25], v[22:23] op_sel_hi:[1,0,0]
    buffer_load_dwordx4 v[144:147], v2, s[44:47], s60 offen offset:2048 sc1
    v_pk_fma_f32 v[240:241], v[240:241], v[24:25], v[22:23] op_sel_hi:[1,0,0]
    v_pk_fma_f32 v[242:243], v[242:243], v[24:25], v[22:23] op_sel_hi:[1,0,0]
    v_pk_fma_f32 v[244:245], v[244:245], v[24:25], v[22:23] op_sel_hi:[1,0,0]
    v_pk_fma_f32 v[246:247], v[246:247], v[24:25], v[22:23] op_sel_hi:[1,0,0]
    v_pk_mul_f32 v[224:225], v[224:225], v[88:89]
    buffer_load_dwordx4 v[148:151], v4, s[44:47], s60 offen offset:2048 sc1
    v_pk_mul_f32 v[226:227], v[226:227], v[90:91]
    v_pk_mul_f32 v[228:229], v[228:229], v[92:93]
    v_pk_mul_f32 v[230:231], v[230:231], v[94:95]
    v_pk_mul_f32 v[232:233], v[232:233], v[96:97]
    v_pk_mul_f32 v[234:235], v[234:235], v[98:99]
    buffer_load_dwordx4 v[152:155], v2, s[44:47], s60 offen offset:3072 sc1
    v_pk_mul_f32 v[236:237], v[236:237], v[100:101]
    v_pk_mul_f32 v[238:239], v[238:239], v[102:103]
    v_pk_mul_f32 v[240:241], v[240:241], v[104:105]
    v_pk_mul_f32 v[242:243], v[242:243], v[106:107]
    v_pk_mul_f32 v[244:245], v[244:245], v[108:109]
    buffer_load_dwordx4 v[156:159], v4, s[44:47], s60 offen offset:3072 sc1
    v_pk_mul_f32 v[246:247], v[246:247], v[110:111]
    v_exp_f32 v224, v224
    v_exp_f32 v225, v225
    v_exp_f32 v226, v226
    v_exp_f32 v227, v227
    s_add_u32 s60, s56, 4096
    buffer_load_dwordx4 v[160:163], v2, s[44:47], s60 offen offset:0 sc1
    v_exp_f32 v228, v228
    v_exp_f32 v229, v229
    v_exp_f32 v230, v230
    v_exp_f32 v231, v231
    v_exp_f32 v232, v232
    buffer_load_dwordx4 v[164:167], v4, s[44:47], s60 offen offset:0 sc1
    v_exp_f32 v233, v233
    v_exp_f32 v234, v234
    v_exp_f32 v235, v235
    v_exp_f32 v236, v236
    v_exp_f32 v237, v237
    buffer_load_dwordx4 v[168:171], v2, s[44:47], s60 offen offset:1024 sc1
    v_exp_f32 v238, v238
    v_exp_f32 v239, v239
    v_exp_f32 v240, v240
    v_exp_f32 v241, v241
    v_exp_f32 v242, v242
    buffer_load_dwordx4 v[172:175], v4, s[44:47], s60 offen offset:1024 sc1
    v_exp_f32 v243, v243
    v_exp_f32 v244, v244
    v_exp_f32 v245, v245
    v_exp_f32 v246, v246
    v_exp_f32 v247, v247
    buffer_load_dwordx4 v[176:179], v2, s[44:47], s60 offen offset:2048 sc1
    v_pk_add_f32 v[224:225], v[224:225], v[26:27] op_sel_hi:[1,0]
    v_pk_add_f32 v[226:227], v[226:227], v[26:27] op_sel_hi:[1,0]
    v_pk_add_f32 v[228:229], v[228:229], v[26:27] op_sel_hi:[1,0]
    v_pk_add_f32 v[230:231], v[230:231], v[26:27] op_sel_hi:[1,0]
    v_pk_add_f32 v[232:233], v[232:233], v[26:27] op_sel_hi:[1,0]
    buffer_load_dwordx4 v[180:183], v4, s[44:47], s60 offen offset:2048 sc1
    v_pk_add_f32 v[234:235], v[234:235], v[26:27] op_sel_hi:[1,0]
    v_pk_add_f32 v[236:237], v[236:237], v[26:27] op_sel_hi:[1,0]
    v_pk_add_f32 v[238:239], v[238:239], v[26:27] op_sel_hi:[1,0]
    v_pk_add_f32 v[240:241], v[240:241], v[26:27] op_sel_hi:[1,0]
    v_pk_add_f32 v[242:243], v[242:243], v[26:27] op_sel_hi:[1,0]
    buffer_load_dwordx4 v[184:187], v2, s[44:47], s60 offen offset:3072 sc1
    v_pk_add_f32 v[244:245], v[244:245], v[26:27] op_sel_hi:[1,0]
    v_pk_add_f32 v[246:247], v[246:247], v[26:27] op_sel_hi:[1,0]
    v_rcp_f32 v224, v224
    v_rcp_f32 v225, v225
    v_rcp_f32 v226, v226
    buffer_load_dwordx4 v[188:191], v4, s[44:47], s60 offen offset:3072 sc1
    v_rcp_f32 v227, v227
    v_rcp_f32 v228, v228
    v_rcp_f32 v229, v229
    v_rcp_f32 v230, v230
    v_rcp_f32 v231, v231
    s_add_u32 s60, s56, 8192
    buffer_load_dwordx4 v[192:195], v2, s[44:47], s60 offen offset:0 sc1
    v_rcp_f32 v232, v232
    v_rcp_f32 v233, v233
    v_rcp_f32 v234, v234
    v_rcp_f32 v235, v235
    v_rcp_f32 v236, v236
    buffer_load_dwordx4 v[196:199], v4, s[44:47], s60 offen offset:0 sc1
    v_rcp_f32 v237, v237
    v_rcp_f32 v238, v238
    v_rcp_f32 v239, v239
    v_rcp_f32 v240, v240
    v_rcp_f32 v241, v241
    buffer_load_dwordx4 v[200:203], v2, s[44:47], s60 offen offset:1024 sc1
    v_rcp_f32 v242, v242
    v_rcp_f32 v243, v243
    v_rcp_f32 v244, v244
    v_rcp_f32 v245, v245
    v_rcp_f32 v246, v246
    buffer_load_dwordx4 v[204:207], v4, s[44:47], s60 offen offset:1024 sc1
    v_rcp_f32 v247, v247
    v_pk_mul_f32 v[88:89], v[88:89], v[224:225]
    v_pk_mul_f32 v[90:91], v[90:91], v[226:227]
    v_pk_mul_f32 v[92:93], v[92:93], v[228:229]
    v_pk_mul_f32 v[94:95], v[94:95], v[230:231]
    s_cmp_eq_u32 s3, 3
    s_cselect_b32 s60, 0x40000000, s60
    buffer_load_dwordx4 v[208:211], v2, s[44:47], s60 offen offset:2048 sc1
    v_pk_mul_f32 v[96:97], v[96:97], v[232:233]
    v_pk_mul_f32 v[98:99], v[98:99], v[234:235]
    v_pk_mul_f32 v[100:101], v[100:101], v[236:237]
    v_pk_mul_f32 v[102:103], v[102:103], v[238:239]
    v_pk_mul_f32 v[104:105], v[104:105], v[240:241]
    buffer_load_dwordx4 v[212:215], v4, s[44:47], s60 offen offset:2048 sc1
    v_pk_mul_f32 v[106:107], v[106:107], v[242:243]
    v_pk_mul_f32 v[108:109], v[108:109], v[244:245]
    v_pk_mul_f32 v[110:111], v[110:111], v[246:247]
    s_add_u32 s62, s18, 2818048
    s_or_b32 s63, s62, s19
    v_cvt_pk_bf16_f32 v88, v88, v89
    v_cvt_pk_bf16_f32 v89, v90, v91
    v_cvt_pk_bf16_f32 v90, v92, v93
    v_cvt_pk_bf16_f32 v91, v94, v95
    buffer_store_dwordx4 v[88:91], v2, s[44:47], s62 offen offset:0 sc1
    v_cvt_pk_bf16_f32 v96, v96, v97
    v_cvt_pk_bf16_f32 v97, v98, v99
    v_cvt_pk_bf16_f32 v98, v100, v101
    v_cvt_pk_bf16_f32 v99, v102, v103
    buffer_store_dwordx4 v[96:99], v2, s[44:47], s63 offen offset:1024 sc1
    v_cvt_pk_bf16_f32 v104, v104, v105
    v_cvt_pk_bf16_f32 v105, v106, v107
    v_cvt_pk_bf16_f32 v106, v108, v109
    v_cvt_pk_bf16_f32 v107, v110, v111
    buffer_store_dwordx4 v[104:107], v2, s[44:47], s63 offen offset:2048 sc1
    s_waitcnt vmcnt(24)
    v_mfma_f32_16x16x32_bf16 v[64:67], a[0:3], v[128:131], 0
    v_add_u32 v116, 0xffff0000, v116
    v_mfma_f32_16x16x32_bf16 v[68:71], a[4:7], v[128:131], 0
    v_add_u32 v117, 0xffff0000, v117
    v_add_u32 v118, 0xffff0000, v118
    v_mfma_f32_16x16x32_bf16 v[72:75], a[8:11], v[128:131], 0
    ds_read_b64_tr_b16 a[112:113], v116 offset:32768
    v_add_u32 v119, 0xffff0000, v119
    v_mfma_f32_16x16x32_bf16 v[76:79], a[12:15], v[128:131], 0
    s_waitcnt vmcnt(23)
    ds_read_b64_tr_b16 a[114:115], v116 offset:34816
    ds_read_b64_tr_b16 a[116:117], v117 offset:32768
    v_mfma_f32_16x16x32_bf16 v[80:83], a[0:3], v[132:135], 0
    s_nop 0
    ds_read_b64_tr_b16 a[118:119], v117 offset:34816
    ds_read_b64_tr_b16 a[120:121], v118 offset:32768
    v_mfma_f32_16x16x32_bf16 v[84:87], a[4:7], v[132:135], 0
    s_nop 0
    ds_read_b64_tr_b16 a[122:123], v118 offset:34816
    ds_read_b64_tr_b16 a[124:125], v119 offset:32768
    v_mfma_f32_16x16x32_bf16 v[88:91], a[8:11], v[132:135], 0
    ds_read_b64_tr_b16 a[126:127], v119 offset:34816
    v_mfma_f32_16x16x32_bf16 v[92:95], a[12:15], v[132:135], 0
    s_waitcnt vmcnt(22)
    ds_read_b64_tr_b16 a[128:129], v116 offset:49152
    ds_read_b64_tr_b16 a[130:131], v116 offset:51200
    v_mfma_f32_16x16x32_bf16 v[64:67], a[16:19], v[136:139], v[64:67]
    s_nop 0
    ds_read_b64_tr_b16 a[132:133], v117 offset:49152
    ds_read_b64_tr_b16 a[134:135], v117 offset:51200
    v_mfma_f32_16x16x32_bf16 v[68:71], a[20:23], v[136:139], v[68:71]
    s_nop 0
    ds_read_b64_tr_b16 a[136:137], v118 offset:49152
    ds_read_b64_tr_b16 a[138:139], v118 offset:51200
    v_mfma_f32_16x16x32_bf16 v[72:75], a[24:27], v[136:139], v[72:75]
    s_nop 0
    ds_read_b64_tr_b16 a[140:141], v119 offset:49152
    ds_read_b64_tr_b16 a[142:143], v119 offset:51200
    v_mfma_f32_16x16x32_bf16 v[76:79], a[28:31], v[136:139], v[76:79]
    s_waitcnt vmcnt(21)
    v_add_u32 v116, 0x10000, v116
    v_mfma_f32_16x16x32_bf16 v[80:83], a[16:19], v[140:143], v[80:83]
    v_add_u32 v117, 0x10000, v117
    v_add_u32 v118, 0x10000, v118
    v_mfma_f32_16x16x32_bf16 v[84:87], a[20:23], v[140:143], v[84:87]
    ds_read_b64_tr_b16 a[144:145], v116 offset:0
    v_add_u32 v119, 0x10000, v119
    v_mfma_f32_16x16x32_bf16 v[88:91], a[24:27], v[140:143], v[88:91]
    s_nop 0
    ds_read_b64_tr_b16 a[146:147], v116 offset:2048
    ds_read_b64_tr_b16 a[148:149], v117 offset:0
    v_mfma_f32_16x16x32_bf16 v[92:95], a[28:31], v[140:143], v[92:95]
    s_waitcnt vmcnt(20)
    ds_read_b64_tr_b16 a[150:151], v117 offset:2048
    ds_read_b64_tr_b16 a[152:153], v118 offset:0
    v_mfma_f32_16x16x32_bf16 v[64:67], a[32:35], v[144:147], v[64:67]
    s_nop 0
    ds_read_b64_tr_b16 a[154:155], v118 offset:2048
    ds_read_b64_tr_b16 a[156:157], v119 offset:0
    v_mfma_f32_16x16x32_bf16 v[68:71], a[36:39], v[144:147], v[68:71]
    ds_read_b64_tr_b16 a[158:159], v119 offset:2048
    v_mfma_f32_16x16x32_bf16 v[72:75], a[40:43], v[144:147], v[72:75]
    s_nop 0
    ds_read_b64_tr_b16 a[160:161], v116 offset:16384
    ds_read_b64_tr_b16 a[162:163], v116 offset:18432
    v_mfma_f32_16x16x32_bf16 v[76:79], a[44:47], v[144:147], v[76:79]
    s_waitcnt vmcnt(19)
    ds_read_b64_tr_b16 a[164:165], v117 offset:16384
    ds_read_b64_tr_b16 a[166:167], v117 offset:18432
    v_mfma_f32_16x16x32_bf16 v[80:83], a[32:35], v[148:151], v[80:83]
    s_nop 0
    ds_read_b64_tr_b16 a[168:169], v118 offset:16384
    ds_read_b64_tr_b16 a[170:171], v118 offset:18432
    v_mfma_f32_16x16x32_bf16 v[84:87], a[36:39], v[148:151], v[84:87]
    s_nop 0
    ds_read_b64_tr_b16 a[172:173], v119 offset:16384
    ds_read_b64_tr_b16 a[174:175], v119 offset:18432
    v_mfma_f32_16x16x32_bf16 v[88:91], a[40:43], v[148:151], v[88:91]
    s_mov_b32 s24, s94
    s_mov_b32 s25, s95
    v_mfma_f32_16x16x32_bf16 v[92:95], a[44:47], v[148:151], v[92:95]
    s_mov_b32 s26, 0x400
    s_mov_b32 s27, 0x20000
    s_waitcnt vmcnt(0)
    s_barrier
    s_cmp_lg_u32 s3, 0
    s_cbranch_scc1 main_skip59
    v_mov_b32 v3, 1
    s_mov_b64 exec, 1
    buffer_atomic_add v3, off, s[84:87], s77 sc1
    s_mov_b64 exec, -1
main_skip59:
    v_mfma_f32_16x16x32_bf16 v[64:67], a[48:51], v[152:155], v[64:67]
    s_mov_b32 s48, s74
    s_mov_b32 s49, s75
    v_mfma_f32_16x16x32_bf16 v[68:71], a[52:55], v[152:155], v[68:71]
    s_mov_b32 s50, 0x200000
    s_mov_b32 s51, 0x20000
    v_mfma_f32_16x16x32_bf16 v[72:75], a[56:59], v[152:155], v[72:75]
    s_lshr_b32 s21, s3, 1
    s_add_u32 s20, s16, s21
    v_mfma_f32_16x16x32_bf16 v[76:79], a[60:63], v[152:155], v[76:79]
    s_and_b32 s23, s3, 1
    s_lshl_b32 s22, s65, 1
    v_mfma_f32_16x16x32_bf16 v[80:83], a[48:51], v[156:159], v[80:83]
    s_add_u32 s23, s23, s22
    s_lshl_b32 s62, s23, 6
    v_mfma_f32_16x16x32_bf16 v[84:87], a[52:55], v[156:159], v[84:87]
    s_lshl_b32 s61, s23, 7
    s_add_u32 s61, s61, 10240
    v_mfma_f32_16x16x32_bf16 v[88:91], a[56:59], v[156:159], v[88:91]
    s_lshl_b32 s21, s21, 4
    v_lshlrev_b32 v21, 1, v16
    v_mfma_f32_16x16x32_bf16 v[92:95], a[60:63], v[156:159], v[92:95]
    v_and_b32 v18, 15, v1
    v_add_u32 v18, s21, v18
    v_mfma_f32_16x16x32_bf16 v[64:67], a[64:67], v[160:163], v[64:67]
    v_and_b32 v19, 4, v18
    v_lshlrev_b32 v19, 1, v19
    v_mfma_f32_16x16x32_bf16 v[68:71], a[68:71], v[160:163], v[68:71]
    v_and_b32 v22, 8, v18
    v_lshrrev_b32 v22, 1, v22
    v_mfma_f32_16x16x32_bf16 v[72:75], a[72:75], v[160:163], v[72:75]
    v_or_b32 v19, v19, v22
    v_and_b32 v22, 0xfffffff3, v18
    v_mfma_f32_16x16x32_bf16 v[76:79], a[76:79], v[160:163], v[76:79]
    v_or_b32 v22, v22, v19
    v_lshlrev_b32 v22, 10, v22
    v_mfma_f32_16x16x32_bf16 v[80:83], a[64:67], v[164:167], v[80:83]
    v_bfe_u32 v18, v1, 4, 1
    v_lshl_add_u32 v22, v18, 5, v22
    v_mfma_f32_16x16x32_bf16 v[84:87], a[68:71], v[164:167], v[84:87]
    v_lshrrev_b32 v18, 5, v1
    v_lshl_add_u32 v22, v18, 4, v22
    v_mfma_f32_16x16x32_bf16 v[88:91], a[72:75], v[164:167], v[88:91]
    s_lshl_b32 s21, s64, 15
    s_add_u32 s21, s21, s62
    v_mfma_f32_16x16x32_bf16 v[92:95], a[76:79], v[164:167], v[92:95]
    s_lshl_b32 s22, s20, 14
    s_lshl_b32 s23, s23, 10
    v_mfma_f32_16x16x32_bf16 v[64:67], a[80:83], v[168:171], v[64:67]
    s_add_u32 s22, s22, s23
    s_add_u32 s23, s22, 0x100000
    v_mfma_f32_16x16x32_bf16 v[68:71], a[84:87], v[168:171], v[68:71]
    s_lshl_b32 s59, s3, 13
    v_add_u32 v8, s59, v2
    v_mfma_f32_16x16x32_bf16 v[72:75], a[88:91], v[168:171], v[72:75]
    s_lshl_b32 s59, s3, 11
    v_add_u32 v9, s59, v2
    v_mfma_f32_16x16x32_bf16 v[76:79], a[92:95], v[168:171], v[76:79]
    v_mfma_f32_16x16x32_bf16 v[80:83], a[80:83], v[172:175], v[80:83]
    v_mfma_f32_16x16x32_bf16 v[84:87], a[84:87], v[172:175], v[84:87]
    v_mfma_f32_16x16x32_bf16 v[88:91], a[88:91], v[172:175], v[88:91]
    v_mfma_f32_16x16x32_bf16 v[92:95], a[92:95], v[172:175], v[92:95]
    v_mfma_f32_16x16x32_bf16 v[64:67], a[96:99], v[176:179], v[64:67]
    buffer_load_dwordx2 v[248:249], v16, s[24:27], s62 offen offset:0
    v_mfma_f32_16x16x32_bf16 v[68:71], a[100:103], v[176:179], v[68:71]
    v_mfma_f32_16x16x32_bf16 v[72:75], a[104:107], v[176:179], v[72:75]
    v_mfma_f32_16x16x32_bf16 v[76:79], a[108:111], v[176:179], v[76:79]
    buffer_load_dwordx4 v[48:51], v21, s[84:87], s61 offen offset:0 sc1
    v_mfma_f32_16x16x32_bf16 v[80:83], a[96:99], v[180:183], v[80:83]
    v_mfma_f32_16x16x32_bf16 v[84:87], a[100:103], v[180:183], v[84:87]
    v_mfma_f32_16x16x32_bf16 v[88:91], a[104:107], v[180:183], v[88:91]
    buffer_load_dwordx2 v[250:251], v16, s[24:27], s62 offen offset:32
    v_mfma_f32_16x16x32_bf16 v[92:95], a[108:111], v[180:183], v[92:95]
    s_waitcnt lgkmcnt(0)
    v_mfma_f32_16x16x32_bf16 v[64:67], a[112:115], v[184:187], v[64:67]
    v_mfma_f32_16x16x32_bf16 v[68:71], a[116:119], v[184:187], v[68:71]
    buffer_load_dwordx4 v[52:55], v21, s[84:87], s61 offen offset:64 sc1
    v_mfma_f32_16x16x32_bf16 v[72:75], a[120:123], v[184:187], v[72:75]
    v_mfma_f32_16x16x32_bf16 v[76:79], a[124:127], v[184:187], v[76:79]
    v_mfma_f32_16x16x32_bf16 v[80:83], a[112:115], v[188:191], v[80:83]
    buffer_load_dwordx4 v[32:35], v15, s[80:83], s22 offen sc1
    v_mfma_f32_16x16x32_bf16 v[84:87], a[116:119], v[188:191], v[84:87]
    v_mfma_f32_16x16x32_bf16 v[88:91], a[120:123], v[188:191], v[88:91]
    v_mfma_f32_16x16x32_bf16 v[92:95], a[124:127], v[188:191], v[92:95]
    v_mfma_f32_16x16x32_bf16 v[64:67], a[128:131], v[192:195], v[64:67]
    v_mfma_f32_16x16x32_bf16 v[68:71], a[132:135], v[192:195], v[68:71]
    v_mfma_f32_16x16x32_bf16 v[72:75], a[136:139], v[192:195], v[72:75]
    v_mfma_f32_16x16x32_bf16 v[76:79], a[140:143], v[192:195], v[76:79]
    v_mfma_f32_16x16x32_bf16 v[80:83], a[128:131], v[196:199], v[80:83]
    v_mfma_f32_16x16x32_bf16 v[84:87], a[132:135], v[196:199], v[84:87]
    v_mfma_f32_16x16x32_bf16 v[88:91], a[136:139], v[196:199], v[88:91]
    v_mfma_f32_16x16x32_bf16 v[92:95], a[140:143], v[196:199], v[92:95]
    v_mfma_f32_16x16x32_bf16 v[64:67], a[144:147], v[200:203], v[64:67]
    buffer_load_dword v28, off, s[84:87], s73 sc1
    v_mfma_f32_16x16x32_bf16 v[68:71], a[148:151], v[200:203], v[68:71]
    v_mfma_f32_16x16x32_bf16 v[72:75], a[152:155], v[200:203], v[72:75]
    v_mfma_f32_16x16x32_bf16 v[76:79], a[156:159], v[200:203], v[76:79]
    v_mfma_f32_16x16x32_bf16 v[80:83], a[144:147], v[204:207], v[80:83]
    v_mfma_f32_16x16x32_bf16 v[84:87], a[148:151], v[204:207], v[84:87]
    v_mfma_f32_16x16x32_bf16 v[88:91], a[152:155], v[204:207], v[88:91]
    v_mfma_f32_16x16x32_bf16 v[92:95], a[156:159], v[204:207], v[92:95]
    v_mfma_f32_16x16x32_bf16 v[64:67], a[160:163], v[208:211], v[64:67]
    v_mfma_f32_16x16x32_bf16 v[68:71], a[164:167], v[208:211], v[68:71]
    v_mfma_f32_16x16x32_bf16 v[72:75], a[168:171], v[208:211], v[72:75]
    v_mfma_f32_16x16x32_bf16 v[76:79], a[172:175], v[208:211], v[76:79]
    v_mfma_f32_16x16x32_bf16 v[80:83], a[160:163], v[212:215], v[80:83]
    v_mfma_f32_16x16x32_bf16 v[84:87], a[164:167], v[212:215], v[84:87]
    v_mfma_f32_16x16x32_bf16 v[88:91], a[168:171], v[212:215], v[88:91]
    v_mfma_f32_16x16x32_bf16 v[92:95], a[172:175], v[212:215], v[92:95]
    s_waitcnt vmcnt(0)
    v_cmp_gt_u32 vcc, 16, v28
    s_nop 1
    s_cbranch_vccnz main_spin60
main_back61:
    s_add_u32 s60, s56, 2818048
    buffer_load_dwordx4 a[176:179], v2, s[44:47], s60 offen offset:0 sc1
    buffer_load_dwordx4 a[180:183], v4, s[44:47], s60 offen offset:0 sc1
    buffer_load_dwordx4 a[184:187], v2, s[44:47], s60 offen offset:1024 sc1
    buffer_load_dwordx4 a[188:191], v4, s[44:47], s60 offen offset:1024 sc1
    buffer_load_dwordx4 a[192:195], v2, s[44:47], s60 offen offset:2048 sc1
    buffer_load_dwordx4 a[196:199], v4, s[44:47], s60 offen offset:2048 sc1
    buffer_load_dwordx4 a[200:203], v2, s[44:47], s60 offen offset:3072 sc1
    buffer_load_dwordx4 a[204:207], v4, s[44:47], s60 offen offset:3072 sc1
    s_add_u32 s60, s56, 2822144
    buffer_load_dwordx4 a[208:211], v2, s[44:47], s60 offen offset:0 sc1
    buffer_load_dwordx4 a[212:215], v4, s[44:47], s60 offen offset:0 sc1
    ds_write_b128 v8, v[64:67] offset:0
    ds_write_b128 v8, v[68:71] offset:1024
    ds_write_b128 v8, v[72:75] offset:2048
    ds_write_b128 v8, v[76:79] offset:3072
    buffer_load_dwordx4 a[216:219], v2, s[44:47], s60 offen offset:1024 sc1
    ds_write_b128 v8, v[80:83] offset:4096
    ds_write_b128 v8, v[84:87] offset:5120
    ds_write_b128 v8, v[88:91] offset:6144
    ds_write_b128 v8, v[92:95] offset:7168
    v_and_b32 v41, 0xffff0000, v248
    buffer_load_dwordx4 a[220:223], v4, s[44:47], s60 offen offset:1024 sc1
    v_lshlrev_b32 v40, 16, v248
    v_and_b32 v43, 0xffff0000, v249
    v_lshlrev_b32 v42, 16, v249
    v_and_b32 v45, 0xffff0000, v250
    v_lshlrev_b32 v44, 16, v250
    buffer_load_dwordx4 a[224:227], v2, s[44:47], s60 offen offset:2048 sc1
    v_and_b32 v47, 0xffff0000, v251
    v_lshlrev_b32 v46, 16, v251
    v_lshlrev_b32 v56, 16, v32
    v_and_b32 v57, 0xffff0000, v32
    v_lshlrev_b32 v58, 16, v33
    buffer_load_dwordx4 a[228:231], v4, s[44:47], s60 offen offset:2048 sc1
    v_and_b32 v59, 0xffff0000, v33
    v_lshlrev_b32 v60, 16, v34
    v_and_b32 v61, 0xffff0000, v34
    v_lshlrev_b32 v62, 16, v35
    v_and_b32 v63, 0xffff0000, v35
    buffer_load_dwordx4 a[232:235], v2, s[44:47], s60 offen offset:3072 sc1
    s_waitcnt lgkmcnt(0)
    s_barrier
    ds_read_b128 v[64:67], v9 offset:0
    ds_read_b128 v[68:71], v9 offset:1024
    ds_read_b128 v[72:75], v9 offset:8192
    buffer_load_dwordx4 a[236:239], v4, s[44:47], s60 offen offset:3072 sc1
    ds_read_b128 v[76:79], v9 offset:9216
    ds_read_b128 v[80:83], v9 offset:16384
    ds_read_b128 v[84:87], v9 offset:17408
    ds_read_b128 v[88:91], v9 offset:24576
    ds_read_b128 v[92:95], v9 offset:25600
    s_add_u32 s60, s56, 2826240
    buffer_load_dwordx4 a[240:243], v2, s[44:47], s60 offen offset:0 sc1
    s_waitcnt lgkmcnt(7)
    v_pk_add_f32 v[40:41], v[40:41], v[64:65]
    v_pk_add_f32 v[42:43], v[42:43], v[66:67]
    s_waitcnt lgkmcnt(6)
    v_pk_add_f32 v[44:45], v[44:45], v[68:69]
    v_pk_add_f32 v[46:47], v[46:47], v[70:71]
    s_waitcnt lgkmcnt(5)
    v_pk_add_f32 v[40:41], v[40:41], v[72:73]
    buffer_load_dwordx4 a[244:247], v4, s[44:47], s60 offen offset:0 sc1
    v_pk_add_f32 v[42:43], v[42:43], v[74:75]
    s_waitcnt lgkmcnt(4)
    v_pk_add_f32 v[44:45], v[44:45], v[76:77]
    v_pk_add_f32 v[46:47], v[46:47], v[78:79]
    s_waitcnt lgkmcnt(3)
    v_pk_add_f32 v[40:41], v[40:41], v[80:81]
    v_pk_add_f32 v[42:43], v[42:43], v[82:83]
    buffer_load_dwordx4 a[248:251], v2, s[44:47], s60 offen offset:1024 sc1
    s_waitcnt lgkmcnt(2)
    v_pk_add_f32 v[44:45], v[44:45], v[84:85]
    v_pk_add_f32 v[46:47], v[46:47], v[86:87]
    s_waitcnt lgkmcnt(1)
    v_pk_add_f32 v[40:41], v[40:41], v[88:89]
    v_pk_add_f32 v[42:43], v[42:43], v[90:91]
    s_waitcnt lgkmcnt(0)
    v_pk_add_f32 v[44:45], v[44:45], v[92:93]
    buffer_load_dwordx4 a[252:255], v4, s[44:47], s60 offen offset:1024 sc1
    v_pk_add_f32 v[46:47], v[46:47], v[94:95]
    v_pk_fma_f32 v[40:41], v[40:41], v[48:49], v[56:57]
    v_pk_fma_f32 v[42:43], v[42:43], v[50:51], v[58:59]
    v_pk_fma_f32 v[44:45], v[44:45], v[52:53], v[60:61]
    v_pk_fma_f32 v[46:47], v[46:47], v[54:55], v[62:63]
    s_cmp_eq_u32 s3, 3
    s_cselect_b32 s60, 0x40000000, s60
    buffer_load_dwordx4 v[216:219], v2, s[44:47], s60 offen offset:2048 sc1
    v_cvt_pk_bf16_f32 v40, v40, v41
    v_cvt_pk_bf16_f32 v41, v42, v43
    v_cvt_pk_bf16_f32 v42, v44, v45
    v_cvt_pk_bf16_f32 v43, v46, v47
    s_nop 0
    v_permlane16_swap_b32 v40, v42
    buffer_load_dwordx4 v[220:223], v4, s[44:47], s60 offen offset:2048 sc1
    v_permlane16_swap_b32 v41, v43
    buffer_store_dwordx4 v[40:43], v22, s[48:51], s21 offen
    s_waitcnt vmcnt(22)
    v_mfma_f32_16x16x32_bf16 v[96:99], a[0:3], a[176:179], 0
    buffer_load_dwordx4 v[36:39], v15, s[80:83], s23 offen sc1
    v_mfma_f32_16x16x32_bf16 v[100:103], a[4:7], a[176:179], 0
    v_mfma_f32_16x16x32_bf16 v[104:107], a[8:11], a[176:179], 0
    v_mfma_f32_16x16x32_bf16 v[108:111], a[12:15], a[176:179], 0
    s_waitcnt vmcnt(22)
    v_mfma_f32_16x16x32_bf16 v[112:115], a[0:3], a[180:183], 0
    v_mfma_f32_16x16x32_bf16 v[116:119], a[4:7], a[180:183], 0
    v_mfma_f32_16x16x32_bf16 v[120:123], a[8:11], a[180:183], 0
    v_mfma_f32_16x16x32_bf16 v[124:127], a[12:15], a[180:183], 0
    s_waitcnt vmcnt(21)
    v_mfma_f32_16x16x32_bf16 v[96:99], a[16:19], a[184:187], v[96:99]
    v_mfma_f32_16x16x32_bf16 v[100:103], a[20:23], a[184:187], v[100:103]
    v_mfma_f32_16x16x32_bf16 v[104:107], a[24:27], a[184:187], v[104:107]
    v_mfma_f32_16x16x32_bf16 v[108:111], a[28:31], a[184:187], v[108:111]
    s_waitcnt vmcnt(20)
    v_mfma_f32_16x16x32_bf16 v[112:115], a[16:19], a[188:191], v[112:115]
    v_mfma_f32_16x16x32_bf16 v[116:119], a[20:23], a[188:191], v[116:119]
    v_mfma_f32_16x16x32_bf16 v[120:123], a[24:27], a[188:191], v[120:123]
    v_mfma_f32_16x16x32_bf16 v[124:127], a[28:31], a[188:191], v[124:127]
    s_waitcnt vmcnt(19)
    v_mfma_f32_16x16x32_bf16 v[96:99], a[32:35], a[192:195], v[96:99]
    v_mfma_f32_16x16x32_bf16 v[100:103], a[36:39], a[192:195], v[100:103]
    v_mfma_f32_16x16x32_bf16 v[104:107], a[40:43], a[192:195], v[104:107]
    v_mfma_f32_16x16x32_bf16 v[108:111], a[44:47], a[192:195], v[108:111]
    s_waitcnt vmcnt(18)
    v_mfma_f32_16x16x32_bf16 v[112:115], a[32:35], a[196:199], v[112:115]
    v_mfma_f32_16x16x32_bf16 v[116:119], a[36:39], a[196:199], v[116:119]
    v_mfma_f32_16x16x32_bf16 v[120:123], a[40:43], a[196:199], v[120:123]
    v_mfma_f32_16x16x32_bf16 v[124:127], a[44:47], a[196:199], v[124:127]
    s_waitcnt vmcnt(17)
    v_mfma_f32_16x16x32_bf16 v[96:99], a[48:51], a[200:203], v[96:99]
    v_mfma_f32_16x16x32_bf16 v[100:103], a[52:55], a[200:203], v[100:103]
    v_mfma_f32_16x16x32_bf16 v[104:107], a[56:59], a[200:203], v[104:107]
    v_mfma_f32_16x16x32_bf16 v[108:111], a[60:63], a[200:203], v[108:111]
    s_waitcnt vmcnt(16)
    v_mfma_f32_16x16x32_bf16 v[112:115], a[48:51], a[204:207], v[112:115]
    v_mfma_f32_16x16x32_bf16 v[116:119], a[52:55], a[204:207], v[116:119]
    v_mfma_f32_16x16x32_bf16 v[120:123], a[56:59], a[204:207], v[120:123]
    v_mfma_f32_16x16x32_bf16 v[124:127], a[60:63], a[204:207], v[124:127]
    s_waitcnt vmcnt(15)
    v_mfma_f32_16x16x32_bf16 v[96:99], a[64:67], a[208:211], v[96:99]
    v_mfma_f32_16x16x32_bf16 v[100:103], a[68:71], a[208:211], v[100:103]
    v_mfma_f32_16x16x32_bf16 v[104:107], a[72:75], a[208:211], v[104:107]
    v_mfma_f32_16x16x32_bf16 v[108:111], a[76:79], a[208:211], v[108:111]
    s_waitcnt vmcnt(14)
    v_mfma_f32_16x16x32_bf16 v[112:115], a[64:67], a[212:215], v[112:115]
    v_mfma_f32_16x16x32_bf16 v[116:119], a[68:71], a[212:215], v[116:119]
    v_mfma_f32_16x16x32_bf16 v[120:123], a[72:75], a[212:215], v[120:123]
    v_mfma_f32_16x16x32_bf16 v[124:127], a[76:79], a[212:215], v[124:127]
    s_waitcnt vmcnt(13)
    v_mfma_f32_16x16x32_bf16 v[96:99], a[80:83], a[216:219], v[96:99]
    v_mfma_f32_16x16x32_bf16 v[100:103], a[84:87], a[216:219], v[100:103]
    v_mfma_f32_16x16x32_bf16 v[104:107], a[88:91], a[216:219], v[104:107]
    v_mfma_f32_16x16x32_bf16 v[108:111], a[92:95], a[216:219], v[108:111]
    s_waitcnt vmcnt(12)
    v_mfma_f32_16x16x32_bf16 v[112:115], a[80:83], a[220:223], v[112:115]
    v_mfma_f32_16x16x32_bf16 v[116:119], a[84:87], a[220:223], v[116:119]
    v_mfma_f32_16x16x32_bf16 v[120:123], a[88:91], a[220:223], v[120:123]
    v_mfma_f32_16x16x32_bf16 v[124:127], a[92:95], a[220:223], v[124:127]
    s_waitcnt vmcnt(11)
    v_mfma_f32_16x16x32_bf16 v[96:99], a[96:99], a[224:227], v[96:99]
    v_mfma_f32_16x16x32_bf16 v[100:103], a[100:103], a[224:227], v[100:103]
    v_mfma_f32_16x16x32_bf16 v[104:107], a[104:107], a[224:227], v[104:107]
    v_mfma_f32_16x16x32_bf16 v[108:111], a[108:111], a[224:227], v[108:111]
    s_waitcnt vmcnt(10)
    v_mfma_f32_16x16x32_bf16 v[112:115], a[96:99], a[228:231], v[112:115]
    v_mfma_f32_16x16x32_bf16 v[116:119], a[100:103], a[228:231], v[116:119]
    v_mfma_f32_16x16x32_bf16 v[120:123], a[104:107], a[228:231], v[120:123]
    v_mfma_f32_16x16x32_bf16 v[124:127], a[108:111], a[228:231], v[124:127]
    s_waitcnt vmcnt(9)
    v_mfma_f32_16x16x32_bf16 v[96:99], a[112:115], a[232:235], v[96:99]
    v_mfma_f32_16x16x32_bf16 v[100:103], a[116:119], a[232:235], v[100:103]
    v_mfma_f32_16x16x32_bf16 v[104:107], a[120:123], a[232:235], v[104:107]
    v_mfma_f32_16x16x32_bf16 v[108:111], a[124:127], a[232:235], v[108:111]
    s_waitcnt vmcnt(8)
    v_mfma_f32_16x16x32_bf16 v[112:115], a[112:115], a[236:239], v[112:115]
    v_mfma_f32_16x16x32_bf16 v[116:119], a[116:119], a[236:239], v[116:119]
    v_mfma_f32_16x16x32_bf16 v[120:123], a[120:123], a[236:239], v[120:123]
    v_mfma_f32_16x16x32_bf16 v[124:127], a[124:127], a[236:239], v[124:127]
    s_waitcnt vmcnt(7)
    v_mfma_f32_16x16x32_bf16 v[96:99], a[128:131], a[240:243], v[96:99]
    v_mfma_f32_16x16x32_bf16 v[100:103], a[132:135], a[240:243], v[100:103]
    v_mfma_f32_16x16x32_bf16 v[104:107], a[136:139], a[240:243], v[104:107]
    v_mfma_f32_16x16x32_bf16 v[108:111], a[140:143], a[240:243], v[108:111]
    s_waitcnt vmcnt(6)
    v_mfma_f32_16x16x32_bf16 v[112:115], a[128:131], a[244:247], v[112:115]
    v_mfma_f32_16x16x32_bf16 v[116:119], a[132:135], a[244:247], v[116:119]
    v_mfma_f32_16x16x32_bf16 v[120:123], a[136:139], a[244:247], v[120:123]
    v_mfma_f32_16x16x32_bf16 v[124:127], a[140:143], a[244:247], v[124:127]
    s_waitcnt vmcnt(5)
    v_mfma_f32_16x16x32_bf16 v[96:99], a[144:147], a[248:251], v[96:99]
    v_mfma_f32_16x16x32_bf16 v[100:103], a[148:151], a[248:251], v[100:103]
    v_mfma_f32_16x16x32_bf16 v[104:107], a[152:155], a[248:251], v[104:107]
    v_mfma_f32_16x16x32_bf16 v[108:111], a[156:159], a[248:251], v[108:111]
    s_waitcnt vmcnt(4)
    v_mfma_f32_16x16x32_bf16 v[112:115], a[144:147], a[252:255], v[112:115]
    v_mfma_f32_16x16x32_bf16 v[116:119], a[148:151], a[252:255], v[116:119]
    v_mfma_f32_16x16x32_bf16 v[120:123], a[152:155], a[252:255], v[120:123]
    v_mfma_f32_16x16x32_bf16 v[124:127], a[156:159], a[252:255], v[124:127]
    s_waitcnt vmcnt(3)
    v_mfma_f32_16x16x32_bf16 v[96:99], a[160:163], v[216:219], v[96:99]
    v_mfma_f32_16x16x32_bf16 v[100:103], a[164:167], v[216:219], v[100:103]
    v_mfma_f32_16x16x32_bf16 v[104:107], a[168:171], v[216:219], v[104:107]
    v_mfma_f32_16x16x32_bf16 v[108:111], a[172:175], v[216:219], v[108:111]
    s_waitcnt vmcnt(2)
    v_mfma_f32_16x16x32_bf16 v[112:115], a[160:163], v[220:223], v[112:115]
    v_mfma_f32_16x16x32_bf16 v[116:119], a[164:167], v[220:223], v[116:119]
    v_mfma_f32_16x16x32_bf16 v[120:123], a[168:171], v[220:223], v[120:123]
    v_mfma_f32_16x16x32_bf16 v[124:127], a[172:175], v[220:223], v[124:127]
    ds_write_b128 v8, v[96:99] offset:32768
    ds_write_b128 v8, v[100:103] offset:33792
    ds_write_b128 v8, v[104:107] offset:34816
    ds_write_b128 v8, v[108:111] offset:35840
    s_nop 0
    ds_write_b128 v8, v[112:115] offset:36864
    ds_write_b128 v8, v[116:119] offset:37888
    ds_write_b128 v8, v[120:123] offset:38912
    ds_write_b128 v8, v[124:127] offset:39936
    v_and_b32 v41, 0xffff0000, v248
    v_lshlrev_b32 v40, 16, v248
    v_and_b32 v43, 0xffff0000, v249
    v_lshlrev_b32 v42, 16, v249
    v_and_b32 v45, 0xffff0000, v250
    v_lshlrev_b32 v44, 16, v250
    v_and_b32 v47, 0xffff0000, v251
    v_lshlrev_b32 v46, 16, v251
    s_waitcnt vmcnt(0)
    v_lshlrev_b32 v56, 16, v36
    v_and_b32 v57, 0xffff0000, v36
    v_lshlrev_b32 v58, 16, v37
    v_and_b32 v59, 0xffff0000, v37
    v_lshlrev_b32 v60, 16, v38
    v_and_b32 v61, 0xffff0000, v38
    v_lshlrev_b32 v62, 16, v39
    v_and_b32 v63, 0xffff0000, v39
    s_waitcnt lgkmcnt(0)
    s_barrier
    ds_read_b128 v[96:99], v9 offset:32768
    ds_read_b128 v[100:103], v9 offset:33792
    ds_read_b128 v[104:107], v9 offset:40960
    ds_read_b128 v[108:111], v9 offset:41984
    ds_read_b128 v[112:115], v9 offset:49152
    ds_read_b128 v[116:119], v9 offset:50176
    ds_read_b128 v[120:123], v9 offset:57344
    ds_read_b128 v[124:127], v9 offset:58368
    s_waitcnt lgkmcnt(7)
    v_pk_add_f32 v[40:41], v[40:41], v[96:97]
    v_pk_add_f32 v[42:43], v[42:43], v[98:99]
    s_waitcnt lgkmcnt(6)
    v_pk_add_f32 v[44:45], v[44:45], v[100:101]
    v_pk_add_f32 v[46:47], v[46:47], v[102:103]
    s_waitcnt lgkmcnt(5)
    v_pk_add_f32 v[40:41], v[40:41], v[104:105]
    v_pk_add_f32 v[42:43], v[42:43], v[106:107]
    s_waitcnt lgkmcnt(4)
    v_pk_add_f32 v[44:45], v[44:45], v[108:109]
    v_pk_add_f32 v[46:47], v[46:47], v[110:111]
    s_waitcnt lgkmcnt(3)
    v_pk_add_f32 v[40:41], v[40:41], v[112:113]
    v_pk_add_f32 v[42:43], v[42:43], v[114:115]
    s_waitcnt lgkmcnt(2)
    v_pk_add_f32 v[44:45], v[44:45], v[116:117]
    v_pk_add_f32 v[46:47], v[46:47], v[118:119]
    s_waitcnt lgkmcnt(1)
    v_pk_add_f32 v[40:41], v[40:41], v[120:121]
    v_pk_add_f32 v[42:43], v[42:43], v[122:123]
    s_waitcnt lgkmcnt(0)
    v_pk_add_f32 v[44:45], v[44:45], v[124:125]
    v_pk_add_f32 v[46:47], v[46:47], v[126:127]
    v_pk_fma_f32 v[40:41], v[40:41], v[48:49], v[56:57]
    v_pk_fma_f32 v[42:43], v[42:43], v[50:51], v[58:59]
    v_pk_fma_f32 v[44:45], v[44:45], v[52:53], v[60:61]
    v_pk_fma_f32 v[46:47], v[46:47], v[54:55], v[62:63]
    v_cvt_pk_bf16_f32 v40, v40, v41
    v_cvt_pk_bf16_f32 v41, v42, v43
    v_cvt_pk_bf16_f32 v42, v44, v45
    v_cvt_pk_bf16_f32 v43, v46, v47
    s_add_u32 s21, s21, 0x100000
    v_permlane16_swap_b32 v40, v42
    v_permlane16_swap_b32 v41, v43
    buffer_store_dwordx4 v[40:43], v22, s[48:51], s21 offen
    s_endpgm
main_spin5:
    s_mov_b32 s33, 0
main_sp62:
    s_sleep 8
    buffer_load_dword v30, v26, s[88:91], 0 offen sc1
    s_waitcnt vmcnt(0)
    v_cmp_gt_u32 vcc, 64, v30
    s_add_u32 s33, s33, 1
    s_nop 0
    s_cbranch_vccz main_back6
    s_cmp_lt_u32 s33, 0x40000
    s_cbranch_scc1 main_sp62
    s_branch main_back6
main_spin7:
    s_mov_b32 s33, 0
main_sp63:
    s_sleep 8
    buffer_load_dword v29, off, s[84:87], s24 sc1
    s_waitcnt vmcnt(0)
    v_cmp_gt_u32 vcc, 64, v29
    s_add_u32 s33, s33, 1
    s_nop 0
    s_cbranch_vccz main_back8
    s_cmp_lt_u32 s33, 0x40000
    s_cbranch_scc1 main_sp63
    s_branch main_back8
main_spin9:
    s_mov_b32 s33, 0
main_sp64:
    s_sleep 8
    buffer_load_dword v30, off, s[84:87], s25 sc1
    s_waitcnt vmcnt(0)
    v_cmp_gt_u32 vcc, 64, v30
    s_add_u32 s33, s33, 1
    s_nop 0
    s_cbranch_vccz main_back10
    s_cmp_lt_u32 s33, 0x40000
    s_cbranch_scc1 main_sp64
    s_branch main_back10
main_spin14:
    s_mov_b32 s33, 0
main_sp65:
    s_sleep 8
    buffer_load_dword v30, off, s[84:87], s35 sc1
    s_waitcnt vmcnt(0)
    v_cmp_gt_u32 vcc, 32, v30
    s_add_u32 s33, s33, 1
    s_nop 0
    s_cbranch_vccz main_back15
    s_cmp_lt_u32 s33, 0x40000
    s_cbranch_scc1 main_sp65
    s_branch main_back15
main_spin37:
    s_mov_b32 s34, 0
main_sp66:
    s_sleep 2
    buffer_load_dword v28, off, s[40:43], s56 sc1
    s_waitcnt vmcnt(0)
    v_cmp_gt_u32 vcc, 32, v28
    s_add_u32 s34, s34, 1
    s_nop 0
    s_cbranch_vccz main_back38
    s_cmp_lt_u32 s34, 0x40000
    s_cbranch_scc1 main_sp66
    s_branch main_back38
main_spin40:
    s_mov_b32 s34, 0
main_sp67:
    s_sleep 2
    buffer_load_dword v28, off, s[40:43], s57 sc1
    s_waitcnt vmcnt(0)
    v_cmp_gt_u32 vcc, 8, v28
    s_add_u32 s34, s34, 1
    s_nop 0
    s_cbranch_vccz main_back41
    s_cmp_lt_u32 s34, 0x40000
    s_cbranch_scc1 main_sp67
    s_branch main_back41
main_spin42:
    s_mov_b32 s34, 0
main_sp68:
    s_sleep 2
    buffer_load_dword v24, v23, s[84:87], 0 offen sc1
    s_waitcnt vmcnt(0)
    v_cmp_gt_u32 vcc, 64, v24
    s_add_u32 s34, s34, 1
    s_nop 0
    s_cbranch_vccz main_back43
    s_cmp_lt_u32 s34, 0x40000
    s_cbranch_scc1 main_sp68
    s_branch main_back43
main_spin45:
    s_mov_b32 s34, 0
main_sp69:
    s_sleep 2
    buffer_load_dword v30, off, s[84:87], s77 sc1
    s_waitcnt vmcnt(0)
    v_cmp_gt_u32 vcc, 16, v30
    s_add_u32 s34, s34, 1
    s_nop 0
    s_cbranch_vccz main_back46
    s_cmp_lt_u32 s34, 0x40000
    s_cbranch_scc1 main_sp69
    s_branch main_back46
main_spin48:
    s_mov_b32 s34, 0
main_sp70:
    s_sleep 2
    buffer_load_dword v30, off, s[84:87], s76 sc1
    s_waitcnt vmcnt(0)
    v_cmp_gt_u32 vcc, 16, v30
    s_add_u32 s34, s34, 1
    s_nop 0
    s_cbranch_vccz main_back49
    s_cmp_lt_u32 s34, 0x40000
    s_cbranch_scc1 main_sp70
    s_branch main_back49
main_spin51:
    s_mov_b32 s34, 0
main_sp71:
    s_sleep 2
    buffer_load_dword v30, off, s[84:87], s70 sc1
    s_waitcnt vmcnt(0)
    v_cmp_gt_u32 vcc, 16, v30
    s_add_u32 s34, s34, 1
    s_nop 0
    s_cbranch_vccz main_back52
    s_cmp_lt_u32 s34, 0x40000
    s_cbranch_scc1 main_sp71
    s_branch main_back52
main_spin54:
    s_mov_b32 s34, 0
main_sp72:
    s_sleep 2
    buffer_load_dword v28, off, s[84:87], s71 sc1
    s_waitcnt vmcnt(0)
    v_cmp_gt_u32 vcc, 16, v28
    s_add_u32 s34, s34, 1
    s_nop 0
    s_cbranch_vccz main_back55
    s_cmp_lt_u32 s34, 0x40000
    s_cbranch_scc1 main_sp72
    s_branch main_back55
main_spin57:
    s_mov_b32 s34, 0
main_sp73:
    s_sleep 2
    buffer_load_dword v28, off, s[84:87], s72 sc1
    s_waitcnt vmcnt(0)
    v_cmp_gt_u32 vcc, 16, v28
    s_add_u32 s34, s34, 1
    s_nop 0
    s_cbranch_vccz main_back58
    s_cmp_lt_u32 s34, 0x40000
    s_cbranch_scc1 main_sp73
    s_branch main_back58
main_spin60:
    s_mov_b32 s34, 0
main_sp74:
    s_sleep 2
    buffer_load_dword v28, off, s[84:87], s73 sc1
    s_waitcnt vmcnt(0)
    v_cmp_gt_u32 vcc, 16, v28
    s_add_u32 s34, s34, 1
    s_nop 0
    s_cbranch_vccz main_back61
    s_cmp_lt_u32 s34, 0x40000
    s_cbranch_scc1 main_sp74
    s_branch main_back61
main_done1:
    s_endpgm
.section .rodata,"a"
.p2align 6
.amdhsa_kernel adaLN_cond__compressed_kv_cla__mixer_channel_mlp__prompt_kernel
  .amdhsa_next_free_vgpr 512
  .amdhsa_next_free_sgpr 102
  .amdhsa_accum_offset 256
  .amdhsa_group_segment_fixed_size 0
  .amdhsa_kernarg_size 128
  .amdhsa_user_sgpr_count 2
  .amdhsa_user_sgpr_kernarg_segment_ptr 1
  .amdhsa_system_sgpr_workgroup_id_x 1
  .amdhsa_float_denorm_mode_32 3
.end_amdhsa_kernel
```
